```python
import torch

def _softmax(x, axis=-1):
    return torch.softmax(x, dim=axis)

def _gelu(x):
    return torch.nn.functional.gelu(x, approximate='tanh')

def _silu(x):
    return torch.nn.functional.silu(x)

def _sigmoid(x):
    return torch.sigmoid(x)

def _layernorm(x, axis=-1, eps=1e-05):
    m = x.mean(dim=axis, keepdim=True)
    v = x.var(dim=axis, keepdim=True, unbiased=False)
    return (x - m) / torch.sqrt(v + eps)

def _scatter_add(tgt, idx, src, axis=0):
    return tgt.clone().index_add_(axis, idx, src)

def _segment_sum(src, seg, n):
    out = torch.zeros((n,) + src.shape[1:], dtype=src.dtype)
    return out.index_add_(0, seg, src)

def _pad(x, pw):
    flat = tuple((v for pair in reversed(pw) for v in pair))
    return torch.nn.functional.pad(x, flat)
kernel_name = 'concat_heads__memory_aug_recurrent_mem_tr__compressed_kv_cla__prompt'

def setup_inputs():

    _w = lambda a: (lambda t: t.to(torch.bfloat16) if t.is_floating_point() else t)(torch.as_tensor(a))

    def _A_setup():
        B, S, Dm = (1, 2048, 512)
        H, Dh = (32, 128)
        M, seg = (8, 32)
        seg = min(seg, S)
        S = S // seg * seg
        return {'x': _w((lambda *s: torch.randn(*s, dtype=torch.bfloat16) * 0.05)(B, S, Dm)), 'mem0': _w((lambda *s: torch.randn(*s, dtype=torch.bfloat16) * 0.4)(B, M, Dm)), 'Wq': _w((lambda *s: torch.randn(*s, dtype=torch.bfloat16) * 6.4)(Dm, H, Dh) * Dm ** (-0.5)), 'Wk': _w((lambda *s: torch.randn(*s, dtype=torch.bfloat16) * 6.4)(Dm, H, Dh) * Dm ** (-0.5)), 'Wv': _w((lambda *s: torch.randn(*s, dtype=torch.bfloat16) * 0.4)(Dm, H, Dh) * Dm ** (-0.5)), 'Wo': _w((lambda *s: torch.randn(*s, dtype=torch.bfloat16) * 0.4)(H, Dh, Dm) * (H * Dh) ** (-0.5)), 'seg_len': seg}
    _A_in = _A_setup()

    def _B_setup():
        B, H, Sq, Sk, D, M = (1, 32, 2048, 2048, 128, 512)
        Dc = 4 * D
        return {'x': _w((lambda *s: torch.randn(*s, dtype=torch.bfloat16) * 1.6)(B, Sq, M)), 'c_kv': _w((lambda *s: torch.randn(*s, dtype=torch.bfloat16) * 0.2)(B, Sk, Dc)), 'w_q': _w((lambda *s: torch.randn(*s, dtype=torch.bfloat16) * 3.2)(M, H, D) * M ** (-0.5)), 'w_uk': _w((lambda *s: torch.randn(*s, dtype=torch.bfloat16) * 3.2)(Dc, H, D) * Dc ** (-0.5)), 'w_uv': _w((lambda *s: torch.randn(*s, dtype=torch.bfloat16) * 0.2)(Dc, H, D) * Dc ** (-0.5)), 'w_o': _w((lambda *s: torch.randn(*s, dtype=torch.bfloat16) * 0.2)(H, D, M) * (H * D) ** (-0.5))}
    _B_in = _B_setup()
    return {'A_x': _A_in['x'], 'A_mem0': _A_in['mem0'], 'A_Wq': _A_in['Wq'], 'A_Wk': _A_in['Wk'], 'A_Wv': _A_in['Wv'], 'A_Wo': _A_in['Wo'], 'A_seg_len': _A_in['seg_len'], 'B_x': _B_in['x'], 'B_c_kv': _B_in['c_kv'], 'B_w_q': _B_in['w_q'], 'B_w_uk': _B_in['w_uk'], 'B_w_uv': _B_in['w_uv'], 'B_w_o': _B_in['w_o']}

def reference(A_x, A_mem0, A_Wq, A_Wk, A_Wv, A_Wo, A_seg_len, B_x, B_c_kv, B_w_q, B_w_uk, B_w_uv, B_w_o):

    def _A_ref(x, mem0, Wq, Wk, Wv, Wo, seg_len):
        B, S, Dm = x.shape
        H, Dh = (Wq.shape[1], Wq.shape[2])
        M = mem0.shape[1]
        scale = Dh ** (-0.5)
        n_seg = S // seg_len
        L = M + seg_len
        idx = torch.arange(L)
        mask = (idx[:, None] < M) | (idx[:, None] >= idx[None, :])
        mem = mem0
        outs = []
        for s in range(n_seg):
            xs = x[:, s * seg_len:(s + 1) * seg_len, :].clone()
            h = torch.concatenate([mem, xs], axis=1)
            q = torch.einsum('btd,dhe->bhte', h, Wq)
            k = torch.einsum('btd,dhe->bhte', h, Wk)
            v = torch.einsum('btd,dhe->bhte', h, Wv)
            scores = torch.einsum('bhqe,bhke->bhqk', q, k) * scale
            scores = torch.where(mask[None, None], scores, -1000000000.0)
            p = _softmax(scores, axis=-1)
            o = torch.einsum('bhqk,bhke->bhqe', p, v)
            o = torch.einsum('bhte,hed->btd', o, Wo)
            mem = o[:, :M, :].clone()
            outs.append(o[:, M:, :])
        return torch.concatenate(outs, axis=1)

    def _B_ref(x, c_kv, w_q, w_uk, w_uv, w_o):
        B, Sq, M = (x.shape[0], x.shape[1], x.shape[2])
        Sk = c_kv.shape[1]
        H, D = (w_q.shape[1], w_q.shape[2])
        q = torch.einsum('bqm,mhd->bhqd', x, w_q)
        k = torch.einsum('bkc,chd->bhkd', c_kv, w_uk)
        v = torch.einsum('bkc,chd->bhkd', c_kv, w_uv)
        scores = torch.einsum('bhqd,bhkd->bhqk', q, k) * D ** (-0.5)
        off = Sk - Sq
        qi = torch.arange(Sq)[:, None]
        kj = torch.arange(Sk)[None, :]
        cmask = kj <= qi + off
        scores = torch.where(cmask[None, None], scores, -1000000000.0)
        p = _softmax(scores, axis=-1)
        ctx = torch.einsum('bhqk,bhkd->bhqd', p, v)
        return torch.einsum('bhqd,hdm->bqm', ctx, w_o)
    a = _A_ref(A_x, A_mem0, A_Wq, A_Wk, A_Wv, A_Wo, A_seg_len)
    b = _B_ref(B_x, B_c_kv, B_w_q, B_w_uk, B_w_uv, B_w_o)
    return torch.concatenate([a, b], axis=-1)
```

```asm
; @launch kernel=fused_kernel grid=(256,1,1) block=(256,1,1) lds=163840
.amdgcn_target "amdgcn-amd-amdhsa--gfx950"
.text
.globl fused_kernel
.p2align 8
.type fused_kernel,@function

fused_kernel:
  s_cmp_ge_u32 s2, 256
  s_cbranch_scc1 L_exit
  s_getpc_b64 s[92:93]
L_pc0:
  s_lshr_b32 s41, s2, 3
  s_lshl_b32 s41, s41, 12
  v_lshlrev_b32 v1, 4, v0
  v_add_u32 v1, s41, v1
  v_min_u32 v1, L_table+8188-L_pc0, v1
  global_load_dword v239, v1, s[92:93]
  s_load_dwordx16 s[4:19], s[0:1], 0
  s_load_dwordx16 s[20:35], s[0:1], 64
  v_lshrrev_b32 v1, 6, v0
  s_nop 0
  v_readfirstlane_b32 s40, v1
  v_and_b32 v0, 63, v0
  s_waitcnt lgkmcnt(0)
  s_mov_b32 s36, s34
  s_and_b32 s37, s35, 0xffff
  s_mov_b32 s38, 0x10000000
  s_mov_b32 s39, 0x20000
  s_mov_b32 s84, s32
  s_and_b32 s85, s33, 0xffff
  s_mov_b32 s86, 0x100
  s_mov_b32 s87, 0x20000
  v_mov_b32 v255, v0
  v_lshlrev_b32 v253, 7, v0
  v_add_u32 v253, 0x8a00000, v253
  s_mov_b32 s101, 0
  s_mov_b32 s3, 0
  v_mov_b32 v252, 0
  s_mov_b32 s91, 0
  s_mov_b32 s90, 0
  s_getreg_b32 s41, hwreg(HW_REG_XCC_ID, 0, 4)
  s_and_b32 s41, s41, 7
  s_lshl_b32 s41, s41, 2
  s_lshr_b32 s41, 0x76543120, s41
  s_and_b32 s41, s41, 7
  s_mov_b32 s42, s41
  s_mov_b32 s44, s14
  s_and_b32 s45, s15, 0xffff
  s_mov_b32 s46, 0x400000
  s_mov_b32 s47, 0x20000
  s_cmp_ge_u32 s41, 2
  s_cbranch_scc1 L_nopt
  s_cmp_eq_u32 s40, 0
  s_cbranch_scc1 L_nopt
  s_lshr_b32 s48, s2, 3
  s_sub_u32 s49, s40, 1
  s_mul_i32 s49, s49, 8192
  v_lshlrev_b32 v230, 6, v0
  s_lshl_b32 s43, s48, 17
  s_cmp_eq_u32 s41, 0
  s_cbranch_scc1 L_pt0
  s_bitcmp1_b32 s48, 0
  s_cselect_b64 s[44:45], s[12:13], s[10:11]
  s_and_b32 s45, s45, 0xffff
  s_lshr_b32 s48, s48, 1
  s_mul_i32 s43, s48, 24576
L_pt0:
  s_add_u32 s43, s43, s49
  s_nop 15
  s_nop 15
  buffer_load_dword v238, v230, s[44:47], s43 offen
  s_add_u32 s43, s43, 4096
  buffer_load_dword v238, v230, s[44:47], s43 offen
  s_add_u32 s43, s43, 4096
L_nopt:
  v_mov_b32 v1, 131072
  s_cmp_lg_u32 s40, 0
  s_cbranch_scc1 L_gotslot
  s_mov_b64 exec, 1
L_slot:
  s_lshr_b32 s43, s42, 1
  s_lshl_b32 s43, s43, 2
  s_cmp_eq_u32 s43, 0
  s_cselect_b32 s43, 128, s43
  s_and_b32 s44, s42, 1
  s_lshl_b32 s44, s44, 4
  s_lshl_b32 s45, 1, s44
  v_mov_b32 v2, s45
  buffer_atomic_add v2, off, s[84:87], s43 sc0
  s_waitcnt vmcnt(0)
  v_readfirstlane_b32 s45, v2
  s_nop 0
  s_lshr_b32 s45, s45, s44
  s_and_b32 s45, s45, 0xffff
  s_cmp_lt_u32 s45, 32
  s_cbranch_scc1 L_slotok
  s_add_u32 s42, s42, 1
  s_and_b32 s42, s42, 7
  s_cmp_lg_u32 s42, s41
  s_cbranch_scc1 L_slot
  s_mov_b32 s42, 8
L_slotok:
  s_xor_b32 s45, s45, 0
  s_lshl_b32 s42, s42, 5
  s_add_u32 s42, s42, s45
  v_mov_b32 v2, s42
  ds_write_b32 v1, v2
  s_waitcnt lgkmcnt(0)
  s_mov_b64 exec, -1
L_gotslot:
  s_barrier
  ds_read_b32 v2, v1
  s_waitcnt lgkmcnt(0)
  v_readfirstlane_b32 s88, v2
  s_barrier
  s_cmp_ge_u32 s88, 256
  s_cbranch_scc1 L_exit
  s_lshl_b32 s42, s40, 8
  s_or_b32 s42, s42, s88
  s_cmp_lg_u32 s42, 0x300
  s_cbranch_scc1 L_noinit
  v_mov_b32 v2, 0
  s_mov_b32 s42, 8192
  s_mov_b32 s43, 16384
  buffer_store_dword v2, v253, s[36:39], 0 offen sc1
  buffer_store_dword v2, v253, s[36:39], s42 offen sc1
  buffer_store_dword v2, v253, s[36:39], s43 offen sc1
  s_mov_b32 s43, 24576
  buffer_store_dword v2, v253, s[36:39], s43 offen sc1
  v_mov_b32 v2, 1
  s_waitcnt vmcnt(0)
  buffer_store_dword v2, off, s[84:87], 0 offset:144 sc1
L_noinit:
  s_cmp_lt_u32 s88, 32
  s_cbranch_scc1 L_chain
  s_lshr_b32 s89, s88, 5
  s_getpc_b64 s[92:93]
L_pc:
  s_add_u32 s92, s92, L_table-L_pc
  s_addc_u32 s93, s93, 0
  s_and_b32 s41, s88, 31
L_fetch:
  s_min_u32 s41, s41, 255
  s_lshl_b32 s42, s89, 8
  s_add_u32 s41, s41, s42
  s_lshl_b32 s41, s41, 2
  s_load_dword s90, s[92:93], s41
  s_waitcnt lgkmcnt(0)
  s_and_b32 s41, s90, 7
  s_cmp_eq_u32 s41, 1
  s_cbranch_scc1 L_proj
  s_cmp_eq_u32 s41, 2
  s_cbranch_scc1 L_attnb
  s_cmp_eq_u32 s41, 3
  s_cbranch_scc1 L_attna
  s_cmp_eq_u32 s41, 4
  s_cbranch_scc1 L_oproj
  s_cmp_eq_u32 s41, 5
  s_cbranch_scc1 L_ops
  s_cmp_eq_u32 s41, 6
  s_cbranch_scc1 L_pf
  s_branch L_fin
L_jobend:
  s_cmp_lg_u32 s101, 0
  s_cbranch_scc1 Li_2
  v_readfirstlane_b32 s101, v252
  s_nop 0
  s_cmp_lg_u32 s101, 0
  s_cbranch_scc1 Li_2
Li_1:
  buffer_load_dword v252, off, s[84:87], 0 offset:144 sc1
  s_waitcnt vmcnt(0)
  v_readfirstlane_b32 s101, v252
  s_add_u32 s91, s91, 1
  s_cmp_gt_u32 s91, 0x20000
  s_cbranch_scc1 L_abort
  s_cmp_eq_u32 s101, 0
  s_cbranch_scc1 Li_1
Li_2:
  v_mov_b32 v250, 1
  v_mov_b32 v251, 131072
  s_cmp_lg_u32 s40, 0
  s_cbranch_scc1 L_je1
  s_lshl_b32 s41, s89, 7
  s_add_u32 s41, s41, 0x8a00400
  s_mov_b64 exec, 1
  buffer_atomic_add v250, off, s[36:39], s41 sc0
  s_mov_b64 exec, -1
L_je1:
  s_waitcnt vmcnt(0)
  s_cmp_lg_u32 s40, 0
  s_cbranch_scc1 L_je2
  s_mov_b64 exec, 1
  ds_write_b32 v251, v250
  s_mov_b64 exec, -1
L_je2:
  s_waitcnt lgkmcnt(0)
  s_barrier
  ds_read_b32 v252, v251
  s_cmp_lg_u32 s40, 0
  s_cbranch_scc1 Ls_3
  s_cmp_eq_u32 s82, 0
  s_cbranch_scc1 Ls_3
  s_lshl_b32 s47, s81, 7
  s_add_u32 s47, s47, 0x8a00000
  v_mov_b32 v250, s82
  s_mov_b64 exec, 1
  buffer_atomic_add v250, off, s[36:39], s47
  s_mov_b64 exec, -1
Ls_3:
  s_cmp_lg_u32 s81, -1
  s_cbranch_scc1 L_je3
  s_cmp_lg_u32 s40, 0
  s_cbranch_scc1 Lg_4
  s_cmp_lt_i32 s70, s71
  s_cbranch_scc1 Lg_4
  s_cmp_lg_u32 s101, 0
  s_cbranch_scc1 Li_8
  v_readfirstlane_b32 s101, v252
  s_nop 0
  s_cmp_lg_u32 s101, 0
  s_cbranch_scc1 Li_8
Li_7:
  buffer_load_dword v252, off, s[84:87], 0 offset:144 sc1
  s_waitcnt vmcnt(0)
  v_readfirstlane_b32 s101, v252
  s_add_u32 s91, s91, 1
  s_cmp_gt_u32 s91, 0x20000
  s_cbranch_scc1 L_abort
  s_cmp_eq_u32 s101, 0
  s_cbranch_scc1 Li_7
Li_8:
  s_cmp_lg_u32 s56, 0
  s_cbranch_scc1 Lg_5
  s_lshl_b32 s41, s57, 3
  s_lshl_b32 s41, 1, s41
  s_mov_b64 exec, 1
  s_add_u32 s42, s70, 1
  s_lshl_b32 s42, s42, 1
  v_mov_b32 v249, s42
  s_add_u32 s42, s58, 168
  s_lshl_b32 s42, s42, 7
  s_cmp_lg_u32 s57, 0
  s_cselect_b32 s42, 0x10000000, s42
  buffer_store_dword v249, v253, s[36:39], s42 offen sc1
  s_add_u32 s42, s70, 136
  s_branch Lg_6
Lg_5:
  s_and_b32 s41, s70, 3
  s_cmp_lg_u32 s41, 3
  s_cbranch_scc1 Lg_4
  s_lshr_b32 s41, s70, 2
  s_lshl_b32 s42, s57, 3
  s_add_u32 s41, s41, s42
  s_lshl_b32 s41, 1, s41
  s_lshl_b32 s42, s58, s57
  s_add_u32 s42, s42, 32
  s_lshl_b32 s43, s57, 1
  s_add_u32 exec_lo, s43, 1
  s_mov_b32 exec_hi, 0
Lg_6:
  s_lshl_b32 s42, s42, 7
  v_mov_b32 v250, s41
  buffer_atomic_add v250, v253, s[36:39], s42 offen
  s_mov_b64 exec, -1
Lg_4:
  s_add_u32 s70, s70, 1
  s_cmp_lg_u32 s40, 0
  s_cbranch_scc1 Lg_9
  s_cmp_lt_i32 s70, s71
  s_cbranch_scc1 Lg_9
  s_cmp_lg_u32 s101, 0
  s_cbranch_scc1 Li_13
  v_readfirstlane_b32 s101, v252
  s_nop 0
  s_cmp_lg_u32 s101, 0
  s_cbranch_scc1 Li_13
Li_12:
  buffer_load_dword v252, off, s[84:87], 0 offset:144 sc1
  s_waitcnt vmcnt(0)
  v_readfirstlane_b32 s101, v252
  s_add_u32 s91, s91, 1
  s_cmp_gt_u32 s91, 0x20000
  s_cbranch_scc1 L_abort
  s_cmp_eq_u32 s101, 0
  s_cbranch_scc1 Li_12
Li_13:
  s_cmp_lg_u32 s56, 0
  s_cbranch_scc1 Lg_10
  s_lshl_b32 s41, s57, 3
  s_lshl_b32 s41, 1, s41
  s_mov_b64 exec, 1
  s_add_u32 s42, s70, 1
  s_lshl_b32 s42, s42, 1
  v_mov_b32 v249, s42
  s_add_u32 s42, s58, 168
  s_lshl_b32 s42, s42, 7
  s_cmp_lg_u32 s57, 0
  s_cselect_b32 s42, 0x10000000, s42
  buffer_store_dword v249, v253, s[36:39], s42 offen sc1
  s_add_u32 s42, s70, 136
  s_branch Lg_11
Lg_10:
  s_and_b32 s41, s70, 3
  s_cmp_lg_u32 s41, 3
  s_cbranch_scc1 Lg_9
  s_lshr_b32 s41, s70, 2
  s_lshl_b32 s42, s57, 3
  s_add_u32 s41, s41, s42
  s_lshl_b32 s41, 1, s41
  s_lshl_b32 s42, s58, s57
  s_add_u32 s42, s42, 32
  s_lshl_b32 s43, s57, 1
  s_add_u32 exec_lo, s43, 1
  s_mov_b32 exec_hi, 0
Lg_11:
  s_lshl_b32 s42, s42, 7
  v_mov_b32 v250, s41
  buffer_atomic_add v250, v253, s[36:39], s42 offen
  s_mov_b64 exec, -1
Lg_9:
  s_add_u32 s70, s70, 1
L_je3:
  s_waitcnt lgkmcnt(0)
  v_readfirstlane_b32 s41, v252
  s_nop 0
  s_add_u32 s41, s41, 32
  s_branch L_fetch
L_proj:
  s_bfe_u32 s56, s90, 0x10003
  s_bfe_u32 s57, s90, 0x10004
  s_bfe_u32 s58, s90, 0x50005
  s_bfe_u32 s59, s90, 0x5000a
  s_bfe_u32 s60, s90, 0x6000f
  s_mov_b32 s48, s4
  s_and_b32 s49, s5, 0xffff
  s_mov_b32 s50, 0x200000
  s_mov_b32 s51, 0x20000
  s_mov_b32 s52, s10
  s_and_b32 s53, s11, 0xffff
  s_mov_b32 s54, 0x400000
  s_mov_b32 s55, 0x20000
  s_lshr_b32 s41, s40, 1
  s_cmp_lg_u32 s57, 0
  s_cselect_b32 s42, 2, s41
  s_cselect_b32 s68, s41, 0
  s_mov_b32 s65, 0x3f800000
  s_cselect_b32 s65, 0x3e0293ee, s65
  s_lshl_b32 s43, s58, s57
  s_add_u32 s43, s43, s68
  s_and_b32 s66, s42, 1
  s_mul_i32 s68, s56, 3
  s_add_u32 s42, s42, s68
  s_mov_b32 s63, 0
  s_cmp_eq_u32 s42, 0
  s_cselect_b64 s[52:53], s[10:11], s[52:53]
  s_cselect_b32 s63, 0x1100000, s63
  s_cmp_eq_u32 s42, 1
  s_cselect_b64 s[52:53], s[12:13], s[52:53]
  s_cselect_b32 s63, 0x2200000, s63
  s_cmp_eq_u32 s42, 2
  s_cselect_b64 s[52:53], s[8:9], s[52:53]
  s_cselect_b32 s63, 0x0, s63
  s_cmp_eq_u32 s42, 3
  s_cselect_b64 s[52:53], s[24:25], s[52:53]
  s_cselect_b32 s63, 0x4400000, s63
  s_cmp_eq_u32 s42, 4
  s_cselect_b64 s[52:53], s[26:27], s[52:53]
  s_cselect_b32 s63, 0x5500000, s63
  s_cmp_eq_u32 s42, 5
  s_cselect_b64 s[52:53], s[22:23], s[52:53]
  s_cselect_b32 s63, 0x3300000, s63
  s_and_b32 s53, s53, 0xffff
  s_cmp_ge_u32 s42, 3
  s_cselect_b64 s[48:49], s[20:21], s[48:49]
  s_cmp_eq_u32 s42, 5
  s_cselect_b64 s[48:49], s[18:19], s[48:49]
  s_and_b32 s49, s49, 0xffff
  s_and_b32 s41, s40, 1
  s_lshl_b32 s69, s43, 8
  s_lshl_b32 s68, s41, 7
  s_add_u32 s69, s69, s68
  s_mul_i32 s68, s43, 0x86000
  s_add_u32 s63, s63, s68
  s_lshl_b32 s68, s41, 12
  s_add_u32 s63, s63, s68
  s_lshl_b32 s68, s59, 14
  s_add_u32 s63, s63, s68
  s_mov_b32 s64, 0x10000000
  s_lshl_b32 s61, s59, 16
  s_lshl_b32 s68, s40, 14
  s_add_u32 s61, s61, s68
  s_mov_b32 s71, s59
  s_sub_u32 s70, s59, 2
  s_lshl_b32 s67, s40, 12
  s_cmp_lg_u32 s66, 0
  s_cselect_b64 vcc, -1, 0
  s_cselect_b32 s41, 32, 16
  s_cselect_b32 s42, 1, 2
  s_lshl_b32 s42, s42, 11
  v_lshrrev_b32 v220, 4, v255
  v_lshlrev_b32 v220, 3, v220
  v_bfe_u32 v221, v255, 2, 2
  v_add_u32 v220, v220, v221
  v_lshlrev_b32 v220, 7, v220
  v_bfe_u32 v221, v255, 3, 1
  v_lshl_add_u32 v220, v221, 6, v220
  v_and_b32 v221, 1, v255
  v_lshl_add_u32 v220, v221, 3, v220
  v_bfe_u32 v221, v255, 1, 1
  v_lshlrev_b32 v222, 5, v221
  v_lshlrev_b32 v221, 4, v221
  v_cndmask_b32 v221, v222, v221, vcc
  v_add_u32 v220, v220, v221
  v_add_u32 v240, s67, v220
  v_add_u32 v241, s41, v240
  v_xor_b32 v242, 64, v240
  v_xor_b32 v243, 64, v241
  v_add_u32 v244, 0x10000, v240
  v_add_u32 v245, 0x10000, v241
  v_add_u32 v246, 0x10000, v242
  v_add_u32 v247, 0x10000, v243
  v_lshrrev_b32 v220, 3, v255
  v_lshlrev_b32 v220, 13, v220
  v_bfe_u32 v221, v255, 4, 1
  v_lshlrev_b32 v221, 2, v221
  v_and_b32 v222, 7, v255
  v_xor_b32 v221, v221, v222
  v_lshl_add_u32 v218, v221, 4, v220
  v_lshrrev_b32 v220, 4, v255
  v_and_b32 v221, 15, v255
  v_xor_b32 v221, v221, v220
  v_lshlrev_b32 v221, 4, v221
  s_and_b32 s43, s40, 1
  s_lshl_b32 s43, s43, 7
  v_xor_b32 v221, s43, v221
  v_lshl_add_u32 v208, v220, 10, v221
  v_xor_b32 v209, 64, v208
  v_add_u32 v209, 3072, v209
  v_xor_b32 v210, 128, v208
  v_add_u32 v210, 6144, v210
  v_xor_b32 v211, 192, v208
  v_add_u32 v211, 9216, v211
  v_and_b32 v220, 7, v255
  v_bfe_u32 v221, v255, 3, 1
  v_lshlrev_b32 v222, 3, v221
  v_lshlrev_b32 v221, 4, v221
  v_cndmask_b32 v221, v222, v221, vcc
  v_add_u32 v220, v220, v221
  v_lshlrev_b32 v220, 8, v220
  v_and_b32 v221, 15, v255
  v_lshrrev_b32 v222, 4, v255
  v_xor_b32 v221, v221, v222
  v_lshl_add_u32 v192, v221, 4, v220
  v_xor_b32 v196, 128, v192
  v_add_u32 v196, s42, v196
  v_xor_b32 v193, 64, v192
  v_xor_b32 v194, 128, v192
  v_xor_b32 v195, 192, v192
  v_xor_b32 v197, 64, v196
  v_xor_b32 v198, 128, v196
  v_xor_b32 v199, 192, v196
  v_add_u32 v200, 0x10000, v192
  v_add_u32 v201, 0x10000, v193
  v_add_u32 v202, 0x10000, v194
  v_add_u32 v203, 0x10000, v195
  v_add_u32 v204, 0x10000, v196
  v_add_u32 v205, 0x10000, v197
  v_add_u32 v206, 0x10000, v198
  v_add_u32 v207, 0x10000, v199
  v_lshrrev_b32 v220, 4, v255
  v_lshlrev_b32 v220, 9, v220
  v_and_b32 v221, 15, v255
  v_lshl_add_u32 v212, v221, 4, v220
  v_add_u32 v213, 0x2000, v212
  s_cmp_lg_u32 s56, 0
  s_cbranch_scc1 PJ_lb
  s_barrier
  s_bitcmp1_b32 s3, 3
  s_cbranch_scc1 Lq_14
  s_bitset1_b32 s3, 3
  s_cmp_lt_u32 s89, 2
  s_cbranch_scc1 Lq_14
  s_mov_b32 s44, s10
  s_and_b32 s45, s11, 0xffff
  s_mov_b32 s46, 0x400000
  s_mov_b32 s47, 0x20000
  s_cmp_ge_u32 s89, 4
  s_cselect_b64 s[44:45], s[12:13], s[44:45]
  s_cmp_ge_u32 s89, 6
  s_cselect_b64 s[44:45], s[8:9], s[44:45]
  s_and_b32 s45, s45, 0xffff
  s_and_b32 s41, s88, 63
  s_lshl_b32 s41, s41, 2
  s_add_u32 s41, s41, s40
  s_lshl_b32 s41, s41, 14
  v_lshrrev_b32 v230, 2, v255
  v_and_b32 v229, 3, v255
  v_lshlrev_b32 v229, 6, v229
  v_lshl_add_u32 v230, v230, 10, v229
  buffer_load_dword v231, v230, s[44:47], s41 offen offset:256
  s_and_b32 s42, s41, 0x1c000
  s_cmp_lg_u32 s42, 0
  s_cbranch_scc1 Lq_14
  s_add_u32 s41, s41, 7936
  v_lshrrev_b32 v230, 2, v255
  v_lshl_add_u32 v230, v230, 13, v229
  buffer_load_dword v231, v230, s[44:47], s41 offen
Lq_14:
  s_add_u32 m0, s67, 0x0
  s_add_u32 s68, s69, 0x0
  buffer_load_dwordx4 v218, s[52:55], s68 offen  lds
  s_add_u32 m0, s67, 0x400
  s_add_u32 s68, s69, 0x10000
  buffer_load_dwordx4 v218, s[52:55], s68 offen  lds
  s_add_u32 m0, s67, 0x800
  s_add_u32 s68, s69, 0x20000
  buffer_load_dwordx4 v218, s[52:55], s68 offen  lds
  s_add_u32 m0, s67, 0xc00
  s_add_u32 s68, s69, 0x30000
  buffer_load_dwordx4 v218, s[52:55], s68 offen  lds
  s_add_u32 m0, s67, 0x4000
  s_add_u32 s68, s69, 0x40000
  buffer_load_dwordx4 v218, s[52:55], s68 offen  lds
  s_add_u32 m0, s67, 0x4400
  s_add_u32 s68, s69, 0x50000
  buffer_load_dwordx4 v218, s[52:55], s68 offen  lds
  s_add_u32 m0, s67, 0x4800
  s_add_u32 s68, s69, 0x60000
  buffer_load_dwordx4 v218, s[52:55], s68 offen  lds
  s_add_u32 m0, s67, 0x4c00
  s_add_u32 s68, s69, 0x70000
  buffer_load_dwordx4 v218, s[52:55], s68 offen  lds
  s_add_u32 m0, s67, 0x8000
  s_add_u32 s68, s69, 0x80000
  buffer_load_dwordx4 v218, s[52:55], s68 offen  lds
  s_add_u32 m0, s67, 0x8400
  s_add_u32 s68, s69, 0x90000
  buffer_load_dwordx4 v218, s[52:55], s68 offen  lds
  s_add_u32 m0, s67, 0x8800
  s_add_u32 s68, s69, 0xa0000
  buffer_load_dwordx4 v218, s[52:55], s68 offen  lds
  s_add_u32 m0, s67, 0x8c00
  s_add_u32 s68, s69, 0xb0000
  buffer_load_dwordx4 v218, s[52:55], s68 offen  lds
  s_add_u32 m0, s67, 0xc000
  s_add_u32 s68, s69, 0xc0000
  buffer_load_dwordx4 v218, s[52:55], s68 offen  lds
  s_add_u32 m0, s67, 0xc400
  s_add_u32 s68, s69, 0xd0000
  buffer_load_dwordx4 v218, s[52:55], s68 offen  lds
  s_add_u32 m0, s67, 0xc800
  s_add_u32 s68, s69, 0xe0000
  buffer_load_dwordx4 v218, s[52:55], s68 offen  lds
  s_add_u32 m0, s67, 0xcc00
  s_add_u32 s68, s69, 0xf0000
  buffer_load_dwordx4 v218, s[52:55], s68 offen  lds
  s_add_u32 m0, s67, 0x10000
  s_add_u32 s68, s69, 0x100000
  buffer_load_dwordx4 v218, s[52:55], s68 offen  lds
  s_add_u32 m0, s67, 0x10400
  s_add_u32 s68, s69, 0x110000
  buffer_load_dwordx4 v218, s[52:55], s68 offen  lds
  s_add_u32 m0, s67, 0x10800
  s_add_u32 s68, s69, 0x120000
  buffer_load_dwordx4 v218, s[52:55], s68 offen  lds
  s_add_u32 m0, s67, 0x10c00
  s_add_u32 s68, s69, 0x130000
  buffer_load_dwordx4 v218, s[52:55], s68 offen  lds
  s_add_u32 m0, s67, 0x14000
  s_add_u32 s68, s69, 0x140000
  buffer_load_dwordx4 v218, s[52:55], s68 offen  lds
  s_add_u32 m0, s67, 0x14400
  s_add_u32 s68, s69, 0x150000
  buffer_load_dwordx4 v218, s[52:55], s68 offen  lds
  s_add_u32 m0, s67, 0x14800
  s_add_u32 s68, s69, 0x160000
  buffer_load_dwordx4 v218, s[52:55], s68 offen  lds
  s_add_u32 m0, s67, 0x14c00
  s_add_u32 s68, s69, 0x170000
  buffer_load_dwordx4 v218, s[52:55], s68 offen  lds
  s_add_u32 m0, s67, 0x18000
  s_add_u32 s68, s69, 0x180000
  buffer_load_dwordx4 v218, s[52:55], s68 offen  lds
  s_add_u32 m0, s67, 0x18400
  s_add_u32 s68, s69, 0x190000
  buffer_load_dwordx4 v218, s[52:55], s68 offen  lds
  s_add_u32 m0, s67, 0x18800
  s_add_u32 s68, s69, 0x1a0000
  buffer_load_dwordx4 v218, s[52:55], s68 offen  lds
  s_add_u32 m0, s67, 0x18c00
  s_add_u32 s68, s69, 0x1b0000
  buffer_load_dwordx4 v218, s[52:55], s68 offen  lds
  s_add_u32 m0, s67, 0x1c000
  s_add_u32 s68, s69, 0x1c0000
  buffer_load_dwordx4 v218, s[52:55], s68 offen  lds
  s_add_u32 m0, s67, 0x1c400
  s_add_u32 s68, s69, 0x1d0000
  buffer_load_dwordx4 v218, s[52:55], s68 offen  lds
  s_add_u32 m0, s67, 0x1c800
  s_add_u32 s68, s69, 0x1e0000
  buffer_load_dwordx4 v218, s[52:55], s68 offen  lds
  s_add_u32 m0, s67, 0x1cc00
  s_add_u32 s68, s69, 0x1f0000
  buffer_load_dwordx4 v218, s[52:55], s68 offen  lds
  s_waitcnt vmcnt(24)
  ds_read_b64_tr_b16 a[0:1], v240 offset:0
  ds_read_b64_tr_b16 a[2:3], v240 offset:512
  ds_read_b64_tr_b16 a[64:65], v241 offset:0
  ds_read_b64_tr_b16 a[66:67], v241 offset:512
  ds_read_b64_tr_b16 a[128:129], v242 offset:0
  ds_read_b64_tr_b16 a[130:131], v242 offset:512
  ds_read_b64_tr_b16 a[192:193], v243 offset:0
  ds_read_b64_tr_b16 a[194:195], v243 offset:512
  s_waitcnt lgkmcnt(0)
  ds_read_b64_tr_b16 a[4:5], v240 offset:16384
  ds_read_b64_tr_b16 a[6:7], v240 offset:16896
  ds_read_b64_tr_b16 a[68:69], v241 offset:16384
  ds_read_b64_tr_b16 a[70:71], v241 offset:16896
  ds_read_b64_tr_b16 a[132:133], v242 offset:16384
  ds_read_b64_tr_b16 a[134:135], v242 offset:16896
  ds_read_b64_tr_b16 a[196:197], v243 offset:16384
  ds_read_b64_tr_b16 a[198:199], v243 offset:16896
  s_waitcnt lgkmcnt(0)
  s_add_u32 m0, s67, 0x0
  s_add_u32 s68, s69, 0x200000
  buffer_load_dwordx4 v218, s[52:55], s68 offen  lds
  s_add_u32 m0, s67, 0x400
  s_add_u32 s68, s69, 0x210000
  buffer_load_dwordx4 v218, s[52:55], s68 offen  lds
  s_add_u32 m0, s67, 0x800
  s_add_u32 s68, s69, 0x220000
  buffer_load_dwordx4 v218, s[52:55], s68 offen  lds
  s_add_u32 m0, s67, 0xc00
  s_add_u32 s68, s69, 0x230000
  buffer_load_dwordx4 v218, s[52:55], s68 offen  lds
  s_add_u32 m0, s67, 0x4000
  s_add_u32 s68, s69, 0x240000
  buffer_load_dwordx4 v218, s[52:55], s68 offen  lds
  s_add_u32 m0, s67, 0x4400
  s_add_u32 s68, s69, 0x250000
  buffer_load_dwordx4 v218, s[52:55], s68 offen  lds
  s_add_u32 m0, s67, 0x4800
  s_add_u32 s68, s69, 0x260000
  buffer_load_dwordx4 v218, s[52:55], s68 offen  lds
  s_add_u32 m0, s67, 0x4c00
  s_add_u32 s68, s69, 0x270000
  buffer_load_dwordx4 v218, s[52:55], s68 offen  lds
  s_waitcnt vmcnt(24)
  ds_read_b64_tr_b16 a[8:9], v240 offset:32768
  ds_read_b64_tr_b16 a[10:11], v240 offset:33280
  ds_read_b64_tr_b16 a[72:73], v241 offset:32768
  ds_read_b64_tr_b16 a[74:75], v241 offset:33280
  ds_read_b64_tr_b16 a[136:137], v242 offset:32768
  ds_read_b64_tr_b16 a[138:139], v242 offset:33280
  ds_read_b64_tr_b16 a[200:201], v243 offset:32768
  ds_read_b64_tr_b16 a[202:203], v243 offset:33280
  s_waitcnt lgkmcnt(0)
  ds_read_b64_tr_b16 a[12:13], v240 offset:49152
  ds_read_b64_tr_b16 a[14:15], v240 offset:49664
  ds_read_b64_tr_b16 a[76:77], v241 offset:49152
  ds_read_b64_tr_b16 a[78:79], v241 offset:49664
  ds_read_b64_tr_b16 a[140:141], v242 offset:49152
  ds_read_b64_tr_b16 a[142:143], v242 offset:49664
  ds_read_b64_tr_b16 a[204:205], v243 offset:49152
  ds_read_b64_tr_b16 a[206:207], v243 offset:49664
  s_waitcnt lgkmcnt(0)
  s_add_u32 m0, s67, 0x8000
  s_add_u32 s68, s69, 0x280000
  buffer_load_dwordx4 v218, s[52:55], s68 offen  lds
  s_add_u32 m0, s67, 0x8400
  s_add_u32 s68, s69, 0x290000
  buffer_load_dwordx4 v218, s[52:55], s68 offen  lds
  s_add_u32 m0, s67, 0x8800
  s_add_u32 s68, s69, 0x2a0000
  buffer_load_dwordx4 v218, s[52:55], s68 offen  lds
  s_add_u32 m0, s67, 0x8c00
  s_add_u32 s68, s69, 0x2b0000
  buffer_load_dwordx4 v218, s[52:55], s68 offen  lds
  s_add_u32 m0, s67, 0xc000
  s_add_u32 s68, s69, 0x2c0000
  buffer_load_dwordx4 v218, s[52:55], s68 offen  lds
  s_add_u32 m0, s67, 0xc400
  s_add_u32 s68, s69, 0x2d0000
  buffer_load_dwordx4 v218, s[52:55], s68 offen  lds
  s_add_u32 m0, s67, 0xc800
  s_add_u32 s68, s69, 0x2e0000
  buffer_load_dwordx4 v218, s[52:55], s68 offen  lds
  s_add_u32 m0, s67, 0xcc00
  s_add_u32 s68, s69, 0x2f0000
  buffer_load_dwordx4 v218, s[52:55], s68 offen  lds
  s_waitcnt vmcnt(24)
  ds_read_b64_tr_b16 a[16:17], v244 offset:0
  ds_read_b64_tr_b16 a[18:19], v244 offset:512
  ds_read_b64_tr_b16 a[80:81], v245 offset:0
  ds_read_b64_tr_b16 a[82:83], v245 offset:512
  ds_read_b64_tr_b16 a[144:145], v246 offset:0
  ds_read_b64_tr_b16 a[146:147], v246 offset:512
  ds_read_b64_tr_b16 a[208:209], v247 offset:0
  ds_read_b64_tr_b16 a[210:211], v247 offset:512
  s_waitcnt lgkmcnt(0)
  ds_read_b64_tr_b16 a[20:21], v244 offset:16384
  ds_read_b64_tr_b16 a[22:23], v244 offset:16896
  ds_read_b64_tr_b16 a[84:85], v245 offset:16384
  ds_read_b64_tr_b16 a[86:87], v245 offset:16896
  ds_read_b64_tr_b16 a[148:149], v246 offset:16384
  ds_read_b64_tr_b16 a[150:151], v246 offset:16896
  ds_read_b64_tr_b16 a[212:213], v247 offset:16384
  ds_read_b64_tr_b16 a[214:215], v247 offset:16896
  s_waitcnt lgkmcnt(0)
  s_add_u32 m0, s67, 0x10000
  s_add_u32 s68, s69, 0x300000
  buffer_load_dwordx4 v218, s[52:55], s68 offen  lds
  s_add_u32 m0, s67, 0x10400
  s_add_u32 s68, s69, 0x310000
  buffer_load_dwordx4 v218, s[52:55], s68 offen  lds
  s_add_u32 m0, s67, 0x10800
  s_add_u32 s68, s69, 0x320000
  buffer_load_dwordx4 v218, s[52:55], s68 offen  lds
  s_add_u32 m0, s67, 0x10c00
  s_add_u32 s68, s69, 0x330000
  buffer_load_dwordx4 v218, s[52:55], s68 offen  lds
  s_add_u32 m0, s67, 0x14000
  s_add_u32 s68, s69, 0x340000
  buffer_load_dwordx4 v218, s[52:55], s68 offen  lds
  s_add_u32 m0, s67, 0x14400
  s_add_u32 s68, s69, 0x350000
  buffer_load_dwordx4 v218, s[52:55], s68 offen  lds
  s_add_u32 m0, s67, 0x14800
  s_add_u32 s68, s69, 0x360000
  buffer_load_dwordx4 v218, s[52:55], s68 offen  lds
  s_add_u32 m0, s67, 0x14c00
  s_add_u32 s68, s69, 0x370000
  buffer_load_dwordx4 v218, s[52:55], s68 offen  lds
  s_waitcnt vmcnt(24)
  ds_read_b64_tr_b16 a[24:25], v244 offset:32768
  ds_read_b64_tr_b16 a[26:27], v244 offset:33280
  ds_read_b64_tr_b16 a[88:89], v245 offset:32768
  ds_read_b64_tr_b16 a[90:91], v245 offset:33280
  ds_read_b64_tr_b16 a[152:153], v246 offset:32768
  ds_read_b64_tr_b16 a[154:155], v246 offset:33280
  ds_read_b64_tr_b16 a[216:217], v247 offset:32768
  ds_read_b64_tr_b16 a[218:219], v247 offset:33280
  s_waitcnt lgkmcnt(0)
  ds_read_b64_tr_b16 a[28:29], v244 offset:49152
  ds_read_b64_tr_b16 a[30:31], v244 offset:49664
  ds_read_b64_tr_b16 a[92:93], v245 offset:49152
  ds_read_b64_tr_b16 a[94:95], v245 offset:49664
  ds_read_b64_tr_b16 a[156:157], v246 offset:49152
  ds_read_b64_tr_b16 a[158:159], v246 offset:49664
  ds_read_b64_tr_b16 a[220:221], v247 offset:49152
  ds_read_b64_tr_b16 a[222:223], v247 offset:49664
  s_waitcnt lgkmcnt(0)
  s_add_u32 m0, s67, 0x18000
  s_add_u32 s68, s69, 0x380000
  buffer_load_dwordx4 v218, s[52:55], s68 offen  lds
  s_add_u32 m0, s67, 0x18400
  s_add_u32 s68, s69, 0x390000
  buffer_load_dwordx4 v218, s[52:55], s68 offen  lds
  s_add_u32 m0, s67, 0x18800
  s_add_u32 s68, s69, 0x3a0000
  buffer_load_dwordx4 v218, s[52:55], s68 offen  lds
  s_add_u32 m0, s67, 0x18c00
  s_add_u32 s68, s69, 0x3b0000
  buffer_load_dwordx4 v218, s[52:55], s68 offen  lds
  s_add_u32 m0, s67, 0x1c000
  s_add_u32 s68, s69, 0x3c0000
  buffer_load_dwordx4 v218, s[52:55], s68 offen  lds
  s_add_u32 m0, s67, 0x1c400
  s_add_u32 s68, s69, 0x3d0000
  buffer_load_dwordx4 v218, s[52:55], s68 offen  lds
  s_add_u32 m0, s67, 0x1c800
  s_add_u32 s68, s69, 0x3e0000
  buffer_load_dwordx4 v218, s[52:55], s68 offen  lds
  s_add_u32 m0, s67, 0x1cc00
  s_add_u32 s68, s69, 0x3f0000
  buffer_load_dwordx4 v218, s[52:55], s68 offen  lds
  s_waitcnt vmcnt(24)
  ds_read_b64_tr_b16 a[32:33], v240 offset:0
  ds_read_b64_tr_b16 a[34:35], v240 offset:512
  ds_read_b64_tr_b16 a[96:97], v241 offset:0
  ds_read_b64_tr_b16 a[98:99], v241 offset:512
  ds_read_b64_tr_b16 a[160:161], v242 offset:0
  ds_read_b64_tr_b16 a[162:163], v242 offset:512
  ds_read_b64_tr_b16 a[224:225], v243 offset:0
  ds_read_b64_tr_b16 a[226:227], v243 offset:512
  s_waitcnt lgkmcnt(0)
  ds_read_b64_tr_b16 a[36:37], v240 offset:16384
  ds_read_b64_tr_b16 a[38:39], v240 offset:16896
  ds_read_b64_tr_b16 a[100:101], v241 offset:16384
  ds_read_b64_tr_b16 a[102:103], v241 offset:16896
  ds_read_b64_tr_b16 a[164:165], v242 offset:16384
  ds_read_b64_tr_b16 a[166:167], v242 offset:16896
  ds_read_b64_tr_b16 a[228:229], v243 offset:16384
  ds_read_b64_tr_b16 a[230:231], v243 offset:16896
  s_waitcnt lgkmcnt(0)
  s_add_u32 m0, s67, 0x0
  s_add_u32 s68, s61, 0x0
  buffer_load_dwordx4 v208, s[48:51], s68 offen offset:0  lds
  buffer_load_dwordx4 v209, s[48:51], s68 offen offset:1024  lds
  buffer_load_dwordx4 v210, s[48:51], s68 offen offset:2048  lds
  buffer_load_dwordx4 v211, s[48:51], s68 offen offset:3072  lds
  s_add_u32 m0, s67, 0x4000
  s_add_u32 s68, s61, 0x100
  buffer_load_dwordx4 v208, s[48:51], s68 offen offset:0  lds
  buffer_load_dwordx4 v209, s[48:51], s68 offen offset:1024  lds
  buffer_load_dwordx4 v210, s[48:51], s68 offen offset:2048  lds
  buffer_load_dwordx4 v211, s[48:51], s68 offen offset:3072  lds
  s_waitcnt vmcnt(24)
  ds_read_b64_tr_b16 a[40:41], v240 offset:32768
  ds_read_b64_tr_b16 a[42:43], v240 offset:33280
  ds_read_b64_tr_b16 a[104:105], v241 offset:32768
  ds_read_b64_tr_b16 a[106:107], v241 offset:33280
  ds_read_b64_tr_b16 a[168:169], v242 offset:32768
  ds_read_b64_tr_b16 a[170:171], v242 offset:33280
  ds_read_b64_tr_b16 a[232:233], v243 offset:32768
  ds_read_b64_tr_b16 a[234:235], v243 offset:33280
  s_waitcnt lgkmcnt(0)
  ds_read_b64_tr_b16 a[44:45], v240 offset:49152
  ds_read_b64_tr_b16 a[46:47], v240 offset:49664
  ds_read_b64_tr_b16 a[108:109], v241 offset:49152
  ds_read_b64_tr_b16 a[110:111], v241 offset:49664
  ds_read_b64_tr_b16 a[172:173], v242 offset:49152
  ds_read_b64_tr_b16 a[174:175], v242 offset:49664
  ds_read_b64_tr_b16 a[236:237], v243 offset:49152
  ds_read_b64_tr_b16 a[238:239], v243 offset:49664
  s_waitcnt lgkmcnt(0)
  s_add_u32 m0, s67, 0x8000
  s_add_u32 s68, s61, 0x200
  buffer_load_dwordx4 v208, s[48:51], s68 offen offset:0  lds
  buffer_load_dwordx4 v209, s[48:51], s68 offen offset:1024  lds
  buffer_load_dwordx4 v210, s[48:51], s68 offen offset:2048  lds
  buffer_load_dwordx4 v211, s[48:51], s68 offen offset:3072  lds
  buffer_store_dwordx4 v[160:163], v212, s[36:39], s64 offen
  buffer_store_dwordx4 v[160:163], v212, s[36:39], s64 offen
  buffer_store_dwordx4 v[160:163], v212, s[36:39], s64 offen
  buffer_store_dwordx4 v[160:163], v212, s[36:39], s64 offen
  s_add_u32 m0, s67, 0xc000
  s_add_u32 s68, s61, 0x300
  buffer_load_dwordx4 v208, s[48:51], s68 offen offset:0  lds
  buffer_load_dwordx4 v209, s[48:51], s68 offen offset:1024  lds
  buffer_load_dwordx4 v210, s[48:51], s68 offen offset:2048  lds
  buffer_load_dwordx4 v211, s[48:51], s68 offen offset:3072  lds
  buffer_store_dwordx4 v[160:163], v212, s[36:39], s64 offen
  buffer_store_dwordx4 v[160:163], v212, s[36:39], s64 offen
  buffer_store_dwordx4 v[160:163], v212, s[36:39], s64 offen
  buffer_store_dwordx4 v[160:163], v212, s[36:39], s64 offen
  s_waitcnt vmcnt(32)
  ds_read_b64_tr_b16 a[48:49], v244 offset:0
  ds_read_b64_tr_b16 a[50:51], v244 offset:512
  ds_read_b64_tr_b16 a[112:113], v245 offset:0
  ds_read_b64_tr_b16 a[114:115], v245 offset:512
  ds_read_b64_tr_b16 a[176:177], v246 offset:0
  ds_read_b64_tr_b16 a[178:179], v246 offset:512
  ds_read_b64_tr_b16 a[240:241], v247 offset:0
  ds_read_b64_tr_b16 a[242:243], v247 offset:512
  s_waitcnt lgkmcnt(0)
  ds_read_b64_tr_b16 a[52:53], v244 offset:16384
  ds_read_b64_tr_b16 a[54:55], v244 offset:16896
  ds_read_b64_tr_b16 a[116:117], v245 offset:16384
  ds_read_b64_tr_b16 a[118:119], v245 offset:16896
  ds_read_b64_tr_b16 a[180:181], v246 offset:16384
  ds_read_b64_tr_b16 a[182:183], v246 offset:16896
  ds_read_b64_tr_b16 a[244:245], v247 offset:16384
  ds_read_b64_tr_b16 a[246:247], v247 offset:16896
  s_waitcnt lgkmcnt(0)
  s_add_u32 m0, s67, 0x10000
  s_add_u32 s68, s61, 0x10000
  buffer_load_dwordx4 v208, s[48:51], s68 offen offset:0  lds
  buffer_load_dwordx4 v209, s[48:51], s68 offen offset:1024  lds
  buffer_load_dwordx4 v210, s[48:51], s68 offen offset:2048  lds
  buffer_load_dwordx4 v211, s[48:51], s68 offen offset:3072  lds
  s_add_u32 m0, s67, 0x14000
  s_add_u32 s68, s61, 0x10100
  buffer_load_dwordx4 v208, s[48:51], s68 offen offset:0  lds
  buffer_load_dwordx4 v209, s[48:51], s68 offen offset:1024  lds
  buffer_load_dwordx4 v210, s[48:51], s68 offen offset:2048  lds
  buffer_load_dwordx4 v211, s[48:51], s68 offen offset:3072  lds
  s_waitcnt vmcnt(32)
  ds_read_b64_tr_b16 a[56:57], v244 offset:32768
  ds_read_b64_tr_b16 a[58:59], v244 offset:33280
  ds_read_b64_tr_b16 a[120:121], v245 offset:32768
  ds_read_b64_tr_b16 a[122:123], v245 offset:33280
  ds_read_b64_tr_b16 a[184:185], v246 offset:32768
  ds_read_b64_tr_b16 a[186:187], v246 offset:33280
  ds_read_b64_tr_b16 a[248:249], v247 offset:32768
  ds_read_b64_tr_b16 a[250:251], v247 offset:33280
  s_waitcnt lgkmcnt(0)
  ds_read_b64_tr_b16 a[60:61], v244 offset:49152
  ds_read_b64_tr_b16 a[62:63], v244 offset:49664
  ds_read_b64_tr_b16 a[124:125], v245 offset:49152
  ds_read_b64_tr_b16 a[126:127], v245 offset:49664
  ds_read_b64_tr_b16 a[188:189], v246 offset:49152
  ds_read_b64_tr_b16 a[190:191], v246 offset:49664
  ds_read_b64_tr_b16 a[252:253], v247 offset:49152
  ds_read_b64_tr_b16 a[254:255], v247 offset:49664
  s_waitcnt lgkmcnt(0)
  s_add_u32 m0, s67, 0x18000
  s_add_u32 s68, s61, 0x10200
  buffer_load_dwordx4 v208, s[48:51], s68 offen offset:0  lds
  buffer_load_dwordx4 v209, s[48:51], s68 offen offset:1024  lds
  buffer_load_dwordx4 v210, s[48:51], s68 offen offset:2048  lds
  buffer_load_dwordx4 v211, s[48:51], s68 offen offset:3072  lds
  s_bitcmp1_b32 s3, 0
  s_cbranch_scc1 Lt_15
  s_bitset1_b32 s3, 0
  s_mov_b32 s44, s4
  s_and_b32 s45, s5, 0xffff
  s_mov_b32 s46, 0x0
  s_mov_b32 s47, 0x20000
  s_cmp_eq_u32 s89, 2
  s_cselect_b64 s[44:45], s[4:5], s[44:45]
  s_cselect_b32 s46, 0x200000, s46
  s_cmp_eq_u32 s89, 3
  s_cselect_b64 s[44:45], s[20:21], s[44:45]
  s_cselect_b32 s46, 0x200000, s46
  s_cmp_eq_u32 s89, 6
  s_cselect_b64 s[44:45], s[18:19], s[44:45]
  s_cselect_b32 s46, 0x200000, s46
  s_cmp_eq_u32 s89, 4
  s_cselect_b64 s[44:45], s[28:29], s[44:45]
  s_cselect_b32 s46, 0x200000, s46
  s_cmp_eq_u32 s89, 5
  s_cselect_b64 s[44:45], s[28:29], s[44:45]
  s_cselect_b32 s46, 0x400000, s46
  s_cmp_eq_u32 s46, 0
  s_cbranch_scc1 Lt_15
  s_and_b32 s45, s45, 0xffff
  s_and_b32 s41, s88, 31
  s_lshl_b32 s41, s41, 14
  s_lshl_b32 s42, s40, 12
  s_add_u32 s41, s41, s42
  s_add_u32 s41, s41, s46
  s_sub_u32 s41, s41, 0x200000
  v_lshlrev_b32 v230, 6, v255
  buffer_load_dword v231, v230, s[44:47], s41 offen
  s_add_u32 s41, s41, 0x80000
  buffer_load_dword v231, v230, s[44:47], s41 offen
  s_add_u32 s41, s41, 0x80000
  buffer_load_dword v231, v230, s[44:47], s41 offen
  s_add_u32 s41, s41, 0x80000
  buffer_load_dword v231, v230, s[44:47], s41 offen
  s_add_u32 s41, s41, 0x80000
Lt_15:
  buffer_load_dword v252, off, s[84:87], 0 offset:144 sc1
  s_waitcnt vmcnt(32)
  s_barrier
  ds_read_b128 v[128:131], v192 offset:0
  ds_read_b128 v[132:135], v196 offset:0
  ds_read_b128 v[136:139], v192 offset:8192
  ds_read_b128 v[140:143], v196 offset:8192
  s_branch PJ_lc
PJ_lb:
  s_barrier
  s_bitcmp1_b32 s3, 3
  s_cbranch_scc1 Lq_16
  s_bitset1_b32 s3, 3
  s_cmp_lt_u32 s89, 2
  s_cbranch_scc1 Lq_16
  s_mov_b32 s44, s10
  s_and_b32 s45, s11, 0xffff
  s_mov_b32 s46, 0x400000
  s_mov_b32 s47, 0x20000
  s_cmp_ge_u32 s89, 4
  s_cselect_b64 s[44:45], s[12:13], s[44:45]
  s_cmp_ge_u32 s89, 6
  s_cselect_b64 s[44:45], s[8:9], s[44:45]
  s_and_b32 s45, s45, 0xffff
  s_and_b32 s41, s88, 63
  s_lshl_b32 s41, s41, 2
  s_add_u32 s41, s41, s40
  s_lshl_b32 s41, s41, 14
  v_lshrrev_b32 v230, 2, v255
  v_and_b32 v229, 3, v255
  v_lshlrev_b32 v229, 6, v229
  v_lshl_add_u32 v230, v230, 10, v229
  buffer_load_dword v231, v230, s[44:47], s41 offen offset:256
  s_and_b32 s42, s41, 0x1c000
  s_cmp_lg_u32 s42, 0
  s_cbranch_scc1 Lq_16
  s_add_u32 s41, s41, 7936
  v_lshrrev_b32 v230, 2, v255
  v_lshl_add_u32 v230, v230, 13, v229
  buffer_load_dword v231, v230, s[44:47], s41 offen
Lq_16:
  s_add_u32 m0, s67, 0x0
  s_add_u32 s68, s69, 0x0
  buffer_load_dwordx4 v218, s[52:55], s68 offen nt lds
  s_add_u32 m0, s67, 0x400
  s_add_u32 s68, s69, 0x10000
  buffer_load_dwordx4 v218, s[52:55], s68 offen nt lds
  s_add_u32 m0, s67, 0x800
  s_add_u32 s68, s69, 0x20000
  buffer_load_dwordx4 v218, s[52:55], s68 offen nt lds
  s_add_u32 m0, s67, 0xc00
  s_add_u32 s68, s69, 0x30000
  buffer_load_dwordx4 v218, s[52:55], s68 offen nt lds
  s_add_u32 m0, s67, 0x4000
  s_add_u32 s68, s69, 0x40000
  buffer_load_dwordx4 v218, s[52:55], s68 offen nt lds
  s_add_u32 m0, s67, 0x4400
  s_add_u32 s68, s69, 0x50000
  buffer_load_dwordx4 v218, s[52:55], s68 offen nt lds
  s_add_u32 m0, s67, 0x4800
  s_add_u32 s68, s69, 0x60000
  buffer_load_dwordx4 v218, s[52:55], s68 offen nt lds
  s_add_u32 m0, s67, 0x4c00
  s_add_u32 s68, s69, 0x70000
  buffer_load_dwordx4 v218, s[52:55], s68 offen nt lds
  s_add_u32 m0, s67, 0x8000
  s_add_u32 s68, s69, 0x80000
  buffer_load_dwordx4 v218, s[52:55], s68 offen nt lds
  s_add_u32 m0, s67, 0x8400
  s_add_u32 s68, s69, 0x90000
  buffer_load_dwordx4 v218, s[52:55], s68 offen nt lds
  s_add_u32 m0, s67, 0x8800
  s_add_u32 s68, s69, 0xa0000
  buffer_load_dwordx4 v218, s[52:55], s68 offen nt lds
  s_add_u32 m0, s67, 0x8c00
  s_add_u32 s68, s69, 0xb0000
  buffer_load_dwordx4 v218, s[52:55], s68 offen nt lds
  s_add_u32 m0, s67, 0xc000
  s_add_u32 s68, s69, 0xc0000
  buffer_load_dwordx4 v218, s[52:55], s68 offen nt lds
  s_add_u32 m0, s67, 0xc400
  s_add_u32 s68, s69, 0xd0000
  buffer_load_dwordx4 v218, s[52:55], s68 offen nt lds
  s_add_u32 m0, s67, 0xc800
  s_add_u32 s68, s69, 0xe0000
  buffer_load_dwordx4 v218, s[52:55], s68 offen nt lds
  s_add_u32 m0, s67, 0xcc00
  s_add_u32 s68, s69, 0xf0000
  buffer_load_dwordx4 v218, s[52:55], s68 offen nt lds
  s_add_u32 m0, s67, 0x10000
  s_add_u32 s68, s69, 0x100000
  buffer_load_dwordx4 v218, s[52:55], s68 offen nt lds
  s_add_u32 m0, s67, 0x10400
  s_add_u32 s68, s69, 0x110000
  buffer_load_dwordx4 v218, s[52:55], s68 offen nt lds
  s_add_u32 m0, s67, 0x10800
  s_add_u32 s68, s69, 0x120000
  buffer_load_dwordx4 v218, s[52:55], s68 offen nt lds
  s_add_u32 m0, s67, 0x10c00
  s_add_u32 s68, s69, 0x130000
  buffer_load_dwordx4 v218, s[52:55], s68 offen nt lds
  s_add_u32 m0, s67, 0x14000
  s_add_u32 s68, s69, 0x140000
  buffer_load_dwordx4 v218, s[52:55], s68 offen nt lds
  s_add_u32 m0, s67, 0x14400
  s_add_u32 s68, s69, 0x150000
  buffer_load_dwordx4 v218, s[52:55], s68 offen nt lds
  s_add_u32 m0, s67, 0x14800
  s_add_u32 s68, s69, 0x160000
  buffer_load_dwordx4 v218, s[52:55], s68 offen nt lds
  s_add_u32 m0, s67, 0x14c00
  s_add_u32 s68, s69, 0x170000
  buffer_load_dwordx4 v218, s[52:55], s68 offen nt lds
  s_add_u32 m0, s67, 0x18000
  s_add_u32 s68, s69, 0x180000
  buffer_load_dwordx4 v218, s[52:55], s68 offen nt lds
  s_add_u32 m0, s67, 0x18400
  s_add_u32 s68, s69, 0x190000
  buffer_load_dwordx4 v218, s[52:55], s68 offen nt lds
  s_add_u32 m0, s67, 0x18800
  s_add_u32 s68, s69, 0x1a0000
  buffer_load_dwordx4 v218, s[52:55], s68 offen nt lds
  s_add_u32 m0, s67, 0x18c00
  s_add_u32 s68, s69, 0x1b0000
  buffer_load_dwordx4 v218, s[52:55], s68 offen nt lds
  s_add_u32 m0, s67, 0x1c000
  s_add_u32 s68, s69, 0x1c0000
  buffer_load_dwordx4 v218, s[52:55], s68 offen nt lds
  s_add_u32 m0, s67, 0x1c400
  s_add_u32 s68, s69, 0x1d0000
  buffer_load_dwordx4 v218, s[52:55], s68 offen nt lds
  s_add_u32 m0, s67, 0x1c800
  s_add_u32 s68, s69, 0x1e0000
  buffer_load_dwordx4 v218, s[52:55], s68 offen nt lds
  s_add_u32 m0, s67, 0x1cc00
  s_add_u32 s68, s69, 0x1f0000
  buffer_load_dwordx4 v218, s[52:55], s68 offen nt lds
  s_waitcnt vmcnt(24)
  ds_read_b64_tr_b16 a[0:1], v240 offset:0
  ds_read_b64_tr_b16 a[2:3], v240 offset:512
  ds_read_b64_tr_b16 a[64:65], v241 offset:0
  ds_read_b64_tr_b16 a[66:67], v241 offset:512
  ds_read_b64_tr_b16 a[128:129], v242 offset:0
  ds_read_b64_tr_b16 a[130:131], v242 offset:512
  ds_read_b64_tr_b16 a[192:193], v243 offset:0
  ds_read_b64_tr_b16 a[194:195], v243 offset:512
  s_waitcnt lgkmcnt(0)
  ds_read_b64_tr_b16 a[4:5], v240 offset:16384
  ds_read_b64_tr_b16 a[6:7], v240 offset:16896
  ds_read_b64_tr_b16 a[68:69], v241 offset:16384
  ds_read_b64_tr_b16 a[70:71], v241 offset:16896
  ds_read_b64_tr_b16 a[132:133], v242 offset:16384
  ds_read_b64_tr_b16 a[134:135], v242 offset:16896
  ds_read_b64_tr_b16 a[196:197], v243 offset:16384
  ds_read_b64_tr_b16 a[198:199], v243 offset:16896
  s_waitcnt lgkmcnt(0)
  s_add_u32 m0, s67, 0x0
  s_add_u32 s68, s69, 0x200000
  buffer_load_dwordx4 v218, s[52:55], s68 offen nt lds
  s_add_u32 m0, s67, 0x400
  s_add_u32 s68, s69, 0x210000
  buffer_load_dwordx4 v218, s[52:55], s68 offen nt lds
  s_add_u32 m0, s67, 0x800
  s_add_u32 s68, s69, 0x220000
  buffer_load_dwordx4 v218, s[52:55], s68 offen nt lds
  s_add_u32 m0, s67, 0xc00
  s_add_u32 s68, s69, 0x230000
  buffer_load_dwordx4 v218, s[52:55], s68 offen nt lds
  s_add_u32 m0, s67, 0x4000
  s_add_u32 s68, s69, 0x240000
  buffer_load_dwordx4 v218, s[52:55], s68 offen nt lds
  s_add_u32 m0, s67, 0x4400
  s_add_u32 s68, s69, 0x250000
  buffer_load_dwordx4 v218, s[52:55], s68 offen nt lds
  s_add_u32 m0, s67, 0x4800
  s_add_u32 s68, s69, 0x260000
  buffer_load_dwordx4 v218, s[52:55], s68 offen nt lds
  s_add_u32 m0, s67, 0x4c00
  s_add_u32 s68, s69, 0x270000
  buffer_load_dwordx4 v218, s[52:55], s68 offen nt lds
  s_waitcnt vmcnt(24)
  ds_read_b64_tr_b16 a[8:9], v240 offset:32768
  ds_read_b64_tr_b16 a[10:11], v240 offset:33280
  ds_read_b64_tr_b16 a[72:73], v241 offset:32768
  ds_read_b64_tr_b16 a[74:75], v241 offset:33280
  ds_read_b64_tr_b16 a[136:137], v242 offset:32768
  ds_read_b64_tr_b16 a[138:139], v242 offset:33280
  ds_read_b64_tr_b16 a[200:201], v243 offset:32768
  ds_read_b64_tr_b16 a[202:203], v243 offset:33280
  s_waitcnt lgkmcnt(0)
  ds_read_b64_tr_b16 a[12:13], v240 offset:49152
  ds_read_b64_tr_b16 a[14:15], v240 offset:49664
  ds_read_b64_tr_b16 a[76:77], v241 offset:49152
  ds_read_b64_tr_b16 a[78:79], v241 offset:49664
  ds_read_b64_tr_b16 a[140:141], v242 offset:49152
  ds_read_b64_tr_b16 a[142:143], v242 offset:49664
  ds_read_b64_tr_b16 a[204:205], v243 offset:49152
  ds_read_b64_tr_b16 a[206:207], v243 offset:49664
  s_waitcnt lgkmcnt(0)
  s_add_u32 m0, s67, 0x8000
  s_add_u32 s68, s69, 0x280000
  buffer_load_dwordx4 v218, s[52:55], s68 offen nt lds
  s_add_u32 m0, s67, 0x8400
  s_add_u32 s68, s69, 0x290000
  buffer_load_dwordx4 v218, s[52:55], s68 offen nt lds
  s_add_u32 m0, s67, 0x8800
  s_add_u32 s68, s69, 0x2a0000
  buffer_load_dwordx4 v218, s[52:55], s68 offen nt lds
  s_add_u32 m0, s67, 0x8c00
  s_add_u32 s68, s69, 0x2b0000
  buffer_load_dwordx4 v218, s[52:55], s68 offen nt lds
  s_add_u32 m0, s67, 0xc000
  s_add_u32 s68, s69, 0x2c0000
  buffer_load_dwordx4 v218, s[52:55], s68 offen nt lds
  s_add_u32 m0, s67, 0xc400
  s_add_u32 s68, s69, 0x2d0000
  buffer_load_dwordx4 v218, s[52:55], s68 offen nt lds
  s_add_u32 m0, s67, 0xc800
  s_add_u32 s68, s69, 0x2e0000
  buffer_load_dwordx4 v218, s[52:55], s68 offen nt lds
  s_add_u32 m0, s67, 0xcc00
  s_add_u32 s68, s69, 0x2f0000
  buffer_load_dwordx4 v218, s[52:55], s68 offen nt lds
  s_waitcnt vmcnt(24)
  ds_read_b64_tr_b16 a[16:17], v244 offset:0
  ds_read_b64_tr_b16 a[18:19], v244 offset:512
  ds_read_b64_tr_b16 a[80:81], v245 offset:0
  ds_read_b64_tr_b16 a[82:83], v245 offset:512
  ds_read_b64_tr_b16 a[144:145], v246 offset:0
  ds_read_b64_tr_b16 a[146:147], v246 offset:512
  ds_read_b64_tr_b16 a[208:209], v247 offset:0
  ds_read_b64_tr_b16 a[210:211], v247 offset:512
  s_waitcnt lgkmcnt(0)
  ds_read_b64_tr_b16 a[20:21], v244 offset:16384
  ds_read_b64_tr_b16 a[22:23], v244 offset:16896
  ds_read_b64_tr_b16 a[84:85], v245 offset:16384
  ds_read_b64_tr_b16 a[86:87], v245 offset:16896
  ds_read_b64_tr_b16 a[148:149], v246 offset:16384
  ds_read_b64_tr_b16 a[150:151], v246 offset:16896
  ds_read_b64_tr_b16 a[212:213], v247 offset:16384
  ds_read_b64_tr_b16 a[214:215], v247 offset:16896
  s_waitcnt lgkmcnt(0)
  s_add_u32 m0, s67, 0x10000
  s_add_u32 s68, s69, 0x300000
  buffer_load_dwordx4 v218, s[52:55], s68 offen nt lds
  s_add_u32 m0, s67, 0x10400
  s_add_u32 s68, s69, 0x310000
  buffer_load_dwordx4 v218, s[52:55], s68 offen nt lds
  s_add_u32 m0, s67, 0x10800
  s_add_u32 s68, s69, 0x320000
  buffer_load_dwordx4 v218, s[52:55], s68 offen nt lds
  s_add_u32 m0, s67, 0x10c00
  s_add_u32 s68, s69, 0x330000
  buffer_load_dwordx4 v218, s[52:55], s68 offen nt lds
  s_add_u32 m0, s67, 0x14000
  s_add_u32 s68, s69, 0x340000
  buffer_load_dwordx4 v218, s[52:55], s68 offen nt lds
  s_add_u32 m0, s67, 0x14400
  s_add_u32 s68, s69, 0x350000
  buffer_load_dwordx4 v218, s[52:55], s68 offen nt lds
  s_add_u32 m0, s67, 0x14800
  s_add_u32 s68, s69, 0x360000
  buffer_load_dwordx4 v218, s[52:55], s68 offen nt lds
  s_add_u32 m0, s67, 0x14c00
  s_add_u32 s68, s69, 0x370000
  buffer_load_dwordx4 v218, s[52:55], s68 offen nt lds
  s_waitcnt vmcnt(24)
  ds_read_b64_tr_b16 a[24:25], v244 offset:32768
  ds_read_b64_tr_b16 a[26:27], v244 offset:33280
  ds_read_b64_tr_b16 a[88:89], v245 offset:32768
  ds_read_b64_tr_b16 a[90:91], v245 offset:33280
  ds_read_b64_tr_b16 a[152:153], v246 offset:32768
  ds_read_b64_tr_b16 a[154:155], v246 offset:33280
  ds_read_b64_tr_b16 a[216:217], v247 offset:32768
  ds_read_b64_tr_b16 a[218:219], v247 offset:33280
  s_waitcnt lgkmcnt(0)
  ds_read_b64_tr_b16 a[28:29], v244 offset:49152
  ds_read_b64_tr_b16 a[30:31], v244 offset:49664
  ds_read_b64_tr_b16 a[92:93], v245 offset:49152
  ds_read_b64_tr_b16 a[94:95], v245 offset:49664
  ds_read_b64_tr_b16 a[156:157], v246 offset:49152
  ds_read_b64_tr_b16 a[158:159], v246 offset:49664
  ds_read_b64_tr_b16 a[220:221], v247 offset:49152
  ds_read_b64_tr_b16 a[222:223], v247 offset:49664
  s_waitcnt lgkmcnt(0)
  s_add_u32 m0, s67, 0x18000
  s_add_u32 s68, s69, 0x380000
  buffer_load_dwordx4 v218, s[52:55], s68 offen nt lds
  s_add_u32 m0, s67, 0x18400
  s_add_u32 s68, s69, 0x390000
  buffer_load_dwordx4 v218, s[52:55], s68 offen nt lds
  s_add_u32 m0, s67, 0x18800
  s_add_u32 s68, s69, 0x3a0000
  buffer_load_dwordx4 v218, s[52:55], s68 offen nt lds
  s_add_u32 m0, s67, 0x18c00
  s_add_u32 s68, s69, 0x3b0000
  buffer_load_dwordx4 v218, s[52:55], s68 offen nt lds
  s_add_u32 m0, s67, 0x1c000
  s_add_u32 s68, s69, 0x3c0000
  buffer_load_dwordx4 v218, s[52:55], s68 offen nt lds
  s_add_u32 m0, s67, 0x1c400
  s_add_u32 s68, s69, 0x3d0000
  buffer_load_dwordx4 v218, s[52:55], s68 offen nt lds
  s_add_u32 m0, s67, 0x1c800
  s_add_u32 s68, s69, 0x3e0000
  buffer_load_dwordx4 v218, s[52:55], s68 offen nt lds
  s_add_u32 m0, s67, 0x1cc00
  s_add_u32 s68, s69, 0x3f0000
  buffer_load_dwordx4 v218, s[52:55], s68 offen nt lds
  s_waitcnt vmcnt(24)
  ds_read_b64_tr_b16 a[32:33], v240 offset:0
  ds_read_b64_tr_b16 a[34:35], v240 offset:512
  ds_read_b64_tr_b16 a[96:97], v241 offset:0
  ds_read_b64_tr_b16 a[98:99], v241 offset:512
  ds_read_b64_tr_b16 a[160:161], v242 offset:0
  ds_read_b64_tr_b16 a[162:163], v242 offset:512
  ds_read_b64_tr_b16 a[224:225], v243 offset:0
  ds_read_b64_tr_b16 a[226:227], v243 offset:512
  s_waitcnt lgkmcnt(0)
  ds_read_b64_tr_b16 a[36:37], v240 offset:16384
  ds_read_b64_tr_b16 a[38:39], v240 offset:16896
  ds_read_b64_tr_b16 a[100:101], v241 offset:16384
  ds_read_b64_tr_b16 a[102:103], v241 offset:16896
  ds_read_b64_tr_b16 a[164:165], v242 offset:16384
  ds_read_b64_tr_b16 a[166:167], v242 offset:16896
  ds_read_b64_tr_b16 a[228:229], v243 offset:16384
  ds_read_b64_tr_b16 a[230:231], v243 offset:16896
  s_waitcnt lgkmcnt(0)
  s_add_u32 m0, s67, 0x0
  s_add_u32 s68, s61, 0x0
  buffer_load_dwordx4 v208, s[48:51], s68 offen offset:0  lds
  buffer_load_dwordx4 v209, s[48:51], s68 offen offset:1024  lds
  buffer_load_dwordx4 v210, s[48:51], s68 offen offset:2048  lds
  buffer_load_dwordx4 v211, s[48:51], s68 offen offset:3072  lds
  s_add_u32 m0, s67, 0x4000
  s_add_u32 s68, s61, 0x100
  buffer_load_dwordx4 v208, s[48:51], s68 offen offset:0  lds
  buffer_load_dwordx4 v209, s[48:51], s68 offen offset:1024  lds
  buffer_load_dwordx4 v210, s[48:51], s68 offen offset:2048  lds
  buffer_load_dwordx4 v211, s[48:51], s68 offen offset:3072  lds
  s_waitcnt vmcnt(24)
  ds_read_b64_tr_b16 a[40:41], v240 offset:32768
  ds_read_b64_tr_b16 a[42:43], v240 offset:33280
  ds_read_b64_tr_b16 a[104:105], v241 offset:32768
  ds_read_b64_tr_b16 a[106:107], v241 offset:33280
  ds_read_b64_tr_b16 a[168:169], v242 offset:32768
  ds_read_b64_tr_b16 a[170:171], v242 offset:33280
  ds_read_b64_tr_b16 a[232:233], v243 offset:32768
  ds_read_b64_tr_b16 a[234:235], v243 offset:33280
  s_waitcnt lgkmcnt(0)
  ds_read_b64_tr_b16 a[44:45], v240 offset:49152
  ds_read_b64_tr_b16 a[46:47], v240 offset:49664
  ds_read_b64_tr_b16 a[108:109], v241 offset:49152
  ds_read_b64_tr_b16 a[110:111], v241 offset:49664
  ds_read_b64_tr_b16 a[172:173], v242 offset:49152
  ds_read_b64_tr_b16 a[174:175], v242 offset:49664
  ds_read_b64_tr_b16 a[236:237], v243 offset:49152
  ds_read_b64_tr_b16 a[238:239], v243 offset:49664
  s_waitcnt lgkmcnt(0)
  s_add_u32 m0, s67, 0x8000
  s_add_u32 s68, s61, 0x200
  buffer_load_dwordx4 v208, s[48:51], s68 offen offset:0  lds
  buffer_load_dwordx4 v209, s[48:51], s68 offen offset:1024  lds
  buffer_load_dwordx4 v210, s[48:51], s68 offen offset:2048  lds
  buffer_load_dwordx4 v211, s[48:51], s68 offen offset:3072  lds
  buffer_store_dwordx4 v[160:163], v212, s[36:39], s64 offen
  buffer_store_dwordx4 v[160:163], v212, s[36:39], s64 offen
  buffer_store_dwordx4 v[160:163], v212, s[36:39], s64 offen
  buffer_store_dwordx4 v[160:163], v212, s[36:39], s64 offen
  s_add_u32 m0, s67, 0xc000
  s_add_u32 s68, s61, 0x300
  buffer_load_dwordx4 v208, s[48:51], s68 offen offset:0  lds
  buffer_load_dwordx4 v209, s[48:51], s68 offen offset:1024  lds
  buffer_load_dwordx4 v210, s[48:51], s68 offen offset:2048  lds
  buffer_load_dwordx4 v211, s[48:51], s68 offen offset:3072  lds
  buffer_store_dwordx4 v[160:163], v212, s[36:39], s64 offen
  buffer_store_dwordx4 v[160:163], v212, s[36:39], s64 offen
  buffer_store_dwordx4 v[160:163], v212, s[36:39], s64 offen
  buffer_store_dwordx4 v[160:163], v212, s[36:39], s64 offen
  s_waitcnt vmcnt(32)
  ds_read_b64_tr_b16 a[48:49], v244 offset:0
  ds_read_b64_tr_b16 a[50:51], v244 offset:512
  ds_read_b64_tr_b16 a[112:113], v245 offset:0
  ds_read_b64_tr_b16 a[114:115], v245 offset:512
  ds_read_b64_tr_b16 a[176:177], v246 offset:0
  ds_read_b64_tr_b16 a[178:179], v246 offset:512
  ds_read_b64_tr_b16 a[240:241], v247 offset:0
  ds_read_b64_tr_b16 a[242:243], v247 offset:512
  s_waitcnt lgkmcnt(0)
  ds_read_b64_tr_b16 a[52:53], v244 offset:16384
  ds_read_b64_tr_b16 a[54:55], v244 offset:16896
  ds_read_b64_tr_b16 a[116:117], v245 offset:16384
  ds_read_b64_tr_b16 a[118:119], v245 offset:16896
  ds_read_b64_tr_b16 a[180:181], v246 offset:16384
  ds_read_b64_tr_b16 a[182:183], v246 offset:16896
  ds_read_b64_tr_b16 a[244:245], v247 offset:16384
  ds_read_b64_tr_b16 a[246:247], v247 offset:16896
  s_waitcnt lgkmcnt(0)
  s_add_u32 m0, s67, 0x10000
  s_add_u32 s68, s61, 0x10000
  buffer_load_dwordx4 v208, s[48:51], s68 offen offset:0  lds
  buffer_load_dwordx4 v209, s[48:51], s68 offen offset:1024  lds
  buffer_load_dwordx4 v210, s[48:51], s68 offen offset:2048  lds
  buffer_load_dwordx4 v211, s[48:51], s68 offen offset:3072  lds
  s_add_u32 m0, s67, 0x14000
  s_add_u32 s68, s61, 0x10100
  buffer_load_dwordx4 v208, s[48:51], s68 offen offset:0  lds
  buffer_load_dwordx4 v209, s[48:51], s68 offen offset:1024  lds
  buffer_load_dwordx4 v210, s[48:51], s68 offen offset:2048  lds
  buffer_load_dwordx4 v211, s[48:51], s68 offen offset:3072  lds
  s_waitcnt vmcnt(32)
  ds_read_b64_tr_b16 a[56:57], v244 offset:32768
  ds_read_b64_tr_b16 a[58:59], v244 offset:33280
  ds_read_b64_tr_b16 a[120:121], v245 offset:32768
  ds_read_b64_tr_b16 a[122:123], v245 offset:33280
  ds_read_b64_tr_b16 a[184:185], v246 offset:32768
  ds_read_b64_tr_b16 a[186:187], v246 offset:33280
  ds_read_b64_tr_b16 a[248:249], v247 offset:32768
  ds_read_b64_tr_b16 a[250:251], v247 offset:33280
  s_waitcnt lgkmcnt(0)
  ds_read_b64_tr_b16 a[60:61], v244 offset:49152
  ds_read_b64_tr_b16 a[62:63], v244 offset:49664
  ds_read_b64_tr_b16 a[124:125], v245 offset:49152
  ds_read_b64_tr_b16 a[126:127], v245 offset:49664
  ds_read_b64_tr_b16 a[188:189], v246 offset:49152
  ds_read_b64_tr_b16 a[190:191], v246 offset:49664
  ds_read_b64_tr_b16 a[252:253], v247 offset:49152
  ds_read_b64_tr_b16 a[254:255], v247 offset:49664
  s_waitcnt lgkmcnt(0)
  s_add_u32 m0, s67, 0x18000
  s_add_u32 s68, s61, 0x10200
  buffer_load_dwordx4 v208, s[48:51], s68 offen offset:0  lds
  buffer_load_dwordx4 v209, s[48:51], s68 offen offset:1024  lds
  buffer_load_dwordx4 v210, s[48:51], s68 offen offset:2048  lds
  buffer_load_dwordx4 v211, s[48:51], s68 offen offset:3072  lds
  s_bitcmp1_b32 s3, 0
  s_cbranch_scc1 Lt_17
  s_bitset1_b32 s3, 0
  s_mov_b32 s44, s4
  s_and_b32 s45, s5, 0xffff
  s_mov_b32 s46, 0x0
  s_mov_b32 s47, 0x20000
  s_cmp_eq_u32 s89, 2
  s_cselect_b64 s[44:45], s[4:5], s[44:45]
  s_cselect_b32 s46, 0x200000, s46
  s_cmp_eq_u32 s89, 3
  s_cselect_b64 s[44:45], s[20:21], s[44:45]
  s_cselect_b32 s46, 0x200000, s46
  s_cmp_eq_u32 s89, 6
  s_cselect_b64 s[44:45], s[18:19], s[44:45]
  s_cselect_b32 s46, 0x200000, s46
  s_cmp_eq_u32 s89, 4
  s_cselect_b64 s[44:45], s[28:29], s[44:45]
  s_cselect_b32 s46, 0x200000, s46
  s_cmp_eq_u32 s89, 5
  s_cselect_b64 s[44:45], s[28:29], s[44:45]
  s_cselect_b32 s46, 0x400000, s46
  s_cmp_eq_u32 s46, 0
  s_cbranch_scc1 Lt_17
  s_and_b32 s45, s45, 0xffff
  s_and_b32 s41, s88, 31
  s_lshl_b32 s41, s41, 14
  s_lshl_b32 s42, s40, 12
  s_add_u32 s41, s41, s42
  s_add_u32 s41, s41, s46
  s_sub_u32 s41, s41, 0x200000
  v_lshlrev_b32 v230, 6, v255
  buffer_load_dword v231, v230, s[44:47], s41 offen
  s_add_u32 s41, s41, 0x80000
  buffer_load_dword v231, v230, s[44:47], s41 offen
  s_add_u32 s41, s41, 0x80000
  buffer_load_dword v231, v230, s[44:47], s41 offen
  s_add_u32 s41, s41, 0x80000
  buffer_load_dword v231, v230, s[44:47], s41 offen
  s_add_u32 s41, s41, 0x80000
Lt_17:
  buffer_load_dword v252, off, s[84:87], 0 offset:144 sc1
  s_waitcnt vmcnt(32)
  s_barrier
  ds_read_b128 v[128:131], v192 offset:0
  ds_read_b128 v[132:135], v196 offset:0
  ds_read_b128 v[136:139], v192 offset:8192
  ds_read_b128 v[140:143], v196 offset:8192
PJ_lc:
PJ_unit:
  s_add_u32 s62, s61, 0x20000
  s_sub_u32 s60, s60, 2
  s_cmp_eq_u32 s60, 0
  s_cselect_b32 s62, 0x400000, s62
  s_cmp_eq_u32 s66, 0
  s_cbranch_scc0 PJ_b1
  s_cmp_eq_u32 s57, 0
  s_cbranch_scc1 PJ_b2
  s_waitcnt lgkmcnt(0)
  v_mfma_f32_16x16x32_bf16 v[0:3], a[0:3], v[128:131], 0
  ds_read_b128 v[144:147], v193 offset:0
  v_mfma_f32_16x16x32_bf16 v[4:7], a[64:67], v[128:131], 0
  v_mfma_f32_16x16x32_bf16 v[8:11], a[128:131], v[128:131], 0
  v_mfma_f32_16x16x32_bf16 v[12:15], a[192:195], v[128:131], 0
  ds_read_b128 v[148:151], v197 offset:0
  v_mul_f32 v160, s65, v64
  v_mul_f32 v161, s65, v65
  v_mfma_f32_16x16x32_bf16 v[28:31], a[192:195], v[132:135], 0
  ds_read_b128 v[152:155], v193 offset:8192
  v_mul_f32 v162, s65, v66
  v_mul_f32 v163, s65, v67
  v_mfma_f32_16x16x32_bf16 v[24:27], a[128:131], v[132:135], 0
  v_mul_f32 v164, s65, v68
  v_mul_f32 v165, s65, v69
  v_mfma_f32_16x16x32_bf16 v[20:23], a[64:67], v[132:135], 0
  v_mul_f32 v166, s65, v70
  v_mul_f32 v167, s65, v71
  v_mfma_f32_16x16x32_bf16 v[16:19], a[0:3], v[132:135], 0
  ds_read_b128 v[156:159], v197 offset:8192
  v_cvt_pk_bf16_f32 v160, v160, v161
  v_cvt_pk_bf16_f32 v161, v162, v163
  v_mfma_f32_16x16x32_bf16 v[32:35], a[0:3], v[136:139], 0
  v_cvt_pk_bf16_f32 v162, v164, v165
  v_cvt_pk_bf16_f32 v163, v166, v167
  v_mfma_f32_16x16x32_bf16 v[36:39], a[64:67], v[136:139], 0
  buffer_store_dwordx4 v[160:163], v212, s[36:39], s64 offen offset:0 sc1
  v_mul_f32 v168, s65, v72
  v_mfma_f32_16x16x32_bf16 v[40:43], a[128:131], v[136:139], 0
  v_mul_f32 v169, s65, v73
  v_mul_f32 v170, s65, v74
  v_mfma_f32_16x16x32_bf16 v[44:47], a[192:195], v[136:139], 0
  v_mfma_f32_16x16x32_bf16 v[60:63], a[192:195], v[140:143], 0
  v_mfma_f32_16x16x32_bf16 v[56:59], a[128:131], v[140:143], 0
  v_mul_f32 v171, s65, v75
  v_mul_f32 v172, s65, v76
  v_mfma_f32_16x16x32_bf16 v[52:55], a[64:67], v[140:143], 0
  v_mul_f32 v173, s65, v77
  v_mul_f32 v174, s65, v78
  v_mfma_f32_16x16x32_bf16 v[48:51], a[0:3], v[140:143], 0
  s_waitcnt lgkmcnt(0)
  v_mfma_f32_16x16x32_bf16 v[0:3], a[4:7], v[144:147], v[0:3]
  ds_read_b128 v[128:131], v194 offset:0
  v_mfma_f32_16x16x32_bf16 v[4:7], a[68:71], v[144:147], v[4:7]
  v_mul_f32 v175, s65, v79
  v_cvt_pk_bf16_f32 v168, v168, v169
  v_mfma_f32_16x16x32_bf16 v[8:11], a[132:135], v[144:147], v[8:11]
  v_cvt_pk_bf16_f32 v169, v170, v171
  v_cvt_pk_bf16_f32 v170, v172, v173
  v_mfma_f32_16x16x32_bf16 v[12:15], a[196:199], v[144:147], v[12:15]
  ds_read_b128 v[132:135], v198 offset:0
  v_mfma_f32_16x16x32_bf16 v[28:31], a[196:199], v[148:151], v[28:31]
  ds_read_b128 v[136:139], v194 offset:8192
  v_mfma_f32_16x16x32_bf16 v[24:27], a[132:135], v[148:151], v[24:27]
  v_cvt_pk_bf16_f32 v171, v174, v175
  buffer_store_dwordx4 v[168:171], v212, s[36:39], s64 offen offset:2048 sc1
  v_mfma_f32_16x16x32_bf16 v[20:23], a[68:71], v[148:151], v[20:23]
  v_mul_f32 v176, s65, v80
  v_mul_f32 v177, s65, v81
  v_mfma_f32_16x16x32_bf16 v[16:19], a[4:7], v[148:151], v[16:19]
  ds_read_b128 v[140:143], v198 offset:8192
  v_mfma_f32_16x16x32_bf16 v[32:35], a[4:7], v[152:155], v[32:35]
  v_mfma_f32_16x16x32_bf16 v[36:39], a[68:71], v[152:155], v[36:39]
  v_mul_f32 v178, s65, v82
  v_mul_f32 v179, s65, v83
  v_mfma_f32_16x16x32_bf16 v[40:43], a[132:135], v[152:155], v[40:43]
  v_mul_f32 v180, s65, v84
  v_mul_f32 v181, s65, v85
  v_mfma_f32_16x16x32_bf16 v[44:47], a[196:199], v[152:155], v[44:47]
  v_mfma_f32_16x16x32_bf16 v[60:63], a[196:199], v[156:159], v[60:63]
  v_mfma_f32_16x16x32_bf16 v[56:59], a[132:135], v[156:159], v[56:59]
  v_mul_f32 v182, s65, v86
  v_mul_f32 v183, s65, v87
  v_mfma_f32_16x16x32_bf16 v[52:55], a[68:71], v[156:159], v[52:55]
  v_cvt_pk_bf16_f32 v176, v176, v177
  v_cvt_pk_bf16_f32 v177, v178, v179
  v_mfma_f32_16x16x32_bf16 v[48:51], a[4:7], v[156:159], v[48:51]
  s_waitcnt lgkmcnt(0)
  v_mfma_f32_16x16x32_bf16 v[0:3], a[8:11], v[128:131], v[0:3]
  ds_read_b128 v[144:147], v195 offset:0
  v_mfma_f32_16x16x32_bf16 v[4:7], a[72:75], v[128:131], v[4:7]
  v_cvt_pk_bf16_f32 v178, v180, v181
  v_cvt_pk_bf16_f32 v179, v182, v183
  v_mfma_f32_16x16x32_bf16 v[8:11], a[136:139], v[128:131], v[8:11]
  buffer_store_dwordx4 v[176:179], v212, s[36:39], s64 offen offset:256 sc1
  v_mul_f32 v184, s65, v88
  v_mfma_f32_16x16x32_bf16 v[12:15], a[200:203], v[128:131], v[12:15]
  ds_read_b128 v[148:151], v199 offset:0
  v_mfma_f32_16x16x32_bf16 v[28:31], a[200:203], v[132:135], v[28:31]
  ds_read_b128 v[152:155], v195 offset:8192
  v_mfma_f32_16x16x32_bf16 v[24:27], a[136:139], v[132:135], v[24:27]
  v_mul_f32 v185, s65, v89
  v_mul_f32 v186, s65, v90
  v_mfma_f32_16x16x32_bf16 v[20:23], a[72:75], v[132:135], v[20:23]
  v_mul_f32 v187, s65, v91
  v_mul_f32 v188, s65, v92
  v_mfma_f32_16x16x32_bf16 v[16:19], a[8:11], v[132:135], v[16:19]
  ds_read_b128 v[156:159], v199 offset:8192
  v_mfma_f32_16x16x32_bf16 v[32:35], a[8:11], v[136:139], v[32:35]
  v_mfma_f32_16x16x32_bf16 v[36:39], a[72:75], v[136:139], v[36:39]
  v_mul_f32 v189, s65, v93
  v_mul_f32 v190, s65, v94
  v_mfma_f32_16x16x32_bf16 v[40:43], a[136:139], v[136:139], v[40:43]
  v_mul_f32 v191, s65, v95
  v_cvt_pk_bf16_f32 v184, v184, v185
  v_mfma_f32_16x16x32_bf16 v[44:47], a[200:203], v[136:139], v[44:47]
  v_mfma_f32_16x16x32_bf16 v[60:63], a[200:203], v[140:143], v[60:63]
  v_mfma_f32_16x16x32_bf16 v[56:59], a[136:139], v[140:143], v[56:59]
  v_cvt_pk_bf16_f32 v185, v186, v187
  v_cvt_pk_bf16_f32 v186, v188, v189
  v_mfma_f32_16x16x32_bf16 v[52:55], a[72:75], v[140:143], v[52:55]
  v_cvt_pk_bf16_f32 v187, v190, v191
  buffer_store_dwordx4 v[184:187], v212, s[36:39], s64 offen offset:2304 sc1
  v_mfma_f32_16x16x32_bf16 v[48:51], a[8:11], v[140:143], v[48:51]
  s_waitcnt vmcnt(16)
  s_barrier
  s_cmp_lg_u32 s40, 0
  s_cbranch_scc1 Lg_18
  s_cmp_lt_i32 s70, s71
  s_cbranch_scc1 Lg_18
  s_cmp_lg_u32 s101, 0
  s_cbranch_scc1 Li_22
  v_readfirstlane_b32 s101, v252
  s_nop 0
  s_cmp_lg_u32 s101, 0
  s_cbranch_scc1 Li_22
Li_21:
  buffer_load_dword v252, off, s[84:87], 0 offset:144 sc1
  s_waitcnt vmcnt(0)
  v_readfirstlane_b32 s101, v252
  s_add_u32 s91, s91, 1
  s_cmp_gt_u32 s91, 0x20000
  s_cbranch_scc1 L_abort
  s_cmp_eq_u32 s101, 0
  s_cbranch_scc1 Li_21
Li_22:
  s_cmp_lg_u32 s56, 0
  s_cbranch_scc1 Lg_19
  s_lshl_b32 s41, s57, 3
  s_lshl_b32 s41, 1, s41
  s_mov_b64 exec, 1
  s_add_u32 s42, s70, 1
  s_lshl_b32 s42, s42, 1
  v_mov_b32 v249, s42
  s_add_u32 s42, s58, 168
  s_lshl_b32 s42, s42, 7
  s_cmp_lg_u32 s57, 0
  s_cselect_b32 s42, 0x10000000, s42
  buffer_store_dword v249, v253, s[36:39], s42 offen sc1
  s_add_u32 s42, s70, 136
  s_branch Lg_20
Lg_19:
  s_and_b32 s41, s70, 3
  s_cmp_lg_u32 s41, 3
  s_cbranch_scc1 Lg_18
  s_lshr_b32 s41, s70, 2
  s_lshl_b32 s42, s57, 3
  s_add_u32 s41, s41, s42
  s_lshl_b32 s41, 1, s41
  s_lshl_b32 s42, s58, s57
  s_add_u32 s42, s42, 32
  s_lshl_b32 s43, s57, 1
  s_add_u32 exec_lo, s43, 1
  s_mov_b32 exec_hi, 0
Lg_20:
  s_lshl_b32 s42, s42, 7
  v_mov_b32 v250, s41
  buffer_atomic_add v250, v253, s[36:39], s42 offen
  s_mov_b64 exec, -1
Lg_18:
  s_add_u32 s70, s70, 1
  s_waitcnt lgkmcnt(0)
  v_mfma_f32_16x16x32_bf16 v[0:3], a[12:15], v[144:147], v[0:3]
  ds_read_b128 v[128:131], v192 offset:16384
  v_mfma_f32_16x16x32_bf16 v[4:7], a[76:79], v[144:147], v[4:7]
  s_add_u32 m0, s67, 0x1c000
  s_add_u32 s68, s61, 0x10300
  v_mfma_f32_16x16x32_bf16 v[8:11], a[140:143], v[144:147], v[8:11]
  buffer_load_dwordx4 v208, s[48:51], s68 offen offset:0  lds
  v_mfma_f32_16x16x32_bf16 v[12:15], a[204:207], v[144:147], v[12:15]
  ds_read_b128 v[132:135], v196 offset:16384
  v_mfma_f32_16x16x32_bf16 v[28:31], a[204:207], v[148:151], v[28:31]
  ds_read_b128 v[136:139], v192 offset:24576
  v_mfma_f32_16x16x32_bf16 v[24:27], a[140:143], v[148:151], v[24:27]
  v_mfma_f32_16x16x32_bf16 v[20:23], a[76:79], v[148:151], v[20:23]
  buffer_load_dwordx4 v209, s[48:51], s68 offen offset:1024  lds
  v_mfma_f32_16x16x32_bf16 v[16:19], a[12:15], v[148:151], v[16:19]
  ds_read_b128 v[140:143], v196 offset:24576
  v_mfma_f32_16x16x32_bf16 v[32:35], a[12:15], v[152:155], v[32:35]
  v_mfma_f32_16x16x32_bf16 v[36:39], a[76:79], v[152:155], v[36:39]
  v_mfma_f32_16x16x32_bf16 v[40:43], a[140:143], v[152:155], v[40:43]
  buffer_load_dwordx4 v210, s[48:51], s68 offen offset:2048  lds
  v_mfma_f32_16x16x32_bf16 v[44:47], a[204:207], v[152:155], v[44:47]
  v_mfma_f32_16x16x32_bf16 v[60:63], a[204:207], v[156:159], v[60:63]
  v_mfma_f32_16x16x32_bf16 v[56:59], a[140:143], v[156:159], v[56:59]
  v_mfma_f32_16x16x32_bf16 v[52:55], a[76:79], v[156:159], v[52:55]
  buffer_load_dwordx4 v211, s[48:51], s68 offen offset:3072  lds
  v_mfma_f32_16x16x32_bf16 v[48:51], a[12:15], v[156:159], v[48:51]
  s_waitcnt lgkmcnt(0)
  v_mfma_f32_16x16x32_bf16 v[0:3], a[16:19], v[128:131], v[0:3]
  ds_read_b128 v[144:147], v193 offset:16384
  v_mul_f32 v160, s65, v96
  v_mul_f32 v161, s65, v97
  v_mfma_f32_16x16x32_bf16 v[4:7], a[80:83], v[128:131], v[4:7]
  v_mul_f32 v162, s65, v98
  v_mul_f32 v163, s65, v99
  v_mfma_f32_16x16x32_bf16 v[8:11], a[144:147], v[128:131], v[8:11]
  v_mul_f32 v164, s65, v100
  v_mul_f32 v165, s65, v101
  v_mfma_f32_16x16x32_bf16 v[12:15], a[208:211], v[128:131], v[12:15]
  ds_read_b128 v[148:151], v197 offset:16384
  v_mul_f32 v166, s65, v102
  v_mul_f32 v167, s65, v103
  v_mfma_f32_16x16x32_bf16 v[28:31], a[208:211], v[132:135], v[28:31]
  ds_read_b128 v[152:155], v193 offset:24576
  v_mfma_f32_16x16x32_bf16 v[24:27], a[144:147], v[132:135], v[24:27]
  v_cvt_pk_bf16_f32 v160, v160, v161
  v_cvt_pk_bf16_f32 v161, v162, v163
  v_mfma_f32_16x16x32_bf16 v[20:23], a[80:83], v[132:135], v[20:23]
  v_cvt_pk_bf16_f32 v162, v164, v165
  v_cvt_pk_bf16_f32 v163, v166, v167
  v_mfma_f32_16x16x32_bf16 v[16:19], a[16:19], v[132:135], v[16:19]
  ds_read_b128 v[156:159], v197 offset:24576
  v_mfma_f32_16x16x32_bf16 v[32:35], a[16:19], v[136:139], v[32:35]
  v_mfma_f32_16x16x32_bf16 v[36:39], a[80:83], v[136:139], v[36:39]
  buffer_store_dwordx4 v[160:163], v213, s[36:39], s64 offen offset:0 sc1
  v_mul_f32 v168, s65, v104
  v_mfma_f32_16x16x32_bf16 v[40:43], a[144:147], v[136:139], v[40:43]
  v_mul_f32 v169, s65, v105
  v_mul_f32 v170, s65, v106
  v_mfma_f32_16x16x32_bf16 v[44:47], a[208:211], v[136:139], v[44:47]
  v_mfma_f32_16x16x32_bf16 v[60:63], a[208:211], v[140:143], v[60:63]
  v_mfma_f32_16x16x32_bf16 v[56:59], a[144:147], v[140:143], v[56:59]
  v_mul_f32 v171, s65, v107
  v_mul_f32 v172, s65, v108
  v_mfma_f32_16x16x32_bf16 v[52:55], a[80:83], v[140:143], v[52:55]
  v_mul_f32 v173, s65, v109
  v_mul_f32 v174, s65, v110
  v_mfma_f32_16x16x32_bf16 v[48:51], a[16:19], v[140:143], v[48:51]
  s_waitcnt lgkmcnt(0)
  v_mfma_f32_16x16x32_bf16 v[0:3], a[20:23], v[144:147], v[0:3]
  ds_read_b128 v[128:131], v194 offset:16384
  v_mfma_f32_16x16x32_bf16 v[4:7], a[84:87], v[144:147], v[4:7]
  v_mul_f32 v175, s65, v111
  v_cvt_pk_bf16_f32 v168, v168, v169
  v_mfma_f32_16x16x32_bf16 v[8:11], a[148:151], v[144:147], v[8:11]
  v_cvt_pk_bf16_f32 v169, v170, v171
  v_cvt_pk_bf16_f32 v170, v172, v173
  v_mfma_f32_16x16x32_bf16 v[12:15], a[212:215], v[144:147], v[12:15]
  ds_read_b128 v[132:135], v198 offset:16384
  v_mfma_f32_16x16x32_bf16 v[28:31], a[212:215], v[148:151], v[28:31]
  ds_read_b128 v[136:139], v194 offset:24576
  v_mfma_f32_16x16x32_bf16 v[24:27], a[148:151], v[148:151], v[24:27]
  v_cvt_pk_bf16_f32 v171, v174, v175
  buffer_store_dwordx4 v[168:171], v213, s[36:39], s64 offen offset:2048 sc1
  v_mfma_f32_16x16x32_bf16 v[20:23], a[84:87], v[148:151], v[20:23]
  v_mul_f32 v176, s65, v112
  v_mul_f32 v177, s65, v113
  v_mfma_f32_16x16x32_bf16 v[16:19], a[20:23], v[148:151], v[16:19]
  ds_read_b128 v[140:143], v198 offset:24576
  v_mfma_f32_16x16x32_bf16 v[32:35], a[20:23], v[152:155], v[32:35]
  v_mfma_f32_16x16x32_bf16 v[36:39], a[84:87], v[152:155], v[36:39]
  v_mul_f32 v178, s65, v114
  v_mul_f32 v179, s65, v115
  v_mfma_f32_16x16x32_bf16 v[40:43], a[148:151], v[152:155], v[40:43]
  v_mul_f32 v180, s65, v116
  v_mul_f32 v181, s65, v117
  v_mfma_f32_16x16x32_bf16 v[44:47], a[212:215], v[152:155], v[44:47]
  v_mfma_f32_16x16x32_bf16 v[60:63], a[212:215], v[156:159], v[60:63]
  v_mfma_f32_16x16x32_bf16 v[56:59], a[148:151], v[156:159], v[56:59]
  v_mul_f32 v182, s65, v118
  v_mul_f32 v183, s65, v119
  v_mfma_f32_16x16x32_bf16 v[52:55], a[84:87], v[156:159], v[52:55]
  v_cvt_pk_bf16_f32 v176, v176, v177
  v_cvt_pk_bf16_f32 v177, v178, v179
  v_mfma_f32_16x16x32_bf16 v[48:51], a[20:23], v[156:159], v[48:51]
  s_waitcnt lgkmcnt(0)
  v_mfma_f32_16x16x32_bf16 v[0:3], a[24:27], v[128:131], v[0:3]
  ds_read_b128 v[144:147], v195 offset:16384
  v_mfma_f32_16x16x32_bf16 v[4:7], a[88:91], v[128:131], v[4:7]
  v_cvt_pk_bf16_f32 v178, v180, v181
  v_cvt_pk_bf16_f32 v179, v182, v183
  v_mfma_f32_16x16x32_bf16 v[8:11], a[152:155], v[128:131], v[8:11]
  buffer_store_dwordx4 v[176:179], v213, s[36:39], s64 offen offset:256 sc1
  v_mul_f32 v184, s65, v120
  v_mfma_f32_16x16x32_bf16 v[12:15], a[216:219], v[128:131], v[12:15]
  ds_read_b128 v[148:151], v199 offset:16384
  v_mfma_f32_16x16x32_bf16 v[28:31], a[216:219], v[132:135], v[28:31]
  ds_read_b128 v[152:155], v195 offset:24576
  v_mfma_f32_16x16x32_bf16 v[24:27], a[152:155], v[132:135], v[24:27]
  v_mul_f32 v185, s65, v121
  v_mul_f32 v186, s65, v122
  v_mfma_f32_16x16x32_bf16 v[20:23], a[88:91], v[132:135], v[20:23]
  v_mul_f32 v187, s65, v123
  v_mul_f32 v188, s65, v124
  v_mfma_f32_16x16x32_bf16 v[16:19], a[24:27], v[132:135], v[16:19]
  ds_read_b128 v[156:159], v199 offset:24576
  v_mfma_f32_16x16x32_bf16 v[32:35], a[24:27], v[136:139], v[32:35]
  v_mfma_f32_16x16x32_bf16 v[36:39], a[88:91], v[136:139], v[36:39]
  v_mul_f32 v189, s65, v125
  v_mul_f32 v190, s65, v126
  v_mfma_f32_16x16x32_bf16 v[40:43], a[152:155], v[136:139], v[40:43]
  v_mul_f32 v191, s65, v127
  v_cvt_pk_bf16_f32 v184, v184, v185
  v_mfma_f32_16x16x32_bf16 v[44:47], a[216:219], v[136:139], v[44:47]
  v_mfma_f32_16x16x32_bf16 v[60:63], a[216:219], v[140:143], v[60:63]
  v_mfma_f32_16x16x32_bf16 v[56:59], a[152:155], v[140:143], v[56:59]
  v_cvt_pk_bf16_f32 v185, v186, v187
  v_cvt_pk_bf16_f32 v186, v188, v189
  v_mfma_f32_16x16x32_bf16 v[52:55], a[88:91], v[140:143], v[52:55]
  v_cvt_pk_bf16_f32 v187, v190, v191
  buffer_store_dwordx4 v[184:187], v213, s[36:39], s64 offen offset:2304 sc1
  v_mfma_f32_16x16x32_bf16 v[48:51], a[24:27], v[140:143], v[48:51]
  s_waitcnt vmcnt(36)
  s_barrier
  s_waitcnt lgkmcnt(0)
  v_mfma_f32_16x16x32_bf16 v[0:3], a[28:31], v[144:147], v[0:3]
  ds_read_b128 v[128:131], v192 offset:32768
  v_mfma_f32_16x16x32_bf16 v[4:7], a[92:95], v[144:147], v[4:7]
  s_add_u32 m0, s67, 0x0
  s_add_u32 s68, s62, 0x0
  v_mfma_f32_16x16x32_bf16 v[8:11], a[156:159], v[144:147], v[8:11]
  buffer_load_dwordx4 v208, s[48:51], s68 offen offset:0  lds
  v_mfma_f32_16x16x32_bf16 v[12:15], a[220:223], v[144:147], v[12:15]
  ds_read_b128 v[132:135], v196 offset:32768
  v_mfma_f32_16x16x32_bf16 v[28:31], a[220:223], v[148:151], v[28:31]
  ds_read_b128 v[136:139], v192 offset:40960
  v_mfma_f32_16x16x32_bf16 v[24:27], a[156:159], v[148:151], v[24:27]
  v_mfma_f32_16x16x32_bf16 v[20:23], a[92:95], v[148:151], v[20:23]
  buffer_load_dwordx4 v209, s[48:51], s68 offen offset:1024  lds
  v_mfma_f32_16x16x32_bf16 v[16:19], a[28:31], v[148:151], v[16:19]
  ds_read_b128 v[140:143], v196 offset:40960
  v_mfma_f32_16x16x32_bf16 v[32:35], a[28:31], v[152:155], v[32:35]
  v_mfma_f32_16x16x32_bf16 v[36:39], a[92:95], v[152:155], v[36:39]
  v_mfma_f32_16x16x32_bf16 v[40:43], a[156:159], v[152:155], v[40:43]
  buffer_load_dwordx4 v210, s[48:51], s68 offen offset:2048  lds
  v_mfma_f32_16x16x32_bf16 v[44:47], a[220:223], v[152:155], v[44:47]
  v_mfma_f32_16x16x32_bf16 v[60:63], a[220:223], v[156:159], v[60:63]
  v_mfma_f32_16x16x32_bf16 v[56:59], a[156:159], v[156:159], v[56:59]
  v_mfma_f32_16x16x32_bf16 v[52:55], a[92:95], v[156:159], v[52:55]
  buffer_load_dwordx4 v211, s[48:51], s68 offen offset:3072  lds
  v_mfma_f32_16x16x32_bf16 v[48:51], a[28:31], v[156:159], v[48:51]
  s_waitcnt lgkmcnt(0)
  v_mfma_f32_16x16x32_bf16 v[0:3], a[32:35], v[128:131], v[0:3]
  ds_read_b128 v[144:147], v193 offset:32768
  v_mfma_f32_16x16x32_bf16 v[4:7], a[96:99], v[128:131], v[4:7]
  v_mfma_f32_16x16x32_bf16 v[8:11], a[160:163], v[128:131], v[8:11]
  v_mfma_f32_16x16x32_bf16 v[12:15], a[224:227], v[128:131], v[12:15]
  ds_read_b128 v[148:151], v197 offset:32768
  v_mfma_f32_16x16x32_bf16 v[28:31], a[224:227], v[132:135], v[28:31]
  ds_read_b128 v[152:155], v193 offset:40960
  v_mfma_f32_16x16x32_bf16 v[24:27], a[160:163], v[132:135], v[24:27]
  v_mfma_f32_16x16x32_bf16 v[20:23], a[96:99], v[132:135], v[20:23]
  v_mfma_f32_16x16x32_bf16 v[16:19], a[32:35], v[132:135], v[16:19]
  ds_read_b128 v[156:159], v197 offset:40960
  v_mfma_f32_16x16x32_bf16 v[32:35], a[32:35], v[136:139], v[32:35]
  v_mfma_f32_16x16x32_bf16 v[36:39], a[96:99], v[136:139], v[36:39]
  v_mfma_f32_16x16x32_bf16 v[40:43], a[160:163], v[136:139], v[40:43]
  v_mfma_f32_16x16x32_bf16 v[44:47], a[224:227], v[136:139], v[44:47]
  v_mfma_f32_16x16x32_bf16 v[60:63], a[224:227], v[140:143], v[60:63]
  v_mfma_f32_16x16x32_bf16 v[56:59], a[160:163], v[140:143], v[56:59]
  v_mfma_f32_16x16x32_bf16 v[52:55], a[96:99], v[140:143], v[52:55]
  v_mfma_f32_16x16x32_bf16 v[48:51], a[32:35], v[140:143], v[48:51]
  s_waitcnt lgkmcnt(0)
  v_mfma_f32_16x16x32_bf16 v[0:3], a[36:39], v[144:147], v[0:3]
  ds_read_b128 v[128:131], v194 offset:32768
  v_mfma_f32_16x16x32_bf16 v[4:7], a[100:103], v[144:147], v[4:7]
  v_mfma_f32_16x16x32_bf16 v[8:11], a[164:167], v[144:147], v[8:11]
  v_mfma_f32_16x16x32_bf16 v[12:15], a[228:231], v[144:147], v[12:15]
  ds_read_b128 v[132:135], v198 offset:32768
  v_mfma_f32_16x16x32_bf16 v[28:31], a[228:231], v[148:151], v[28:31]
  ds_read_b128 v[136:139], v194 offset:40960
  v_mfma_f32_16x16x32_bf16 v[24:27], a[164:167], v[148:151], v[24:27]
  v_mfma_f32_16x16x32_bf16 v[20:23], a[100:103], v[148:151], v[20:23]
  v_mfma_f32_16x16x32_bf16 v[16:19], a[36:39], v[148:151], v[16:19]
  ds_read_b128 v[140:143], v198 offset:40960
  v_mfma_f32_16x16x32_bf16 v[32:35], a[36:39], v[152:155], v[32:35]
  v_mfma_f32_16x16x32_bf16 v[36:39], a[100:103], v[152:155], v[36:39]
  v_mfma_f32_16x16x32_bf16 v[40:43], a[164:167], v[152:155], v[40:43]
  v_mfma_f32_16x16x32_bf16 v[44:47], a[228:231], v[152:155], v[44:47]
  v_mfma_f32_16x16x32_bf16 v[60:63], a[228:231], v[156:159], v[60:63]
  v_mfma_f32_16x16x32_bf16 v[56:59], a[164:167], v[156:159], v[56:59]
  v_mfma_f32_16x16x32_bf16 v[52:55], a[100:103], v[156:159], v[52:55]
  v_mfma_f32_16x16x32_bf16 v[48:51], a[36:39], v[156:159], v[48:51]
  s_waitcnt lgkmcnt(0)
  v_mfma_f32_16x16x32_bf16 v[0:3], a[40:43], v[128:131], v[0:3]
  ds_read_b128 v[144:147], v195 offset:32768
  v_mfma_f32_16x16x32_bf16 v[4:7], a[104:107], v[128:131], v[4:7]
  v_mfma_f32_16x16x32_bf16 v[8:11], a[168:171], v[128:131], v[8:11]
  v_mfma_f32_16x16x32_bf16 v[12:15], a[232:235], v[128:131], v[12:15]
  ds_read_b128 v[148:151], v199 offset:32768
  v_mfma_f32_16x16x32_bf16 v[28:31], a[232:235], v[132:135], v[28:31]
  ds_read_b128 v[152:155], v195 offset:40960
  v_mfma_f32_16x16x32_bf16 v[24:27], a[168:171], v[132:135], v[24:27]
  v_mfma_f32_16x16x32_bf16 v[20:23], a[104:107], v[132:135], v[20:23]
  v_mfma_f32_16x16x32_bf16 v[16:19], a[40:43], v[132:135], v[16:19]
  ds_read_b128 v[156:159], v199 offset:40960
  v_mfma_f32_16x16x32_bf16 v[32:35], a[40:43], v[136:139], v[32:35]
  v_mfma_f32_16x16x32_bf16 v[36:39], a[104:107], v[136:139], v[36:39]
  v_mfma_f32_16x16x32_bf16 v[40:43], a[168:171], v[136:139], v[40:43]
  v_mfma_f32_16x16x32_bf16 v[44:47], a[232:235], v[136:139], v[44:47]
  v_mfma_f32_16x16x32_bf16 v[60:63], a[232:235], v[140:143], v[60:63]
  v_mfma_f32_16x16x32_bf16 v[56:59], a[168:171], v[140:143], v[56:59]
  v_mfma_f32_16x16x32_bf16 v[52:55], a[104:107], v[140:143], v[52:55]
  v_mfma_f32_16x16x32_bf16 v[48:51], a[40:43], v[140:143], v[48:51]
  s_waitcnt vmcnt(32)
  s_barrier
  s_waitcnt lgkmcnt(0)
  v_mfma_f32_16x16x32_bf16 v[0:3], a[44:47], v[144:147], v[0:3]
  ds_read_b128 v[128:131], v192 offset:49152
  v_mfma_f32_16x16x32_bf16 v[4:7], a[108:111], v[144:147], v[4:7]
  s_add_u32 m0, s67, 0x4000
  s_add_u32 s68, s62, 0x100
  v_mfma_f32_16x16x32_bf16 v[8:11], a[172:175], v[144:147], v[8:11]
  buffer_load_dwordx4 v208, s[48:51], s68 offen offset:0  lds
  v_mfma_f32_16x16x32_bf16 v[12:15], a[236:239], v[144:147], v[12:15]
  ds_read_b128 v[132:135], v196 offset:49152
  v_mfma_f32_16x16x32_bf16 v[28:31], a[236:239], v[148:151], v[28:31]
  ds_read_b128 v[136:139], v192 offset:57344
  v_mfma_f32_16x16x32_bf16 v[24:27], a[172:175], v[148:151], v[24:27]
  v_mfma_f32_16x16x32_bf16 v[20:23], a[108:111], v[148:151], v[20:23]
  buffer_load_dwordx4 v209, s[48:51], s68 offen offset:1024  lds
  v_mfma_f32_16x16x32_bf16 v[16:19], a[44:47], v[148:151], v[16:19]
  ds_read_b128 v[140:143], v196 offset:57344
  v_mfma_f32_16x16x32_bf16 v[32:35], a[44:47], v[152:155], v[32:35]
  v_mfma_f32_16x16x32_bf16 v[36:39], a[108:111], v[152:155], v[36:39]
  v_mfma_f32_16x16x32_bf16 v[40:43], a[172:175], v[152:155], v[40:43]
  buffer_load_dwordx4 v210, s[48:51], s68 offen offset:2048  lds
  v_mfma_f32_16x16x32_bf16 v[44:47], a[236:239], v[152:155], v[44:47]
  v_mfma_f32_16x16x32_bf16 v[60:63], a[236:239], v[156:159], v[60:63]
  v_mfma_f32_16x16x32_bf16 v[56:59], a[172:175], v[156:159], v[56:59]
  v_mfma_f32_16x16x32_bf16 v[52:55], a[108:111], v[156:159], v[52:55]
  buffer_load_dwordx4 v211, s[48:51], s68 offen offset:3072  lds
  v_mfma_f32_16x16x32_bf16 v[48:51], a[44:47], v[156:159], v[48:51]
  s_waitcnt lgkmcnt(0)
  v_mfma_f32_16x16x32_bf16 v[0:3], a[48:51], v[128:131], v[0:3]
  ds_read_b128 v[144:147], v193 offset:49152
  v_mfma_f32_16x16x32_bf16 v[4:7], a[112:115], v[128:131], v[4:7]
  v_mfma_f32_16x16x32_bf16 v[8:11], a[176:179], v[128:131], v[8:11]
  v_mfma_f32_16x16x32_bf16 v[12:15], a[240:243], v[128:131], v[12:15]
  ds_read_b128 v[148:151], v197 offset:49152
  v_mfma_f32_16x16x32_bf16 v[28:31], a[240:243], v[132:135], v[28:31]
  ds_read_b128 v[152:155], v193 offset:57344
  v_mfma_f32_16x16x32_bf16 v[24:27], a[176:179], v[132:135], v[24:27]
  v_mfma_f32_16x16x32_bf16 v[20:23], a[112:115], v[132:135], v[20:23]
  v_mfma_f32_16x16x32_bf16 v[16:19], a[48:51], v[132:135], v[16:19]
  ds_read_b128 v[156:159], v197 offset:57344
  v_mfma_f32_16x16x32_bf16 v[32:35], a[48:51], v[136:139], v[32:35]
  v_mfma_f32_16x16x32_bf16 v[36:39], a[112:115], v[136:139], v[36:39]
  v_mfma_f32_16x16x32_bf16 v[40:43], a[176:179], v[136:139], v[40:43]
  v_mfma_f32_16x16x32_bf16 v[44:47], a[240:243], v[136:139], v[44:47]
  v_mfma_f32_16x16x32_bf16 v[60:63], a[240:243], v[140:143], v[60:63]
  v_mfma_f32_16x16x32_bf16 v[56:59], a[176:179], v[140:143], v[56:59]
  v_mfma_f32_16x16x32_bf16 v[52:55], a[112:115], v[140:143], v[52:55]
  v_mfma_f32_16x16x32_bf16 v[48:51], a[48:51], v[140:143], v[48:51]
  s_waitcnt lgkmcnt(0)
  v_mfma_f32_16x16x32_bf16 v[0:3], a[52:55], v[144:147], v[0:3]
  ds_read_b128 v[128:131], v194 offset:49152
  v_mfma_f32_16x16x32_bf16 v[4:7], a[116:119], v[144:147], v[4:7]
  v_mfma_f32_16x16x32_bf16 v[8:11], a[180:183], v[144:147], v[8:11]
  v_mfma_f32_16x16x32_bf16 v[12:15], a[244:247], v[144:147], v[12:15]
  ds_read_b128 v[132:135], v198 offset:49152
  v_mfma_f32_16x16x32_bf16 v[28:31], a[244:247], v[148:151], v[28:31]
  ds_read_b128 v[136:139], v194 offset:57344
  v_mfma_f32_16x16x32_bf16 v[24:27], a[180:183], v[148:151], v[24:27]
  v_mfma_f32_16x16x32_bf16 v[20:23], a[116:119], v[148:151], v[20:23]
  v_mfma_f32_16x16x32_bf16 v[16:19], a[52:55], v[148:151], v[16:19]
  ds_read_b128 v[140:143], v198 offset:57344
  v_mfma_f32_16x16x32_bf16 v[32:35], a[52:55], v[152:155], v[32:35]
  v_mfma_f32_16x16x32_bf16 v[36:39], a[116:119], v[152:155], v[36:39]
  v_mfma_f32_16x16x32_bf16 v[40:43], a[180:183], v[152:155], v[40:43]
  v_mfma_f32_16x16x32_bf16 v[44:47], a[244:247], v[152:155], v[44:47]
  v_mfma_f32_16x16x32_bf16 v[60:63], a[244:247], v[156:159], v[60:63]
  v_mfma_f32_16x16x32_bf16 v[56:59], a[180:183], v[156:159], v[56:59]
  v_mfma_f32_16x16x32_bf16 v[52:55], a[116:119], v[156:159], v[52:55]
  v_mfma_f32_16x16x32_bf16 v[48:51], a[52:55], v[156:159], v[48:51]
  s_waitcnt lgkmcnt(0)
  v_mfma_f32_16x16x32_bf16 v[0:3], a[56:59], v[128:131], v[0:3]
  ds_read_b128 v[144:147], v195 offset:49152
  v_mfma_f32_16x16x32_bf16 v[4:7], a[120:123], v[128:131], v[4:7]
  v_mfma_f32_16x16x32_bf16 v[8:11], a[184:187], v[128:131], v[8:11]
  v_mfma_f32_16x16x32_bf16 v[12:15], a[248:251], v[128:131], v[12:15]
  ds_read_b128 v[148:151], v199 offset:49152
  v_mfma_f32_16x16x32_bf16 v[28:31], a[248:251], v[132:135], v[28:31]
  ds_read_b128 v[152:155], v195 offset:57344
  v_mfma_f32_16x16x32_bf16 v[24:27], a[184:187], v[132:135], v[24:27]
  v_mfma_f32_16x16x32_bf16 v[20:23], a[120:123], v[132:135], v[20:23]
  v_mfma_f32_16x16x32_bf16 v[16:19], a[56:59], v[132:135], v[16:19]
  ds_read_b128 v[156:159], v199 offset:57344
  v_mfma_f32_16x16x32_bf16 v[32:35], a[56:59], v[136:139], v[32:35]
  v_mfma_f32_16x16x32_bf16 v[36:39], a[120:123], v[136:139], v[36:39]
  v_mfma_f32_16x16x32_bf16 v[40:43], a[184:187], v[136:139], v[40:43]
  v_mfma_f32_16x16x32_bf16 v[44:47], a[248:251], v[136:139], v[44:47]
  v_mfma_f32_16x16x32_bf16 v[60:63], a[248:251], v[140:143], v[60:63]
  v_mfma_f32_16x16x32_bf16 v[56:59], a[184:187], v[140:143], v[56:59]
  v_mfma_f32_16x16x32_bf16 v[52:55], a[120:123], v[140:143], v[52:55]
  v_mfma_f32_16x16x32_bf16 v[48:51], a[56:59], v[140:143], v[48:51]
  s_waitcnt vmcnt(28)
  s_barrier
  s_waitcnt lgkmcnt(0)
  v_mfma_f32_16x16x32_bf16 v[0:3], a[60:63], v[144:147], v[0:3]
  ds_read_b128 v[128:131], v200 offset:0
  v_mfma_f32_16x16x32_bf16 v[4:7], a[124:127], v[144:147], v[4:7]
  s_add_u32 m0, s67, 0x8000
  s_add_u32 s68, s62, 0x200
  v_mfma_f32_16x16x32_bf16 v[8:11], a[188:191], v[144:147], v[8:11]
  buffer_load_dwordx4 v208, s[48:51], s68 offen offset:0  lds
  v_mfma_f32_16x16x32_bf16 v[12:15], a[252:255], v[144:147], v[12:15]
  ds_read_b128 v[132:135], v204 offset:0
  v_mfma_f32_16x16x32_bf16 v[28:31], a[252:255], v[148:151], v[28:31]
  ds_read_b128 v[136:139], v200 offset:8192
  v_mfma_f32_16x16x32_bf16 v[24:27], a[188:191], v[148:151], v[24:27]
  v_mfma_f32_16x16x32_bf16 v[20:23], a[124:127], v[148:151], v[20:23]
  buffer_load_dwordx4 v209, s[48:51], s68 offen offset:1024  lds
  v_mfma_f32_16x16x32_bf16 v[16:19], a[60:63], v[148:151], v[16:19]
  ds_read_b128 v[140:143], v204 offset:8192
  v_mfma_f32_16x16x32_bf16 v[32:35], a[60:63], v[152:155], v[32:35]
  v_mfma_f32_16x16x32_bf16 v[36:39], a[124:127], v[152:155], v[36:39]
  v_mfma_f32_16x16x32_bf16 v[40:43], a[188:191], v[152:155], v[40:43]
  buffer_load_dwordx4 v210, s[48:51], s68 offen offset:2048  lds
  v_mfma_f32_16x16x32_bf16 v[44:47], a[252:255], v[152:155], v[44:47]
  v_mfma_f32_16x16x32_bf16 v[60:63], a[252:255], v[156:159], v[60:63]
  v_mfma_f32_16x16x32_bf16 v[56:59], a[188:191], v[156:159], v[56:59]
  v_mfma_f32_16x16x32_bf16 v[52:55], a[124:127], v[156:159], v[52:55]
  buffer_load_dwordx4 v211, s[48:51], s68 offen offset:3072  lds
  v_mfma_f32_16x16x32_bf16 v[48:51], a[60:63], v[156:159], v[48:51]
  s_waitcnt lgkmcnt(0)
  v_mfma_f32_16x16x32_bf16 v[64:67], a[0:3], v[128:131], 0
  ds_read_b128 v[144:147], v201 offset:0
  v_mfma_f32_16x16x32_bf16 v[68:71], a[64:67], v[128:131], 0
  v_mfma_f32_16x16x32_bf16 v[72:75], a[128:131], v[128:131], 0
  v_mfma_f32_16x16x32_bf16 v[76:79], a[192:195], v[128:131], 0
  ds_read_b128 v[148:151], v205 offset:0
  v_mul_f32 v160, s65, v0
  v_mul_f32 v161, s65, v1
  v_mfma_f32_16x16x32_bf16 v[92:95], a[192:195], v[132:135], 0
  ds_read_b128 v[152:155], v201 offset:8192
  v_mul_f32 v162, s65, v2
  v_mul_f32 v163, s65, v3
  v_mfma_f32_16x16x32_bf16 v[88:91], a[128:131], v[132:135], 0
  v_mul_f32 v164, s65, v4
  v_mul_f32 v165, s65, v5
  v_mfma_f32_16x16x32_bf16 v[84:87], a[64:67], v[132:135], 0
  v_mul_f32 v166, s65, v6
  v_mul_f32 v167, s65, v7
  v_mfma_f32_16x16x32_bf16 v[80:83], a[0:3], v[132:135], 0
  ds_read_b128 v[156:159], v205 offset:8192
  v_cvt_pk_bf16_f32 v160, v160, v161
  v_cvt_pk_bf16_f32 v161, v162, v163
  v_mfma_f32_16x16x32_bf16 v[96:99], a[0:3], v[136:139], 0
  v_cvt_pk_bf16_f32 v162, v164, v165
  v_cvt_pk_bf16_f32 v163, v166, v167
  v_mfma_f32_16x16x32_bf16 v[100:103], a[64:67], v[136:139], 0
  buffer_store_dwordx4 v[160:163], v212, s[36:39], s63 offen offset:0 sc1
  v_mul_f32 v168, s65, v8
  v_mfma_f32_16x16x32_bf16 v[104:107], a[128:131], v[136:139], 0
  v_mul_f32 v169, s65, v9
  v_mul_f32 v170, s65, v10
  v_mfma_f32_16x16x32_bf16 v[108:111], a[192:195], v[136:139], 0
  v_mfma_f32_16x16x32_bf16 v[124:127], a[192:195], v[140:143], 0
  v_mfma_f32_16x16x32_bf16 v[120:123], a[128:131], v[140:143], 0
  v_mul_f32 v171, s65, v11
  v_mul_f32 v172, s65, v12
  v_mfma_f32_16x16x32_bf16 v[116:119], a[64:67], v[140:143], 0
  v_mul_f32 v173, s65, v13
  v_mul_f32 v174, s65, v14
  v_mfma_f32_16x16x32_bf16 v[112:115], a[0:3], v[140:143], 0
  s_waitcnt lgkmcnt(0)
  v_mfma_f32_16x16x32_bf16 v[64:67], a[4:7], v[144:147], v[64:67]
  ds_read_b128 v[128:131], v202 offset:0
  v_mfma_f32_16x16x32_bf16 v[68:71], a[68:71], v[144:147], v[68:71]
  v_mul_f32 v175, s65, v15
  v_cvt_pk_bf16_f32 v168, v168, v169
  v_mfma_f32_16x16x32_bf16 v[72:75], a[132:135], v[144:147], v[72:75]
  v_cvt_pk_bf16_f32 v169, v170, v171
  v_cvt_pk_bf16_f32 v170, v172, v173
  v_mfma_f32_16x16x32_bf16 v[76:79], a[196:199], v[144:147], v[76:79]
  ds_read_b128 v[132:135], v206 offset:0
  v_mfma_f32_16x16x32_bf16 v[92:95], a[196:199], v[148:151], v[92:95]
  ds_read_b128 v[136:139], v202 offset:8192
  v_mfma_f32_16x16x32_bf16 v[88:91], a[132:135], v[148:151], v[88:91]
  v_cvt_pk_bf16_f32 v171, v174, v175
  buffer_store_dwordx4 v[168:171], v212, s[36:39], s63 offen offset:2048 sc1
  v_mfma_f32_16x16x32_bf16 v[84:87], a[68:71], v[148:151], v[84:87]
  v_mul_f32 v176, s65, v16
  v_mul_f32 v177, s65, v17
  v_mfma_f32_16x16x32_bf16 v[80:83], a[4:7], v[148:151], v[80:83]
  ds_read_b128 v[140:143], v206 offset:8192
  v_mfma_f32_16x16x32_bf16 v[96:99], a[4:7], v[152:155], v[96:99]
  v_mfma_f32_16x16x32_bf16 v[100:103], a[68:71], v[152:155], v[100:103]
  v_mul_f32 v178, s65, v18
  v_mul_f32 v179, s65, v19
  v_mfma_f32_16x16x32_bf16 v[104:107], a[132:135], v[152:155], v[104:107]
  v_mul_f32 v180, s65, v20
  v_mul_f32 v181, s65, v21
  v_mfma_f32_16x16x32_bf16 v[108:111], a[196:199], v[152:155], v[108:111]
  v_mfma_f32_16x16x32_bf16 v[124:127], a[196:199], v[156:159], v[124:127]
  v_mfma_f32_16x16x32_bf16 v[120:123], a[132:135], v[156:159], v[120:123]
  v_mul_f32 v182, s65, v22
  v_mul_f32 v183, s65, v23
  v_mfma_f32_16x16x32_bf16 v[116:119], a[68:71], v[156:159], v[116:119]
  v_cvt_pk_bf16_f32 v176, v176, v177
  v_cvt_pk_bf16_f32 v177, v178, v179
  v_mfma_f32_16x16x32_bf16 v[112:115], a[4:7], v[156:159], v[112:115]
  s_waitcnt lgkmcnt(0)
  v_mfma_f32_16x16x32_bf16 v[64:67], a[8:11], v[128:131], v[64:67]
  ds_read_b128 v[144:147], v203 offset:0
  v_mfma_f32_16x16x32_bf16 v[68:71], a[72:75], v[128:131], v[68:71]
  v_cvt_pk_bf16_f32 v178, v180, v181
  v_cvt_pk_bf16_f32 v179, v182, v183
  v_mfma_f32_16x16x32_bf16 v[72:75], a[136:139], v[128:131], v[72:75]
  buffer_store_dwordx4 v[176:179], v212, s[36:39], s63 offen offset:256 sc1
  v_mul_f32 v184, s65, v24
  v_mfma_f32_16x16x32_bf16 v[76:79], a[200:203], v[128:131], v[76:79]
  ds_read_b128 v[148:151], v207 offset:0
  v_mfma_f32_16x16x32_bf16 v[92:95], a[200:203], v[132:135], v[92:95]
  ds_read_b128 v[152:155], v203 offset:8192
  v_mfma_f32_16x16x32_bf16 v[88:91], a[136:139], v[132:135], v[88:91]
  v_mul_f32 v185, s65, v25
  v_mul_f32 v186, s65, v26
  v_mfma_f32_16x16x32_bf16 v[84:87], a[72:75], v[132:135], v[84:87]
  v_mul_f32 v187, s65, v27
  v_mul_f32 v188, s65, v28
  v_mfma_f32_16x16x32_bf16 v[80:83], a[8:11], v[132:135], v[80:83]
  ds_read_b128 v[156:159], v207 offset:8192
  v_mfma_f32_16x16x32_bf16 v[96:99], a[8:11], v[136:139], v[96:99]
  v_mfma_f32_16x16x32_bf16 v[100:103], a[72:75], v[136:139], v[100:103]
  v_mul_f32 v189, s65, v29
  v_mul_f32 v190, s65, v30
  v_mfma_f32_16x16x32_bf16 v[104:107], a[136:139], v[136:139], v[104:107]
  v_mul_f32 v191, s65, v31
  v_cvt_pk_bf16_f32 v184, v184, v185
  v_mfma_f32_16x16x32_bf16 v[108:111], a[200:203], v[136:139], v[108:111]
  v_mfma_f32_16x16x32_bf16 v[124:127], a[200:203], v[140:143], v[124:127]
  v_mfma_f32_16x16x32_bf16 v[120:123], a[136:139], v[140:143], v[120:123]
  v_cvt_pk_bf16_f32 v185, v186, v187
  v_cvt_pk_bf16_f32 v186, v188, v189
  v_mfma_f32_16x16x32_bf16 v[116:119], a[72:75], v[140:143], v[116:119]
  v_cvt_pk_bf16_f32 v187, v190, v191
  buffer_store_dwordx4 v[184:187], v212, s[36:39], s63 offen offset:2304 sc1
  v_mfma_f32_16x16x32_bf16 v[112:115], a[8:11], v[140:143], v[112:115]
  s_waitcnt vmcnt(16)
  s_barrier
  s_cmp_lg_u32 s40, 0
  s_cbranch_scc1 Lg_23
  s_cmp_lt_i32 s70, s71
  s_cbranch_scc1 Lg_23
  s_cmp_lg_u32 s101, 0
  s_cbranch_scc1 Li_27
  v_readfirstlane_b32 s101, v252
  s_nop 0
  s_cmp_lg_u32 s101, 0
  s_cbranch_scc1 Li_27
Li_26:
  buffer_load_dword v252, off, s[84:87], 0 offset:144 sc1
  s_waitcnt vmcnt(0)
  v_readfirstlane_b32 s101, v252
  s_add_u32 s91, s91, 1
  s_cmp_gt_u32 s91, 0x20000
  s_cbranch_scc1 L_abort
  s_cmp_eq_u32 s101, 0
  s_cbranch_scc1 Li_26
Li_27:
  s_cmp_lg_u32 s56, 0
  s_cbranch_scc1 Lg_24
  s_lshl_b32 s41, s57, 3
  s_lshl_b32 s41, 1, s41
  s_mov_b64 exec, 1
  s_add_u32 s42, s70, 1
  s_lshl_b32 s42, s42, 1
  v_mov_b32 v249, s42
  s_add_u32 s42, s58, 168
  s_lshl_b32 s42, s42, 7
  s_cmp_lg_u32 s57, 0
  s_cselect_b32 s42, 0x10000000, s42
  buffer_store_dword v249, v253, s[36:39], s42 offen sc1
  s_add_u32 s42, s70, 136
  s_branch Lg_25
Lg_24:
  s_and_b32 s41, s70, 3
  s_cmp_lg_u32 s41, 3
  s_cbranch_scc1 Lg_23
  s_lshr_b32 s41, s70, 2
  s_lshl_b32 s42, s57, 3
  s_add_u32 s41, s41, s42
  s_lshl_b32 s41, 1, s41
  s_lshl_b32 s42, s58, s57
  s_add_u32 s42, s42, 32
  s_lshl_b32 s43, s57, 1
  s_add_u32 exec_lo, s43, 1
  s_mov_b32 exec_hi, 0
Lg_25:
  s_lshl_b32 s42, s42, 7
  v_mov_b32 v250, s41
  buffer_atomic_add v250, v253, s[36:39], s42 offen
  s_mov_b64 exec, -1
Lg_23:
  s_add_u32 s70, s70, 1
  s_waitcnt lgkmcnt(0)
  v_mfma_f32_16x16x32_bf16 v[64:67], a[12:15], v[144:147], v[64:67]
  ds_read_b128 v[128:131], v200 offset:16384
  v_mfma_f32_16x16x32_bf16 v[68:71], a[76:79], v[144:147], v[68:71]
  s_add_u32 m0, s67, 0xc000
  s_add_u32 s68, s62, 0x300
  v_mfma_f32_16x16x32_bf16 v[72:75], a[140:143], v[144:147], v[72:75]
  buffer_load_dwordx4 v208, s[48:51], s68 offen offset:0  lds
  v_mfma_f32_16x16x32_bf16 v[76:79], a[204:207], v[144:147], v[76:79]
  ds_read_b128 v[132:135], v204 offset:16384
  v_mfma_f32_16x16x32_bf16 v[92:95], a[204:207], v[148:151], v[92:95]
  ds_read_b128 v[136:139], v200 offset:24576
  v_mfma_f32_16x16x32_bf16 v[88:91], a[140:143], v[148:151], v[88:91]
  v_mfma_f32_16x16x32_bf16 v[84:87], a[76:79], v[148:151], v[84:87]
  buffer_load_dwordx4 v209, s[48:51], s68 offen offset:1024  lds
  v_mfma_f32_16x16x32_bf16 v[80:83], a[12:15], v[148:151], v[80:83]
  ds_read_b128 v[140:143], v204 offset:24576
  v_mfma_f32_16x16x32_bf16 v[96:99], a[12:15], v[152:155], v[96:99]
  v_mfma_f32_16x16x32_bf16 v[100:103], a[76:79], v[152:155], v[100:103]
  v_mfma_f32_16x16x32_bf16 v[104:107], a[140:143], v[152:155], v[104:107]
  buffer_load_dwordx4 v210, s[48:51], s68 offen offset:2048  lds
  v_mfma_f32_16x16x32_bf16 v[108:111], a[204:207], v[152:155], v[108:111]
  v_mfma_f32_16x16x32_bf16 v[124:127], a[204:207], v[156:159], v[124:127]
  v_mfma_f32_16x16x32_bf16 v[120:123], a[140:143], v[156:159], v[120:123]
  v_mfma_f32_16x16x32_bf16 v[116:119], a[76:79], v[156:159], v[116:119]
  buffer_load_dwordx4 v211, s[48:51], s68 offen offset:3072  lds
  v_mfma_f32_16x16x32_bf16 v[112:115], a[12:15], v[156:159], v[112:115]
  s_waitcnt lgkmcnt(0)
  v_mfma_f32_16x16x32_bf16 v[64:67], a[16:19], v[128:131], v[64:67]
  ds_read_b128 v[144:147], v201 offset:16384
  v_mul_f32 v160, s65, v32
  v_mul_f32 v161, s65, v33
  v_mfma_f32_16x16x32_bf16 v[68:71], a[80:83], v[128:131], v[68:71]
  v_mul_f32 v162, s65, v34
  v_mul_f32 v163, s65, v35
  v_mfma_f32_16x16x32_bf16 v[72:75], a[144:147], v[128:131], v[72:75]
  v_mul_f32 v164, s65, v36
  v_mul_f32 v165, s65, v37
  v_mfma_f32_16x16x32_bf16 v[76:79], a[208:211], v[128:131], v[76:79]
  ds_read_b128 v[148:151], v205 offset:16384
  v_mul_f32 v166, s65, v38
  v_mul_f32 v167, s65, v39
  v_mfma_f32_16x16x32_bf16 v[92:95], a[208:211], v[132:135], v[92:95]
  ds_read_b128 v[152:155], v201 offset:24576
  v_mfma_f32_16x16x32_bf16 v[88:91], a[144:147], v[132:135], v[88:91]
  v_cvt_pk_bf16_f32 v160, v160, v161
  v_cvt_pk_bf16_f32 v161, v162, v163
  v_mfma_f32_16x16x32_bf16 v[84:87], a[80:83], v[132:135], v[84:87]
  v_cvt_pk_bf16_f32 v162, v164, v165
  v_cvt_pk_bf16_f32 v163, v166, v167
  v_mfma_f32_16x16x32_bf16 v[80:83], a[16:19], v[132:135], v[80:83]
  ds_read_b128 v[156:159], v205 offset:24576
  v_mfma_f32_16x16x32_bf16 v[96:99], a[16:19], v[136:139], v[96:99]
  v_mfma_f32_16x16x32_bf16 v[100:103], a[80:83], v[136:139], v[100:103]
  buffer_store_dwordx4 v[160:163], v213, s[36:39], s63 offen offset:0 sc1
  v_mul_f32 v168, s65, v40
  v_mfma_f32_16x16x32_bf16 v[104:107], a[144:147], v[136:139], v[104:107]
  v_mul_f32 v169, s65, v41
  v_mul_f32 v170, s65, v42
  v_mfma_f32_16x16x32_bf16 v[108:111], a[208:211], v[136:139], v[108:111]
  v_mfma_f32_16x16x32_bf16 v[124:127], a[208:211], v[140:143], v[124:127]
  v_mfma_f32_16x16x32_bf16 v[120:123], a[144:147], v[140:143], v[120:123]
  v_mul_f32 v171, s65, v43
  v_mul_f32 v172, s65, v44
  v_mfma_f32_16x16x32_bf16 v[116:119], a[80:83], v[140:143], v[116:119]
  v_mul_f32 v173, s65, v45
  v_mul_f32 v174, s65, v46
  v_mfma_f32_16x16x32_bf16 v[112:115], a[16:19], v[140:143], v[112:115]
  s_waitcnt lgkmcnt(0)
  v_mfma_f32_16x16x32_bf16 v[64:67], a[20:23], v[144:147], v[64:67]
  ds_read_b128 v[128:131], v202 offset:16384
  v_mfma_f32_16x16x32_bf16 v[68:71], a[84:87], v[144:147], v[68:71]
  v_mul_f32 v175, s65, v47
  v_cvt_pk_bf16_f32 v168, v168, v169
  v_mfma_f32_16x16x32_bf16 v[72:75], a[148:151], v[144:147], v[72:75]
  v_cvt_pk_bf16_f32 v169, v170, v171
  v_cvt_pk_bf16_f32 v170, v172, v173
  v_mfma_f32_16x16x32_bf16 v[76:79], a[212:215], v[144:147], v[76:79]
  ds_read_b128 v[132:135], v206 offset:16384
  v_mfma_f32_16x16x32_bf16 v[92:95], a[212:215], v[148:151], v[92:95]
  ds_read_b128 v[136:139], v202 offset:24576
  v_mfma_f32_16x16x32_bf16 v[88:91], a[148:151], v[148:151], v[88:91]
  v_cvt_pk_bf16_f32 v171, v174, v175
  buffer_store_dwordx4 v[168:171], v213, s[36:39], s63 offen offset:2048 sc1
  v_mfma_f32_16x16x32_bf16 v[84:87], a[84:87], v[148:151], v[84:87]
  v_mul_f32 v176, s65, v48
  v_mul_f32 v177, s65, v49
  v_mfma_f32_16x16x32_bf16 v[80:83], a[20:23], v[148:151], v[80:83]
  ds_read_b128 v[140:143], v206 offset:24576
  v_mfma_f32_16x16x32_bf16 v[96:99], a[20:23], v[152:155], v[96:99]
  v_mfma_f32_16x16x32_bf16 v[100:103], a[84:87], v[152:155], v[100:103]
  v_mul_f32 v178, s65, v50
  v_mul_f32 v179, s65, v51
  v_mfma_f32_16x16x32_bf16 v[104:107], a[148:151], v[152:155], v[104:107]
  v_mul_f32 v180, s65, v52
  v_mul_f32 v181, s65, v53
  v_mfma_f32_16x16x32_bf16 v[108:111], a[212:215], v[152:155], v[108:111]
  v_mfma_f32_16x16x32_bf16 v[124:127], a[212:215], v[156:159], v[124:127]
  v_mfma_f32_16x16x32_bf16 v[120:123], a[148:151], v[156:159], v[120:123]
  v_mul_f32 v182, s65, v54
  v_mul_f32 v183, s65, v55
  v_mfma_f32_16x16x32_bf16 v[116:119], a[84:87], v[156:159], v[116:119]
  v_cvt_pk_bf16_f32 v176, v176, v177
  v_cvt_pk_bf16_f32 v177, v178, v179
  v_mfma_f32_16x16x32_bf16 v[112:115], a[20:23], v[156:159], v[112:115]
  s_waitcnt lgkmcnt(0)
  v_mfma_f32_16x16x32_bf16 v[64:67], a[24:27], v[128:131], v[64:67]
  ds_read_b128 v[144:147], v203 offset:16384
  v_mfma_f32_16x16x32_bf16 v[68:71], a[88:91], v[128:131], v[68:71]
  v_cvt_pk_bf16_f32 v178, v180, v181
  v_cvt_pk_bf16_f32 v179, v182, v183
  v_mfma_f32_16x16x32_bf16 v[72:75], a[152:155], v[128:131], v[72:75]
  buffer_store_dwordx4 v[176:179], v213, s[36:39], s63 offen offset:256 sc1
  v_mul_f32 v184, s65, v56
  v_mfma_f32_16x16x32_bf16 v[76:79], a[216:219], v[128:131], v[76:79]
  ds_read_b128 v[148:151], v207 offset:16384
  v_mfma_f32_16x16x32_bf16 v[92:95], a[216:219], v[132:135], v[92:95]
  ds_read_b128 v[152:155], v203 offset:24576
  v_mfma_f32_16x16x32_bf16 v[88:91], a[152:155], v[132:135], v[88:91]
  v_mul_f32 v185, s65, v57
  v_mul_f32 v186, s65, v58
  v_mfma_f32_16x16x32_bf16 v[84:87], a[88:91], v[132:135], v[84:87]
  v_mul_f32 v187, s65, v59
  v_mul_f32 v188, s65, v60
  v_mfma_f32_16x16x32_bf16 v[80:83], a[24:27], v[132:135], v[80:83]
  ds_read_b128 v[156:159], v207 offset:24576
  v_mfma_f32_16x16x32_bf16 v[96:99], a[24:27], v[136:139], v[96:99]
  v_mfma_f32_16x16x32_bf16 v[100:103], a[88:91], v[136:139], v[100:103]
  v_mul_f32 v189, s65, v61
  v_mul_f32 v190, s65, v62
  v_mfma_f32_16x16x32_bf16 v[104:107], a[152:155], v[136:139], v[104:107]
  v_mul_f32 v191, s65, v63
  v_cvt_pk_bf16_f32 v184, v184, v185
  v_mfma_f32_16x16x32_bf16 v[108:111], a[216:219], v[136:139], v[108:111]
  v_mfma_f32_16x16x32_bf16 v[124:127], a[216:219], v[140:143], v[124:127]
  v_mfma_f32_16x16x32_bf16 v[120:123], a[152:155], v[140:143], v[120:123]
  v_cvt_pk_bf16_f32 v185, v186, v187
  v_cvt_pk_bf16_f32 v186, v188, v189
  v_mfma_f32_16x16x32_bf16 v[116:119], a[88:91], v[140:143], v[116:119]
  v_cvt_pk_bf16_f32 v187, v190, v191
  buffer_store_dwordx4 v[184:187], v213, s[36:39], s63 offen offset:2304 sc1
  v_mfma_f32_16x16x32_bf16 v[112:115], a[24:27], v[140:143], v[112:115]
  s_waitcnt vmcnt(36)
  s_barrier
  s_waitcnt lgkmcnt(0)
  v_mfma_f32_16x16x32_bf16 v[64:67], a[28:31], v[144:147], v[64:67]
  ds_read_b128 v[128:131], v200 offset:32768
  v_mfma_f32_16x16x32_bf16 v[68:71], a[92:95], v[144:147], v[68:71]
  s_add_u32 m0, s67, 0x10000
  s_add_u32 s68, s62, 0x10000
  v_mfma_f32_16x16x32_bf16 v[72:75], a[156:159], v[144:147], v[72:75]
  buffer_load_dwordx4 v208, s[48:51], s68 offen offset:0  lds
  v_mfma_f32_16x16x32_bf16 v[76:79], a[220:223], v[144:147], v[76:79]
  ds_read_b128 v[132:135], v204 offset:32768
  v_mfma_f32_16x16x32_bf16 v[92:95], a[220:223], v[148:151], v[92:95]
  ds_read_b128 v[136:139], v200 offset:40960
  v_mfma_f32_16x16x32_bf16 v[88:91], a[156:159], v[148:151], v[88:91]
  v_mfma_f32_16x16x32_bf16 v[84:87], a[92:95], v[148:151], v[84:87]
  buffer_load_dwordx4 v209, s[48:51], s68 offen offset:1024  lds
  v_mfma_f32_16x16x32_bf16 v[80:83], a[28:31], v[148:151], v[80:83]
  ds_read_b128 v[140:143], v204 offset:40960
  v_mfma_f32_16x16x32_bf16 v[96:99], a[28:31], v[152:155], v[96:99]
  v_mfma_f32_16x16x32_bf16 v[100:103], a[92:95], v[152:155], v[100:103]
  v_mfma_f32_16x16x32_bf16 v[104:107], a[156:159], v[152:155], v[104:107]
  buffer_load_dwordx4 v210, s[48:51], s68 offen offset:2048  lds
  v_mfma_f32_16x16x32_bf16 v[108:111], a[220:223], v[152:155], v[108:111]
  v_mfma_f32_16x16x32_bf16 v[124:127], a[220:223], v[156:159], v[124:127]
  v_mfma_f32_16x16x32_bf16 v[120:123], a[156:159], v[156:159], v[120:123]
  v_mfma_f32_16x16x32_bf16 v[116:119], a[92:95], v[156:159], v[116:119]
  buffer_load_dwordx4 v211, s[48:51], s68 offen offset:3072  lds
  v_mfma_f32_16x16x32_bf16 v[112:115], a[28:31], v[156:159], v[112:115]
  s_waitcnt lgkmcnt(0)
  v_mfma_f32_16x16x32_bf16 v[64:67], a[32:35], v[128:131], v[64:67]
  ds_read_b128 v[144:147], v201 offset:32768
  v_mfma_f32_16x16x32_bf16 v[68:71], a[96:99], v[128:131], v[68:71]
  v_mfma_f32_16x16x32_bf16 v[72:75], a[160:163], v[128:131], v[72:75]
  v_mfma_f32_16x16x32_bf16 v[76:79], a[224:227], v[128:131], v[76:79]
  ds_read_b128 v[148:151], v205 offset:32768
  v_mfma_f32_16x16x32_bf16 v[92:95], a[224:227], v[132:135], v[92:95]
  ds_read_b128 v[152:155], v201 offset:40960
  v_mfma_f32_16x16x32_bf16 v[88:91], a[160:163], v[132:135], v[88:91]
  v_mfma_f32_16x16x32_bf16 v[84:87], a[96:99], v[132:135], v[84:87]
  v_mfma_f32_16x16x32_bf16 v[80:83], a[32:35], v[132:135], v[80:83]
  ds_read_b128 v[156:159], v205 offset:40960
  v_mfma_f32_16x16x32_bf16 v[96:99], a[32:35], v[136:139], v[96:99]
  v_mfma_f32_16x16x32_bf16 v[100:103], a[96:99], v[136:139], v[100:103]
  v_mfma_f32_16x16x32_bf16 v[104:107], a[160:163], v[136:139], v[104:107]
  v_mfma_f32_16x16x32_bf16 v[108:111], a[224:227], v[136:139], v[108:111]
  v_mfma_f32_16x16x32_bf16 v[124:127], a[224:227], v[140:143], v[124:127]
  v_mfma_f32_16x16x32_bf16 v[120:123], a[160:163], v[140:143], v[120:123]
  v_mfma_f32_16x16x32_bf16 v[116:119], a[96:99], v[140:143], v[116:119]
  v_mfma_f32_16x16x32_bf16 v[112:115], a[32:35], v[140:143], v[112:115]
  s_waitcnt lgkmcnt(0)
  v_mfma_f32_16x16x32_bf16 v[64:67], a[36:39], v[144:147], v[64:67]
  ds_read_b128 v[128:131], v202 offset:32768
  v_mfma_f32_16x16x32_bf16 v[68:71], a[100:103], v[144:147], v[68:71]
  v_mfma_f32_16x16x32_bf16 v[72:75], a[164:167], v[144:147], v[72:75]
  v_mfma_f32_16x16x32_bf16 v[76:79], a[228:231], v[144:147], v[76:79]
  ds_read_b128 v[132:135], v206 offset:32768
  v_mfma_f32_16x16x32_bf16 v[92:95], a[228:231], v[148:151], v[92:95]
  ds_read_b128 v[136:139], v202 offset:40960
  v_mfma_f32_16x16x32_bf16 v[88:91], a[164:167], v[148:151], v[88:91]
  v_mfma_f32_16x16x32_bf16 v[84:87], a[100:103], v[148:151], v[84:87]
  v_mfma_f32_16x16x32_bf16 v[80:83], a[36:39], v[148:151], v[80:83]
  ds_read_b128 v[140:143], v206 offset:40960
  v_mfma_f32_16x16x32_bf16 v[96:99], a[36:39], v[152:155], v[96:99]
  v_mfma_f32_16x16x32_bf16 v[100:103], a[100:103], v[152:155], v[100:103]
  v_mfma_f32_16x16x32_bf16 v[104:107], a[164:167], v[152:155], v[104:107]
  v_mfma_f32_16x16x32_bf16 v[108:111], a[228:231], v[152:155], v[108:111]
  v_mfma_f32_16x16x32_bf16 v[124:127], a[228:231], v[156:159], v[124:127]
  v_mfma_f32_16x16x32_bf16 v[120:123], a[164:167], v[156:159], v[120:123]
  v_mfma_f32_16x16x32_bf16 v[116:119], a[100:103], v[156:159], v[116:119]
  v_mfma_f32_16x16x32_bf16 v[112:115], a[36:39], v[156:159], v[112:115]
  s_waitcnt lgkmcnt(0)
  v_mfma_f32_16x16x32_bf16 v[64:67], a[40:43], v[128:131], v[64:67]
  ds_read_b128 v[144:147], v203 offset:32768
  v_mfma_f32_16x16x32_bf16 v[68:71], a[104:107], v[128:131], v[68:71]
  v_mfma_f32_16x16x32_bf16 v[72:75], a[168:171], v[128:131], v[72:75]
  v_mfma_f32_16x16x32_bf16 v[76:79], a[232:235], v[128:131], v[76:79]
  ds_read_b128 v[148:151], v207 offset:32768
  v_mfma_f32_16x16x32_bf16 v[92:95], a[232:235], v[132:135], v[92:95]
  ds_read_b128 v[152:155], v203 offset:40960
  v_mfma_f32_16x16x32_bf16 v[88:91], a[168:171], v[132:135], v[88:91]
  v_mfma_f32_16x16x32_bf16 v[84:87], a[104:107], v[132:135], v[84:87]
  v_mfma_f32_16x16x32_bf16 v[80:83], a[40:43], v[132:135], v[80:83]
  ds_read_b128 v[156:159], v207 offset:40960
  v_mfma_f32_16x16x32_bf16 v[96:99], a[40:43], v[136:139], v[96:99]
  v_mfma_f32_16x16x32_bf16 v[100:103], a[104:107], v[136:139], v[100:103]
  v_mfma_f32_16x16x32_bf16 v[104:107], a[168:171], v[136:139], v[104:107]
  v_mfma_f32_16x16x32_bf16 v[108:111], a[232:235], v[136:139], v[108:111]
  v_mfma_f32_16x16x32_bf16 v[124:127], a[232:235], v[140:143], v[124:127]
  v_mfma_f32_16x16x32_bf16 v[120:123], a[168:171], v[140:143], v[120:123]
  v_mfma_f32_16x16x32_bf16 v[116:119], a[104:107], v[140:143], v[116:119]
  v_mfma_f32_16x16x32_bf16 v[112:115], a[40:43], v[140:143], v[112:115]
  s_waitcnt vmcnt(32)
  s_barrier
  s_waitcnt lgkmcnt(0)
  v_mfma_f32_16x16x32_bf16 v[64:67], a[44:47], v[144:147], v[64:67]
  ds_read_b128 v[128:131], v200 offset:49152
  v_mfma_f32_16x16x32_bf16 v[68:71], a[108:111], v[144:147], v[68:71]
  s_add_u32 m0, s67, 0x14000
  s_add_u32 s68, s62, 0x10100
  v_mfma_f32_16x16x32_bf16 v[72:75], a[172:175], v[144:147], v[72:75]
  buffer_load_dwordx4 v208, s[48:51], s68 offen offset:0  lds
  v_mfma_f32_16x16x32_bf16 v[76:79], a[236:239], v[144:147], v[76:79]
  ds_read_b128 v[132:135], v204 offset:49152
  v_mfma_f32_16x16x32_bf16 v[92:95], a[236:239], v[148:151], v[92:95]
  ds_read_b128 v[136:139], v200 offset:57344
  v_mfma_f32_16x16x32_bf16 v[88:91], a[172:175], v[148:151], v[88:91]
  v_mfma_f32_16x16x32_bf16 v[84:87], a[108:111], v[148:151], v[84:87]
  buffer_load_dwordx4 v209, s[48:51], s68 offen offset:1024  lds
  v_mfma_f32_16x16x32_bf16 v[80:83], a[44:47], v[148:151], v[80:83]
  ds_read_b128 v[140:143], v204 offset:57344
  v_mfma_f32_16x16x32_bf16 v[96:99], a[44:47], v[152:155], v[96:99]
  v_mfma_f32_16x16x32_bf16 v[100:103], a[108:111], v[152:155], v[100:103]
  v_mfma_f32_16x16x32_bf16 v[104:107], a[172:175], v[152:155], v[104:107]
  buffer_load_dwordx4 v210, s[48:51], s68 offen offset:2048  lds
  v_mfma_f32_16x16x32_bf16 v[108:111], a[236:239], v[152:155], v[108:111]
  v_mfma_f32_16x16x32_bf16 v[124:127], a[236:239], v[156:159], v[124:127]
  v_mfma_f32_16x16x32_bf16 v[120:123], a[172:175], v[156:159], v[120:123]
  v_mfma_f32_16x16x32_bf16 v[116:119], a[108:111], v[156:159], v[116:119]
  buffer_load_dwordx4 v211, s[48:51], s68 offen offset:3072  lds
  v_mfma_f32_16x16x32_bf16 v[112:115], a[44:47], v[156:159], v[112:115]
  s_waitcnt lgkmcnt(0)
  v_mfma_f32_16x16x32_bf16 v[64:67], a[48:51], v[128:131], v[64:67]
  ds_read_b128 v[144:147], v201 offset:49152
  v_mfma_f32_16x16x32_bf16 v[68:71], a[112:115], v[128:131], v[68:71]
  v_mfma_f32_16x16x32_bf16 v[72:75], a[176:179], v[128:131], v[72:75]
  v_mfma_f32_16x16x32_bf16 v[76:79], a[240:243], v[128:131], v[76:79]
  ds_read_b128 v[148:151], v205 offset:49152
  v_mfma_f32_16x16x32_bf16 v[92:95], a[240:243], v[132:135], v[92:95]
  ds_read_b128 v[152:155], v201 offset:57344
  v_mfma_f32_16x16x32_bf16 v[88:91], a[176:179], v[132:135], v[88:91]
  v_mfma_f32_16x16x32_bf16 v[84:87], a[112:115], v[132:135], v[84:87]
  v_mfma_f32_16x16x32_bf16 v[80:83], a[48:51], v[132:135], v[80:83]
  ds_read_b128 v[156:159], v205 offset:57344
  v_mfma_f32_16x16x32_bf16 v[96:99], a[48:51], v[136:139], v[96:99]
  v_mfma_f32_16x16x32_bf16 v[100:103], a[112:115], v[136:139], v[100:103]
  v_mfma_f32_16x16x32_bf16 v[104:107], a[176:179], v[136:139], v[104:107]
  v_mfma_f32_16x16x32_bf16 v[108:111], a[240:243], v[136:139], v[108:111]
  v_mfma_f32_16x16x32_bf16 v[124:127], a[240:243], v[140:143], v[124:127]
  v_mfma_f32_16x16x32_bf16 v[120:123], a[176:179], v[140:143], v[120:123]
  v_mfma_f32_16x16x32_bf16 v[116:119], a[112:115], v[140:143], v[116:119]
  v_mfma_f32_16x16x32_bf16 v[112:115], a[48:51], v[140:143], v[112:115]
  s_waitcnt lgkmcnt(0)
  v_mfma_f32_16x16x32_bf16 v[64:67], a[52:55], v[144:147], v[64:67]
  ds_read_b128 v[128:131], v202 offset:49152
  v_mfma_f32_16x16x32_bf16 v[68:71], a[116:119], v[144:147], v[68:71]
  v_mfma_f32_16x16x32_bf16 v[72:75], a[180:183], v[144:147], v[72:75]
  v_mfma_f32_16x16x32_bf16 v[76:79], a[244:247], v[144:147], v[76:79]
  ds_read_b128 v[132:135], v206 offset:49152
  v_mfma_f32_16x16x32_bf16 v[92:95], a[244:247], v[148:151], v[92:95]
  ds_read_b128 v[136:139], v202 offset:57344
  v_mfma_f32_16x16x32_bf16 v[88:91], a[180:183], v[148:151], v[88:91]
  v_mfma_f32_16x16x32_bf16 v[84:87], a[116:119], v[148:151], v[84:87]
  v_mfma_f32_16x16x32_bf16 v[80:83], a[52:55], v[148:151], v[80:83]
  ds_read_b128 v[140:143], v206 offset:57344
  v_mfma_f32_16x16x32_bf16 v[96:99], a[52:55], v[152:155], v[96:99]
  v_mfma_f32_16x16x32_bf16 v[100:103], a[116:119], v[152:155], v[100:103]
  v_mfma_f32_16x16x32_bf16 v[104:107], a[180:183], v[152:155], v[104:107]
  v_mfma_f32_16x16x32_bf16 v[108:111], a[244:247], v[152:155], v[108:111]
  v_mfma_f32_16x16x32_bf16 v[124:127], a[244:247], v[156:159], v[124:127]
  v_mfma_f32_16x16x32_bf16 v[120:123], a[180:183], v[156:159], v[120:123]
  v_mfma_f32_16x16x32_bf16 v[116:119], a[116:119], v[156:159], v[116:119]
  v_mfma_f32_16x16x32_bf16 v[112:115], a[52:55], v[156:159], v[112:115]
  s_waitcnt lgkmcnt(0)
  v_mfma_f32_16x16x32_bf16 v[64:67], a[56:59], v[128:131], v[64:67]
  ds_read_b128 v[144:147], v203 offset:49152
  v_mfma_f32_16x16x32_bf16 v[68:71], a[120:123], v[128:131], v[68:71]
  v_mfma_f32_16x16x32_bf16 v[72:75], a[184:187], v[128:131], v[72:75]
  v_mfma_f32_16x16x32_bf16 v[76:79], a[248:251], v[128:131], v[76:79]
  ds_read_b128 v[148:151], v207 offset:49152
  v_mfma_f32_16x16x32_bf16 v[92:95], a[248:251], v[132:135], v[92:95]
  ds_read_b128 v[152:155], v203 offset:57344
  v_mfma_f32_16x16x32_bf16 v[88:91], a[184:187], v[132:135], v[88:91]
  v_mfma_f32_16x16x32_bf16 v[84:87], a[120:123], v[132:135], v[84:87]
  v_mfma_f32_16x16x32_bf16 v[80:83], a[56:59], v[132:135], v[80:83]
  ds_read_b128 v[156:159], v207 offset:57344
  v_mfma_f32_16x16x32_bf16 v[96:99], a[56:59], v[136:139], v[96:99]
  v_mfma_f32_16x16x32_bf16 v[100:103], a[120:123], v[136:139], v[100:103]
  v_mfma_f32_16x16x32_bf16 v[104:107], a[184:187], v[136:139], v[104:107]
  v_mfma_f32_16x16x32_bf16 v[108:111], a[248:251], v[136:139], v[108:111]
  v_mfma_f32_16x16x32_bf16 v[124:127], a[248:251], v[140:143], v[124:127]
  v_mfma_f32_16x16x32_bf16 v[120:123], a[184:187], v[140:143], v[120:123]
  v_mfma_f32_16x16x32_bf16 v[116:119], a[120:123], v[140:143], v[116:119]
  v_mfma_f32_16x16x32_bf16 v[112:115], a[56:59], v[140:143], v[112:115]
  s_waitcnt vmcnt(28)
  s_barrier
  s_waitcnt lgkmcnt(0)
  v_mfma_f32_16x16x32_bf16 v[64:67], a[60:63], v[144:147], v[64:67]
  ds_read_b128 v[128:131], v192 offset:0
  v_mfma_f32_16x16x32_bf16 v[68:71], a[124:127], v[144:147], v[68:71]
  s_add_u32 m0, s67, 0x18000
  s_add_u32 s68, s62, 0x10200
  v_mfma_f32_16x16x32_bf16 v[72:75], a[188:191], v[144:147], v[72:75]
  buffer_load_dwordx4 v208, s[48:51], s68 offen offset:0  lds
  v_mfma_f32_16x16x32_bf16 v[76:79], a[252:255], v[144:147], v[76:79]
  ds_read_b128 v[132:135], v196 offset:0
  v_mfma_f32_16x16x32_bf16 v[92:95], a[252:255], v[148:151], v[92:95]
  ds_read_b128 v[136:139], v192 offset:8192
  v_mfma_f32_16x16x32_bf16 v[88:91], a[188:191], v[148:151], v[88:91]
  v_mfma_f32_16x16x32_bf16 v[84:87], a[124:127], v[148:151], v[84:87]
  buffer_load_dwordx4 v209, s[48:51], s68 offen offset:1024  lds
  v_mfma_f32_16x16x32_bf16 v[80:83], a[60:63], v[148:151], v[80:83]
  ds_read_b128 v[140:143], v196 offset:8192
  v_mfma_f32_16x16x32_bf16 v[96:99], a[60:63], v[152:155], v[96:99]
  v_mfma_f32_16x16x32_bf16 v[100:103], a[124:127], v[152:155], v[100:103]
  v_mfma_f32_16x16x32_bf16 v[104:107], a[188:191], v[152:155], v[104:107]
  buffer_load_dwordx4 v210, s[48:51], s68 offen offset:2048  lds
  v_mfma_f32_16x16x32_bf16 v[108:111], a[252:255], v[152:155], v[108:111]
  v_mfma_f32_16x16x32_bf16 v[124:127], a[252:255], v[156:159], v[124:127]
  v_mfma_f32_16x16x32_bf16 v[120:123], a[188:191], v[156:159], v[120:123]
  v_mfma_f32_16x16x32_bf16 v[116:119], a[124:127], v[156:159], v[116:119]
  buffer_load_dwordx4 v211, s[48:51], s68 offen offset:3072  lds
  v_mfma_f32_16x16x32_bf16 v[112:115], a[60:63], v[156:159], v[112:115]
  s_branch PJ_bend
PJ_b2:
  s_waitcnt lgkmcnt(0)
  v_mfma_f32_16x16x32_bf16 v[0:3], a[0:3], v[128:131], 0
  ds_read_b128 v[144:147], v193 offset:0
  v_mfma_f32_16x16x32_bf16 v[4:7], a[64:67], v[128:131], 0
  v_mfma_f32_16x16x32_bf16 v[8:11], a[128:131], v[128:131], 0
  v_mfma_f32_16x16x32_bf16 v[12:15], a[192:195], v[128:131], 0
  ds_read_b128 v[148:151], v197 offset:0
  v_mfma_f32_16x16x32_bf16 v[28:31], a[192:195], v[132:135], 0
  ds_read_b128 v[152:155], v193 offset:8192
  v_mfma_f32_16x16x32_bf16 v[24:27], a[128:131], v[132:135], 0
  v_cvt_pk_bf16_f32 v160, v64, v65
  v_mfma_f32_16x16x32_bf16 v[20:23], a[64:67], v[132:135], 0
  v_cvt_pk_bf16_f32 v161, v66, v67
  v_mfma_f32_16x16x32_bf16 v[16:19], a[0:3], v[132:135], 0
  ds_read_b128 v[156:159], v197 offset:8192
  v_mfma_f32_16x16x32_bf16 v[32:35], a[0:3], v[136:139], 0
  v_mfma_f32_16x16x32_bf16 v[36:39], a[64:67], v[136:139], 0
  v_cvt_pk_bf16_f32 v162, v68, v69
  v_mfma_f32_16x16x32_bf16 v[40:43], a[128:131], v[136:139], 0
  v_cvt_pk_bf16_f32 v163, v70, v71
  v_mfma_f32_16x16x32_bf16 v[44:47], a[192:195], v[136:139], 0
  v_mfma_f32_16x16x32_bf16 v[60:63], a[192:195], v[140:143], 0
  v_mfma_f32_16x16x32_bf16 v[56:59], a[128:131], v[140:143], 0
  buffer_store_dwordx4 v[160:163], v212, s[36:39], s64 offen offset:0 sc1
  v_mfma_f32_16x16x32_bf16 v[52:55], a[64:67], v[140:143], 0
  v_cvt_pk_bf16_f32 v168, v72, v73
  v_mfma_f32_16x16x32_bf16 v[48:51], a[0:3], v[140:143], 0
  s_waitcnt lgkmcnt(0)
  v_mfma_f32_16x16x32_bf16 v[0:3], a[4:7], v[144:147], v[0:3]
  ds_read_b128 v[128:131], v194 offset:0
  v_mfma_f32_16x16x32_bf16 v[4:7], a[68:71], v[144:147], v[4:7]
  v_cvt_pk_bf16_f32 v169, v74, v75
  v_mfma_f32_16x16x32_bf16 v[8:11], a[132:135], v[144:147], v[8:11]
  v_cvt_pk_bf16_f32 v170, v76, v77
  v_mfma_f32_16x16x32_bf16 v[12:15], a[196:199], v[144:147], v[12:15]
  ds_read_b128 v[132:135], v198 offset:0
  v_mfma_f32_16x16x32_bf16 v[28:31], a[196:199], v[148:151], v[28:31]
  ds_read_b128 v[136:139], v194 offset:8192
  v_mfma_f32_16x16x32_bf16 v[24:27], a[132:135], v[148:151], v[24:27]
  v_cvt_pk_bf16_f32 v171, v78, v79
  v_mfma_f32_16x16x32_bf16 v[20:23], a[68:71], v[148:151], v[20:23]
  buffer_store_dwordx4 v[168:171], v212, s[36:39], s64 offen offset:2048 sc1
  v_mfma_f32_16x16x32_bf16 v[16:19], a[4:7], v[148:151], v[16:19]
  ds_read_b128 v[140:143], v198 offset:8192
  v_mfma_f32_16x16x32_bf16 v[32:35], a[4:7], v[152:155], v[32:35]
  v_mfma_f32_16x16x32_bf16 v[36:39], a[68:71], v[152:155], v[36:39]
  v_cvt_pk_bf16_f32 v176, v80, v81
  v_mfma_f32_16x16x32_bf16 v[40:43], a[132:135], v[152:155], v[40:43]
  v_cvt_pk_bf16_f32 v177, v82, v83
  v_mfma_f32_16x16x32_bf16 v[44:47], a[196:199], v[152:155], v[44:47]
  v_mfma_f32_16x16x32_bf16 v[60:63], a[196:199], v[156:159], v[60:63]
  v_mfma_f32_16x16x32_bf16 v[56:59], a[132:135], v[156:159], v[56:59]
  v_cvt_pk_bf16_f32 v178, v84, v85
  v_mfma_f32_16x16x32_bf16 v[52:55], a[68:71], v[156:159], v[52:55]
  v_cvt_pk_bf16_f32 v179, v86, v87
  v_mfma_f32_16x16x32_bf16 v[48:51], a[4:7], v[156:159], v[48:51]
  s_waitcnt lgkmcnt(0)
  v_mfma_f32_16x16x32_bf16 v[0:3], a[8:11], v[128:131], v[0:3]
  ds_read_b128 v[144:147], v195 offset:0
  v_mfma_f32_16x16x32_bf16 v[4:7], a[72:75], v[128:131], v[4:7]
  buffer_store_dwordx4 v[176:179], v212, s[36:39], s64 offen offset:256 sc1
  v_mfma_f32_16x16x32_bf16 v[8:11], a[136:139], v[128:131], v[8:11]
  v_cvt_pk_bf16_f32 v184, v88, v89
  v_mfma_f32_16x16x32_bf16 v[12:15], a[200:203], v[128:131], v[12:15]
  ds_read_b128 v[148:151], v199 offset:0
  v_mfma_f32_16x16x32_bf16 v[28:31], a[200:203], v[132:135], v[28:31]
  ds_read_b128 v[152:155], v195 offset:8192
  v_mfma_f32_16x16x32_bf16 v[24:27], a[136:139], v[132:135], v[24:27]
  v_cvt_pk_bf16_f32 v185, v90, v91
  v_mfma_f32_16x16x32_bf16 v[20:23], a[72:75], v[132:135], v[20:23]
  v_cvt_pk_bf16_f32 v186, v92, v93
  v_mfma_f32_16x16x32_bf16 v[16:19], a[8:11], v[132:135], v[16:19]
  ds_read_b128 v[156:159], v199 offset:8192
  v_mfma_f32_16x16x32_bf16 v[32:35], a[8:11], v[136:139], v[32:35]
  v_mfma_f32_16x16x32_bf16 v[36:39], a[72:75], v[136:139], v[36:39]
  v_cvt_pk_bf16_f32 v187, v94, v95
  v_mfma_f32_16x16x32_bf16 v[40:43], a[136:139], v[136:139], v[40:43]
  buffer_store_dwordx4 v[184:187], v212, s[36:39], s64 offen offset:2304 sc1
  v_mfma_f32_16x16x32_bf16 v[44:47], a[200:203], v[136:139], v[44:47]
  v_mfma_f32_16x16x32_bf16 v[60:63], a[200:203], v[140:143], v[60:63]
  v_mfma_f32_16x16x32_bf16 v[56:59], a[136:139], v[140:143], v[56:59]
  v_mfma_f32_16x16x32_bf16 v[52:55], a[72:75], v[140:143], v[52:55]
  v_mfma_f32_16x16x32_bf16 v[48:51], a[8:11], v[140:143], v[48:51]
  s_waitcnt vmcnt(16)
  s_barrier
  s_cmp_lg_u32 s40, 0
  s_cbranch_scc1 Lg_28
  s_cmp_lt_i32 s70, s71
  s_cbranch_scc1 Lg_28
  s_cmp_lg_u32 s101, 0
  s_cbranch_scc1 Li_32
  v_readfirstlane_b32 s101, v252
  s_nop 0
  s_cmp_lg_u32 s101, 0
  s_cbranch_scc1 Li_32
Li_31:
  buffer_load_dword v252, off, s[84:87], 0 offset:144 sc1
  s_waitcnt vmcnt(0)
  v_readfirstlane_b32 s101, v252
  s_add_u32 s91, s91, 1
  s_cmp_gt_u32 s91, 0x20000
  s_cbranch_scc1 L_abort
  s_cmp_eq_u32 s101, 0
  s_cbranch_scc1 Li_31
Li_32:
  s_cmp_lg_u32 s56, 0
  s_cbranch_scc1 Lg_29
  s_lshl_b32 s41, s57, 3
  s_lshl_b32 s41, 1, s41
  s_mov_b64 exec, 1
  s_add_u32 s42, s70, 1
  s_lshl_b32 s42, s42, 1
  v_mov_b32 v249, s42
  s_add_u32 s42, s58, 168
  s_lshl_b32 s42, s42, 7
  s_cmp_lg_u32 s57, 0
  s_cselect_b32 s42, 0x10000000, s42
  buffer_store_dword v249, v253, s[36:39], s42 offen sc1
  s_add_u32 s42, s70, 136
  s_branch Lg_30
Lg_29:
  s_and_b32 s41, s70, 3
  s_cmp_lg_u32 s41, 3
  s_cbranch_scc1 Lg_28
  s_lshr_b32 s41, s70, 2
  s_lshl_b32 s42, s57, 3
  s_add_u32 s41, s41, s42
  s_lshl_b32 s41, 1, s41
  s_lshl_b32 s42, s58, s57
  s_add_u32 s42, s42, 32
  s_lshl_b32 s43, s57, 1
  s_add_u32 exec_lo, s43, 1
  s_mov_b32 exec_hi, 0
Lg_30:
  s_lshl_b32 s42, s42, 7
  v_mov_b32 v250, s41
  buffer_atomic_add v250, v253, s[36:39], s42 offen
  s_mov_b64 exec, -1
Lg_28:
  s_add_u32 s70, s70, 1
  s_waitcnt lgkmcnt(0)
  v_mfma_f32_16x16x32_bf16 v[0:3], a[12:15], v[144:147], v[0:3]
  ds_read_b128 v[128:131], v192 offset:16384
  v_mfma_f32_16x16x32_bf16 v[4:7], a[76:79], v[144:147], v[4:7]
  s_add_u32 m0, s67, 0x1c000
  s_add_u32 s68, s61, 0x10300
  v_mfma_f32_16x16x32_bf16 v[8:11], a[140:143], v[144:147], v[8:11]
  buffer_load_dwordx4 v208, s[48:51], s68 offen offset:0  lds
  v_mfma_f32_16x16x32_bf16 v[12:15], a[204:207], v[144:147], v[12:15]
  ds_read_b128 v[132:135], v196 offset:16384
  v_mfma_f32_16x16x32_bf16 v[28:31], a[204:207], v[148:151], v[28:31]
  ds_read_b128 v[136:139], v192 offset:24576
  v_mfma_f32_16x16x32_bf16 v[24:27], a[140:143], v[148:151], v[24:27]
  v_mfma_f32_16x16x32_bf16 v[20:23], a[76:79], v[148:151], v[20:23]
  buffer_load_dwordx4 v209, s[48:51], s68 offen offset:1024  lds
  v_mfma_f32_16x16x32_bf16 v[16:19], a[12:15], v[148:151], v[16:19]
  ds_read_b128 v[140:143], v196 offset:24576
  v_mfma_f32_16x16x32_bf16 v[32:35], a[12:15], v[152:155], v[32:35]
  v_mfma_f32_16x16x32_bf16 v[36:39], a[76:79], v[152:155], v[36:39]
  v_mfma_f32_16x16x32_bf16 v[40:43], a[140:143], v[152:155], v[40:43]
  buffer_load_dwordx4 v210, s[48:51], s68 offen offset:2048  lds
  v_mfma_f32_16x16x32_bf16 v[44:47], a[204:207], v[152:155], v[44:47]
  v_mfma_f32_16x16x32_bf16 v[60:63], a[204:207], v[156:159], v[60:63]
  v_mfma_f32_16x16x32_bf16 v[56:59], a[140:143], v[156:159], v[56:59]
  v_mfma_f32_16x16x32_bf16 v[52:55], a[76:79], v[156:159], v[52:55]
  buffer_load_dwordx4 v211, s[48:51], s68 offen offset:3072  lds
  v_mfma_f32_16x16x32_bf16 v[48:51], a[12:15], v[156:159], v[48:51]
  s_waitcnt lgkmcnt(0)
  v_mfma_f32_16x16x32_bf16 v[0:3], a[16:19], v[128:131], v[0:3]
  ds_read_b128 v[144:147], v193 offset:16384
  v_mfma_f32_16x16x32_bf16 v[4:7], a[80:83], v[128:131], v[4:7]
  v_cvt_pk_bf16_f32 v160, v96, v97
  v_mfma_f32_16x16x32_bf16 v[8:11], a[144:147], v[128:131], v[8:11]
  v_cvt_pk_bf16_f32 v161, v98, v99
  v_mfma_f32_16x16x32_bf16 v[12:15], a[208:211], v[128:131], v[12:15]
  ds_read_b128 v[148:151], v197 offset:16384
  v_mfma_f32_16x16x32_bf16 v[28:31], a[208:211], v[132:135], v[28:31]
  ds_read_b128 v[152:155], v193 offset:24576
  v_mfma_f32_16x16x32_bf16 v[24:27], a[144:147], v[132:135], v[24:27]
  v_cvt_pk_bf16_f32 v162, v100, v101
  v_mfma_f32_16x16x32_bf16 v[20:23], a[80:83], v[132:135], v[20:23]
  v_cvt_pk_bf16_f32 v163, v102, v103
  v_mfma_f32_16x16x32_bf16 v[16:19], a[16:19], v[132:135], v[16:19]
  ds_read_b128 v[156:159], v197 offset:24576
  v_mfma_f32_16x16x32_bf16 v[32:35], a[16:19], v[136:139], v[32:35]
  v_mfma_f32_16x16x32_bf16 v[36:39], a[80:83], v[136:139], v[36:39]
  buffer_store_dwordx4 v[160:163], v213, s[36:39], s64 offen offset:0 sc1
  v_mfma_f32_16x16x32_bf16 v[40:43], a[144:147], v[136:139], v[40:43]
  v_cvt_pk_bf16_f32 v168, v104, v105
  v_mfma_f32_16x16x32_bf16 v[44:47], a[208:211], v[136:139], v[44:47]
  v_mfma_f32_16x16x32_bf16 v[60:63], a[208:211], v[140:143], v[60:63]
  v_mfma_f32_16x16x32_bf16 v[56:59], a[144:147], v[140:143], v[56:59]
  v_cvt_pk_bf16_f32 v169, v106, v107
  v_mfma_f32_16x16x32_bf16 v[52:55], a[80:83], v[140:143], v[52:55]
  v_cvt_pk_bf16_f32 v170, v108, v109
  v_mfma_f32_16x16x32_bf16 v[48:51], a[16:19], v[140:143], v[48:51]
  s_waitcnt lgkmcnt(0)
  v_mfma_f32_16x16x32_bf16 v[0:3], a[20:23], v[144:147], v[0:3]
  ds_read_b128 v[128:131], v194 offset:16384
  v_mfma_f32_16x16x32_bf16 v[4:7], a[84:87], v[144:147], v[4:7]
  v_cvt_pk_bf16_f32 v171, v110, v111
  v_mfma_f32_16x16x32_bf16 v[8:11], a[148:151], v[144:147], v[8:11]
  buffer_store_dwordx4 v[168:171], v213, s[36:39], s64 offen offset:2048 sc1
  v_mfma_f32_16x16x32_bf16 v[12:15], a[212:215], v[144:147], v[12:15]
  ds_read_b128 v[132:135], v198 offset:16384
  v_mfma_f32_16x16x32_bf16 v[28:31], a[212:215], v[148:151], v[28:31]
  ds_read_b128 v[136:139], v194 offset:24576
  v_mfma_f32_16x16x32_bf16 v[24:27], a[148:151], v[148:151], v[24:27]
  v_cvt_pk_bf16_f32 v176, v112, v113
  v_mfma_f32_16x16x32_bf16 v[20:23], a[84:87], v[148:151], v[20:23]
  v_cvt_pk_bf16_f32 v177, v114, v115
  v_mfma_f32_16x16x32_bf16 v[16:19], a[20:23], v[148:151], v[16:19]
  ds_read_b128 v[140:143], v198 offset:24576
  v_mfma_f32_16x16x32_bf16 v[32:35], a[20:23], v[152:155], v[32:35]
  v_mfma_f32_16x16x32_bf16 v[36:39], a[84:87], v[152:155], v[36:39]
  v_cvt_pk_bf16_f32 v178, v116, v117
  v_mfma_f32_16x16x32_bf16 v[40:43], a[148:151], v[152:155], v[40:43]
  v_cvt_pk_bf16_f32 v179, v118, v119
  v_mfma_f32_16x16x32_bf16 v[44:47], a[212:215], v[152:155], v[44:47]
  v_mfma_f32_16x16x32_bf16 v[60:63], a[212:215], v[156:159], v[60:63]
  v_mfma_f32_16x16x32_bf16 v[56:59], a[148:151], v[156:159], v[56:59]
  buffer_store_dwordx4 v[176:179], v213, s[36:39], s64 offen offset:256 sc1
  v_mfma_f32_16x16x32_bf16 v[52:55], a[84:87], v[156:159], v[52:55]
  v_cvt_pk_bf16_f32 v184, v120, v121
  v_mfma_f32_16x16x32_bf16 v[48:51], a[20:23], v[156:159], v[48:51]
  s_waitcnt lgkmcnt(0)
  v_mfma_f32_16x16x32_bf16 v[0:3], a[24:27], v[128:131], v[0:3]
  ds_read_b128 v[144:147], v195 offset:16384
  v_mfma_f32_16x16x32_bf16 v[4:7], a[88:91], v[128:131], v[4:7]
  v_cvt_pk_bf16_f32 v185, v122, v123
  v_mfma_f32_16x16x32_bf16 v[8:11], a[152:155], v[128:131], v[8:11]
  v_cvt_pk_bf16_f32 v186, v124, v125
  v_mfma_f32_16x16x32_bf16 v[12:15], a[216:219], v[128:131], v[12:15]
  ds_read_b128 v[148:151], v199 offset:16384
  v_mfma_f32_16x16x32_bf16 v[28:31], a[216:219], v[132:135], v[28:31]
  ds_read_b128 v[152:155], v195 offset:24576
  v_mfma_f32_16x16x32_bf16 v[24:27], a[152:155], v[132:135], v[24:27]
  v_cvt_pk_bf16_f32 v187, v126, v127
  v_mfma_f32_16x16x32_bf16 v[20:23], a[88:91], v[132:135], v[20:23]
  buffer_store_dwordx4 v[184:187], v213, s[36:39], s64 offen offset:2304 sc1
  v_mfma_f32_16x16x32_bf16 v[16:19], a[24:27], v[132:135], v[16:19]
  ds_read_b128 v[156:159], v199 offset:24576
  v_mfma_f32_16x16x32_bf16 v[32:35], a[24:27], v[136:139], v[32:35]
  v_mfma_f32_16x16x32_bf16 v[36:39], a[88:91], v[136:139], v[36:39]
  v_mfma_f32_16x16x32_bf16 v[40:43], a[152:155], v[136:139], v[40:43]
  v_mfma_f32_16x16x32_bf16 v[44:47], a[216:219], v[136:139], v[44:47]
  v_mfma_f32_16x16x32_bf16 v[60:63], a[216:219], v[140:143], v[60:63]
  v_mfma_f32_16x16x32_bf16 v[56:59], a[152:155], v[140:143], v[56:59]
  v_mfma_f32_16x16x32_bf16 v[52:55], a[88:91], v[140:143], v[52:55]
  v_mfma_f32_16x16x32_bf16 v[48:51], a[24:27], v[140:143], v[48:51]
  s_waitcnt vmcnt(36)
  s_barrier
  s_waitcnt lgkmcnt(0)
  v_mfma_f32_16x16x32_bf16 v[0:3], a[28:31], v[144:147], v[0:3]
  ds_read_b128 v[128:131], v192 offset:32768
  v_mfma_f32_16x16x32_bf16 v[4:7], a[92:95], v[144:147], v[4:7]
  s_add_u32 m0, s67, 0x0
  s_add_u32 s68, s62, 0x0
  v_mfma_f32_16x16x32_bf16 v[8:11], a[156:159], v[144:147], v[8:11]
  buffer_load_dwordx4 v208, s[48:51], s68 offen offset:0  lds
  v_mfma_f32_16x16x32_bf16 v[12:15], a[220:223], v[144:147], v[12:15]
  ds_read_b128 v[132:135], v196 offset:32768
  v_mfma_f32_16x16x32_bf16 v[28:31], a[220:223], v[148:151], v[28:31]
  ds_read_b128 v[136:139], v192 offset:40960
  v_mfma_f32_16x16x32_bf16 v[24:27], a[156:159], v[148:151], v[24:27]
  v_mfma_f32_16x16x32_bf16 v[20:23], a[92:95], v[148:151], v[20:23]
  buffer_load_dwordx4 v209, s[48:51], s68 offen offset:1024  lds
  v_mfma_f32_16x16x32_bf16 v[16:19], a[28:31], v[148:151], v[16:19]
  ds_read_b128 v[140:143], v196 offset:40960
  v_mfma_f32_16x16x32_bf16 v[32:35], a[28:31], v[152:155], v[32:35]
  v_mfma_f32_16x16x32_bf16 v[36:39], a[92:95], v[152:155], v[36:39]
  v_mfma_f32_16x16x32_bf16 v[40:43], a[156:159], v[152:155], v[40:43]
  buffer_load_dwordx4 v210, s[48:51], s68 offen offset:2048  lds
  v_mfma_f32_16x16x32_bf16 v[44:47], a[220:223], v[152:155], v[44:47]
  v_mfma_f32_16x16x32_bf16 v[60:63], a[220:223], v[156:159], v[60:63]
  v_mfma_f32_16x16x32_bf16 v[56:59], a[156:159], v[156:159], v[56:59]
  v_mfma_f32_16x16x32_bf16 v[52:55], a[92:95], v[156:159], v[52:55]
  buffer_load_dwordx4 v211, s[48:51], s68 offen offset:3072  lds
  v_mfma_f32_16x16x32_bf16 v[48:51], a[28:31], v[156:159], v[48:51]
  s_waitcnt lgkmcnt(0)
  v_mfma_f32_16x16x32_bf16 v[0:3], a[32:35], v[128:131], v[0:3]
  ds_read_b128 v[144:147], v193 offset:32768
  v_mfma_f32_16x16x32_bf16 v[4:7], a[96:99], v[128:131], v[4:7]
  v_mfma_f32_16x16x32_bf16 v[8:11], a[160:163], v[128:131], v[8:11]
  v_mfma_f32_16x16x32_bf16 v[12:15], a[224:227], v[128:131], v[12:15]
  ds_read_b128 v[148:151], v197 offset:32768
  v_mfma_f32_16x16x32_bf16 v[28:31], a[224:227], v[132:135], v[28:31]
  ds_read_b128 v[152:155], v193 offset:40960
  v_mfma_f32_16x16x32_bf16 v[24:27], a[160:163], v[132:135], v[24:27]
  v_mfma_f32_16x16x32_bf16 v[20:23], a[96:99], v[132:135], v[20:23]
  v_mfma_f32_16x16x32_bf16 v[16:19], a[32:35], v[132:135], v[16:19]
  ds_read_b128 v[156:159], v197 offset:40960
  v_mfma_f32_16x16x32_bf16 v[32:35], a[32:35], v[136:139], v[32:35]
  v_mfma_f32_16x16x32_bf16 v[36:39], a[96:99], v[136:139], v[36:39]
  v_mfma_f32_16x16x32_bf16 v[40:43], a[160:163], v[136:139], v[40:43]
  v_mfma_f32_16x16x32_bf16 v[44:47], a[224:227], v[136:139], v[44:47]
  v_mfma_f32_16x16x32_bf16 v[60:63], a[224:227], v[140:143], v[60:63]
  v_mfma_f32_16x16x32_bf16 v[56:59], a[160:163], v[140:143], v[56:59]
  v_mfma_f32_16x16x32_bf16 v[52:55], a[96:99], v[140:143], v[52:55]
  v_mfma_f32_16x16x32_bf16 v[48:51], a[32:35], v[140:143], v[48:51]
  s_waitcnt lgkmcnt(0)
  v_mfma_f32_16x16x32_bf16 v[0:3], a[36:39], v[144:147], v[0:3]
  ds_read_b128 v[128:131], v194 offset:32768
  v_mfma_f32_16x16x32_bf16 v[4:7], a[100:103], v[144:147], v[4:7]
  v_mfma_f32_16x16x32_bf16 v[8:11], a[164:167], v[144:147], v[8:11]
  v_mfma_f32_16x16x32_bf16 v[12:15], a[228:231], v[144:147], v[12:15]
  ds_read_b128 v[132:135], v198 offset:32768
  v_mfma_f32_16x16x32_bf16 v[28:31], a[228:231], v[148:151], v[28:31]
  ds_read_b128 v[136:139], v194 offset:40960
  v_mfma_f32_16x16x32_bf16 v[24:27], a[164:167], v[148:151], v[24:27]
  v_mfma_f32_16x16x32_bf16 v[20:23], a[100:103], v[148:151], v[20:23]
  v_mfma_f32_16x16x32_bf16 v[16:19], a[36:39], v[148:151], v[16:19]
  ds_read_b128 v[140:143], v198 offset:40960
  v_mfma_f32_16x16x32_bf16 v[32:35], a[36:39], v[152:155], v[32:35]
  v_mfma_f32_16x16x32_bf16 v[36:39], a[100:103], v[152:155], v[36:39]
  v_mfma_f32_16x16x32_bf16 v[40:43], a[164:167], v[152:155], v[40:43]
  v_mfma_f32_16x16x32_bf16 v[44:47], a[228:231], v[152:155], v[44:47]
  v_mfma_f32_16x16x32_bf16 v[60:63], a[228:231], v[156:159], v[60:63]
  v_mfma_f32_16x16x32_bf16 v[56:59], a[164:167], v[156:159], v[56:59]
  v_mfma_f32_16x16x32_bf16 v[52:55], a[100:103], v[156:159], v[52:55]
  v_mfma_f32_16x16x32_bf16 v[48:51], a[36:39], v[156:159], v[48:51]
  s_waitcnt lgkmcnt(0)
  v_mfma_f32_16x16x32_bf16 v[0:3], a[40:43], v[128:131], v[0:3]
  ds_read_b128 v[144:147], v195 offset:32768
  v_mfma_f32_16x16x32_bf16 v[4:7], a[104:107], v[128:131], v[4:7]
  v_mfma_f32_16x16x32_bf16 v[8:11], a[168:171], v[128:131], v[8:11]
  v_mfma_f32_16x16x32_bf16 v[12:15], a[232:235], v[128:131], v[12:15]
  ds_read_b128 v[148:151], v199 offset:32768
  v_mfma_f32_16x16x32_bf16 v[28:31], a[232:235], v[132:135], v[28:31]
  ds_read_b128 v[152:155], v195 offset:40960
  v_mfma_f32_16x16x32_bf16 v[24:27], a[168:171], v[132:135], v[24:27]
  v_mfma_f32_16x16x32_bf16 v[20:23], a[104:107], v[132:135], v[20:23]
  v_mfma_f32_16x16x32_bf16 v[16:19], a[40:43], v[132:135], v[16:19]
  ds_read_b128 v[156:159], v199 offset:40960
  v_mfma_f32_16x16x32_bf16 v[32:35], a[40:43], v[136:139], v[32:35]
  v_mfma_f32_16x16x32_bf16 v[36:39], a[104:107], v[136:139], v[36:39]
  v_mfma_f32_16x16x32_bf16 v[40:43], a[168:171], v[136:139], v[40:43]
  v_mfma_f32_16x16x32_bf16 v[44:47], a[232:235], v[136:139], v[44:47]
  v_mfma_f32_16x16x32_bf16 v[60:63], a[232:235], v[140:143], v[60:63]
  v_mfma_f32_16x16x32_bf16 v[56:59], a[168:171], v[140:143], v[56:59]
  v_mfma_f32_16x16x32_bf16 v[52:55], a[104:107], v[140:143], v[52:55]
  v_mfma_f32_16x16x32_bf16 v[48:51], a[40:43], v[140:143], v[48:51]
  s_waitcnt vmcnt(32)
  s_barrier
  s_waitcnt lgkmcnt(0)
  v_mfma_f32_16x16x32_bf16 v[0:3], a[44:47], v[144:147], v[0:3]
  ds_read_b128 v[128:131], v192 offset:49152
  v_mfma_f32_16x16x32_bf16 v[4:7], a[108:111], v[144:147], v[4:7]
  s_add_u32 m0, s67, 0x4000
  s_add_u32 s68, s62, 0x100
  v_mfma_f32_16x16x32_bf16 v[8:11], a[172:175], v[144:147], v[8:11]
  buffer_load_dwordx4 v208, s[48:51], s68 offen offset:0  lds
  v_mfma_f32_16x16x32_bf16 v[12:15], a[236:239], v[144:147], v[12:15]
  ds_read_b128 v[132:135], v196 offset:49152
  v_mfma_f32_16x16x32_bf16 v[28:31], a[236:239], v[148:151], v[28:31]
  ds_read_b128 v[136:139], v192 offset:57344
  v_mfma_f32_16x16x32_bf16 v[24:27], a[172:175], v[148:151], v[24:27]
  v_mfma_f32_16x16x32_bf16 v[20:23], a[108:111], v[148:151], v[20:23]
  buffer_load_dwordx4 v209, s[48:51], s68 offen offset:1024  lds
  v_mfma_f32_16x16x32_bf16 v[16:19], a[44:47], v[148:151], v[16:19]
  ds_read_b128 v[140:143], v196 offset:57344
  v_mfma_f32_16x16x32_bf16 v[32:35], a[44:47], v[152:155], v[32:35]
  v_mfma_f32_16x16x32_bf16 v[36:39], a[108:111], v[152:155], v[36:39]
  v_mfma_f32_16x16x32_bf16 v[40:43], a[172:175], v[152:155], v[40:43]
  buffer_load_dwordx4 v210, s[48:51], s68 offen offset:2048  lds
  v_mfma_f32_16x16x32_bf16 v[44:47], a[236:239], v[152:155], v[44:47]
  v_mfma_f32_16x16x32_bf16 v[60:63], a[236:239], v[156:159], v[60:63]
  v_mfma_f32_16x16x32_bf16 v[56:59], a[172:175], v[156:159], v[56:59]
  v_mfma_f32_16x16x32_bf16 v[52:55], a[108:111], v[156:159], v[52:55]
  buffer_load_dwordx4 v211, s[48:51], s68 offen offset:3072  lds
  v_mfma_f32_16x16x32_bf16 v[48:51], a[44:47], v[156:159], v[48:51]
  s_waitcnt lgkmcnt(0)
  v_mfma_f32_16x16x32_bf16 v[0:3], a[48:51], v[128:131], v[0:3]
  ds_read_b128 v[144:147], v193 offset:49152
  v_mfma_f32_16x16x32_bf16 v[4:7], a[112:115], v[128:131], v[4:7]
  v_mfma_f32_16x16x32_bf16 v[8:11], a[176:179], v[128:131], v[8:11]
  v_mfma_f32_16x16x32_bf16 v[12:15], a[240:243], v[128:131], v[12:15]
  ds_read_b128 v[148:151], v197 offset:49152
  v_mfma_f32_16x16x32_bf16 v[28:31], a[240:243], v[132:135], v[28:31]
  ds_read_b128 v[152:155], v193 offset:57344
  v_mfma_f32_16x16x32_bf16 v[24:27], a[176:179], v[132:135], v[24:27]
  v_mfma_f32_16x16x32_bf16 v[20:23], a[112:115], v[132:135], v[20:23]
  v_mfma_f32_16x16x32_bf16 v[16:19], a[48:51], v[132:135], v[16:19]
  ds_read_b128 v[156:159], v197 offset:57344
  v_mfma_f32_16x16x32_bf16 v[32:35], a[48:51], v[136:139], v[32:35]
  v_mfma_f32_16x16x32_bf16 v[36:39], a[112:115], v[136:139], v[36:39]
  v_mfma_f32_16x16x32_bf16 v[40:43], a[176:179], v[136:139], v[40:43]
  v_mfma_f32_16x16x32_bf16 v[44:47], a[240:243], v[136:139], v[44:47]
  v_mfma_f32_16x16x32_bf16 v[60:63], a[240:243], v[140:143], v[60:63]
  v_mfma_f32_16x16x32_bf16 v[56:59], a[176:179], v[140:143], v[56:59]
  v_mfma_f32_16x16x32_bf16 v[52:55], a[112:115], v[140:143], v[52:55]
  v_mfma_f32_16x16x32_bf16 v[48:51], a[48:51], v[140:143], v[48:51]
  s_waitcnt lgkmcnt(0)
  v_mfma_f32_16x16x32_bf16 v[0:3], a[52:55], v[144:147], v[0:3]
  ds_read_b128 v[128:131], v194 offset:49152
  v_mfma_f32_16x16x32_bf16 v[4:7], a[116:119], v[144:147], v[4:7]
  v_mfma_f32_16x16x32_bf16 v[8:11], a[180:183], v[144:147], v[8:11]
  v_mfma_f32_16x16x32_bf16 v[12:15], a[244:247], v[144:147], v[12:15]
  ds_read_b128 v[132:135], v198 offset:49152
  v_mfma_f32_16x16x32_bf16 v[28:31], a[244:247], v[148:151], v[28:31]
  ds_read_b128 v[136:139], v194 offset:57344
  v_mfma_f32_16x16x32_bf16 v[24:27], a[180:183], v[148:151], v[24:27]
  v_mfma_f32_16x16x32_bf16 v[20:23], a[116:119], v[148:151], v[20:23]
  v_mfma_f32_16x16x32_bf16 v[16:19], a[52:55], v[148:151], v[16:19]
  ds_read_b128 v[140:143], v198 offset:57344
  v_mfma_f32_16x16x32_bf16 v[32:35], a[52:55], v[152:155], v[32:35]
  v_mfma_f32_16x16x32_bf16 v[36:39], a[116:119], v[152:155], v[36:39]
  v_mfma_f32_16x16x32_bf16 v[40:43], a[180:183], v[152:155], v[40:43]
  v_mfma_f32_16x16x32_bf16 v[44:47], a[244:247], v[152:155], v[44:47]
  v_mfma_f32_16x16x32_bf16 v[60:63], a[244:247], v[156:159], v[60:63]
  v_mfma_f32_16x16x32_bf16 v[56:59], a[180:183], v[156:159], v[56:59]
  v_mfma_f32_16x16x32_bf16 v[52:55], a[116:119], v[156:159], v[52:55]
  v_mfma_f32_16x16x32_bf16 v[48:51], a[52:55], v[156:159], v[48:51]
  s_waitcnt lgkmcnt(0)
  v_mfma_f32_16x16x32_bf16 v[0:3], a[56:59], v[128:131], v[0:3]
  ds_read_b128 v[144:147], v195 offset:49152
  v_mfma_f32_16x16x32_bf16 v[4:7], a[120:123], v[128:131], v[4:7]
  v_mfma_f32_16x16x32_bf16 v[8:11], a[184:187], v[128:131], v[8:11]
  v_mfma_f32_16x16x32_bf16 v[12:15], a[248:251], v[128:131], v[12:15]
  ds_read_b128 v[148:151], v199 offset:49152
  v_mfma_f32_16x16x32_bf16 v[28:31], a[248:251], v[132:135], v[28:31]
  ds_read_b128 v[152:155], v195 offset:57344
  v_mfma_f32_16x16x32_bf16 v[24:27], a[184:187], v[132:135], v[24:27]
  v_mfma_f32_16x16x32_bf16 v[20:23], a[120:123], v[132:135], v[20:23]
  v_mfma_f32_16x16x32_bf16 v[16:19], a[56:59], v[132:135], v[16:19]
  ds_read_b128 v[156:159], v199 offset:57344
  v_mfma_f32_16x16x32_bf16 v[32:35], a[56:59], v[136:139], v[32:35]
  v_mfma_f32_16x16x32_bf16 v[36:39], a[120:123], v[136:139], v[36:39]
  v_mfma_f32_16x16x32_bf16 v[40:43], a[184:187], v[136:139], v[40:43]
  v_mfma_f32_16x16x32_bf16 v[44:47], a[248:251], v[136:139], v[44:47]
  v_mfma_f32_16x16x32_bf16 v[60:63], a[248:251], v[140:143], v[60:63]
  v_mfma_f32_16x16x32_bf16 v[56:59], a[184:187], v[140:143], v[56:59]
  v_mfma_f32_16x16x32_bf16 v[52:55], a[120:123], v[140:143], v[52:55]
  v_mfma_f32_16x16x32_bf16 v[48:51], a[56:59], v[140:143], v[48:51]
  s_waitcnt vmcnt(28)
  s_barrier
  s_waitcnt lgkmcnt(0)
  v_mfma_f32_16x16x32_bf16 v[0:3], a[60:63], v[144:147], v[0:3]
  ds_read_b128 v[128:131], v200 offset:0
  v_mfma_f32_16x16x32_bf16 v[4:7], a[124:127], v[144:147], v[4:7]
  s_add_u32 m0, s67, 0x8000
  s_add_u32 s68, s62, 0x200
  v_mfma_f32_16x16x32_bf16 v[8:11], a[188:191], v[144:147], v[8:11]
  buffer_load_dwordx4 v208, s[48:51], s68 offen offset:0  lds
  v_mfma_f32_16x16x32_bf16 v[12:15], a[252:255], v[144:147], v[12:15]
  ds_read_b128 v[132:135], v204 offset:0
  v_mfma_f32_16x16x32_bf16 v[28:31], a[252:255], v[148:151], v[28:31]
  ds_read_b128 v[136:139], v200 offset:8192
  v_mfma_f32_16x16x32_bf16 v[24:27], a[188:191], v[148:151], v[24:27]
  v_mfma_f32_16x16x32_bf16 v[20:23], a[124:127], v[148:151], v[20:23]
  buffer_load_dwordx4 v209, s[48:51], s68 offen offset:1024  lds
  v_mfma_f32_16x16x32_bf16 v[16:19], a[60:63], v[148:151], v[16:19]
  ds_read_b128 v[140:143], v204 offset:8192
  v_mfma_f32_16x16x32_bf16 v[32:35], a[60:63], v[152:155], v[32:35]
  v_mfma_f32_16x16x32_bf16 v[36:39], a[124:127], v[152:155], v[36:39]
  v_mfma_f32_16x16x32_bf16 v[40:43], a[188:191], v[152:155], v[40:43]
  buffer_load_dwordx4 v210, s[48:51], s68 offen offset:2048  lds
  v_mfma_f32_16x16x32_bf16 v[44:47], a[252:255], v[152:155], v[44:47]
  v_mfma_f32_16x16x32_bf16 v[60:63], a[252:255], v[156:159], v[60:63]
  v_mfma_f32_16x16x32_bf16 v[56:59], a[188:191], v[156:159], v[56:59]
  v_mfma_f32_16x16x32_bf16 v[52:55], a[124:127], v[156:159], v[52:55]
  buffer_load_dwordx4 v211, s[48:51], s68 offen offset:3072  lds
  v_mfma_f32_16x16x32_bf16 v[48:51], a[60:63], v[156:159], v[48:51]
  s_waitcnt lgkmcnt(0)
  v_mfma_f32_16x16x32_bf16 v[64:67], a[0:3], v[128:131], 0
  ds_read_b128 v[144:147], v201 offset:0
  v_mfma_f32_16x16x32_bf16 v[68:71], a[64:67], v[128:131], 0
  v_mfma_f32_16x16x32_bf16 v[72:75], a[128:131], v[128:131], 0
  v_mfma_f32_16x16x32_bf16 v[76:79], a[192:195], v[128:131], 0
  ds_read_b128 v[148:151], v205 offset:0
  v_mfma_f32_16x16x32_bf16 v[92:95], a[192:195], v[132:135], 0
  ds_read_b128 v[152:155], v201 offset:8192
  v_mfma_f32_16x16x32_bf16 v[88:91], a[128:131], v[132:135], 0
  v_cvt_pk_bf16_f32 v160, v0, v1
  v_mfma_f32_16x16x32_bf16 v[84:87], a[64:67], v[132:135], 0
  v_cvt_pk_bf16_f32 v161, v2, v3
  v_mfma_f32_16x16x32_bf16 v[80:83], a[0:3], v[132:135], 0
  ds_read_b128 v[156:159], v205 offset:8192
  v_mfma_f32_16x16x32_bf16 v[96:99], a[0:3], v[136:139], 0
  v_mfma_f32_16x16x32_bf16 v[100:103], a[64:67], v[136:139], 0
  v_cvt_pk_bf16_f32 v162, v4, v5
  v_mfma_f32_16x16x32_bf16 v[104:107], a[128:131], v[136:139], 0
  v_cvt_pk_bf16_f32 v163, v6, v7
  v_mfma_f32_16x16x32_bf16 v[108:111], a[192:195], v[136:139], 0
  v_mfma_f32_16x16x32_bf16 v[124:127], a[192:195], v[140:143], 0
  v_mfma_f32_16x16x32_bf16 v[120:123], a[128:131], v[140:143], 0
  buffer_store_dwordx4 v[160:163], v212, s[36:39], s63 offen offset:0 sc1
  v_mfma_f32_16x16x32_bf16 v[116:119], a[64:67], v[140:143], 0
  v_cvt_pk_bf16_f32 v168, v8, v9
  v_mfma_f32_16x16x32_bf16 v[112:115], a[0:3], v[140:143], 0
  s_waitcnt lgkmcnt(0)
  v_mfma_f32_16x16x32_bf16 v[64:67], a[4:7], v[144:147], v[64:67]
  ds_read_b128 v[128:131], v202 offset:0
  v_mfma_f32_16x16x32_bf16 v[68:71], a[68:71], v[144:147], v[68:71]
  v_cvt_pk_bf16_f32 v169, v10, v11
  v_mfma_f32_16x16x32_bf16 v[72:75], a[132:135], v[144:147], v[72:75]
  v_cvt_pk_bf16_f32 v170, v12, v13
  v_mfma_f32_16x16x32_bf16 v[76:79], a[196:199], v[144:147], v[76:79]
  ds_read_b128 v[132:135], v206 offset:0
  v_mfma_f32_16x16x32_bf16 v[92:95], a[196:199], v[148:151], v[92:95]
  ds_read_b128 v[136:139], v202 offset:8192
  v_mfma_f32_16x16x32_bf16 v[88:91], a[132:135], v[148:151], v[88:91]
  v_cvt_pk_bf16_f32 v171, v14, v15
  v_mfma_f32_16x16x32_bf16 v[84:87], a[68:71], v[148:151], v[84:87]
  buffer_store_dwordx4 v[168:171], v212, s[36:39], s63 offen offset:2048 sc1
  v_mfma_f32_16x16x32_bf16 v[80:83], a[4:7], v[148:151], v[80:83]
  ds_read_b128 v[140:143], v206 offset:8192
  v_mfma_f32_16x16x32_bf16 v[96:99], a[4:7], v[152:155], v[96:99]
  v_mfma_f32_16x16x32_bf16 v[100:103], a[68:71], v[152:155], v[100:103]
  v_cvt_pk_bf16_f32 v176, v16, v17
  v_mfma_f32_16x16x32_bf16 v[104:107], a[132:135], v[152:155], v[104:107]
  v_cvt_pk_bf16_f32 v177, v18, v19
  v_mfma_f32_16x16x32_bf16 v[108:111], a[196:199], v[152:155], v[108:111]
  v_mfma_f32_16x16x32_bf16 v[124:127], a[196:199], v[156:159], v[124:127]
  v_mfma_f32_16x16x32_bf16 v[120:123], a[132:135], v[156:159], v[120:123]
  v_cvt_pk_bf16_f32 v178, v20, v21
  v_mfma_f32_16x16x32_bf16 v[116:119], a[68:71], v[156:159], v[116:119]
  v_cvt_pk_bf16_f32 v179, v22, v23
  v_mfma_f32_16x16x32_bf16 v[112:115], a[4:7], v[156:159], v[112:115]
  s_waitcnt lgkmcnt(0)
  v_mfma_f32_16x16x32_bf16 v[64:67], a[8:11], v[128:131], v[64:67]
  ds_read_b128 v[144:147], v203 offset:0
  v_mfma_f32_16x16x32_bf16 v[68:71], a[72:75], v[128:131], v[68:71]
  buffer_store_dwordx4 v[176:179], v212, s[36:39], s63 offen offset:256 sc1
  v_mfma_f32_16x16x32_bf16 v[72:75], a[136:139], v[128:131], v[72:75]
  v_cvt_pk_bf16_f32 v184, v24, v25
  v_mfma_f32_16x16x32_bf16 v[76:79], a[200:203], v[128:131], v[76:79]
  ds_read_b128 v[148:151], v207 offset:0
  v_mfma_f32_16x16x32_bf16 v[92:95], a[200:203], v[132:135], v[92:95]
  ds_read_b128 v[152:155], v203 offset:8192
  v_mfma_f32_16x16x32_bf16 v[88:91], a[136:139], v[132:135], v[88:91]
  v_cvt_pk_bf16_f32 v185, v26, v27
  v_mfma_f32_16x16x32_bf16 v[84:87], a[72:75], v[132:135], v[84:87]
  v_cvt_pk_bf16_f32 v186, v28, v29
  v_mfma_f32_16x16x32_bf16 v[80:83], a[8:11], v[132:135], v[80:83]
  ds_read_b128 v[156:159], v207 offset:8192
  v_mfma_f32_16x16x32_bf16 v[96:99], a[8:11], v[136:139], v[96:99]
  v_mfma_f32_16x16x32_bf16 v[100:103], a[72:75], v[136:139], v[100:103]
  v_cvt_pk_bf16_f32 v187, v30, v31
  v_mfma_f32_16x16x32_bf16 v[104:107], a[136:139], v[136:139], v[104:107]
  buffer_store_dwordx4 v[184:187], v212, s[36:39], s63 offen offset:2304 sc1
  v_mfma_f32_16x16x32_bf16 v[108:111], a[200:203], v[136:139], v[108:111]
  v_mfma_f32_16x16x32_bf16 v[124:127], a[200:203], v[140:143], v[124:127]
  v_mfma_f32_16x16x32_bf16 v[120:123], a[136:139], v[140:143], v[120:123]
  v_mfma_f32_16x16x32_bf16 v[116:119], a[72:75], v[140:143], v[116:119]
  v_mfma_f32_16x16x32_bf16 v[112:115], a[8:11], v[140:143], v[112:115]
  s_waitcnt vmcnt(16)
  s_barrier
  s_cmp_lg_u32 s40, 0
  s_cbranch_scc1 Lg_33
  s_cmp_lt_i32 s70, s71
  s_cbranch_scc1 Lg_33
  s_cmp_lg_u32 s101, 0
  s_cbranch_scc1 Li_37
  v_readfirstlane_b32 s101, v252
  s_nop 0
  s_cmp_lg_u32 s101, 0
  s_cbranch_scc1 Li_37
Li_36:
  buffer_load_dword v252, off, s[84:87], 0 offset:144 sc1
  s_waitcnt vmcnt(0)
  v_readfirstlane_b32 s101, v252
  s_add_u32 s91, s91, 1
  s_cmp_gt_u32 s91, 0x20000
  s_cbranch_scc1 L_abort
  s_cmp_eq_u32 s101, 0
  s_cbranch_scc1 Li_36
Li_37:
  s_cmp_lg_u32 s56, 0
  s_cbranch_scc1 Lg_34
  s_lshl_b32 s41, s57, 3
  s_lshl_b32 s41, 1, s41
  s_mov_b64 exec, 1
  s_add_u32 s42, s70, 1
  s_lshl_b32 s42, s42, 1
  v_mov_b32 v249, s42
  s_add_u32 s42, s58, 168
  s_lshl_b32 s42, s42, 7
  s_cmp_lg_u32 s57, 0
  s_cselect_b32 s42, 0x10000000, s42
  buffer_store_dword v249, v253, s[36:39], s42 offen sc1
  s_add_u32 s42, s70, 136
  s_branch Lg_35
Lg_34:
  s_and_b32 s41, s70, 3
  s_cmp_lg_u32 s41, 3
  s_cbranch_scc1 Lg_33
  s_lshr_b32 s41, s70, 2
  s_lshl_b32 s42, s57, 3
  s_add_u32 s41, s41, s42
  s_lshl_b32 s41, 1, s41
  s_lshl_b32 s42, s58, s57
  s_add_u32 s42, s42, 32
  s_lshl_b32 s43, s57, 1
  s_add_u32 exec_lo, s43, 1
  s_mov_b32 exec_hi, 0
Lg_35:
  s_lshl_b32 s42, s42, 7
  v_mov_b32 v250, s41
  buffer_atomic_add v250, v253, s[36:39], s42 offen
  s_mov_b64 exec, -1
Lg_33:
  s_add_u32 s70, s70, 1
  s_waitcnt lgkmcnt(0)
  v_mfma_f32_16x16x32_bf16 v[64:67], a[12:15], v[144:147], v[64:67]
  ds_read_b128 v[128:131], v200 offset:16384
  v_mfma_f32_16x16x32_bf16 v[68:71], a[76:79], v[144:147], v[68:71]
  s_add_u32 m0, s67, 0xc000
  s_add_u32 s68, s62, 0x300
  v_mfma_f32_16x16x32_bf16 v[72:75], a[140:143], v[144:147], v[72:75]
  buffer_load_dwordx4 v208, s[48:51], s68 offen offset:0  lds
  v_mfma_f32_16x16x32_bf16 v[76:79], a[204:207], v[144:147], v[76:79]
  ds_read_b128 v[132:135], v204 offset:16384
  v_mfma_f32_16x16x32_bf16 v[92:95], a[204:207], v[148:151], v[92:95]
  ds_read_b128 v[136:139], v200 offset:24576
  v_mfma_f32_16x16x32_bf16 v[88:91], a[140:143], v[148:151], v[88:91]
  v_mfma_f32_16x16x32_bf16 v[84:87], a[76:79], v[148:151], v[84:87]
  buffer_load_dwordx4 v209, s[48:51], s68 offen offset:1024  lds
  v_mfma_f32_16x16x32_bf16 v[80:83], a[12:15], v[148:151], v[80:83]
  ds_read_b128 v[140:143], v204 offset:24576
  v_mfma_f32_16x16x32_bf16 v[96:99], a[12:15], v[152:155], v[96:99]
  v_mfma_f32_16x16x32_bf16 v[100:103], a[76:79], v[152:155], v[100:103]
  v_mfma_f32_16x16x32_bf16 v[104:107], a[140:143], v[152:155], v[104:107]
  buffer_load_dwordx4 v210, s[48:51], s68 offen offset:2048  lds
  v_mfma_f32_16x16x32_bf16 v[108:111], a[204:207], v[152:155], v[108:111]
  v_mfma_f32_16x16x32_bf16 v[124:127], a[204:207], v[156:159], v[124:127]
  v_mfma_f32_16x16x32_bf16 v[120:123], a[140:143], v[156:159], v[120:123]
  v_mfma_f32_16x16x32_bf16 v[116:119], a[76:79], v[156:159], v[116:119]
  buffer_load_dwordx4 v211, s[48:51], s68 offen offset:3072  lds
  v_mfma_f32_16x16x32_bf16 v[112:115], a[12:15], v[156:159], v[112:115]
  s_waitcnt lgkmcnt(0)
  v_mfma_f32_16x16x32_bf16 v[64:67], a[16:19], v[128:131], v[64:67]
  ds_read_b128 v[144:147], v201 offset:16384
  v_mfma_f32_16x16x32_bf16 v[68:71], a[80:83], v[128:131], v[68:71]
  v_cvt_pk_bf16_f32 v160, v32, v33
  v_mfma_f32_16x16x32_bf16 v[72:75], a[144:147], v[128:131], v[72:75]
  v_cvt_pk_bf16_f32 v161, v34, v35
  v_mfma_f32_16x16x32_bf16 v[76:79], a[208:211], v[128:131], v[76:79]
  ds_read_b128 v[148:151], v205 offset:16384
  v_mfma_f32_16x16x32_bf16 v[92:95], a[208:211], v[132:135], v[92:95]
  ds_read_b128 v[152:155], v201 offset:24576
  v_mfma_f32_16x16x32_bf16 v[88:91], a[144:147], v[132:135], v[88:91]
  v_cvt_pk_bf16_f32 v162, v36, v37
  v_mfma_f32_16x16x32_bf16 v[84:87], a[80:83], v[132:135], v[84:87]
  v_cvt_pk_bf16_f32 v163, v38, v39
  v_mfma_f32_16x16x32_bf16 v[80:83], a[16:19], v[132:135], v[80:83]
  ds_read_b128 v[156:159], v205 offset:24576
  v_mfma_f32_16x16x32_bf16 v[96:99], a[16:19], v[136:139], v[96:99]
  v_mfma_f32_16x16x32_bf16 v[100:103], a[80:83], v[136:139], v[100:103]
  buffer_store_dwordx4 v[160:163], v213, s[36:39], s63 offen offset:0 sc1
  v_mfma_f32_16x16x32_bf16 v[104:107], a[144:147], v[136:139], v[104:107]
  v_cvt_pk_bf16_f32 v168, v40, v41
  v_mfma_f32_16x16x32_bf16 v[108:111], a[208:211], v[136:139], v[108:111]
  v_mfma_f32_16x16x32_bf16 v[124:127], a[208:211], v[140:143], v[124:127]
  v_mfma_f32_16x16x32_bf16 v[120:123], a[144:147], v[140:143], v[120:123]
  v_cvt_pk_bf16_f32 v169, v42, v43
  v_mfma_f32_16x16x32_bf16 v[116:119], a[80:83], v[140:143], v[116:119]
  v_cvt_pk_bf16_f32 v170, v44, v45
  v_mfma_f32_16x16x32_bf16 v[112:115], a[16:19], v[140:143], v[112:115]
  s_waitcnt lgkmcnt(0)
  v_mfma_f32_16x16x32_bf16 v[64:67], a[20:23], v[144:147], v[64:67]
  ds_read_b128 v[128:131], v202 offset:16384
  v_mfma_f32_16x16x32_bf16 v[68:71], a[84:87], v[144:147], v[68:71]
  v_cvt_pk_bf16_f32 v171, v46, v47
  v_mfma_f32_16x16x32_bf16 v[72:75], a[148:151], v[144:147], v[72:75]
  buffer_store_dwordx4 v[168:171], v213, s[36:39], s63 offen offset:2048 sc1
  v_mfma_f32_16x16x32_bf16 v[76:79], a[212:215], v[144:147], v[76:79]
  ds_read_b128 v[132:135], v206 offset:16384
  v_mfma_f32_16x16x32_bf16 v[92:95], a[212:215], v[148:151], v[92:95]
  ds_read_b128 v[136:139], v202 offset:24576
  v_mfma_f32_16x16x32_bf16 v[88:91], a[148:151], v[148:151], v[88:91]
  v_cvt_pk_bf16_f32 v176, v48, v49
  v_mfma_f32_16x16x32_bf16 v[84:87], a[84:87], v[148:151], v[84:87]
  v_cvt_pk_bf16_f32 v177, v50, v51
  v_mfma_f32_16x16x32_bf16 v[80:83], a[20:23], v[148:151], v[80:83]
  ds_read_b128 v[140:143], v206 offset:24576
  v_mfma_f32_16x16x32_bf16 v[96:99], a[20:23], v[152:155], v[96:99]
  v_mfma_f32_16x16x32_bf16 v[100:103], a[84:87], v[152:155], v[100:103]
  v_cvt_pk_bf16_f32 v178, v52, v53
  v_mfma_f32_16x16x32_bf16 v[104:107], a[148:151], v[152:155], v[104:107]
  v_cvt_pk_bf16_f32 v179, v54, v55
  v_mfma_f32_16x16x32_bf16 v[108:111], a[212:215], v[152:155], v[108:111]
  v_mfma_f32_16x16x32_bf16 v[124:127], a[212:215], v[156:159], v[124:127]
  v_mfma_f32_16x16x32_bf16 v[120:123], a[148:151], v[156:159], v[120:123]
  buffer_store_dwordx4 v[176:179], v213, s[36:39], s63 offen offset:256 sc1
  v_mfma_f32_16x16x32_bf16 v[116:119], a[84:87], v[156:159], v[116:119]
  v_cvt_pk_bf16_f32 v184, v56, v57
  v_mfma_f32_16x16x32_bf16 v[112:115], a[20:23], v[156:159], v[112:115]
  s_waitcnt lgkmcnt(0)
  v_mfma_f32_16x16x32_bf16 v[64:67], a[24:27], v[128:131], v[64:67]
  ds_read_b128 v[144:147], v203 offset:16384
  v_mfma_f32_16x16x32_bf16 v[68:71], a[88:91], v[128:131], v[68:71]
  v_cvt_pk_bf16_f32 v185, v58, v59
  v_mfma_f32_16x16x32_bf16 v[72:75], a[152:155], v[128:131], v[72:75]
  v_cvt_pk_bf16_f32 v186, v60, v61
  v_mfma_f32_16x16x32_bf16 v[76:79], a[216:219], v[128:131], v[76:79]
  ds_read_b128 v[148:151], v207 offset:16384
  v_mfma_f32_16x16x32_bf16 v[92:95], a[216:219], v[132:135], v[92:95]
  ds_read_b128 v[152:155], v203 offset:24576
  v_mfma_f32_16x16x32_bf16 v[88:91], a[152:155], v[132:135], v[88:91]
  v_cvt_pk_bf16_f32 v187, v62, v63
  v_mfma_f32_16x16x32_bf16 v[84:87], a[88:91], v[132:135], v[84:87]
  buffer_store_dwordx4 v[184:187], v213, s[36:39], s63 offen offset:2304 sc1
  v_mfma_f32_16x16x32_bf16 v[80:83], a[24:27], v[132:135], v[80:83]
  ds_read_b128 v[156:159], v207 offset:24576
  v_mfma_f32_16x16x32_bf16 v[96:99], a[24:27], v[136:139], v[96:99]
  v_mfma_f32_16x16x32_bf16 v[100:103], a[88:91], v[136:139], v[100:103]
  v_mfma_f32_16x16x32_bf16 v[104:107], a[152:155], v[136:139], v[104:107]
  v_mfma_f32_16x16x32_bf16 v[108:111], a[216:219], v[136:139], v[108:111]
  v_mfma_f32_16x16x32_bf16 v[124:127], a[216:219], v[140:143], v[124:127]
  v_mfma_f32_16x16x32_bf16 v[120:123], a[152:155], v[140:143], v[120:123]
  v_mfma_f32_16x16x32_bf16 v[116:119], a[88:91], v[140:143], v[116:119]
  v_mfma_f32_16x16x32_bf16 v[112:115], a[24:27], v[140:143], v[112:115]
  s_waitcnt vmcnt(36)
  s_barrier
  s_waitcnt lgkmcnt(0)
  v_mfma_f32_16x16x32_bf16 v[64:67], a[28:31], v[144:147], v[64:67]
  ds_read_b128 v[128:131], v200 offset:32768
  v_mfma_f32_16x16x32_bf16 v[68:71], a[92:95], v[144:147], v[68:71]
  s_add_u32 m0, s67, 0x10000
  s_add_u32 s68, s62, 0x10000
  v_mfma_f32_16x16x32_bf16 v[72:75], a[156:159], v[144:147], v[72:75]
  buffer_load_dwordx4 v208, s[48:51], s68 offen offset:0  lds
  v_mfma_f32_16x16x32_bf16 v[76:79], a[220:223], v[144:147], v[76:79]
  ds_read_b128 v[132:135], v204 offset:32768
  v_mfma_f32_16x16x32_bf16 v[92:95], a[220:223], v[148:151], v[92:95]
  ds_read_b128 v[136:139], v200 offset:40960
  v_mfma_f32_16x16x32_bf16 v[88:91], a[156:159], v[148:151], v[88:91]
  v_mfma_f32_16x16x32_bf16 v[84:87], a[92:95], v[148:151], v[84:87]
  buffer_load_dwordx4 v209, s[48:51], s68 offen offset:1024  lds
  v_mfma_f32_16x16x32_bf16 v[80:83], a[28:31], v[148:151], v[80:83]
  ds_read_b128 v[140:143], v204 offset:40960
  v_mfma_f32_16x16x32_bf16 v[96:99], a[28:31], v[152:155], v[96:99]
  v_mfma_f32_16x16x32_bf16 v[100:103], a[92:95], v[152:155], v[100:103]
  v_mfma_f32_16x16x32_bf16 v[104:107], a[156:159], v[152:155], v[104:107]
  buffer_load_dwordx4 v210, s[48:51], s68 offen offset:2048  lds
  v_mfma_f32_16x16x32_bf16 v[108:111], a[220:223], v[152:155], v[108:111]
  v_mfma_f32_16x16x32_bf16 v[124:127], a[220:223], v[156:159], v[124:127]
  v_mfma_f32_16x16x32_bf16 v[120:123], a[156:159], v[156:159], v[120:123]
  v_mfma_f32_16x16x32_bf16 v[116:119], a[92:95], v[156:159], v[116:119]
  buffer_load_dwordx4 v211, s[48:51], s68 offen offset:3072  lds
  v_mfma_f32_16x16x32_bf16 v[112:115], a[28:31], v[156:159], v[112:115]
  s_waitcnt lgkmcnt(0)
  v_mfma_f32_16x16x32_bf16 v[64:67], a[32:35], v[128:131], v[64:67]
  ds_read_b128 v[144:147], v201 offset:32768
  v_mfma_f32_16x16x32_bf16 v[68:71], a[96:99], v[128:131], v[68:71]
  v_mfma_f32_16x16x32_bf16 v[72:75], a[160:163], v[128:131], v[72:75]
  v_mfma_f32_16x16x32_bf16 v[76:79], a[224:227], v[128:131], v[76:79]
  ds_read_b128 v[148:151], v205 offset:32768
  v_mfma_f32_16x16x32_bf16 v[92:95], a[224:227], v[132:135], v[92:95]
  ds_read_b128 v[152:155], v201 offset:40960
  v_mfma_f32_16x16x32_bf16 v[88:91], a[160:163], v[132:135], v[88:91]
  v_mfma_f32_16x16x32_bf16 v[84:87], a[96:99], v[132:135], v[84:87]
  v_mfma_f32_16x16x32_bf16 v[80:83], a[32:35], v[132:135], v[80:83]
  ds_read_b128 v[156:159], v205 offset:40960
  v_mfma_f32_16x16x32_bf16 v[96:99], a[32:35], v[136:139], v[96:99]
  v_mfma_f32_16x16x32_bf16 v[100:103], a[96:99], v[136:139], v[100:103]
  v_mfma_f32_16x16x32_bf16 v[104:107], a[160:163], v[136:139], v[104:107]
  v_mfma_f32_16x16x32_bf16 v[108:111], a[224:227], v[136:139], v[108:111]
  v_mfma_f32_16x16x32_bf16 v[124:127], a[224:227], v[140:143], v[124:127]
  v_mfma_f32_16x16x32_bf16 v[120:123], a[160:163], v[140:143], v[120:123]
  v_mfma_f32_16x16x32_bf16 v[116:119], a[96:99], v[140:143], v[116:119]
  v_mfma_f32_16x16x32_bf16 v[112:115], a[32:35], v[140:143], v[112:115]
  s_waitcnt lgkmcnt(0)
  v_mfma_f32_16x16x32_bf16 v[64:67], a[36:39], v[144:147], v[64:67]
  ds_read_b128 v[128:131], v202 offset:32768
  v_mfma_f32_16x16x32_bf16 v[68:71], a[100:103], v[144:147], v[68:71]
  v_mfma_f32_16x16x32_bf16 v[72:75], a[164:167], v[144:147], v[72:75]
  v_mfma_f32_16x16x32_bf16 v[76:79], a[228:231], v[144:147], v[76:79]
  ds_read_b128 v[132:135], v206 offset:32768
  v_mfma_f32_16x16x32_bf16 v[92:95], a[228:231], v[148:151], v[92:95]
  ds_read_b128 v[136:139], v202 offset:40960
  v_mfma_f32_16x16x32_bf16 v[88:91], a[164:167], v[148:151], v[88:91]
  v_mfma_f32_16x16x32_bf16 v[84:87], a[100:103], v[148:151], v[84:87]
  v_mfma_f32_16x16x32_bf16 v[80:83], a[36:39], v[148:151], v[80:83]
  ds_read_b128 v[140:143], v206 offset:40960
  v_mfma_f32_16x16x32_bf16 v[96:99], a[36:39], v[152:155], v[96:99]
  v_mfma_f32_16x16x32_bf16 v[100:103], a[100:103], v[152:155], v[100:103]
  v_mfma_f32_16x16x32_bf16 v[104:107], a[164:167], v[152:155], v[104:107]
  v_mfma_f32_16x16x32_bf16 v[108:111], a[228:231], v[152:155], v[108:111]
  v_mfma_f32_16x16x32_bf16 v[124:127], a[228:231], v[156:159], v[124:127]
  v_mfma_f32_16x16x32_bf16 v[120:123], a[164:167], v[156:159], v[120:123]
  v_mfma_f32_16x16x32_bf16 v[116:119], a[100:103], v[156:159], v[116:119]
  v_mfma_f32_16x16x32_bf16 v[112:115], a[36:39], v[156:159], v[112:115]
  s_waitcnt lgkmcnt(0)
  v_mfma_f32_16x16x32_bf16 v[64:67], a[40:43], v[128:131], v[64:67]
  ds_read_b128 v[144:147], v203 offset:32768
  v_mfma_f32_16x16x32_bf16 v[68:71], a[104:107], v[128:131], v[68:71]
  v_mfma_f32_16x16x32_bf16 v[72:75], a[168:171], v[128:131], v[72:75]
  v_mfma_f32_16x16x32_bf16 v[76:79], a[232:235], v[128:131], v[76:79]
  ds_read_b128 v[148:151], v207 offset:32768
  v_mfma_f32_16x16x32_bf16 v[92:95], a[232:235], v[132:135], v[92:95]
  ds_read_b128 v[152:155], v203 offset:40960
  v_mfma_f32_16x16x32_bf16 v[88:91], a[168:171], v[132:135], v[88:91]
  v_mfma_f32_16x16x32_bf16 v[84:87], a[104:107], v[132:135], v[84:87]
  v_mfma_f32_16x16x32_bf16 v[80:83], a[40:43], v[132:135], v[80:83]
  ds_read_b128 v[156:159], v207 offset:40960
  v_mfma_f32_16x16x32_bf16 v[96:99], a[40:43], v[136:139], v[96:99]
  v_mfma_f32_16x16x32_bf16 v[100:103], a[104:107], v[136:139], v[100:103]
  v_mfma_f32_16x16x32_bf16 v[104:107], a[168:171], v[136:139], v[104:107]
  v_mfma_f32_16x16x32_bf16 v[108:111], a[232:235], v[136:139], v[108:111]
  v_mfma_f32_16x16x32_bf16 v[124:127], a[232:235], v[140:143], v[124:127]
  v_mfma_f32_16x16x32_bf16 v[120:123], a[168:171], v[140:143], v[120:123]
  v_mfma_f32_16x16x32_bf16 v[116:119], a[104:107], v[140:143], v[116:119]
  v_mfma_f32_16x16x32_bf16 v[112:115], a[40:43], v[140:143], v[112:115]
  s_waitcnt vmcnt(32)
  s_barrier
  s_waitcnt lgkmcnt(0)
  v_mfma_f32_16x16x32_bf16 v[64:67], a[44:47], v[144:147], v[64:67]
  ds_read_b128 v[128:131], v200 offset:49152
  v_mfma_f32_16x16x32_bf16 v[68:71], a[108:111], v[144:147], v[68:71]
  s_add_u32 m0, s67, 0x14000
  s_add_u32 s68, s62, 0x10100
  v_mfma_f32_16x16x32_bf16 v[72:75], a[172:175], v[144:147], v[72:75]
  buffer_load_dwordx4 v208, s[48:51], s68 offen offset:0  lds
  v_mfma_f32_16x16x32_bf16 v[76:79], a[236:239], v[144:147], v[76:79]
  ds_read_b128 v[132:135], v204 offset:49152
  v_mfma_f32_16x16x32_bf16 v[92:95], a[236:239], v[148:151], v[92:95]
  ds_read_b128 v[136:139], v200 offset:57344
  v_mfma_f32_16x16x32_bf16 v[88:91], a[172:175], v[148:151], v[88:91]
  v_mfma_f32_16x16x32_bf16 v[84:87], a[108:111], v[148:151], v[84:87]
  buffer_load_dwordx4 v209, s[48:51], s68 offen offset:1024  lds
  v_mfma_f32_16x16x32_bf16 v[80:83], a[44:47], v[148:151], v[80:83]
  ds_read_b128 v[140:143], v204 offset:57344
  v_mfma_f32_16x16x32_bf16 v[96:99], a[44:47], v[152:155], v[96:99]
  v_mfma_f32_16x16x32_bf16 v[100:103], a[108:111], v[152:155], v[100:103]
  v_mfma_f32_16x16x32_bf16 v[104:107], a[172:175], v[152:155], v[104:107]
  buffer_load_dwordx4 v210, s[48:51], s68 offen offset:2048  lds
  v_mfma_f32_16x16x32_bf16 v[108:111], a[236:239], v[152:155], v[108:111]
  v_mfma_f32_16x16x32_bf16 v[124:127], a[236:239], v[156:159], v[124:127]
  v_mfma_f32_16x16x32_bf16 v[120:123], a[172:175], v[156:159], v[120:123]
  v_mfma_f32_16x16x32_bf16 v[116:119], a[108:111], v[156:159], v[116:119]
  buffer_load_dwordx4 v211, s[48:51], s68 offen offset:3072  lds
  v_mfma_f32_16x16x32_bf16 v[112:115], a[44:47], v[156:159], v[112:115]
  s_waitcnt lgkmcnt(0)
  v_mfma_f32_16x16x32_bf16 v[64:67], a[48:51], v[128:131], v[64:67]
  ds_read_b128 v[144:147], v201 offset:49152
  v_mfma_f32_16x16x32_bf16 v[68:71], a[112:115], v[128:131], v[68:71]
  v_mfma_f32_16x16x32_bf16 v[72:75], a[176:179], v[128:131], v[72:75]
  v_mfma_f32_16x16x32_bf16 v[76:79], a[240:243], v[128:131], v[76:79]
  ds_read_b128 v[148:151], v205 offset:49152
  v_mfma_f32_16x16x32_bf16 v[92:95], a[240:243], v[132:135], v[92:95]
  ds_read_b128 v[152:155], v201 offset:57344
  v_mfma_f32_16x16x32_bf16 v[88:91], a[176:179], v[132:135], v[88:91]
  v_mfma_f32_16x16x32_bf16 v[84:87], a[112:115], v[132:135], v[84:87]
  v_mfma_f32_16x16x32_bf16 v[80:83], a[48:51], v[132:135], v[80:83]
  ds_read_b128 v[156:159], v205 offset:57344
  v_mfma_f32_16x16x32_bf16 v[96:99], a[48:51], v[136:139], v[96:99]
  v_mfma_f32_16x16x32_bf16 v[100:103], a[112:115], v[136:139], v[100:103]
  v_mfma_f32_16x16x32_bf16 v[104:107], a[176:179], v[136:139], v[104:107]
  v_mfma_f32_16x16x32_bf16 v[108:111], a[240:243], v[136:139], v[108:111]
  v_mfma_f32_16x16x32_bf16 v[124:127], a[240:243], v[140:143], v[124:127]
  v_mfma_f32_16x16x32_bf16 v[120:123], a[176:179], v[140:143], v[120:123]
  v_mfma_f32_16x16x32_bf16 v[116:119], a[112:115], v[140:143], v[116:119]
  v_mfma_f32_16x16x32_bf16 v[112:115], a[48:51], v[140:143], v[112:115]
  s_waitcnt lgkmcnt(0)
  v_mfma_f32_16x16x32_bf16 v[64:67], a[52:55], v[144:147], v[64:67]
  ds_read_b128 v[128:131], v202 offset:49152
  v_mfma_f32_16x16x32_bf16 v[68:71], a[116:119], v[144:147], v[68:71]
  v_mfma_f32_16x16x32_bf16 v[72:75], a[180:183], v[144:147], v[72:75]
  v_mfma_f32_16x16x32_bf16 v[76:79], a[244:247], v[144:147], v[76:79]
  ds_read_b128 v[132:135], v206 offset:49152
  v_mfma_f32_16x16x32_bf16 v[92:95], a[244:247], v[148:151], v[92:95]
  ds_read_b128 v[136:139], v202 offset:57344
  v_mfma_f32_16x16x32_bf16 v[88:91], a[180:183], v[148:151], v[88:91]
  v_mfma_f32_16x16x32_bf16 v[84:87], a[116:119], v[148:151], v[84:87]
  v_mfma_f32_16x16x32_bf16 v[80:83], a[52:55], v[148:151], v[80:83]
  ds_read_b128 v[140:143], v206 offset:57344
  v_mfma_f32_16x16x32_bf16 v[96:99], a[52:55], v[152:155], v[96:99]
  v_mfma_f32_16x16x32_bf16 v[100:103], a[116:119], v[152:155], v[100:103]
  v_mfma_f32_16x16x32_bf16 v[104:107], a[180:183], v[152:155], v[104:107]
  v_mfma_f32_16x16x32_bf16 v[108:111], a[244:247], v[152:155], v[108:111]
  v_mfma_f32_16x16x32_bf16 v[124:127], a[244:247], v[156:159], v[124:127]
  v_mfma_f32_16x16x32_bf16 v[120:123], a[180:183], v[156:159], v[120:123]
  v_mfma_f32_16x16x32_bf16 v[116:119], a[116:119], v[156:159], v[116:119]
  v_mfma_f32_16x16x32_bf16 v[112:115], a[52:55], v[156:159], v[112:115]
  s_waitcnt lgkmcnt(0)
  v_mfma_f32_16x16x32_bf16 v[64:67], a[56:59], v[128:131], v[64:67]
  ds_read_b128 v[144:147], v203 offset:49152
  v_mfma_f32_16x16x32_bf16 v[68:71], a[120:123], v[128:131], v[68:71]
  v_mfma_f32_16x16x32_bf16 v[72:75], a[184:187], v[128:131], v[72:75]
  v_mfma_f32_16x16x32_bf16 v[76:79], a[248:251], v[128:131], v[76:79]
  ds_read_b128 v[148:151], v207 offset:49152
  v_mfma_f32_16x16x32_bf16 v[92:95], a[248:251], v[132:135], v[92:95]
  ds_read_b128 v[152:155], v203 offset:57344
  v_mfma_f32_16x16x32_bf16 v[88:91], a[184:187], v[132:135], v[88:91]
  v_mfma_f32_16x16x32_bf16 v[84:87], a[120:123], v[132:135], v[84:87]
  v_mfma_f32_16x16x32_bf16 v[80:83], a[56:59], v[132:135], v[80:83]
  ds_read_b128 v[156:159], v207 offset:57344
  v_mfma_f32_16x16x32_bf16 v[96:99], a[56:59], v[136:139], v[96:99]
  v_mfma_f32_16x16x32_bf16 v[100:103], a[120:123], v[136:139], v[100:103]
  v_mfma_f32_16x16x32_bf16 v[104:107], a[184:187], v[136:139], v[104:107]
  v_mfma_f32_16x16x32_bf16 v[108:111], a[248:251], v[136:139], v[108:111]
  v_mfma_f32_16x16x32_bf16 v[124:127], a[248:251], v[140:143], v[124:127]
  v_mfma_f32_16x16x32_bf16 v[120:123], a[184:187], v[140:143], v[120:123]
  v_mfma_f32_16x16x32_bf16 v[116:119], a[120:123], v[140:143], v[116:119]
  v_mfma_f32_16x16x32_bf16 v[112:115], a[56:59], v[140:143], v[112:115]
  s_waitcnt vmcnt(28)
  s_barrier
  s_waitcnt lgkmcnt(0)
  v_mfma_f32_16x16x32_bf16 v[64:67], a[60:63], v[144:147], v[64:67]
  ds_read_b128 v[128:131], v192 offset:0
  v_mfma_f32_16x16x32_bf16 v[68:71], a[124:127], v[144:147], v[68:71]
  s_add_u32 m0, s67, 0x18000
  s_add_u32 s68, s62, 0x10200
  v_mfma_f32_16x16x32_bf16 v[72:75], a[188:191], v[144:147], v[72:75]
  buffer_load_dwordx4 v208, s[48:51], s68 offen offset:0  lds
  v_mfma_f32_16x16x32_bf16 v[76:79], a[252:255], v[144:147], v[76:79]
  ds_read_b128 v[132:135], v196 offset:0
  v_mfma_f32_16x16x32_bf16 v[92:95], a[252:255], v[148:151], v[92:95]
  ds_read_b128 v[136:139], v192 offset:8192
  v_mfma_f32_16x16x32_bf16 v[88:91], a[188:191], v[148:151], v[88:91]
  v_mfma_f32_16x16x32_bf16 v[84:87], a[124:127], v[148:151], v[84:87]
  buffer_load_dwordx4 v209, s[48:51], s68 offen offset:1024  lds
  v_mfma_f32_16x16x32_bf16 v[80:83], a[60:63], v[148:151], v[80:83]
  ds_read_b128 v[140:143], v196 offset:8192
  v_mfma_f32_16x16x32_bf16 v[96:99], a[60:63], v[152:155], v[96:99]
  v_mfma_f32_16x16x32_bf16 v[100:103], a[124:127], v[152:155], v[100:103]
  v_mfma_f32_16x16x32_bf16 v[104:107], a[188:191], v[152:155], v[104:107]
  buffer_load_dwordx4 v210, s[48:51], s68 offen offset:2048  lds
  v_mfma_f32_16x16x32_bf16 v[108:111], a[252:255], v[152:155], v[108:111]
  v_mfma_f32_16x16x32_bf16 v[124:127], a[252:255], v[156:159], v[124:127]
  v_mfma_f32_16x16x32_bf16 v[120:123], a[188:191], v[156:159], v[120:123]
  v_mfma_f32_16x16x32_bf16 v[116:119], a[124:127], v[156:159], v[116:119]
  buffer_load_dwordx4 v211, s[48:51], s68 offen offset:3072  lds
  v_mfma_f32_16x16x32_bf16 v[112:115], a[60:63], v[156:159], v[112:115]
  s_branch PJ_bend
PJ_b1:
  s_waitcnt lgkmcnt(0)
  v_mfma_f32_16x16x32_bf16 v[0:3], v[128:131], a[0:3], 0
  ds_read_b128 v[144:147], v193 offset:0
  v_mfma_f32_16x16x32_bf16 v[8:11], v[128:131], a[64:67], 0
  v_mfma_f32_16x16x32_bf16 v[16:19], v[128:131], a[128:131], 0
  v_mfma_f32_16x16x32_bf16 v[24:27], v[128:131], a[192:195], 0
  ds_read_b128 v[148:151], v197 offset:0
  v_mfma_f32_16x16x32_bf16 v[28:31], v[132:135], a[192:195], 0
  ds_read_b128 v[152:155], v193 offset:8192
  v_mfma_f32_16x16x32_bf16 v[20:23], v[132:135], a[128:131], 0
  v_cvt_pk_bf16_f32 v160, v64, v65
  v_mfma_f32_16x16x32_bf16 v[12:15], v[132:135], a[64:67], 0
  v_cvt_pk_bf16_f32 v161, v66, v67
  v_mfma_f32_16x16x32_bf16 v[4:7], v[132:135], a[0:3], 0
  ds_read_b128 v[156:159], v197 offset:8192
  v_mfma_f32_16x16x32_bf16 v[32:35], v[136:139], a[0:3], 0
  v_mfma_f32_16x16x32_bf16 v[40:43], v[136:139], a[64:67], 0
  v_cvt_pk_bf16_f32 v162, v68, v69
  v_mfma_f32_16x16x32_bf16 v[48:51], v[136:139], a[128:131], 0
  v_cvt_pk_bf16_f32 v163, v70, v71
  v_mfma_f32_16x16x32_bf16 v[56:59], v[136:139], a[192:195], 0
  v_mfma_f32_16x16x32_bf16 v[60:63], v[140:143], a[192:195], 0
  v_mfma_f32_16x16x32_bf16 v[52:55], v[140:143], a[128:131], 0
  buffer_store_dwordx4 v[160:163], v212, s[36:39], s64 offen offset:0 sc1
  v_mfma_f32_16x16x32_bf16 v[44:47], v[140:143], a[64:67], 0
  v_cvt_pk_bf16_f32 v168, v72, v73
  v_mfma_f32_16x16x32_bf16 v[36:39], v[140:143], a[0:3], 0
  s_waitcnt lgkmcnt(0)
  v_mfma_f32_16x16x32_bf16 v[0:3], v[144:147], a[4:7], v[0:3]
  ds_read_b128 v[128:131], v194 offset:0
  v_mfma_f32_16x16x32_bf16 v[8:11], v[144:147], a[68:71], v[8:11]
  v_cvt_pk_bf16_f32 v169, v74, v75
  v_mfma_f32_16x16x32_bf16 v[16:19], v[144:147], a[132:135], v[16:19]
  v_cvt_pk_bf16_f32 v170, v76, v77
  v_mfma_f32_16x16x32_bf16 v[24:27], v[144:147], a[196:199], v[24:27]
  ds_read_b128 v[132:135], v198 offset:0
  v_mfma_f32_16x16x32_bf16 v[28:31], v[148:151], a[196:199], v[28:31]
  ds_read_b128 v[136:139], v194 offset:8192
  v_mfma_f32_16x16x32_bf16 v[20:23], v[148:151], a[132:135], v[20:23]
  v_cvt_pk_bf16_f32 v171, v78, v79
  v_mfma_f32_16x16x32_bf16 v[12:15], v[148:151], a[68:71], v[12:15]
  buffer_store_dwordx4 v[168:171], v212, s[36:39], s64 offen offset:256 sc1
  v_mfma_f32_16x16x32_bf16 v[4:7], v[148:151], a[4:7], v[4:7]
  ds_read_b128 v[140:143], v198 offset:8192
  v_mfma_f32_16x16x32_bf16 v[32:35], v[152:155], a[4:7], v[32:35]
  v_mfma_f32_16x16x32_bf16 v[40:43], v[152:155], a[68:71], v[40:43]
  v_cvt_pk_bf16_f32 v176, v80, v81
  v_mfma_f32_16x16x32_bf16 v[48:51], v[152:155], a[132:135], v[48:51]
  v_cvt_pk_bf16_f32 v177, v82, v83
  v_mfma_f32_16x16x32_bf16 v[56:59], v[152:155], a[196:199], v[56:59]
  v_mfma_f32_16x16x32_bf16 v[60:63], v[156:159], a[196:199], v[60:63]
  v_mfma_f32_16x16x32_bf16 v[52:55], v[156:159], a[132:135], v[52:55]
  v_cvt_pk_bf16_f32 v178, v84, v85
  v_mfma_f32_16x16x32_bf16 v[44:47], v[156:159], a[68:71], v[44:47]
  v_cvt_pk_bf16_f32 v179, v86, v87
  v_mfma_f32_16x16x32_bf16 v[36:39], v[156:159], a[4:7], v[36:39]
  s_waitcnt lgkmcnt(0)
  v_mfma_f32_16x16x32_bf16 v[0:3], v[128:131], a[8:11], v[0:3]
  ds_read_b128 v[144:147], v195 offset:0
  v_mfma_f32_16x16x32_bf16 v[8:11], v[128:131], a[72:75], v[8:11]
  buffer_store_dwordx4 v[176:179], v212, s[36:39], s64 offen offset:2048 sc1
  v_mfma_f32_16x16x32_bf16 v[16:19], v[128:131], a[136:139], v[16:19]
  v_cvt_pk_bf16_f32 v184, v88, v89
  v_mfma_f32_16x16x32_bf16 v[24:27], v[128:131], a[200:203], v[24:27]
  ds_read_b128 v[148:151], v199 offset:0
  v_mfma_f32_16x16x32_bf16 v[28:31], v[132:135], a[200:203], v[28:31]
  ds_read_b128 v[152:155], v195 offset:8192
  v_mfma_f32_16x16x32_bf16 v[20:23], v[132:135], a[136:139], v[20:23]
  v_cvt_pk_bf16_f32 v185, v90, v91
  v_mfma_f32_16x16x32_bf16 v[12:15], v[132:135], a[72:75], v[12:15]
  v_cvt_pk_bf16_f32 v186, v92, v93
  v_mfma_f32_16x16x32_bf16 v[4:7], v[132:135], a[8:11], v[4:7]
  ds_read_b128 v[156:159], v199 offset:8192
  v_mfma_f32_16x16x32_bf16 v[32:35], v[136:139], a[8:11], v[32:35]
  v_mfma_f32_16x16x32_bf16 v[40:43], v[136:139], a[72:75], v[40:43]
  v_cvt_pk_bf16_f32 v187, v94, v95
  v_mfma_f32_16x16x32_bf16 v[48:51], v[136:139], a[136:139], v[48:51]
  buffer_store_dwordx4 v[184:187], v212, s[36:39], s64 offen offset:2304 sc1
  v_mfma_f32_16x16x32_bf16 v[56:59], v[136:139], a[200:203], v[56:59]
  v_mfma_f32_16x16x32_bf16 v[60:63], v[140:143], a[200:203], v[60:63]
  v_mfma_f32_16x16x32_bf16 v[52:55], v[140:143], a[136:139], v[52:55]
  v_mfma_f32_16x16x32_bf16 v[44:47], v[140:143], a[72:75], v[44:47]
  v_mfma_f32_16x16x32_bf16 v[36:39], v[140:143], a[8:11], v[36:39]
  s_waitcnt vmcnt(16)
  s_barrier
  s_cmp_lg_u32 s40, 0
  s_cbranch_scc1 Lg_38
  s_cmp_lt_i32 s70, s71
  s_cbranch_scc1 Lg_38
  s_cmp_lg_u32 s101, 0
  s_cbranch_scc1 Li_42
  v_readfirstlane_b32 s101, v252
  s_nop 0
  s_cmp_lg_u32 s101, 0
  s_cbranch_scc1 Li_42
Li_41:
  buffer_load_dword v252, off, s[84:87], 0 offset:144 sc1
  s_waitcnt vmcnt(0)
  v_readfirstlane_b32 s101, v252
  s_add_u32 s91, s91, 1
  s_cmp_gt_u32 s91, 0x20000
  s_cbranch_scc1 L_abort
  s_cmp_eq_u32 s101, 0
  s_cbranch_scc1 Li_41
Li_42:
  s_cmp_lg_u32 s56, 0
  s_cbranch_scc1 Lg_39
  s_lshl_b32 s41, s57, 3
  s_lshl_b32 s41, 1, s41
  s_mov_b64 exec, 1
  s_add_u32 s42, s70, 1
  s_lshl_b32 s42, s42, 1
  v_mov_b32 v249, s42
  s_add_u32 s42, s58, 168
  s_lshl_b32 s42, s42, 7
  s_cmp_lg_u32 s57, 0
  s_cselect_b32 s42, 0x10000000, s42
  buffer_store_dword v249, v253, s[36:39], s42 offen sc1
  s_add_u32 s42, s70, 136
  s_branch Lg_40
Lg_39:
  s_and_b32 s41, s70, 3
  s_cmp_lg_u32 s41, 3
  s_cbranch_scc1 Lg_38
  s_lshr_b32 s41, s70, 2
  s_lshl_b32 s42, s57, 3
  s_add_u32 s41, s41, s42
  s_lshl_b32 s41, 1, s41
  s_lshl_b32 s42, s58, s57
  s_add_u32 s42, s42, 32
  s_lshl_b32 s43, s57, 1
  s_add_u32 exec_lo, s43, 1
  s_mov_b32 exec_hi, 0
Lg_40:
  s_lshl_b32 s42, s42, 7
  v_mov_b32 v250, s41
  buffer_atomic_add v250, v253, s[36:39], s42 offen
  s_mov_b64 exec, -1
Lg_38:
  s_add_u32 s70, s70, 1
  s_waitcnt lgkmcnt(0)
  v_mfma_f32_16x16x32_bf16 v[0:3], v[144:147], a[12:15], v[0:3]
  ds_read_b128 v[128:131], v192 offset:16384
  v_mfma_f32_16x16x32_bf16 v[8:11], v[144:147], a[76:79], v[8:11]
  s_add_u32 m0, s67, 0x1c000
  s_add_u32 s68, s61, 0x10300
  v_mfma_f32_16x16x32_bf16 v[16:19], v[144:147], a[140:143], v[16:19]
  buffer_load_dwordx4 v208, s[48:51], s68 offen offset:0  lds
  v_mfma_f32_16x16x32_bf16 v[24:27], v[144:147], a[204:207], v[24:27]
  ds_read_b128 v[132:135], v196 offset:16384
  v_mfma_f32_16x16x32_bf16 v[28:31], v[148:151], a[204:207], v[28:31]
  ds_read_b128 v[136:139], v192 offset:24576
  v_mfma_f32_16x16x32_bf16 v[20:23], v[148:151], a[140:143], v[20:23]
  v_mfma_f32_16x16x32_bf16 v[12:15], v[148:151], a[76:79], v[12:15]
  buffer_load_dwordx4 v209, s[48:51], s68 offen offset:1024  lds
  v_mfma_f32_16x16x32_bf16 v[4:7], v[148:151], a[12:15], v[4:7]
  ds_read_b128 v[140:143], v196 offset:24576
  v_mfma_f32_16x16x32_bf16 v[32:35], v[152:155], a[12:15], v[32:35]
  v_mfma_f32_16x16x32_bf16 v[40:43], v[152:155], a[76:79], v[40:43]
  v_mfma_f32_16x16x32_bf16 v[48:51], v[152:155], a[140:143], v[48:51]
  buffer_load_dwordx4 v210, s[48:51], s68 offen offset:2048  lds
  v_mfma_f32_16x16x32_bf16 v[56:59], v[152:155], a[204:207], v[56:59]
  v_mfma_f32_16x16x32_bf16 v[60:63], v[156:159], a[204:207], v[60:63]
  v_mfma_f32_16x16x32_bf16 v[52:55], v[156:159], a[140:143], v[52:55]
  v_mfma_f32_16x16x32_bf16 v[44:47], v[156:159], a[76:79], v[44:47]
  buffer_load_dwordx4 v211, s[48:51], s68 offen offset:3072  lds
  v_mfma_f32_16x16x32_bf16 v[36:39], v[156:159], a[12:15], v[36:39]
  s_waitcnt lgkmcnt(0)
  v_mfma_f32_16x16x32_bf16 v[0:3], v[128:131], a[16:19], v[0:3]
  ds_read_b128 v[144:147], v193 offset:16384
  v_mfma_f32_16x16x32_bf16 v[8:11], v[128:131], a[80:83], v[8:11]
  v_cvt_pk_bf16_f32 v160, v96, v97
  v_mfma_f32_16x16x32_bf16 v[16:19], v[128:131], a[144:147], v[16:19]
  v_cvt_pk_bf16_f32 v161, v98, v99
  v_mfma_f32_16x16x32_bf16 v[24:27], v[128:131], a[208:211], v[24:27]
  ds_read_b128 v[148:151], v197 offset:16384
  v_mfma_f32_16x16x32_bf16 v[28:31], v[132:135], a[208:211], v[28:31]
  ds_read_b128 v[152:155], v193 offset:24576
  v_mfma_f32_16x16x32_bf16 v[20:23], v[132:135], a[144:147], v[20:23]
  v_cvt_pk_bf16_f32 v162, v100, v101
  v_mfma_f32_16x16x32_bf16 v[12:15], v[132:135], a[80:83], v[12:15]
  v_cvt_pk_bf16_f32 v163, v102, v103
  v_mfma_f32_16x16x32_bf16 v[4:7], v[132:135], a[16:19], v[4:7]
  ds_read_b128 v[156:159], v197 offset:24576
  v_mfma_f32_16x16x32_bf16 v[32:35], v[136:139], a[16:19], v[32:35]
  v_mfma_f32_16x16x32_bf16 v[40:43], v[136:139], a[80:83], v[40:43]
  buffer_store_dwordx4 v[160:163], v213, s[36:39], s64 offen offset:0 sc1
  v_mfma_f32_16x16x32_bf16 v[48:51], v[136:139], a[144:147], v[48:51]
  v_cvt_pk_bf16_f32 v168, v104, v105
  v_mfma_f32_16x16x32_bf16 v[56:59], v[136:139], a[208:211], v[56:59]
  v_mfma_f32_16x16x32_bf16 v[60:63], v[140:143], a[208:211], v[60:63]
  v_mfma_f32_16x16x32_bf16 v[52:55], v[140:143], a[144:147], v[52:55]
  v_cvt_pk_bf16_f32 v169, v106, v107
  v_mfma_f32_16x16x32_bf16 v[44:47], v[140:143], a[80:83], v[44:47]
  v_cvt_pk_bf16_f32 v170, v108, v109
  v_mfma_f32_16x16x32_bf16 v[36:39], v[140:143], a[16:19], v[36:39]
  s_waitcnt lgkmcnt(0)
  v_mfma_f32_16x16x32_bf16 v[0:3], v[144:147], a[20:23], v[0:3]
  ds_read_b128 v[128:131], v194 offset:16384
  v_mfma_f32_16x16x32_bf16 v[8:11], v[144:147], a[84:87], v[8:11]
  v_cvt_pk_bf16_f32 v171, v110, v111
  v_mfma_f32_16x16x32_bf16 v[16:19], v[144:147], a[148:151], v[16:19]
  buffer_store_dwordx4 v[168:171], v213, s[36:39], s64 offen offset:256 sc1
  v_mfma_f32_16x16x32_bf16 v[24:27], v[144:147], a[212:215], v[24:27]
  ds_read_b128 v[132:135], v198 offset:16384
  v_mfma_f32_16x16x32_bf16 v[28:31], v[148:151], a[212:215], v[28:31]
  ds_read_b128 v[136:139], v194 offset:24576
  v_mfma_f32_16x16x32_bf16 v[20:23], v[148:151], a[148:151], v[20:23]
  v_cvt_pk_bf16_f32 v176, v112, v113
  v_mfma_f32_16x16x32_bf16 v[12:15], v[148:151], a[84:87], v[12:15]
  v_cvt_pk_bf16_f32 v177, v114, v115
  v_mfma_f32_16x16x32_bf16 v[4:7], v[148:151], a[20:23], v[4:7]
  ds_read_b128 v[140:143], v198 offset:24576
  v_mfma_f32_16x16x32_bf16 v[32:35], v[152:155], a[20:23], v[32:35]
  v_mfma_f32_16x16x32_bf16 v[40:43], v[152:155], a[84:87], v[40:43]
  v_cvt_pk_bf16_f32 v178, v116, v117
  v_mfma_f32_16x16x32_bf16 v[48:51], v[152:155], a[148:151], v[48:51]
  v_cvt_pk_bf16_f32 v179, v118, v119
  v_mfma_f32_16x16x32_bf16 v[56:59], v[152:155], a[212:215], v[56:59]
  v_mfma_f32_16x16x32_bf16 v[60:63], v[156:159], a[212:215], v[60:63]
  v_mfma_f32_16x16x32_bf16 v[52:55], v[156:159], a[148:151], v[52:55]
  buffer_store_dwordx4 v[176:179], v213, s[36:39], s64 offen offset:2048 sc1
  v_mfma_f32_16x16x32_bf16 v[44:47], v[156:159], a[84:87], v[44:47]
  v_cvt_pk_bf16_f32 v184, v120, v121
  v_mfma_f32_16x16x32_bf16 v[36:39], v[156:159], a[20:23], v[36:39]
  s_waitcnt lgkmcnt(0)
  v_mfma_f32_16x16x32_bf16 v[0:3], v[128:131], a[24:27], v[0:3]
  ds_read_b128 v[144:147], v195 offset:16384
  v_mfma_f32_16x16x32_bf16 v[8:11], v[128:131], a[88:91], v[8:11]
  v_cvt_pk_bf16_f32 v185, v122, v123
  v_mfma_f32_16x16x32_bf16 v[16:19], v[128:131], a[152:155], v[16:19]
  v_cvt_pk_bf16_f32 v186, v124, v125
  v_mfma_f32_16x16x32_bf16 v[24:27], v[128:131], a[216:219], v[24:27]
  ds_read_b128 v[148:151], v199 offset:16384
  v_mfma_f32_16x16x32_bf16 v[28:31], v[132:135], a[216:219], v[28:31]
  ds_read_b128 v[152:155], v195 offset:24576
  v_mfma_f32_16x16x32_bf16 v[20:23], v[132:135], a[152:155], v[20:23]
  v_cvt_pk_bf16_f32 v187, v126, v127
  v_mfma_f32_16x16x32_bf16 v[12:15], v[132:135], a[88:91], v[12:15]
  buffer_store_dwordx4 v[184:187], v213, s[36:39], s64 offen offset:2304 sc1
  v_mfma_f32_16x16x32_bf16 v[4:7], v[132:135], a[24:27], v[4:7]
  ds_read_b128 v[156:159], v199 offset:24576
  v_mfma_f32_16x16x32_bf16 v[32:35], v[136:139], a[24:27], v[32:35]
  v_mfma_f32_16x16x32_bf16 v[40:43], v[136:139], a[88:91], v[40:43]
  v_mfma_f32_16x16x32_bf16 v[48:51], v[136:139], a[152:155], v[48:51]
  v_mfma_f32_16x16x32_bf16 v[56:59], v[136:139], a[216:219], v[56:59]
  v_mfma_f32_16x16x32_bf16 v[60:63], v[140:143], a[216:219], v[60:63]
  v_mfma_f32_16x16x32_bf16 v[52:55], v[140:143], a[152:155], v[52:55]
  v_mfma_f32_16x16x32_bf16 v[44:47], v[140:143], a[88:91], v[44:47]
  v_mfma_f32_16x16x32_bf16 v[36:39], v[140:143], a[24:27], v[36:39]
  s_waitcnt vmcnt(36)
  s_barrier
  s_waitcnt lgkmcnt(0)
  v_mfma_f32_16x16x32_bf16 v[0:3], v[144:147], a[28:31], v[0:3]
  ds_read_b128 v[128:131], v192 offset:32768
  v_mfma_f32_16x16x32_bf16 v[8:11], v[144:147], a[92:95], v[8:11]
  s_add_u32 m0, s67, 0x0
  s_add_u32 s68, s62, 0x0
  v_mfma_f32_16x16x32_bf16 v[16:19], v[144:147], a[156:159], v[16:19]
  buffer_load_dwordx4 v208, s[48:51], s68 offen offset:0  lds
  v_mfma_f32_16x16x32_bf16 v[24:27], v[144:147], a[220:223], v[24:27]
  ds_read_b128 v[132:135], v196 offset:32768
  v_mfma_f32_16x16x32_bf16 v[28:31], v[148:151], a[220:223], v[28:31]
  ds_read_b128 v[136:139], v192 offset:40960
  v_mfma_f32_16x16x32_bf16 v[20:23], v[148:151], a[156:159], v[20:23]
  v_mfma_f32_16x16x32_bf16 v[12:15], v[148:151], a[92:95], v[12:15]
  buffer_load_dwordx4 v209, s[48:51], s68 offen offset:1024  lds
  v_mfma_f32_16x16x32_bf16 v[4:7], v[148:151], a[28:31], v[4:7]
  ds_read_b128 v[140:143], v196 offset:40960
  v_mfma_f32_16x16x32_bf16 v[32:35], v[152:155], a[28:31], v[32:35]
  v_mfma_f32_16x16x32_bf16 v[40:43], v[152:155], a[92:95], v[40:43]
  v_mfma_f32_16x16x32_bf16 v[48:51], v[152:155], a[156:159], v[48:51]
  buffer_load_dwordx4 v210, s[48:51], s68 offen offset:2048  lds
  v_mfma_f32_16x16x32_bf16 v[56:59], v[152:155], a[220:223], v[56:59]
  v_mfma_f32_16x16x32_bf16 v[60:63], v[156:159], a[220:223], v[60:63]
  v_mfma_f32_16x16x32_bf16 v[52:55], v[156:159], a[156:159], v[52:55]
  v_mfma_f32_16x16x32_bf16 v[44:47], v[156:159], a[92:95], v[44:47]
  buffer_load_dwordx4 v211, s[48:51], s68 offen offset:3072  lds
  v_mfma_f32_16x16x32_bf16 v[36:39], v[156:159], a[28:31], v[36:39]
  s_waitcnt lgkmcnt(0)
  v_mfma_f32_16x16x32_bf16 v[0:3], v[128:131], a[32:35], v[0:3]
  ds_read_b128 v[144:147], v193 offset:32768
  v_mfma_f32_16x16x32_bf16 v[8:11], v[128:131], a[96:99], v[8:11]
  v_mfma_f32_16x16x32_bf16 v[16:19], v[128:131], a[160:163], v[16:19]
  v_mfma_f32_16x16x32_bf16 v[24:27], v[128:131], a[224:227], v[24:27]
  ds_read_b128 v[148:151], v197 offset:32768
  v_mfma_f32_16x16x32_bf16 v[28:31], v[132:135], a[224:227], v[28:31]
  ds_read_b128 v[152:155], v193 offset:40960
  v_mfma_f32_16x16x32_bf16 v[20:23], v[132:135], a[160:163], v[20:23]
  v_mfma_f32_16x16x32_bf16 v[12:15], v[132:135], a[96:99], v[12:15]
  v_mfma_f32_16x16x32_bf16 v[4:7], v[132:135], a[32:35], v[4:7]
  ds_read_b128 v[156:159], v197 offset:40960
  v_mfma_f32_16x16x32_bf16 v[32:35], v[136:139], a[32:35], v[32:35]
  v_mfma_f32_16x16x32_bf16 v[40:43], v[136:139], a[96:99], v[40:43]
  v_mfma_f32_16x16x32_bf16 v[48:51], v[136:139], a[160:163], v[48:51]
  v_mfma_f32_16x16x32_bf16 v[56:59], v[136:139], a[224:227], v[56:59]
  v_mfma_f32_16x16x32_bf16 v[60:63], v[140:143], a[224:227], v[60:63]
  v_mfma_f32_16x16x32_bf16 v[52:55], v[140:143], a[160:163], v[52:55]
  v_mfma_f32_16x16x32_bf16 v[44:47], v[140:143], a[96:99], v[44:47]
  v_mfma_f32_16x16x32_bf16 v[36:39], v[140:143], a[32:35], v[36:39]
  s_waitcnt lgkmcnt(0)
  v_mfma_f32_16x16x32_bf16 v[0:3], v[144:147], a[36:39], v[0:3]
  ds_read_b128 v[128:131], v194 offset:32768
  v_mfma_f32_16x16x32_bf16 v[8:11], v[144:147], a[100:103], v[8:11]
  v_mfma_f32_16x16x32_bf16 v[16:19], v[144:147], a[164:167], v[16:19]
  v_mfma_f32_16x16x32_bf16 v[24:27], v[144:147], a[228:231], v[24:27]
  ds_read_b128 v[132:135], v198 offset:32768
  v_mfma_f32_16x16x32_bf16 v[28:31], v[148:151], a[228:231], v[28:31]
  ds_read_b128 v[136:139], v194 offset:40960
  v_mfma_f32_16x16x32_bf16 v[20:23], v[148:151], a[164:167], v[20:23]
  v_mfma_f32_16x16x32_bf16 v[12:15], v[148:151], a[100:103], v[12:15]
  v_mfma_f32_16x16x32_bf16 v[4:7], v[148:151], a[36:39], v[4:7]
  ds_read_b128 v[140:143], v198 offset:40960
  v_mfma_f32_16x16x32_bf16 v[32:35], v[152:155], a[36:39], v[32:35]
  v_mfma_f32_16x16x32_bf16 v[40:43], v[152:155], a[100:103], v[40:43]
  v_mfma_f32_16x16x32_bf16 v[48:51], v[152:155], a[164:167], v[48:51]
  v_mfma_f32_16x16x32_bf16 v[56:59], v[152:155], a[228:231], v[56:59]
  v_mfma_f32_16x16x32_bf16 v[60:63], v[156:159], a[228:231], v[60:63]
  v_mfma_f32_16x16x32_bf16 v[52:55], v[156:159], a[164:167], v[52:55]
  v_mfma_f32_16x16x32_bf16 v[44:47], v[156:159], a[100:103], v[44:47]
  v_mfma_f32_16x16x32_bf16 v[36:39], v[156:159], a[36:39], v[36:39]
  s_waitcnt lgkmcnt(0)
  v_mfma_f32_16x16x32_bf16 v[0:3], v[128:131], a[40:43], v[0:3]
  ds_read_b128 v[144:147], v195 offset:32768
  v_mfma_f32_16x16x32_bf16 v[8:11], v[128:131], a[104:107], v[8:11]
  v_mfma_f32_16x16x32_bf16 v[16:19], v[128:131], a[168:171], v[16:19]
  v_mfma_f32_16x16x32_bf16 v[24:27], v[128:131], a[232:235], v[24:27]
  ds_read_b128 v[148:151], v199 offset:32768
  v_mfma_f32_16x16x32_bf16 v[28:31], v[132:135], a[232:235], v[28:31]
  ds_read_b128 v[152:155], v195 offset:40960
  v_mfma_f32_16x16x32_bf16 v[20:23], v[132:135], a[168:171], v[20:23]
  v_mfma_f32_16x16x32_bf16 v[12:15], v[132:135], a[104:107], v[12:15]
  v_mfma_f32_16x16x32_bf16 v[4:7], v[132:135], a[40:43], v[4:7]
  ds_read_b128 v[156:159], v199 offset:40960
  v_mfma_f32_16x16x32_bf16 v[32:35], v[136:139], a[40:43], v[32:35]
  v_mfma_f32_16x16x32_bf16 v[40:43], v[136:139], a[104:107], v[40:43]
  v_mfma_f32_16x16x32_bf16 v[48:51], v[136:139], a[168:171], v[48:51]
  v_mfma_f32_16x16x32_bf16 v[56:59], v[136:139], a[232:235], v[56:59]
  v_mfma_f32_16x16x32_bf16 v[60:63], v[140:143], a[232:235], v[60:63]
  v_mfma_f32_16x16x32_bf16 v[52:55], v[140:143], a[168:171], v[52:55]
  v_mfma_f32_16x16x32_bf16 v[44:47], v[140:143], a[104:107], v[44:47]
  v_mfma_f32_16x16x32_bf16 v[36:39], v[140:143], a[40:43], v[36:39]
  s_waitcnt vmcnt(32)
  s_barrier
  s_waitcnt lgkmcnt(0)
  v_mfma_f32_16x16x32_bf16 v[0:3], v[144:147], a[44:47], v[0:3]
  ds_read_b128 v[128:131], v192 offset:49152
  v_mfma_f32_16x16x32_bf16 v[8:11], v[144:147], a[108:111], v[8:11]
  s_add_u32 m0, s67, 0x4000
  s_add_u32 s68, s62, 0x100
  v_mfma_f32_16x16x32_bf16 v[16:19], v[144:147], a[172:175], v[16:19]
  buffer_load_dwordx4 v208, s[48:51], s68 offen offset:0  lds
  v_mfma_f32_16x16x32_bf16 v[24:27], v[144:147], a[236:239], v[24:27]
  ds_read_b128 v[132:135], v196 offset:49152
  v_mfma_f32_16x16x32_bf16 v[28:31], v[148:151], a[236:239], v[28:31]
  ds_read_b128 v[136:139], v192 offset:57344
  v_mfma_f32_16x16x32_bf16 v[20:23], v[148:151], a[172:175], v[20:23]
  v_mfma_f32_16x16x32_bf16 v[12:15], v[148:151], a[108:111], v[12:15]
  buffer_load_dwordx4 v209, s[48:51], s68 offen offset:1024  lds
  v_mfma_f32_16x16x32_bf16 v[4:7], v[148:151], a[44:47], v[4:7]
  ds_read_b128 v[140:143], v196 offset:57344
  v_mfma_f32_16x16x32_bf16 v[32:35], v[152:155], a[44:47], v[32:35]
  v_mfma_f32_16x16x32_bf16 v[40:43], v[152:155], a[108:111], v[40:43]
  v_mfma_f32_16x16x32_bf16 v[48:51], v[152:155], a[172:175], v[48:51]
  buffer_load_dwordx4 v210, s[48:51], s68 offen offset:2048  lds
  v_mfma_f32_16x16x32_bf16 v[56:59], v[152:155], a[236:239], v[56:59]
  v_mfma_f32_16x16x32_bf16 v[60:63], v[156:159], a[236:239], v[60:63]
  v_mfma_f32_16x16x32_bf16 v[52:55], v[156:159], a[172:175], v[52:55]
  v_mfma_f32_16x16x32_bf16 v[44:47], v[156:159], a[108:111], v[44:47]
  buffer_load_dwordx4 v211, s[48:51], s68 offen offset:3072  lds
  v_mfma_f32_16x16x32_bf16 v[36:39], v[156:159], a[44:47], v[36:39]
  s_waitcnt lgkmcnt(0)
  v_mfma_f32_16x16x32_bf16 v[0:3], v[128:131], a[48:51], v[0:3]
  ds_read_b128 v[144:147], v193 offset:49152
  v_mfma_f32_16x16x32_bf16 v[8:11], v[128:131], a[112:115], v[8:11]
  v_mfma_f32_16x16x32_bf16 v[16:19], v[128:131], a[176:179], v[16:19]
  v_mfma_f32_16x16x32_bf16 v[24:27], v[128:131], a[240:243], v[24:27]
  ds_read_b128 v[148:151], v197 offset:49152
  v_mfma_f32_16x16x32_bf16 v[28:31], v[132:135], a[240:243], v[28:31]
  ds_read_b128 v[152:155], v193 offset:57344
  v_mfma_f32_16x16x32_bf16 v[20:23], v[132:135], a[176:179], v[20:23]
  v_mfma_f32_16x16x32_bf16 v[12:15], v[132:135], a[112:115], v[12:15]
  v_mfma_f32_16x16x32_bf16 v[4:7], v[132:135], a[48:51], v[4:7]
  ds_read_b128 v[156:159], v197 offset:57344
  v_mfma_f32_16x16x32_bf16 v[32:35], v[136:139], a[48:51], v[32:35]
  v_mfma_f32_16x16x32_bf16 v[40:43], v[136:139], a[112:115], v[40:43]
  v_mfma_f32_16x16x32_bf16 v[48:51], v[136:139], a[176:179], v[48:51]
  v_mfma_f32_16x16x32_bf16 v[56:59], v[136:139], a[240:243], v[56:59]
  v_mfma_f32_16x16x32_bf16 v[60:63], v[140:143], a[240:243], v[60:63]
  v_mfma_f32_16x16x32_bf16 v[52:55], v[140:143], a[176:179], v[52:55]
  v_mfma_f32_16x16x32_bf16 v[44:47], v[140:143], a[112:115], v[44:47]
  v_mfma_f32_16x16x32_bf16 v[36:39], v[140:143], a[48:51], v[36:39]
  s_waitcnt lgkmcnt(0)
  v_mfma_f32_16x16x32_bf16 v[0:3], v[144:147], a[52:55], v[0:3]
  ds_read_b128 v[128:131], v194 offset:49152
  v_mfma_f32_16x16x32_bf16 v[8:11], v[144:147], a[116:119], v[8:11]
  v_mfma_f32_16x16x32_bf16 v[16:19], v[144:147], a[180:183], v[16:19]
  v_mfma_f32_16x16x32_bf16 v[24:27], v[144:147], a[244:247], v[24:27]
  ds_read_b128 v[132:135], v198 offset:49152
  v_mfma_f32_16x16x32_bf16 v[28:31], v[148:151], a[244:247], v[28:31]
  ds_read_b128 v[136:139], v194 offset:57344
  v_mfma_f32_16x16x32_bf16 v[20:23], v[148:151], a[180:183], v[20:23]
  v_mfma_f32_16x16x32_bf16 v[12:15], v[148:151], a[116:119], v[12:15]
  v_mfma_f32_16x16x32_bf16 v[4:7], v[148:151], a[52:55], v[4:7]
  ds_read_b128 v[140:143], v198 offset:57344
  v_mfma_f32_16x16x32_bf16 v[32:35], v[152:155], a[52:55], v[32:35]
  v_mfma_f32_16x16x32_bf16 v[40:43], v[152:155], a[116:119], v[40:43]
  v_mfma_f32_16x16x32_bf16 v[48:51], v[152:155], a[180:183], v[48:51]
  v_mfma_f32_16x16x32_bf16 v[56:59], v[152:155], a[244:247], v[56:59]
  v_mfma_f32_16x16x32_bf16 v[60:63], v[156:159], a[244:247], v[60:63]
  v_mfma_f32_16x16x32_bf16 v[52:55], v[156:159], a[180:183], v[52:55]
  v_mfma_f32_16x16x32_bf16 v[44:47], v[156:159], a[116:119], v[44:47]
  v_mfma_f32_16x16x32_bf16 v[36:39], v[156:159], a[52:55], v[36:39]
  s_waitcnt lgkmcnt(0)
  v_mfma_f32_16x16x32_bf16 v[0:3], v[128:131], a[56:59], v[0:3]
  ds_read_b128 v[144:147], v195 offset:49152
  v_mfma_f32_16x16x32_bf16 v[8:11], v[128:131], a[120:123], v[8:11]
  v_mfma_f32_16x16x32_bf16 v[16:19], v[128:131], a[184:187], v[16:19]
  v_mfma_f32_16x16x32_bf16 v[24:27], v[128:131], a[248:251], v[24:27]
  ds_read_b128 v[148:151], v199 offset:49152
  v_mfma_f32_16x16x32_bf16 v[28:31], v[132:135], a[248:251], v[28:31]
  ds_read_b128 v[152:155], v195 offset:57344
  v_mfma_f32_16x16x32_bf16 v[20:23], v[132:135], a[184:187], v[20:23]
  v_mfma_f32_16x16x32_bf16 v[12:15], v[132:135], a[120:123], v[12:15]
  v_mfma_f32_16x16x32_bf16 v[4:7], v[132:135], a[56:59], v[4:7]
  ds_read_b128 v[156:159], v199 offset:57344
  v_mfma_f32_16x16x32_bf16 v[32:35], v[136:139], a[56:59], v[32:35]
  v_mfma_f32_16x16x32_bf16 v[40:43], v[136:139], a[120:123], v[40:43]
  v_mfma_f32_16x16x32_bf16 v[48:51], v[136:139], a[184:187], v[48:51]
  v_mfma_f32_16x16x32_bf16 v[56:59], v[136:139], a[248:251], v[56:59]
  v_mfma_f32_16x16x32_bf16 v[60:63], v[140:143], a[248:251], v[60:63]
  v_mfma_f32_16x16x32_bf16 v[52:55], v[140:143], a[184:187], v[52:55]
  v_mfma_f32_16x16x32_bf16 v[44:47], v[140:143], a[120:123], v[44:47]
  v_mfma_f32_16x16x32_bf16 v[36:39], v[140:143], a[56:59], v[36:39]
  s_waitcnt vmcnt(28)
  s_barrier
  s_waitcnt lgkmcnt(0)
  v_mfma_f32_16x16x32_bf16 v[0:3], v[144:147], a[60:63], v[0:3]
  ds_read_b128 v[128:131], v200 offset:0
  v_mfma_f32_16x16x32_bf16 v[8:11], v[144:147], a[124:127], v[8:11]
  s_add_u32 m0, s67, 0x8000
  s_add_u32 s68, s62, 0x200
  v_mfma_f32_16x16x32_bf16 v[16:19], v[144:147], a[188:191], v[16:19]
  buffer_load_dwordx4 v208, s[48:51], s68 offen offset:0  lds
  v_mfma_f32_16x16x32_bf16 v[24:27], v[144:147], a[252:255], v[24:27]
  ds_read_b128 v[132:135], v204 offset:0
  v_mfma_f32_16x16x32_bf16 v[28:31], v[148:151], a[252:255], v[28:31]
  ds_read_b128 v[136:139], v200 offset:8192
  v_mfma_f32_16x16x32_bf16 v[20:23], v[148:151], a[188:191], v[20:23]
  v_mfma_f32_16x16x32_bf16 v[12:15], v[148:151], a[124:127], v[12:15]
  buffer_load_dwordx4 v209, s[48:51], s68 offen offset:1024  lds
  v_mfma_f32_16x16x32_bf16 v[4:7], v[148:151], a[60:63], v[4:7]
  ds_read_b128 v[140:143], v204 offset:8192
  v_mfma_f32_16x16x32_bf16 v[32:35], v[152:155], a[60:63], v[32:35]
  v_mfma_f32_16x16x32_bf16 v[40:43], v[152:155], a[124:127], v[40:43]
  v_mfma_f32_16x16x32_bf16 v[48:51], v[152:155], a[188:191], v[48:51]
  buffer_load_dwordx4 v210, s[48:51], s68 offen offset:2048  lds
  v_mfma_f32_16x16x32_bf16 v[56:59], v[152:155], a[252:255], v[56:59]
  v_mfma_f32_16x16x32_bf16 v[60:63], v[156:159], a[252:255], v[60:63]
  v_mfma_f32_16x16x32_bf16 v[52:55], v[156:159], a[188:191], v[52:55]
  v_mfma_f32_16x16x32_bf16 v[44:47], v[156:159], a[124:127], v[44:47]
  buffer_load_dwordx4 v211, s[48:51], s68 offen offset:3072  lds
  v_mfma_f32_16x16x32_bf16 v[36:39], v[156:159], a[60:63], v[36:39]
  s_waitcnt lgkmcnt(0)
  v_mfma_f32_16x16x32_bf16 v[64:67], v[128:131], a[0:3], 0
  ds_read_b128 v[144:147], v201 offset:0
  v_mfma_f32_16x16x32_bf16 v[72:75], v[128:131], a[64:67], 0
  v_mfma_f32_16x16x32_bf16 v[80:83], v[128:131], a[128:131], 0
  v_mfma_f32_16x16x32_bf16 v[88:91], v[128:131], a[192:195], 0
  ds_read_b128 v[148:151], v205 offset:0
  v_mfma_f32_16x16x32_bf16 v[92:95], v[132:135], a[192:195], 0
  ds_read_b128 v[152:155], v201 offset:8192
  v_mfma_f32_16x16x32_bf16 v[84:87], v[132:135], a[128:131], 0
  v_cvt_pk_bf16_f32 v160, v0, v1
  v_mfma_f32_16x16x32_bf16 v[76:79], v[132:135], a[64:67], 0
  v_cvt_pk_bf16_f32 v161, v2, v3
  v_mfma_f32_16x16x32_bf16 v[68:71], v[132:135], a[0:3], 0
  ds_read_b128 v[156:159], v205 offset:8192
  v_mfma_f32_16x16x32_bf16 v[96:99], v[136:139], a[0:3], 0
  v_mfma_f32_16x16x32_bf16 v[104:107], v[136:139], a[64:67], 0
  v_cvt_pk_bf16_f32 v162, v4, v5
  v_mfma_f32_16x16x32_bf16 v[112:115], v[136:139], a[128:131], 0
  v_cvt_pk_bf16_f32 v163, v6, v7
  v_mfma_f32_16x16x32_bf16 v[120:123], v[136:139], a[192:195], 0
  v_mfma_f32_16x16x32_bf16 v[124:127], v[140:143], a[192:195], 0
  v_mfma_f32_16x16x32_bf16 v[116:119], v[140:143], a[128:131], 0
  buffer_store_dwordx4 v[160:163], v212, s[36:39], s63 offen offset:0 sc1
  v_mfma_f32_16x16x32_bf16 v[108:111], v[140:143], a[64:67], 0
  v_cvt_pk_bf16_f32 v168, v8, v9
  v_mfma_f32_16x16x32_bf16 v[100:103], v[140:143], a[0:3], 0
  s_waitcnt lgkmcnt(0)
  v_mfma_f32_16x16x32_bf16 v[64:67], v[144:147], a[4:7], v[64:67]
  ds_read_b128 v[128:131], v202 offset:0
  v_mfma_f32_16x16x32_bf16 v[72:75], v[144:147], a[68:71], v[72:75]
  v_cvt_pk_bf16_f32 v169, v10, v11
  v_mfma_f32_16x16x32_bf16 v[80:83], v[144:147], a[132:135], v[80:83]
  v_cvt_pk_bf16_f32 v170, v12, v13
  v_mfma_f32_16x16x32_bf16 v[88:91], v[144:147], a[196:199], v[88:91]
  ds_read_b128 v[132:135], v206 offset:0
  v_mfma_f32_16x16x32_bf16 v[92:95], v[148:151], a[196:199], v[92:95]
  ds_read_b128 v[136:139], v202 offset:8192
  v_mfma_f32_16x16x32_bf16 v[84:87], v[148:151], a[132:135], v[84:87]
  v_cvt_pk_bf16_f32 v171, v14, v15
  v_mfma_f32_16x16x32_bf16 v[76:79], v[148:151], a[68:71], v[76:79]
  buffer_store_dwordx4 v[168:171], v212, s[36:39], s63 offen offset:256 sc1
  v_mfma_f32_16x16x32_bf16 v[68:71], v[148:151], a[4:7], v[68:71]
  ds_read_b128 v[140:143], v206 offset:8192
  v_mfma_f32_16x16x32_bf16 v[96:99], v[152:155], a[4:7], v[96:99]
  v_mfma_f32_16x16x32_bf16 v[104:107], v[152:155], a[68:71], v[104:107]
  v_cvt_pk_bf16_f32 v176, v16, v17
  v_mfma_f32_16x16x32_bf16 v[112:115], v[152:155], a[132:135], v[112:115]
  v_cvt_pk_bf16_f32 v177, v18, v19
  v_mfma_f32_16x16x32_bf16 v[120:123], v[152:155], a[196:199], v[120:123]
  v_mfma_f32_16x16x32_bf16 v[124:127], v[156:159], a[196:199], v[124:127]
  v_mfma_f32_16x16x32_bf16 v[116:119], v[156:159], a[132:135], v[116:119]
  v_cvt_pk_bf16_f32 v178, v20, v21
  v_mfma_f32_16x16x32_bf16 v[108:111], v[156:159], a[68:71], v[108:111]
  v_cvt_pk_bf16_f32 v179, v22, v23
  v_mfma_f32_16x16x32_bf16 v[100:103], v[156:159], a[4:7], v[100:103]
  s_waitcnt lgkmcnt(0)
  v_mfma_f32_16x16x32_bf16 v[64:67], v[128:131], a[8:11], v[64:67]
  ds_read_b128 v[144:147], v203 offset:0
  v_mfma_f32_16x16x32_bf16 v[72:75], v[128:131], a[72:75], v[72:75]
  buffer_store_dwordx4 v[176:179], v212, s[36:39], s63 offen offset:2048 sc1
  v_mfma_f32_16x16x32_bf16 v[80:83], v[128:131], a[136:139], v[80:83]
  v_cvt_pk_bf16_f32 v184, v24, v25
  v_mfma_f32_16x16x32_bf16 v[88:91], v[128:131], a[200:203], v[88:91]
  ds_read_b128 v[148:151], v207 offset:0
  v_mfma_f32_16x16x32_bf16 v[92:95], v[132:135], a[200:203], v[92:95]
  ds_read_b128 v[152:155], v203 offset:8192
  v_mfma_f32_16x16x32_bf16 v[84:87], v[132:135], a[136:139], v[84:87]
  v_cvt_pk_bf16_f32 v185, v26, v27
  v_mfma_f32_16x16x32_bf16 v[76:79], v[132:135], a[72:75], v[76:79]
  v_cvt_pk_bf16_f32 v186, v28, v29
  v_mfma_f32_16x16x32_bf16 v[68:71], v[132:135], a[8:11], v[68:71]
  ds_read_b128 v[156:159], v207 offset:8192
  v_mfma_f32_16x16x32_bf16 v[96:99], v[136:139], a[8:11], v[96:99]
  v_mfma_f32_16x16x32_bf16 v[104:107], v[136:139], a[72:75], v[104:107]
  v_cvt_pk_bf16_f32 v187, v30, v31
  v_mfma_f32_16x16x32_bf16 v[112:115], v[136:139], a[136:139], v[112:115]
  buffer_store_dwordx4 v[184:187], v212, s[36:39], s63 offen offset:2304 sc1
  v_mfma_f32_16x16x32_bf16 v[120:123], v[136:139], a[200:203], v[120:123]
  v_mfma_f32_16x16x32_bf16 v[124:127], v[140:143], a[200:203], v[124:127]
  v_mfma_f32_16x16x32_bf16 v[116:119], v[140:143], a[136:139], v[116:119]
  v_mfma_f32_16x16x32_bf16 v[108:111], v[140:143], a[72:75], v[108:111]
  v_mfma_f32_16x16x32_bf16 v[100:103], v[140:143], a[8:11], v[100:103]
  s_waitcnt vmcnt(16)
  s_barrier
  s_cmp_lg_u32 s40, 0
  s_cbranch_scc1 Lg_43
  s_cmp_lt_i32 s70, s71
  s_cbranch_scc1 Lg_43
  s_cmp_lg_u32 s101, 0
  s_cbranch_scc1 Li_47
  v_readfirstlane_b32 s101, v252
  s_nop 0
  s_cmp_lg_u32 s101, 0
  s_cbranch_scc1 Li_47
Li_46:
  buffer_load_dword v252, off, s[84:87], 0 offset:144 sc1
  s_waitcnt vmcnt(0)
  v_readfirstlane_b32 s101, v252
  s_add_u32 s91, s91, 1
  s_cmp_gt_u32 s91, 0x20000
  s_cbranch_scc1 L_abort
  s_cmp_eq_u32 s101, 0
  s_cbranch_scc1 Li_46
Li_47:
  s_cmp_lg_u32 s56, 0
  s_cbranch_scc1 Lg_44
  s_lshl_b32 s41, s57, 3
  s_lshl_b32 s41, 1, s41
  s_mov_b64 exec, 1
  s_add_u32 s42, s70, 1
  s_lshl_b32 s42, s42, 1
  v_mov_b32 v249, s42
  s_add_u32 s42, s58, 168
  s_lshl_b32 s42, s42, 7
  s_cmp_lg_u32 s57, 0
  s_cselect_b32 s42, 0x10000000, s42
  buffer_store_dword v249, v253, s[36:39], s42 offen sc1
  s_add_u32 s42, s70, 136
  s_branch Lg_45
Lg_44:
  s_and_b32 s41, s70, 3
  s_cmp_lg_u32 s41, 3
  s_cbranch_scc1 Lg_43
  s_lshr_b32 s41, s70, 2
  s_lshl_b32 s42, s57, 3
  s_add_u32 s41, s41, s42
  s_lshl_b32 s41, 1, s41
  s_lshl_b32 s42, s58, s57
  s_add_u32 s42, s42, 32
  s_lshl_b32 s43, s57, 1
  s_add_u32 exec_lo, s43, 1
  s_mov_b32 exec_hi, 0
Lg_45:
  s_lshl_b32 s42, s42, 7
  v_mov_b32 v250, s41
  buffer_atomic_add v250, v253, s[36:39], s42 offen
  s_mov_b64 exec, -1
Lg_43:
  s_add_u32 s70, s70, 1
  s_waitcnt lgkmcnt(0)
  v_mfma_f32_16x16x32_bf16 v[64:67], v[144:147], a[12:15], v[64:67]
  ds_read_b128 v[128:131], v200 offset:16384
  v_mfma_f32_16x16x32_bf16 v[72:75], v[144:147], a[76:79], v[72:75]
  s_add_u32 m0, s67, 0xc000
  s_add_u32 s68, s62, 0x300
  v_mfma_f32_16x16x32_bf16 v[80:83], v[144:147], a[140:143], v[80:83]
  buffer_load_dwordx4 v208, s[48:51], s68 offen offset:0  lds
  v_mfma_f32_16x16x32_bf16 v[88:91], v[144:147], a[204:207], v[88:91]
  ds_read_b128 v[132:135], v204 offset:16384
  v_mfma_f32_16x16x32_bf16 v[92:95], v[148:151], a[204:207], v[92:95]
  ds_read_b128 v[136:139], v200 offset:24576
  v_mfma_f32_16x16x32_bf16 v[84:87], v[148:151], a[140:143], v[84:87]
  v_mfma_f32_16x16x32_bf16 v[76:79], v[148:151], a[76:79], v[76:79]
  buffer_load_dwordx4 v209, s[48:51], s68 offen offset:1024  lds
  v_mfma_f32_16x16x32_bf16 v[68:71], v[148:151], a[12:15], v[68:71]
  ds_read_b128 v[140:143], v204 offset:24576
  v_mfma_f32_16x16x32_bf16 v[96:99], v[152:155], a[12:15], v[96:99]
  v_mfma_f32_16x16x32_bf16 v[104:107], v[152:155], a[76:79], v[104:107]
  v_mfma_f32_16x16x32_bf16 v[112:115], v[152:155], a[140:143], v[112:115]
  buffer_load_dwordx4 v210, s[48:51], s68 offen offset:2048  lds
  v_mfma_f32_16x16x32_bf16 v[120:123], v[152:155], a[204:207], v[120:123]
  v_mfma_f32_16x16x32_bf16 v[124:127], v[156:159], a[204:207], v[124:127]
  v_mfma_f32_16x16x32_bf16 v[116:119], v[156:159], a[140:143], v[116:119]
  v_mfma_f32_16x16x32_bf16 v[108:111], v[156:159], a[76:79], v[108:111]
  buffer_load_dwordx4 v211, s[48:51], s68 offen offset:3072  lds
  v_mfma_f32_16x16x32_bf16 v[100:103], v[156:159], a[12:15], v[100:103]
  s_waitcnt lgkmcnt(0)
  v_mfma_f32_16x16x32_bf16 v[64:67], v[128:131], a[16:19], v[64:67]
  ds_read_b128 v[144:147], v201 offset:16384
  v_mfma_f32_16x16x32_bf16 v[72:75], v[128:131], a[80:83], v[72:75]
  v_cvt_pk_bf16_f32 v160, v32, v33
  v_mfma_f32_16x16x32_bf16 v[80:83], v[128:131], a[144:147], v[80:83]
  v_cvt_pk_bf16_f32 v161, v34, v35
  v_mfma_f32_16x16x32_bf16 v[88:91], v[128:131], a[208:211], v[88:91]
  ds_read_b128 v[148:151], v205 offset:16384
  v_mfma_f32_16x16x32_bf16 v[92:95], v[132:135], a[208:211], v[92:95]
  ds_read_b128 v[152:155], v201 offset:24576
  v_mfma_f32_16x16x32_bf16 v[84:87], v[132:135], a[144:147], v[84:87]
  v_cvt_pk_bf16_f32 v162, v36, v37
  v_mfma_f32_16x16x32_bf16 v[76:79], v[132:135], a[80:83], v[76:79]
  v_cvt_pk_bf16_f32 v163, v38, v39
  v_mfma_f32_16x16x32_bf16 v[68:71], v[132:135], a[16:19], v[68:71]
  ds_read_b128 v[156:159], v205 offset:24576
  v_mfma_f32_16x16x32_bf16 v[96:99], v[136:139], a[16:19], v[96:99]
  v_mfma_f32_16x16x32_bf16 v[104:107], v[136:139], a[80:83], v[104:107]
  buffer_store_dwordx4 v[160:163], v213, s[36:39], s63 offen offset:0 sc1
  v_mfma_f32_16x16x32_bf16 v[112:115], v[136:139], a[144:147], v[112:115]
  v_cvt_pk_bf16_f32 v168, v40, v41
  v_mfma_f32_16x16x32_bf16 v[120:123], v[136:139], a[208:211], v[120:123]
  v_mfma_f32_16x16x32_bf16 v[124:127], v[140:143], a[208:211], v[124:127]
  v_mfma_f32_16x16x32_bf16 v[116:119], v[140:143], a[144:147], v[116:119]
  v_cvt_pk_bf16_f32 v169, v42, v43
  v_mfma_f32_16x16x32_bf16 v[108:111], v[140:143], a[80:83], v[108:111]
  v_cvt_pk_bf16_f32 v170, v44, v45
  v_mfma_f32_16x16x32_bf16 v[100:103], v[140:143], a[16:19], v[100:103]
  s_waitcnt lgkmcnt(0)
  v_mfma_f32_16x16x32_bf16 v[64:67], v[144:147], a[20:23], v[64:67]
  ds_read_b128 v[128:131], v202 offset:16384
  v_mfma_f32_16x16x32_bf16 v[72:75], v[144:147], a[84:87], v[72:75]
  v_cvt_pk_bf16_f32 v171, v46, v47
  v_mfma_f32_16x16x32_bf16 v[80:83], v[144:147], a[148:151], v[80:83]
  buffer_store_dwordx4 v[168:171], v213, s[36:39], s63 offen offset:256 sc1
  v_mfma_f32_16x16x32_bf16 v[88:91], v[144:147], a[212:215], v[88:91]
  ds_read_b128 v[132:135], v206 offset:16384
  v_mfma_f32_16x16x32_bf16 v[92:95], v[148:151], a[212:215], v[92:95]
  ds_read_b128 v[136:139], v202 offset:24576
  v_mfma_f32_16x16x32_bf16 v[84:87], v[148:151], a[148:151], v[84:87]
  v_cvt_pk_bf16_f32 v176, v48, v49
  v_mfma_f32_16x16x32_bf16 v[76:79], v[148:151], a[84:87], v[76:79]
  v_cvt_pk_bf16_f32 v177, v50, v51
  v_mfma_f32_16x16x32_bf16 v[68:71], v[148:151], a[20:23], v[68:71]
  ds_read_b128 v[140:143], v206 offset:24576
  v_mfma_f32_16x16x32_bf16 v[96:99], v[152:155], a[20:23], v[96:99]
  v_mfma_f32_16x16x32_bf16 v[104:107], v[152:155], a[84:87], v[104:107]
  v_cvt_pk_bf16_f32 v178, v52, v53
  v_mfma_f32_16x16x32_bf16 v[112:115], v[152:155], a[148:151], v[112:115]
  v_cvt_pk_bf16_f32 v179, v54, v55
  v_mfma_f32_16x16x32_bf16 v[120:123], v[152:155], a[212:215], v[120:123]
  v_mfma_f32_16x16x32_bf16 v[124:127], v[156:159], a[212:215], v[124:127]
  v_mfma_f32_16x16x32_bf16 v[116:119], v[156:159], a[148:151], v[116:119]
  buffer_store_dwordx4 v[176:179], v213, s[36:39], s63 offen offset:2048 sc1
  v_mfma_f32_16x16x32_bf16 v[108:111], v[156:159], a[84:87], v[108:111]
  v_cvt_pk_bf16_f32 v184, v56, v57
  v_mfma_f32_16x16x32_bf16 v[100:103], v[156:159], a[20:23], v[100:103]
  s_waitcnt lgkmcnt(0)
  v_mfma_f32_16x16x32_bf16 v[64:67], v[128:131], a[24:27], v[64:67]
  ds_read_b128 v[144:147], v203 offset:16384
  v_mfma_f32_16x16x32_bf16 v[72:75], v[128:131], a[88:91], v[72:75]
  v_cvt_pk_bf16_f32 v185, v58, v59
  v_mfma_f32_16x16x32_bf16 v[80:83], v[128:131], a[152:155], v[80:83]
  v_cvt_pk_bf16_f32 v186, v60, v61
  v_mfma_f32_16x16x32_bf16 v[88:91], v[128:131], a[216:219], v[88:91]
  ds_read_b128 v[148:151], v207 offset:16384
  v_mfma_f32_16x16x32_bf16 v[92:95], v[132:135], a[216:219], v[92:95]
  ds_read_b128 v[152:155], v203 offset:24576
  v_mfma_f32_16x16x32_bf16 v[84:87], v[132:135], a[152:155], v[84:87]
  v_cvt_pk_bf16_f32 v187, v62, v63
  v_mfma_f32_16x16x32_bf16 v[76:79], v[132:135], a[88:91], v[76:79]
  buffer_store_dwordx4 v[184:187], v213, s[36:39], s63 offen offset:2304 sc1
  v_mfma_f32_16x16x32_bf16 v[68:71], v[132:135], a[24:27], v[68:71]
  ds_read_b128 v[156:159], v207 offset:24576
  v_mfma_f32_16x16x32_bf16 v[96:99], v[136:139], a[24:27], v[96:99]
  v_mfma_f32_16x16x32_bf16 v[104:107], v[136:139], a[88:91], v[104:107]
  v_mfma_f32_16x16x32_bf16 v[112:115], v[136:139], a[152:155], v[112:115]
  v_mfma_f32_16x16x32_bf16 v[120:123], v[136:139], a[216:219], v[120:123]
  v_mfma_f32_16x16x32_bf16 v[124:127], v[140:143], a[216:219], v[124:127]
  v_mfma_f32_16x16x32_bf16 v[116:119], v[140:143], a[152:155], v[116:119]
  v_mfma_f32_16x16x32_bf16 v[108:111], v[140:143], a[88:91], v[108:111]
  v_mfma_f32_16x16x32_bf16 v[100:103], v[140:143], a[24:27], v[100:103]
  s_waitcnt vmcnt(36)
  s_barrier
  s_waitcnt lgkmcnt(0)
  v_mfma_f32_16x16x32_bf16 v[64:67], v[144:147], a[28:31], v[64:67]
  ds_read_b128 v[128:131], v200 offset:32768
  v_mfma_f32_16x16x32_bf16 v[72:75], v[144:147], a[92:95], v[72:75]
  s_add_u32 m0, s67, 0x10000
  s_add_u32 s68, s62, 0x10000
  v_mfma_f32_16x16x32_bf16 v[80:83], v[144:147], a[156:159], v[80:83]
  buffer_load_dwordx4 v208, s[48:51], s68 offen offset:0  lds
  v_mfma_f32_16x16x32_bf16 v[88:91], v[144:147], a[220:223], v[88:91]
  ds_read_b128 v[132:135], v204 offset:32768
  v_mfma_f32_16x16x32_bf16 v[92:95], v[148:151], a[220:223], v[92:95]
  ds_read_b128 v[136:139], v200 offset:40960
  v_mfma_f32_16x16x32_bf16 v[84:87], v[148:151], a[156:159], v[84:87]
  v_mfma_f32_16x16x32_bf16 v[76:79], v[148:151], a[92:95], v[76:79]
  buffer_load_dwordx4 v209, s[48:51], s68 offen offset:1024  lds
  v_mfma_f32_16x16x32_bf16 v[68:71], v[148:151], a[28:31], v[68:71]
  ds_read_b128 v[140:143], v204 offset:40960
  v_mfma_f32_16x16x32_bf16 v[96:99], v[152:155], a[28:31], v[96:99]
  v_mfma_f32_16x16x32_bf16 v[104:107], v[152:155], a[92:95], v[104:107]
  v_mfma_f32_16x16x32_bf16 v[112:115], v[152:155], a[156:159], v[112:115]
  buffer_load_dwordx4 v210, s[48:51], s68 offen offset:2048  lds
  v_mfma_f32_16x16x32_bf16 v[120:123], v[152:155], a[220:223], v[120:123]
  v_mfma_f32_16x16x32_bf16 v[124:127], v[156:159], a[220:223], v[124:127]
  v_mfma_f32_16x16x32_bf16 v[116:119], v[156:159], a[156:159], v[116:119]
  v_mfma_f32_16x16x32_bf16 v[108:111], v[156:159], a[92:95], v[108:111]
  buffer_load_dwordx4 v211, s[48:51], s68 offen offset:3072  lds
  v_mfma_f32_16x16x32_bf16 v[100:103], v[156:159], a[28:31], v[100:103]
  s_waitcnt lgkmcnt(0)
  v_mfma_f32_16x16x32_bf16 v[64:67], v[128:131], a[32:35], v[64:67]
  ds_read_b128 v[144:147], v201 offset:32768
  v_mfma_f32_16x16x32_bf16 v[72:75], v[128:131], a[96:99], v[72:75]
  v_mfma_f32_16x16x32_bf16 v[80:83], v[128:131], a[160:163], v[80:83]
  v_mfma_f32_16x16x32_bf16 v[88:91], v[128:131], a[224:227], v[88:91]
  ds_read_b128 v[148:151], v205 offset:32768
  v_mfma_f32_16x16x32_bf16 v[92:95], v[132:135], a[224:227], v[92:95]
  ds_read_b128 v[152:155], v201 offset:40960
  v_mfma_f32_16x16x32_bf16 v[84:87], v[132:135], a[160:163], v[84:87]
  v_mfma_f32_16x16x32_bf16 v[76:79], v[132:135], a[96:99], v[76:79]
  v_mfma_f32_16x16x32_bf16 v[68:71], v[132:135], a[32:35], v[68:71]
  ds_read_b128 v[156:159], v205 offset:40960
  v_mfma_f32_16x16x32_bf16 v[96:99], v[136:139], a[32:35], v[96:99]
  v_mfma_f32_16x16x32_bf16 v[104:107], v[136:139], a[96:99], v[104:107]
  v_mfma_f32_16x16x32_bf16 v[112:115], v[136:139], a[160:163], v[112:115]
  v_mfma_f32_16x16x32_bf16 v[120:123], v[136:139], a[224:227], v[120:123]
  v_mfma_f32_16x16x32_bf16 v[124:127], v[140:143], a[224:227], v[124:127]
  v_mfma_f32_16x16x32_bf16 v[116:119], v[140:143], a[160:163], v[116:119]
  v_mfma_f32_16x16x32_bf16 v[108:111], v[140:143], a[96:99], v[108:111]
  v_mfma_f32_16x16x32_bf16 v[100:103], v[140:143], a[32:35], v[100:103]
  s_waitcnt lgkmcnt(0)
  v_mfma_f32_16x16x32_bf16 v[64:67], v[144:147], a[36:39], v[64:67]
  ds_read_b128 v[128:131], v202 offset:32768
  v_mfma_f32_16x16x32_bf16 v[72:75], v[144:147], a[100:103], v[72:75]
  v_mfma_f32_16x16x32_bf16 v[80:83], v[144:147], a[164:167], v[80:83]
  v_mfma_f32_16x16x32_bf16 v[88:91], v[144:147], a[228:231], v[88:91]
  ds_read_b128 v[132:135], v206 offset:32768
  v_mfma_f32_16x16x32_bf16 v[92:95], v[148:151], a[228:231], v[92:95]
  ds_read_b128 v[136:139], v202 offset:40960
  v_mfma_f32_16x16x32_bf16 v[84:87], v[148:151], a[164:167], v[84:87]
  v_mfma_f32_16x16x32_bf16 v[76:79], v[148:151], a[100:103], v[76:79]
  v_mfma_f32_16x16x32_bf16 v[68:71], v[148:151], a[36:39], v[68:71]
  ds_read_b128 v[140:143], v206 offset:40960
  v_mfma_f32_16x16x32_bf16 v[96:99], v[152:155], a[36:39], v[96:99]
  v_mfma_f32_16x16x32_bf16 v[104:107], v[152:155], a[100:103], v[104:107]
  v_mfma_f32_16x16x32_bf16 v[112:115], v[152:155], a[164:167], v[112:115]
  v_mfma_f32_16x16x32_bf16 v[120:123], v[152:155], a[228:231], v[120:123]
  v_mfma_f32_16x16x32_bf16 v[124:127], v[156:159], a[228:231], v[124:127]
  v_mfma_f32_16x16x32_bf16 v[116:119], v[156:159], a[164:167], v[116:119]
  v_mfma_f32_16x16x32_bf16 v[108:111], v[156:159], a[100:103], v[108:111]
  v_mfma_f32_16x16x32_bf16 v[100:103], v[156:159], a[36:39], v[100:103]
  s_waitcnt lgkmcnt(0)
  v_mfma_f32_16x16x32_bf16 v[64:67], v[128:131], a[40:43], v[64:67]
  ds_read_b128 v[144:147], v203 offset:32768
  v_mfma_f32_16x16x32_bf16 v[72:75], v[128:131], a[104:107], v[72:75]
  v_mfma_f32_16x16x32_bf16 v[80:83], v[128:131], a[168:171], v[80:83]
  v_mfma_f32_16x16x32_bf16 v[88:91], v[128:131], a[232:235], v[88:91]
  ds_read_b128 v[148:151], v207 offset:32768
  v_mfma_f32_16x16x32_bf16 v[92:95], v[132:135], a[232:235], v[92:95]
  ds_read_b128 v[152:155], v203 offset:40960
  v_mfma_f32_16x16x32_bf16 v[84:87], v[132:135], a[168:171], v[84:87]
  v_mfma_f32_16x16x32_bf16 v[76:79], v[132:135], a[104:107], v[76:79]
  v_mfma_f32_16x16x32_bf16 v[68:71], v[132:135], a[40:43], v[68:71]
  ds_read_b128 v[156:159], v207 offset:40960
  v_mfma_f32_16x16x32_bf16 v[96:99], v[136:139], a[40:43], v[96:99]
  v_mfma_f32_16x16x32_bf16 v[104:107], v[136:139], a[104:107], v[104:107]
  v_mfma_f32_16x16x32_bf16 v[112:115], v[136:139], a[168:171], v[112:115]
  v_mfma_f32_16x16x32_bf16 v[120:123], v[136:139], a[232:235], v[120:123]
  v_mfma_f32_16x16x32_bf16 v[124:127], v[140:143], a[232:235], v[124:127]
  v_mfma_f32_16x16x32_bf16 v[116:119], v[140:143], a[168:171], v[116:119]
  v_mfma_f32_16x16x32_bf16 v[108:111], v[140:143], a[104:107], v[108:111]
  v_mfma_f32_16x16x32_bf16 v[100:103], v[140:143], a[40:43], v[100:103]
  s_waitcnt vmcnt(32)
  s_barrier
  s_waitcnt lgkmcnt(0)
  v_mfma_f32_16x16x32_bf16 v[64:67], v[144:147], a[44:47], v[64:67]
  ds_read_b128 v[128:131], v200 offset:49152
  v_mfma_f32_16x16x32_bf16 v[72:75], v[144:147], a[108:111], v[72:75]
  s_add_u32 m0, s67, 0x14000
  s_add_u32 s68, s62, 0x10100
  v_mfma_f32_16x16x32_bf16 v[80:83], v[144:147], a[172:175], v[80:83]
  buffer_load_dwordx4 v208, s[48:51], s68 offen offset:0  lds
  v_mfma_f32_16x16x32_bf16 v[88:91], v[144:147], a[236:239], v[88:91]
  ds_read_b128 v[132:135], v204 offset:49152
  v_mfma_f32_16x16x32_bf16 v[92:95], v[148:151], a[236:239], v[92:95]
  ds_read_b128 v[136:139], v200 offset:57344
  v_mfma_f32_16x16x32_bf16 v[84:87], v[148:151], a[172:175], v[84:87]
  v_mfma_f32_16x16x32_bf16 v[76:79], v[148:151], a[108:111], v[76:79]
  buffer_load_dwordx4 v209, s[48:51], s68 offen offset:1024  lds
  v_mfma_f32_16x16x32_bf16 v[68:71], v[148:151], a[44:47], v[68:71]
  ds_read_b128 v[140:143], v204 offset:57344
  v_mfma_f32_16x16x32_bf16 v[96:99], v[152:155], a[44:47], v[96:99]
  v_mfma_f32_16x16x32_bf16 v[104:107], v[152:155], a[108:111], v[104:107]
  v_mfma_f32_16x16x32_bf16 v[112:115], v[152:155], a[172:175], v[112:115]
  buffer_load_dwordx4 v210, s[48:51], s68 offen offset:2048  lds
  v_mfma_f32_16x16x32_bf16 v[120:123], v[152:155], a[236:239], v[120:123]
  v_mfma_f32_16x16x32_bf16 v[124:127], v[156:159], a[236:239], v[124:127]
  v_mfma_f32_16x16x32_bf16 v[116:119], v[156:159], a[172:175], v[116:119]
  v_mfma_f32_16x16x32_bf16 v[108:111], v[156:159], a[108:111], v[108:111]
  buffer_load_dwordx4 v211, s[48:51], s68 offen offset:3072  lds
  v_mfma_f32_16x16x32_bf16 v[100:103], v[156:159], a[44:47], v[100:103]
  s_waitcnt lgkmcnt(0)
  v_mfma_f32_16x16x32_bf16 v[64:67], v[128:131], a[48:51], v[64:67]
  ds_read_b128 v[144:147], v201 offset:49152
  v_mfma_f32_16x16x32_bf16 v[72:75], v[128:131], a[112:115], v[72:75]
  v_mfma_f32_16x16x32_bf16 v[80:83], v[128:131], a[176:179], v[80:83]
  v_mfma_f32_16x16x32_bf16 v[88:91], v[128:131], a[240:243], v[88:91]
  ds_read_b128 v[148:151], v205 offset:49152
  v_mfma_f32_16x16x32_bf16 v[92:95], v[132:135], a[240:243], v[92:95]
  ds_read_b128 v[152:155], v201 offset:57344
  v_mfma_f32_16x16x32_bf16 v[84:87], v[132:135], a[176:179], v[84:87]
  v_mfma_f32_16x16x32_bf16 v[76:79], v[132:135], a[112:115], v[76:79]
  v_mfma_f32_16x16x32_bf16 v[68:71], v[132:135], a[48:51], v[68:71]
  ds_read_b128 v[156:159], v205 offset:57344
  v_mfma_f32_16x16x32_bf16 v[96:99], v[136:139], a[48:51], v[96:99]
  v_mfma_f32_16x16x32_bf16 v[104:107], v[136:139], a[112:115], v[104:107]
  v_mfma_f32_16x16x32_bf16 v[112:115], v[136:139], a[176:179], v[112:115]
  v_mfma_f32_16x16x32_bf16 v[120:123], v[136:139], a[240:243], v[120:123]
  v_mfma_f32_16x16x32_bf16 v[124:127], v[140:143], a[240:243], v[124:127]
  v_mfma_f32_16x16x32_bf16 v[116:119], v[140:143], a[176:179], v[116:119]
  v_mfma_f32_16x16x32_bf16 v[108:111], v[140:143], a[112:115], v[108:111]
  v_mfma_f32_16x16x32_bf16 v[100:103], v[140:143], a[48:51], v[100:103]
  s_waitcnt lgkmcnt(0)
  v_mfma_f32_16x16x32_bf16 v[64:67], v[144:147], a[52:55], v[64:67]
  ds_read_b128 v[128:131], v202 offset:49152
  v_mfma_f32_16x16x32_bf16 v[72:75], v[144:147], a[116:119], v[72:75]
  v_mfma_f32_16x16x32_bf16 v[80:83], v[144:147], a[180:183], v[80:83]
  v_mfma_f32_16x16x32_bf16 v[88:91], v[144:147], a[244:247], v[88:91]
  ds_read_b128 v[132:135], v206 offset:49152
  v_mfma_f32_16x16x32_bf16 v[92:95], v[148:151], a[244:247], v[92:95]
  ds_read_b128 v[136:139], v202 offset:57344
  v_mfma_f32_16x16x32_bf16 v[84:87], v[148:151], a[180:183], v[84:87]
  v_mfma_f32_16x16x32_bf16 v[76:79], v[148:151], a[116:119], v[76:79]
  v_mfma_f32_16x16x32_bf16 v[68:71], v[148:151], a[52:55], v[68:71]
  ds_read_b128 v[140:143], v206 offset:57344
  v_mfma_f32_16x16x32_bf16 v[96:99], v[152:155], a[52:55], v[96:99]
  v_mfma_f32_16x16x32_bf16 v[104:107], v[152:155], a[116:119], v[104:107]
  v_mfma_f32_16x16x32_bf16 v[112:115], v[152:155], a[180:183], v[112:115]
  v_mfma_f32_16x16x32_bf16 v[120:123], v[152:155], a[244:247], v[120:123]
  v_mfma_f32_16x16x32_bf16 v[124:127], v[156:159], a[244:247], v[124:127]
  v_mfma_f32_16x16x32_bf16 v[116:119], v[156:159], a[180:183], v[116:119]
  v_mfma_f32_16x16x32_bf16 v[108:111], v[156:159], a[116:119], v[108:111]
  v_mfma_f32_16x16x32_bf16 v[100:103], v[156:159], a[52:55], v[100:103]
  s_waitcnt lgkmcnt(0)
  v_mfma_f32_16x16x32_bf16 v[64:67], v[128:131], a[56:59], v[64:67]
  ds_read_b128 v[144:147], v203 offset:49152
  v_mfma_f32_16x16x32_bf16 v[72:75], v[128:131], a[120:123], v[72:75]
  v_mfma_f32_16x16x32_bf16 v[80:83], v[128:131], a[184:187], v[80:83]
  v_mfma_f32_16x16x32_bf16 v[88:91], v[128:131], a[248:251], v[88:91]
  ds_read_b128 v[148:151], v207 offset:49152
  v_mfma_f32_16x16x32_bf16 v[92:95], v[132:135], a[248:251], v[92:95]
  ds_read_b128 v[152:155], v203 offset:57344
  v_mfma_f32_16x16x32_bf16 v[84:87], v[132:135], a[184:187], v[84:87]
  v_mfma_f32_16x16x32_bf16 v[76:79], v[132:135], a[120:123], v[76:79]
  v_mfma_f32_16x16x32_bf16 v[68:71], v[132:135], a[56:59], v[68:71]
  ds_read_b128 v[156:159], v207 offset:57344
  v_mfma_f32_16x16x32_bf16 v[96:99], v[136:139], a[56:59], v[96:99]
  v_mfma_f32_16x16x32_bf16 v[104:107], v[136:139], a[120:123], v[104:107]
  v_mfma_f32_16x16x32_bf16 v[112:115], v[136:139], a[184:187], v[112:115]
  v_mfma_f32_16x16x32_bf16 v[120:123], v[136:139], a[248:251], v[120:123]
  v_mfma_f32_16x16x32_bf16 v[124:127], v[140:143], a[248:251], v[124:127]
  v_mfma_f32_16x16x32_bf16 v[116:119], v[140:143], a[184:187], v[116:119]
  v_mfma_f32_16x16x32_bf16 v[108:111], v[140:143], a[120:123], v[108:111]
  v_mfma_f32_16x16x32_bf16 v[100:103], v[140:143], a[56:59], v[100:103]
  s_waitcnt vmcnt(28)
  s_barrier
  s_waitcnt lgkmcnt(0)
  v_mfma_f32_16x16x32_bf16 v[64:67], v[144:147], a[60:63], v[64:67]
  ds_read_b128 v[128:131], v192 offset:0
  v_mfma_f32_16x16x32_bf16 v[72:75], v[144:147], a[124:127], v[72:75]
  s_add_u32 m0, s67, 0x18000
  s_add_u32 s68, s62, 0x10200
  v_mfma_f32_16x16x32_bf16 v[80:83], v[144:147], a[188:191], v[80:83]
  buffer_load_dwordx4 v208, s[48:51], s68 offen offset:0  lds
  v_mfma_f32_16x16x32_bf16 v[88:91], v[144:147], a[252:255], v[88:91]
  ds_read_b128 v[132:135], v196 offset:0
  v_mfma_f32_16x16x32_bf16 v[92:95], v[148:151], a[252:255], v[92:95]
  ds_read_b128 v[136:139], v192 offset:8192
  v_mfma_f32_16x16x32_bf16 v[84:87], v[148:151], a[188:191], v[84:87]
  v_mfma_f32_16x16x32_bf16 v[76:79], v[148:151], a[124:127], v[76:79]
  buffer_load_dwordx4 v209, s[48:51], s68 offen offset:1024  lds
  v_mfma_f32_16x16x32_bf16 v[68:71], v[148:151], a[60:63], v[68:71]
  ds_read_b128 v[140:143], v196 offset:8192
  v_mfma_f32_16x16x32_bf16 v[96:99], v[152:155], a[60:63], v[96:99]
  v_mfma_f32_16x16x32_bf16 v[104:107], v[152:155], a[124:127], v[104:107]
  v_mfma_f32_16x16x32_bf16 v[112:115], v[152:155], a[188:191], v[112:115]
  buffer_load_dwordx4 v210, s[48:51], s68 offen offset:2048  lds
  v_mfma_f32_16x16x32_bf16 v[120:123], v[152:155], a[252:255], v[120:123]
  v_mfma_f32_16x16x32_bf16 v[124:127], v[156:159], a[252:255], v[124:127]
  v_mfma_f32_16x16x32_bf16 v[116:119], v[156:159], a[188:191], v[116:119]
  v_mfma_f32_16x16x32_bf16 v[108:111], v[156:159], a[124:127], v[108:111]
  buffer_load_dwordx4 v211, s[48:51], s68 offen offset:3072  lds
  v_mfma_f32_16x16x32_bf16 v[100:103], v[156:159], a[60:63], v[100:103]
PJ_bend:
  s_add_u32 s64, s63, 0x4000
  s_add_u32 s63, s63, 0x8000
  s_mov_b32 s61, s62
  s_cmp_lg_u32 s60, 0
  s_cbranch_scc1 PJ_unit
  s_cmp_eq_u32 s66, 0
  s_cbranch_scc0 PJ_f1
  v_mul_f32 v160, s65, v64
  v_mul_f32 v161, s65, v65
  v_mul_f32 v162, s65, v66
  v_mul_f32 v163, s65, v67
  v_mul_f32 v164, s65, v68
  v_mul_f32 v165, s65, v69
  v_mul_f32 v166, s65, v70
  v_mul_f32 v167, s65, v71
  v_cvt_pk_bf16_f32 v160, v160, v161
  v_cvt_pk_bf16_f32 v161, v162, v163
  v_cvt_pk_bf16_f32 v162, v164, v165
  v_cvt_pk_bf16_f32 v163, v166, v167
  buffer_store_dwordx4 v[160:163], v212, s[36:39], s64 offen offset:0 sc1
  v_mul_f32 v168, s65, v72
  v_mul_f32 v169, s65, v73
  v_mul_f32 v170, s65, v74
  v_mul_f32 v171, s65, v75
  v_mul_f32 v172, s65, v76
  v_mul_f32 v173, s65, v77
  v_mul_f32 v174, s65, v78
  v_mul_f32 v175, s65, v79
  v_cvt_pk_bf16_f32 v168, v168, v169
  v_cvt_pk_bf16_f32 v169, v170, v171
  v_cvt_pk_bf16_f32 v170, v172, v173
  v_cvt_pk_bf16_f32 v171, v174, v175
  buffer_store_dwordx4 v[168:171], v212, s[36:39], s64 offen offset:2048 sc1
  v_mul_f32 v176, s65, v80
  v_mul_f32 v177, s65, v81
  v_mul_f32 v178, s65, v82
  v_mul_f32 v179, s65, v83
  v_mul_f32 v180, s65, v84
  v_mul_f32 v181, s65, v85
  v_mul_f32 v182, s65, v86
  v_mul_f32 v183, s65, v87
  v_cvt_pk_bf16_f32 v176, v176, v177
  v_cvt_pk_bf16_f32 v177, v178, v179
  v_cvt_pk_bf16_f32 v178, v180, v181
  v_cvt_pk_bf16_f32 v179, v182, v183
  buffer_store_dwordx4 v[176:179], v212, s[36:39], s64 offen offset:256 sc1
  v_mul_f32 v184, s65, v88
  v_mul_f32 v185, s65, v89
  v_mul_f32 v186, s65, v90
  v_mul_f32 v187, s65, v91
  v_mul_f32 v188, s65, v92
  v_mul_f32 v189, s65, v93
  v_mul_f32 v190, s65, v94
  v_mul_f32 v191, s65, v95
  v_cvt_pk_bf16_f32 v184, v184, v185
  v_cvt_pk_bf16_f32 v185, v186, v187
  v_cvt_pk_bf16_f32 v186, v188, v189
  v_cvt_pk_bf16_f32 v187, v190, v191
  buffer_store_dwordx4 v[184:187], v212, s[36:39], s64 offen offset:2304 sc1
  v_mul_f32 v160, s65, v96
  v_mul_f32 v161, s65, v97
  v_mul_f32 v162, s65, v98
  v_mul_f32 v163, s65, v99
  v_mul_f32 v164, s65, v100
  v_mul_f32 v165, s65, v101
  v_mul_f32 v166, s65, v102
  v_mul_f32 v167, s65, v103
  v_cvt_pk_bf16_f32 v160, v160, v161
  v_cvt_pk_bf16_f32 v161, v162, v163
  v_cvt_pk_bf16_f32 v162, v164, v165
  v_cvt_pk_bf16_f32 v163, v166, v167
  buffer_store_dwordx4 v[160:163], v213, s[36:39], s64 offen offset:0 sc1
  v_mul_f32 v168, s65, v104
  v_mul_f32 v169, s65, v105
  v_mul_f32 v170, s65, v106
  v_mul_f32 v171, s65, v107
  v_mul_f32 v172, s65, v108
  v_mul_f32 v173, s65, v109
  v_mul_f32 v174, s65, v110
  v_mul_f32 v175, s65, v111
  v_cvt_pk_bf16_f32 v168, v168, v169
  v_cvt_pk_bf16_f32 v169, v170, v171
  v_cvt_pk_bf16_f32 v170, v172, v173
  v_cvt_pk_bf16_f32 v171, v174, v175
  buffer_store_dwordx4 v[168:171], v213, s[36:39], s64 offen offset:2048 sc1
  v_mul_f32 v176, s65, v112
  v_mul_f32 v177, s65, v113
  v_mul_f32 v178, s65, v114
  v_mul_f32 v179, s65, v115
  v_mul_f32 v180, s65, v116
  v_mul_f32 v181, s65, v117
  v_mul_f32 v182, s65, v118
  v_mul_f32 v183, s65, v119
  v_cvt_pk_bf16_f32 v176, v176, v177
  v_cvt_pk_bf16_f32 v177, v178, v179
  v_cvt_pk_bf16_f32 v178, v180, v181
  v_cvt_pk_bf16_f32 v179, v182, v183
  buffer_store_dwordx4 v[176:179], v213, s[36:39], s64 offen offset:256 sc1
  v_mul_f32 v184, s65, v120
  v_mul_f32 v185, s65, v121
  v_mul_f32 v186, s65, v122
  v_mul_f32 v187, s65, v123
  v_mul_f32 v188, s65, v124
  v_mul_f32 v189, s65, v125
  v_mul_f32 v190, s65, v126
  v_mul_f32 v191, s65, v127
  v_cvt_pk_bf16_f32 v184, v184, v185
  v_cvt_pk_bf16_f32 v185, v186, v187
  v_cvt_pk_bf16_f32 v186, v188, v189
  v_cvt_pk_bf16_f32 v187, v190, v191
  buffer_store_dwordx4 v[184:187], v213, s[36:39], s64 offen offset:2304 sc1
  s_branch PJ_f2
PJ_f1:
  v_cvt_pk_bf16_f32 v160, v64, v65
  v_cvt_pk_bf16_f32 v161, v66, v67
  v_cvt_pk_bf16_f32 v162, v68, v69
  v_cvt_pk_bf16_f32 v163, v70, v71
  buffer_store_dwordx4 v[160:163], v212, s[36:39], s64 offen offset:0 sc1
  v_cvt_pk_bf16_f32 v168, v72, v73
  v_cvt_pk_bf16_f32 v169, v74, v75
  v_cvt_pk_bf16_f32 v170, v76, v77
  v_cvt_pk_bf16_f32 v171, v78, v79
  buffer_store_dwordx4 v[168:171], v212, s[36:39], s64 offen offset:256 sc1
  v_cvt_pk_bf16_f32 v176, v80, v81
  v_cvt_pk_bf16_f32 v177, v82, v83
  v_cvt_pk_bf16_f32 v178, v84, v85
  v_cvt_pk_bf16_f32 v179, v86, v87
  buffer_store_dwordx4 v[176:179], v212, s[36:39], s64 offen offset:2048 sc1
  v_cvt_pk_bf16_f32 v184, v88, v89
  v_cvt_pk_bf16_f32 v185, v90, v91
  v_cvt_pk_bf16_f32 v186, v92, v93
  v_cvt_pk_bf16_f32 v187, v94, v95
  buffer_store_dwordx4 v[184:187], v212, s[36:39], s64 offen offset:2304 sc1
  v_cvt_pk_bf16_f32 v160, v96, v97
  v_cvt_pk_bf16_f32 v161, v98, v99
  v_cvt_pk_bf16_f32 v162, v100, v101
  v_cvt_pk_bf16_f32 v163, v102, v103
  buffer_store_dwordx4 v[160:163], v213, s[36:39], s64 offen offset:0 sc1
  v_cvt_pk_bf16_f32 v168, v104, v105
  v_cvt_pk_bf16_f32 v169, v106, v107
  v_cvt_pk_bf16_f32 v170, v108, v109
  v_cvt_pk_bf16_f32 v171, v110, v111
  buffer_store_dwordx4 v[168:171], v213, s[36:39], s64 offen offset:256 sc1
  v_cvt_pk_bf16_f32 v176, v112, v113
  v_cvt_pk_bf16_f32 v177, v114, v115
  v_cvt_pk_bf16_f32 v178, v116, v117
  v_cvt_pk_bf16_f32 v179, v118, v119
  buffer_store_dwordx4 v[176:179], v213, s[36:39], s64 offen offset:2048 sc1
  v_cvt_pk_bf16_f32 v184, v120, v121
  v_cvt_pk_bf16_f32 v185, v122, v123
  v_cvt_pk_bf16_f32 v186, v124, v125
  v_cvt_pk_bf16_f32 v187, v126, v127
  buffer_store_dwordx4 v[184:187], v213, s[36:39], s64 offen offset:2304 sc1
PJ_f2:
  s_mov_b32 s81, -1
  s_mov_b32 s82, 0
  s_branch L_jobend
L_attnb:
  s_bfe_u32 s48, s90, 0x50003
  s_bfe_u32 s49, s90, 0x30008
  v_lshlrev_b32 v162, 4, v255
  v_and_b32 v163, 31, v255
  v_lshrrev_b32 v170, 5, v255
  v_lshlrev_b32 v170, 2, v170
  v_sub_u32 v163, v163, v170
  s_lshl_b32 s55, s40, 12
  s_mov_b32 s59, 0x41a00000
  s_add_u32 s44, s48, 32
  s_lshl_b32 s41, 2, s49
  s_sub_u32 s41, s41, 1
  s_lshl_b32 s45, 0x100, s49
  s_or_b32 s45, s45, s41
  s_mov_b32 s46, s45
  s_cmp_lg_u32 s40, 0
  s_cbranch_scc1 Lw_49
  s_lshl_b32 s44, s44, 7
  s_mov_b64 exec, 1
Lw_48:
  buffer_load_dword v252, v253, s[36:39], s44 offen sc1
  s_waitcnt vmcnt(0)
  v_and_b32 v252, s45, v252
  v_cmp_gt_u32 vcc, s46, v252
  s_nop 0
  s_cbranch_vccz Lw_48x
  s_add_u32 s91, s91, 1
  s_cmp_gt_u32 s91, 0x20000
  s_cbranch_scc1 L_abort
  s_sleep 16
  s_branch Lw_48
Lw_48x:
  s_mov_b64 exec, -1
Lw_49:
  s_lshl_b32 s50, s49, 2
  s_add_u32 s51, s50, s40
  s_add_u32 s51, s51, 1
  s_add_u32 s50, s50, 4
  s_mul_i32 s56, s48, 0x86000
  s_add_u32 s53, s56, s55
  s_add_u32 s54, s53, 0x5500000
  s_add_u32 s53, s53, 0x4400000
  s_lshl_b32 s57, s49, 3
  s_lshl_b32 s58, s40, 1
  s_add_u32 s57, s57, s58
  s_mul_i32 s60, s57, 262144
  s_lshl_b32 s58, s48, 13
  s_add_u32 s60, s60, s58
  s_add_u32 s60, s60, 0xa000000
  s_lshl_b32 s57, s57, 13
  s_add_u32 s58, s56, s57
  s_add_u32 s58, s58, 0x3300000
  s_mov_b32 s52, 0
  s_barrier
  s_add_u32 s56, s52, 0
  s_and_b32 s57, s56, 3
  s_lshl_b32 s57, s57, 14
  s_add_u32 s57, s57, s55
  s_add_u32 m0, s57, 0
  s_cmp_lt_u32 s56, s50
  s_mul_i32 s56, s56, 16384
  s_cselect_b32 s56, s56, 0x10000000
  s_add_u32 s56, s56, s53
  buffer_load_dwordx4 v162, s[36:39], s56 offen offset:0 sc1 lds
  buffer_load_dwordx4 v162, s[36:39], s56 offen offset:1024 sc1 lds
  buffer_load_dwordx4 v162, s[36:39], s56 offen offset:2048 sc1 lds
  buffer_load_dwordx4 v162, s[36:39], s56 offen offset:3072 sc1 lds
  buffer_load_dwordx4 a[128:131], v162, s[36:39], s58 offen offset:0 sc1
  buffer_load_dwordx4 a[132:135], v162, s[36:39], s58 offen offset:1024 sc1
  buffer_load_dwordx4 a[136:139], v162, s[36:39], s58 offen offset:2048 sc1
  buffer_load_dwordx4 a[140:143], v162, s[36:39], s58 offen offset:3072 sc1
  s_add_u32 s58, s58, 4096
  buffer_load_dwordx4 a[144:147], v162, s[36:39], s58 offen offset:0 sc1
  buffer_load_dwordx4 a[148:151], v162, s[36:39], s58 offen offset:1024 sc1
  buffer_load_dwordx4 a[152:155], v162, s[36:39], s58 offen offset:2048 sc1
  buffer_load_dwordx4 a[156:159], v162, s[36:39], s58 offen offset:3072 sc1
  s_add_u32 s58, s58, 4096
  buffer_load_dwordx4 a[160:163], v162, s[36:39], s58 offen offset:0 sc1
  buffer_load_dwordx4 a[164:167], v162, s[36:39], s58 offen offset:1024 sc1
  buffer_load_dwordx4 a[168:171], v162, s[36:39], s58 offen offset:2048 sc1
  buffer_load_dwordx4 a[172:175], v162, s[36:39], s58 offen offset:3072 sc1
  s_add_u32 s58, s58, 4096
  buffer_load_dwordx4 a[176:179], v162, s[36:39], s58 offen offset:0 sc1
  buffer_load_dwordx4 a[180:183], v162, s[36:39], s58 offen offset:1024 sc1
  buffer_load_dwordx4 a[184:187], v162, s[36:39], s58 offen offset:2048 sc1
  buffer_load_dwordx4 a[188:191], v162, s[36:39], s58 offen offset:3072 sc1
  s_add_u32 s56, s52, 1
  s_and_b32 s57, s56, 3
  s_lshl_b32 s57, s57, 14
  s_add_u32 s57, s57, s55
  s_add_u32 m0, s57, 0
  s_cmp_lt_u32 s56, s50
  s_mul_i32 s56, s56, 16384
  s_cselect_b32 s56, s56, 0x10000000
  s_add_u32 s56, s56, s53
  buffer_load_dwordx4 v162, s[36:39], s56 offen offset:0 sc1 lds
  buffer_load_dwordx4 v162, s[36:39], s56 offen offset:1024 sc1 lds
  buffer_load_dwordx4 v162, s[36:39], s56 offen offset:2048 sc1 lds
  buffer_load_dwordx4 v162, s[36:39], s56 offen offset:3072 sc1 lds
  s_add_u32 s56, s52, 0
  s_and_b32 s57, s56, 3
  s_lshl_b32 s57, s57, 14
  s_add_u32 s57, s57, s55
  s_add_u32 m0, s57, 65536
  s_cmp_lt_u32 s56, s50
  s_mul_i32 s56, s56, 16384
  s_cselect_b32 s56, s56, 0x10000000
  s_add_u32 s56, s56, s54
  buffer_load_dwordx4 v162, s[36:39], s56 offen offset:0 sc1 lds
  buffer_load_dwordx4 v162, s[36:39], s56 offen offset:1024 sc1 lds
  buffer_load_dwordx4 v162, s[36:39], s56 offen offset:2048 sc1 lds
  buffer_load_dwordx4 v162, s[36:39], s56 offen offset:3072 sc1 lds
  s_add_u32 s56, s52, 2
  s_and_b32 s57, s56, 3
  s_lshl_b32 s57, s57, 14
  s_add_u32 s57, s57, s55
  s_add_u32 m0, s57, 0
  s_cmp_lt_u32 s56, s50
  s_mul_i32 s56, s56, 16384
  s_cselect_b32 s56, s56, 0x10000000
  s_add_u32 s56, s56, s53
  buffer_load_dwordx4 v162, s[36:39], s56 offen offset:0 sc1 lds
  buffer_load_dwordx4 v162, s[36:39], s56 offen offset:1024 sc1 lds
  buffer_load_dwordx4 v162, s[36:39], s56 offen offset:2048 sc1 lds
  buffer_load_dwordx4 v162, s[36:39], s56 offen offset:3072 sc1 lds
  s_add_u32 s56, s52, 1
  s_and_b32 s57, s56, 3
  s_lshl_b32 s57, s57, 14
  s_add_u32 s57, s57, s55
  s_add_u32 m0, s57, 65536
  s_cmp_lt_u32 s56, s50
  s_mul_i32 s56, s56, 16384
  s_cselect_b32 s56, s56, 0x10000000
  s_add_u32 s56, s56, s54
  buffer_load_dwordx4 v162, s[36:39], s56 offen offset:0 sc1 lds
  buffer_load_dwordx4 v162, s[36:39], s56 offen offset:1024 sc1 lds
  buffer_load_dwordx4 v162, s[36:39], s56 offen offset:2048 sc1 lds
  buffer_load_dwordx4 v162, s[36:39], s56 offen offset:3072 sc1 lds
  s_add_u32 s56, s52, 3
  s_and_b32 s57, s56, 3
  s_lshl_b32 s57, s57, 14
  s_add_u32 s57, s57, s55
  s_add_u32 m0, s57, 0
  s_cmp_lt_u32 s56, s50
  s_mul_i32 s56, s56, 16384
  s_cselect_b32 s56, s56, 0x10000000
  s_add_u32 s56, s56, s53
  buffer_load_dwordx4 v162, s[36:39], s56 offen offset:0 sc1 lds
  buffer_load_dwordx4 v162, s[36:39], s56 offen offset:1024 sc1 lds
  buffer_load_dwordx4 v162, s[36:39], s56 offen offset:2048 sc1 lds
  buffer_load_dwordx4 v162, s[36:39], s56 offen offset:3072 sc1 lds
  s_add_u32 s56, s52, 2
  s_and_b32 s57, s56, 3
  s_lshl_b32 s57, s57, 14
  s_add_u32 s57, s57, s55
  s_add_u32 m0, s57, 65536
  s_cmp_lt_u32 s56, s50
  s_mul_i32 s56, s56, 16384
  s_cselect_b32 s56, s56, 0x10000000
  s_add_u32 s56, s56, s54
  buffer_load_dwordx4 v162, s[36:39], s56 offen offset:0 sc1 lds
  buffer_load_dwordx4 v162, s[36:39], s56 offen offset:1024 sc1 lds
  buffer_load_dwordx4 v162, s[36:39], s56 offen offset:2048 sc1 lds
  buffer_load_dwordx4 v162, s[36:39], s56 offen offset:3072 sc1 lds
  v_accvgpr_write_b32 a0, 0
  v_accvgpr_write_b32 a1, 0
  v_accvgpr_write_b32 a2, 0
  v_accvgpr_write_b32 a3, 0
  v_accvgpr_write_b32 a4, 0
  v_accvgpr_write_b32 a5, 0
  v_accvgpr_write_b32 a6, 0
  v_accvgpr_write_b32 a7, 0
  v_accvgpr_write_b32 a8, 0
  v_accvgpr_write_b32 a9, 0
  v_accvgpr_write_b32 a10, 0
  v_accvgpr_write_b32 a11, 0
  v_accvgpr_write_b32 a12, 0
  v_accvgpr_write_b32 a13, 0
  v_accvgpr_write_b32 a14, 0
  v_accvgpr_write_b32 a15, 0
  v_accvgpr_write_b32 a16, 0
  v_accvgpr_write_b32 a17, 0
  v_accvgpr_write_b32 a18, 0
  v_accvgpr_write_b32 a19, 0
  v_accvgpr_write_b32 a20, 0
  v_accvgpr_write_b32 a21, 0
  v_accvgpr_write_b32 a22, 0
  v_accvgpr_write_b32 a23, 0
  v_accvgpr_write_b32 a24, 0
  v_accvgpr_write_b32 a25, 0
  v_accvgpr_write_b32 a26, 0
  v_accvgpr_write_b32 a27, 0
  v_accvgpr_write_b32 a28, 0
  v_accvgpr_write_b32 a29, 0
  v_accvgpr_write_b32 a30, 0
  v_accvgpr_write_b32 a31, 0
  v_accvgpr_write_b32 a32, 0
  v_accvgpr_write_b32 a33, 0
  v_accvgpr_write_b32 a34, 0
  v_accvgpr_write_b32 a35, 0
  v_accvgpr_write_b32 a36, 0
  v_accvgpr_write_b32 a37, 0
  v_accvgpr_write_b32 a38, 0
  v_accvgpr_write_b32 a39, 0
  v_accvgpr_write_b32 a40, 0
  v_accvgpr_write_b32 a41, 0
  v_accvgpr_write_b32 a42, 0
  v_accvgpr_write_b32 a43, 0
  v_accvgpr_write_b32 a44, 0
  v_accvgpr_write_b32 a45, 0
  v_accvgpr_write_b32 a46, 0
  v_accvgpr_write_b32 a47, 0
  v_accvgpr_write_b32 a48, 0
  v_accvgpr_write_b32 a49, 0
  v_accvgpr_write_b32 a50, 0
  v_accvgpr_write_b32 a51, 0
  v_accvgpr_write_b32 a52, 0
  v_accvgpr_write_b32 a53, 0
  v_accvgpr_write_b32 a54, 0
  v_accvgpr_write_b32 a55, 0
  v_accvgpr_write_b32 a56, 0
  v_accvgpr_write_b32 a57, 0
  v_accvgpr_write_b32 a58, 0
  v_accvgpr_write_b32 a59, 0
  v_accvgpr_write_b32 a60, 0
  v_accvgpr_write_b32 a61, 0
  v_accvgpr_write_b32 a62, 0
  v_accvgpr_write_b32 a63, 0
  v_accvgpr_write_b32 a64, 0
  v_accvgpr_write_b32 a65, 0
  v_accvgpr_write_b32 a66, 0
  v_accvgpr_write_b32 a67, 0
  v_accvgpr_write_b32 a68, 0
  v_accvgpr_write_b32 a69, 0
  v_accvgpr_write_b32 a70, 0
  v_accvgpr_write_b32 a71, 0
  v_accvgpr_write_b32 a72, 0
  v_accvgpr_write_b32 a73, 0
  v_accvgpr_write_b32 a74, 0
  v_accvgpr_write_b32 a75, 0
  v_accvgpr_write_b32 a76, 0
  v_accvgpr_write_b32 a77, 0
  v_accvgpr_write_b32 a78, 0
  v_accvgpr_write_b32 a79, 0
  v_accvgpr_write_b32 a80, 0
  v_accvgpr_write_b32 a81, 0
  v_accvgpr_write_b32 a82, 0
  v_accvgpr_write_b32 a83, 0
  v_accvgpr_write_b32 a84, 0
  v_accvgpr_write_b32 a85, 0
  v_accvgpr_write_b32 a86, 0
  v_accvgpr_write_b32 a87, 0
  v_accvgpr_write_b32 a88, 0
  v_accvgpr_write_b32 a89, 0
  v_accvgpr_write_b32 a90, 0
  v_accvgpr_write_b32 a91, 0
  v_accvgpr_write_b32 a92, 0
  v_accvgpr_write_b32 a93, 0
  v_accvgpr_write_b32 a94, 0
  v_accvgpr_write_b32 a95, 0
  v_accvgpr_write_b32 a96, 0
  v_accvgpr_write_b32 a97, 0
  v_accvgpr_write_b32 a98, 0
  v_accvgpr_write_b32 a99, 0
  v_accvgpr_write_b32 a100, 0
  v_accvgpr_write_b32 a101, 0
  v_accvgpr_write_b32 a102, 0
  v_accvgpr_write_b32 a103, 0
  v_accvgpr_write_b32 a104, 0
  v_accvgpr_write_b32 a105, 0
  v_accvgpr_write_b32 a106, 0
  v_accvgpr_write_b32 a107, 0
  v_accvgpr_write_b32 a108, 0
  v_accvgpr_write_b32 a109, 0
  v_accvgpr_write_b32 a110, 0
  v_accvgpr_write_b32 a111, 0
  v_accvgpr_write_b32 a112, 0
  v_accvgpr_write_b32 a113, 0
  v_accvgpr_write_b32 a114, 0
  v_accvgpr_write_b32 a115, 0
  v_accvgpr_write_b32 a116, 0
  v_accvgpr_write_b32 a117, 0
  v_accvgpr_write_b32 a118, 0
  v_accvgpr_write_b32 a119, 0
  v_accvgpr_write_b32 a120, 0
  v_accvgpr_write_b32 a121, 0
  v_accvgpr_write_b32 a122, 0
  v_accvgpr_write_b32 a123, 0
  v_accvgpr_write_b32 a124, 0
  v_accvgpr_write_b32 a125, 0
  v_accvgpr_write_b32 a126, 0
  v_accvgpr_write_b32 a127, 0
  v_mov_b64 v[164:165], 0
  v_mov_b64 v[166:167], 0
  s_add_u32 s58, s52, 0
  s_and_b32 s58, s58, 3
  s_lshl_b32 s58, s58, 14
  s_add_u32 s58, s58, 0
  v_add_u32 v160, s58, v162
  s_waitcnt vmcnt(24)
  s_barrier
  ds_read_b128 a[192:195], v160 offset:0
  ds_read_b128 a[196:199], v160 offset:1024
  ds_read_b128 a[200:203], v160 offset:2048
  ds_read_b128 a[204:207], v160 offset:3072
  s_waitcnt lgkmcnt(3)
  v_mfma_f32_32x32x16_bf16 v[0:15], a[192:195], a[128:131], 0
  ds_read_b128 a[208:211], v160 offset:4096
  v_mfma_f32_32x32x16_bf16 v[16:31], a[192:195], a[160:163], 0
  s_waitcnt lgkmcnt(3)
  v_mfma_f32_32x32x16_bf16 v[0:15], a[196:199], a[132:135], v[0:15]
  ds_read_b128 a[212:215], v160 offset:5120
  v_mfma_f32_32x32x16_bf16 v[16:31], a[196:199], a[164:167], v[16:31]
  s_waitcnt lgkmcnt(3)
  v_mfma_f32_32x32x16_bf16 v[0:15], a[200:203], a[136:139], v[0:15]
  ds_read_b128 a[216:219], v160 offset:6144
  v_mfma_f32_32x32x16_bf16 v[16:31], a[200:203], a[168:171], v[16:31]
  s_waitcnt lgkmcnt(3)
  v_mfma_f32_32x32x16_bf16 v[0:15], a[204:207], a[140:143], v[0:15]
  ds_read_b128 a[220:223], v160 offset:7168
  v_mfma_f32_32x32x16_bf16 v[16:31], a[204:207], a[172:175], v[16:31]
  s_waitcnt lgkmcnt(3)
  v_mfma_f32_32x32x16_bf16 v[0:15], a[208:211], a[144:147], v[0:15]
  ds_read_b128 a[192:195], v160 offset:8192
  v_mfma_f32_32x32x16_bf16 v[16:31], a[208:211], a[176:179], v[16:31]
  s_waitcnt lgkmcnt(3)
  v_mfma_f32_32x32x16_bf16 v[0:15], a[212:215], a[148:151], v[0:15]
  ds_read_b128 a[196:199], v160 offset:9216
  v_mfma_f32_32x32x16_bf16 v[16:31], a[212:215], a[180:183], v[16:31]
  s_waitcnt lgkmcnt(3)
  v_mfma_f32_32x32x16_bf16 v[0:15], a[216:219], a[152:155], v[0:15]
  ds_read_b128 a[200:203], v160 offset:10240
  v_mfma_f32_32x32x16_bf16 v[16:31], a[216:219], a[184:187], v[16:31]
  s_waitcnt lgkmcnt(3)
  v_mfma_f32_32x32x16_bf16 v[0:15], a[220:223], a[156:159], v[0:15]
  ds_read_b128 a[204:207], v160 offset:11264
  v_mfma_f32_32x32x16_bf16 v[16:31], a[220:223], a[188:191], v[16:31]
  s_waitcnt lgkmcnt(3)
  v_mfma_f32_32x32x16_bf16 v[32:47], a[192:195], a[128:131], 0
  ds_read_b128 a[208:211], v160 offset:12288
  v_mfma_f32_32x32x16_bf16 v[48:63], a[192:195], a[160:163], 0
  s_waitcnt lgkmcnt(3)
  v_mfma_f32_32x32x16_bf16 v[32:47], a[196:199], a[132:135], v[32:47]
  ds_read_b128 a[212:215], v160 offset:13312
  v_mfma_f32_32x32x16_bf16 v[48:63], a[196:199], a[164:167], v[48:63]
  s_waitcnt lgkmcnt(3)
  v_mfma_f32_32x32x16_bf16 v[32:47], a[200:203], a[136:139], v[32:47]
  ds_read_b128 a[216:219], v160 offset:14336
  v_mfma_f32_32x32x16_bf16 v[48:63], a[200:203], a[168:171], v[48:63]
  s_waitcnt lgkmcnt(3)
  v_mfma_f32_32x32x16_bf16 v[32:47], a[204:207], a[140:143], v[32:47]
  ds_read_b128 a[220:223], v160 offset:15360
  v_mfma_f32_32x32x16_bf16 v[48:63], a[204:207], a[172:175], v[48:63]
  s_waitcnt lgkmcnt(3)
  v_mfma_f32_32x32x16_bf16 v[32:47], a[208:211], a[144:147], v[32:47]
  v_mfma_f32_32x32x16_bf16 v[48:63], a[208:211], a[176:179], v[48:63]
  s_waitcnt lgkmcnt(2)
  v_mfma_f32_32x32x16_bf16 v[32:47], a[212:215], a[148:151], v[32:47]
  v_mfma_f32_32x32x16_bf16 v[48:63], a[212:215], a[180:183], v[48:63]
  s_waitcnt lgkmcnt(1)
  v_mfma_f32_32x32x16_bf16 v[32:47], a[216:219], a[152:155], v[32:47]
  v_mfma_f32_32x32x16_bf16 v[48:63], a[216:219], a[184:187], v[48:63]
  s_waitcnt lgkmcnt(0)
  v_mfma_f32_32x32x16_bf16 v[32:47], a[220:223], a[156:159], v[32:47]
  v_mfma_f32_32x32x16_bf16 v[48:63], a[220:223], a[188:191], v[48:63]
  s_add_u32 s58, s52, 1
  s_and_b32 s58, s58, 3
  s_lshl_b32 s58, s58, 14
  s_add_u32 s58, s58, 0
  v_add_u32 v160, s58, v162
  s_waitcnt vmcnt(16)
  s_barrier
  ds_read_b128 a[192:195], v160 offset:0
  ds_read_b128 a[196:199], v160 offset:1024
  ds_read_b128 a[200:203], v160 offset:2048
  ds_read_b128 a[204:207], v160 offset:3072
  s_cmp_eq_u32 s51, 1
  s_cbranch_scc0 AB_nm
  v_mov_b32 v170, 0xf149f2ca
  v_cmp_gt_i32 vcc, 0, v163
  v_mov_b32 v32, v170
  s_nop 0
  v_cndmask_b32 v0, v0, v170, vcc
  v_cndmask_b32 v48, v48, v170, vcc
  v_cmp_gt_i32 vcc, 1, v163
  v_mov_b32 v33, v170
  s_nop 0
  v_cndmask_b32 v1, v1, v170, vcc
  v_cndmask_b32 v49, v49, v170, vcc
  v_cmp_gt_i32 vcc, 2, v163
  v_mov_b32 v34, v170
  s_nop 0
  v_cndmask_b32 v2, v2, v170, vcc
  v_cndmask_b32 v50, v50, v170, vcc
  v_cmp_gt_i32 vcc, 3, v163
  v_mov_b32 v35, v170
  s_nop 0
  v_cndmask_b32 v3, v3, v170, vcc
  v_cndmask_b32 v51, v51, v170, vcc
  v_cmp_gt_i32 vcc, 8, v163
  v_mov_b32 v36, v170
  s_nop 0
  v_cndmask_b32 v4, v4, v170, vcc
  v_cndmask_b32 v52, v52, v170, vcc
  v_cmp_gt_i32 vcc, 9, v163
  v_mov_b32 v37, v170
  s_nop 0
  v_cndmask_b32 v5, v5, v170, vcc
  v_cndmask_b32 v53, v53, v170, vcc
  v_cmp_gt_i32 vcc, 10, v163
  v_mov_b32 v38, v170
  s_nop 0
  v_cndmask_b32 v6, v6, v170, vcc
  v_cndmask_b32 v54, v54, v170, vcc
  v_cmp_gt_i32 vcc, 11, v163
  v_mov_b32 v39, v170
  s_nop 0
  v_cndmask_b32 v7, v7, v170, vcc
  v_cndmask_b32 v55, v55, v170, vcc
  v_cmp_gt_i32 vcc, 16, v163
  v_mov_b32 v40, v170
  s_nop 0
  v_cndmask_b32 v8, v8, v170, vcc
  v_cndmask_b32 v56, v56, v170, vcc
  v_cmp_gt_i32 vcc, 17, v163
  v_mov_b32 v41, v170
  s_nop 0
  v_cndmask_b32 v9, v9, v170, vcc
  v_cndmask_b32 v57, v57, v170, vcc
  v_cmp_gt_i32 vcc, 18, v163
  v_mov_b32 v42, v170
  s_nop 0
  v_cndmask_b32 v10, v10, v170, vcc
  v_cndmask_b32 v58, v58, v170, vcc
  v_cmp_gt_i32 vcc, 19, v163
  v_mov_b32 v43, v170
  s_nop 0
  v_cndmask_b32 v11, v11, v170, vcc
  v_cndmask_b32 v59, v59, v170, vcc
  v_cmp_gt_i32 vcc, 24, v163
  v_mov_b32 v44, v170
  s_nop 0
  v_cndmask_b32 v12, v12, v170, vcc
  v_cndmask_b32 v60, v60, v170, vcc
  v_cmp_gt_i32 vcc, 25, v163
  v_mov_b32 v45, v170
  s_nop 0
  v_cndmask_b32 v13, v13, v170, vcc
  v_cndmask_b32 v61, v61, v170, vcc
  v_cmp_gt_i32 vcc, 26, v163
  v_mov_b32 v46, v170
  s_nop 0
  v_cndmask_b32 v14, v14, v170, vcc
  v_cndmask_b32 v62, v62, v170, vcc
  v_cmp_gt_i32 vcc, 27, v163
  v_mov_b32 v47, v170
  s_nop 0
  v_cndmask_b32 v15, v15, v170, vcc
  v_cndmask_b32 v63, v63, v170, vcc
  v_max_f32 v168, v0, v1
  v_max_f32 v169, v16, v17
  v_max3_f32 v168, v168, v2, v3
  v_max3_f32 v169, v169, v18, v19
  v_max3_f32 v168, v168, v4, v5
  v_max3_f32 v169, v169, v20, v21
  v_max3_f32 v168, v168, v6, v7
  v_max3_f32 v169, v169, v22, v23
  v_max3_f32 v168, v168, v8, v9
  v_max3_f32 v169, v169, v24, v25
  v_max3_f32 v168, v168, v10, v11
  v_max3_f32 v169, v169, v26, v27
  v_max3_f32 v168, v168, v12, v13
  v_max3_f32 v169, v169, v28, v29
  v_max3_f32 v168, v168, v14, v15
  v_max3_f32 v169, v169, v30, v31
  v_max3_f32 v168, v168, v32, v33
  v_max3_f32 v169, v169, v48, v49
  v_max3_f32 v168, v168, v34, v35
  v_max3_f32 v169, v169, v50, v51
  v_max3_f32 v168, v168, v36, v37
  v_max3_f32 v169, v169, v52, v53
  v_max3_f32 v168, v168, v38, v39
  v_max3_f32 v169, v169, v54, v55
  v_max3_f32 v168, v168, v40, v41
  v_max3_f32 v169, v169, v56, v57
  v_max3_f32 v168, v168, v42, v43
  v_max3_f32 v169, v169, v58, v59
  v_max3_f32 v168, v168, v44, v45
  v_max3_f32 v169, v169, v60, v61
  v_max3_f32 v168, v168, v46, v47
  v_max3_f32 v169, v169, v62, v63
  s_branch AB_m0
AB_nm:
  v_max_f32 v168, v0, v1
  v_max_f32 v169, v16, v17
  v_max3_f32 v168, v168, v2, v3
  v_max3_f32 v169, v169, v18, v19
  v_max3_f32 v168, v168, v4, v5
  v_max3_f32 v169, v169, v20, v21
  v_max3_f32 v168, v168, v6, v7
  v_max3_f32 v169, v169, v22, v23
  v_max3_f32 v168, v168, v8, v9
  v_max3_f32 v169, v169, v24, v25
  v_max3_f32 v168, v168, v10, v11
  v_max3_f32 v169, v169, v26, v27
  v_max3_f32 v168, v168, v12, v13
  v_max3_f32 v169, v169, v28, v29
  v_max3_f32 v168, v168, v14, v15
  v_max3_f32 v169, v169, v30, v31
  v_max3_f32 v168, v168, v32, v33
  v_max3_f32 v169, v169, v48, v49
  v_max3_f32 v168, v168, v34, v35
  v_max3_f32 v169, v169, v50, v51
  v_max3_f32 v168, v168, v36, v37
  v_max3_f32 v169, v169, v52, v53
  v_max3_f32 v168, v168, v38, v39
  v_max3_f32 v169, v169, v54, v55
  v_max3_f32 v168, v168, v40, v41
  v_max3_f32 v169, v169, v56, v57
  v_max3_f32 v168, v168, v42, v43
  v_max3_f32 v169, v169, v58, v59
  v_max3_f32 v168, v168, v44, v45
  v_max3_f32 v169, v169, v60, v61
  v_max3_f32 v168, v168, v46, v47
  v_max3_f32 v169, v169, v62, v63
AB_m0:
  v_mov_b32 v170, v168
  s_nop 1
  v_permlane32_swap_b32 v170, v168
  v_max_f32 v170, v170, v168
  v_sub_f32 v0, v0, v170
  v_sub_f32 v1, v1, v170
  v_sub_f32 v2, v2, v170
  v_sub_f32 v3, v3, v170
  v_sub_f32 v4, v4, v170
  v_sub_f32 v5, v5, v170
  v_sub_f32 v6, v6, v170
  v_sub_f32 v7, v7, v170
  v_sub_f32 v8, v8, v170
  v_sub_f32 v9, v9, v170
  v_sub_f32 v10, v10, v170
  v_sub_f32 v11, v11, v170
  v_sub_f32 v12, v12, v170
  v_sub_f32 v13, v13, v170
  v_sub_f32 v14, v14, v170
  v_sub_f32 v15, v15, v170
  v_sub_f32 v32, v32, v170
  v_sub_f32 v33, v33, v170
  v_sub_f32 v34, v34, v170
  v_sub_f32 v35, v35, v170
  v_sub_f32 v36, v36, v170
  v_sub_f32 v37, v37, v170
  v_sub_f32 v38, v38, v170
  v_sub_f32 v39, v39, v170
  v_sub_f32 v40, v40, v170
  v_sub_f32 v41, v41, v170
  v_sub_f32 v42, v42, v170
  v_sub_f32 v43, v43, v170
  v_sub_f32 v44, v44, v170
  v_sub_f32 v45, v45, v170
  v_sub_f32 v46, v46, v170
  v_sub_f32 v47, v47, v170
  v_sub_f32 v128, 0, v170
  v_sub_f32 v129, 0, v170
  v_sub_f32 v130, 0, v170
  v_sub_f32 v131, 0, v170
  v_sub_f32 v132, 0, v170
  v_sub_f32 v133, 0, v170
  v_sub_f32 v134, 0, v170
  v_sub_f32 v135, 0, v170
  v_sub_f32 v136, 0, v170
  v_sub_f32 v137, 0, v170
  v_sub_f32 v138, 0, v170
  v_sub_f32 v139, 0, v170
  v_sub_f32 v140, 0, v170
  v_sub_f32 v141, 0, v170
  v_sub_f32 v142, 0, v170
  v_sub_f32 v143, 0, v170
  v_mov_b32 v171, v169
  s_nop 1
  v_permlane32_swap_b32 v171, v169
  v_max_f32 v171, v171, v169
  v_sub_f32 v16, v16, v171
  v_sub_f32 v17, v17, v171
  v_sub_f32 v18, v18, v171
  v_sub_f32 v19, v19, v171
  v_sub_f32 v20, v20, v171
  v_sub_f32 v21, v21, v171
  v_sub_f32 v22, v22, v171
  v_sub_f32 v23, v23, v171
  v_sub_f32 v24, v24, v171
  v_sub_f32 v25, v25, v171
  v_sub_f32 v26, v26, v171
  v_sub_f32 v27, v27, v171
  v_sub_f32 v28, v28, v171
  v_sub_f32 v29, v29, v171
  v_sub_f32 v30, v30, v171
  v_sub_f32 v31, v31, v171
  v_sub_f32 v48, v48, v171
  v_sub_f32 v49, v49, v171
  v_sub_f32 v50, v50, v171
  v_sub_f32 v51, v51, v171
  v_sub_f32 v52, v52, v171
  v_sub_f32 v53, v53, v171
  v_sub_f32 v54, v54, v171
  v_sub_f32 v55, v55, v171
  v_sub_f32 v56, v56, v171
  v_sub_f32 v57, v57, v171
  v_sub_f32 v58, v58, v171
  v_sub_f32 v59, v59, v171
  v_sub_f32 v60, v60, v171
  v_sub_f32 v61, v61, v171
  v_sub_f32 v62, v62, v171
  v_sub_f32 v63, v63, v171
  v_sub_f32 v144, 0, v171
  v_sub_f32 v145, 0, v171
  v_sub_f32 v146, 0, v171
  v_sub_f32 v147, 0, v171
  v_sub_f32 v148, 0, v171
  v_sub_f32 v149, 0, v171
  v_sub_f32 v150, 0, v171
  v_sub_f32 v151, 0, v171
  v_sub_f32 v152, 0, v171
  v_sub_f32 v153, 0, v171
  v_sub_f32 v154, 0, v171
  v_sub_f32 v155, 0, v171
  v_sub_f32 v156, 0, v171
  v_sub_f32 v157, 0, v171
  v_sub_f32 v158, 0, v171
  v_sub_f32 v159, 0, v171
AB_loop:
  s_add_u32 s56, s52, 1
  s_cmp_ge_u32 s56, s51
  s_cbranch_scc1 AB_last0
  s_waitcnt lgkmcnt(3)
  v_mfma_f32_32x32x16_bf16 v[64:79], a[192:195], a[128:131], v[128:143]
  ds_read_b128 a[208:211], v160 offset:4096
  v_exp_f32 v0, v0
  v_exp_f32 v1, v1
  v_mfma_f32_32x32x16_bf16 v[80:95], a[192:195], a[160:163], v[144:159]
  v_exp_f32 v2, v2
  v_exp_f32 v3, v3
  v_add_f32 v164, v164, v0
  v_add_f32 v165, v165, v1
  s_waitcnt lgkmcnt(3)
  v_mfma_f32_32x32x16_bf16 v[64:79], a[196:199], a[132:135], v[64:79]
  ds_read_b128 a[212:215], v160 offset:5120
  s_add_u32 s58, s52, 0
  s_and_b32 s58, s58, 3
  s_lshl_b32 s58, s58, 14
  s_add_u32 s58, s58, 65536
  v_add_u32 v161, s58, v162
  v_cvt_pk_bf16_f32 v0, v0, v1
  v_mfma_f32_32x32x16_bf16 v[80:95], a[196:199], a[164:167], v[80:95]
  v_exp_f32 v4, v4
  v_exp_f32 v5, v5
  v_add_f32 v164, v164, v2
  v_add_f32 v165, v165, v3
  s_waitcnt lgkmcnt(3)
  v_mfma_f32_32x32x16_bf16 v[64:79], a[200:203], a[136:139], v[64:79]
  ds_read_b128 a[216:219], v160 offset:6144
  v_cvt_pk_bf16_f32 v1, v2, v3
  v_exp_f32 v6, v6
  v_mfma_f32_32x32x16_bf16 v[80:95], a[200:203], a[168:171], v[80:95]
  v_exp_f32 v7, v7
  v_add_f32 v164, v164, v4
  v_add_f32 v165, v165, v5
  v_cvt_pk_bf16_f32 v2, v4, v5
  s_waitcnt lgkmcnt(3)
  v_mfma_f32_32x32x16_bf16 v[64:79], a[204:207], a[140:143], v[64:79]
  ds_read_b128 a[220:223], v160 offset:7168
  v_exp_f32 v16, v16
  v_exp_f32 v17, v17
  v_mfma_f32_32x32x16_bf16 v[80:95], a[204:207], a[172:175], v[80:95]
  v_add_f32 v164, v164, v6
  v_add_f32 v165, v165, v7
  v_cvt_pk_bf16_f32 v3, v6, v7
  v_exp_f32 v18, v18
  s_waitcnt lgkmcnt(3)
  v_mfma_f32_32x32x16_bf16 v[64:79], a[208:211], a[144:147], v[64:79]
  ds_read_b128 a[192:195], v160 offset:8192
  v_exp_f32 v19, v19
  v_add_f32 v166, v166, v16
  v_add_f32 v167, v167, v17
  v_mfma_f32_32x32x16_bf16 v[80:95], a[208:211], a[176:179], v[80:95]
  v_cvt_pk_bf16_f32 v16, v16, v17
  v_exp_f32 v20, v20
  v_exp_f32 v21, v21
  s_waitcnt lgkmcnt(3)
  v_mfma_f32_32x32x16_bf16 v[64:79], a[212:215], a[148:151], v[64:79]
  ds_read_b128 a[196:199], v160 offset:9216
  v_add_f32 v166, v166, v18
  v_add_f32 v167, v167, v19
  v_cvt_pk_bf16_f32 v17, v18, v19
  v_mfma_f32_32x32x16_bf16 v[80:95], a[212:215], a[180:183], v[80:95]
  v_exp_f32 v22, v22
  v_exp_f32 v23, v23
  v_add_f32 v166, v166, v20
  v_add_f32 v167, v167, v21
  s_waitcnt lgkmcnt(3)
  v_mfma_f32_32x32x16_bf16 v[64:79], a[216:219], a[152:155], v[64:79]
  ds_read_b128 a[200:203], v160 offset:10240
  v_cvt_pk_bf16_f32 v18, v20, v21
  v_add_f32 v166, v166, v22
  v_add_f32 v167, v167, v23
  v_cvt_pk_bf16_f32 v19, v22, v23
  v_mfma_f32_32x32x16_bf16 v[80:95], a[216:219], a[184:187], v[80:95]
  v_exp_f32 v8, v8
  v_exp_f32 v9, v9
  v_exp_f32 v10, v10
  s_waitcnt lgkmcnt(3)
  v_mfma_f32_32x32x16_bf16 v[64:79], a[220:223], a[156:159], v[64:79]
  ds_read_b128 a[204:207], v160 offset:11264
  v_exp_f32 v11, v11
  v_add_f32 v164, v164, v8
  v_add_f32 v165, v165, v9
  v_mfma_f32_32x32x16_bf16 v[80:95], a[220:223], a[188:191], v[80:95]
  v_cvt_pk_bf16_f32 v4, v8, v9
  v_exp_f32 v12, v12
  v_exp_f32 v13, v13
  s_waitcnt lgkmcnt(3)
  v_mfma_f32_32x32x16_bf16 v[96:111], a[192:195], a[128:131], v[128:143]
  ds_read_b128 a[208:211], v160 offset:12288
  v_add_f32 v164, v164, v10
  v_add_f32 v165, v165, v11
  v_cvt_pk_bf16_f32 v5, v10, v11
  v_mfma_f32_32x32x16_bf16 v[112:127], a[192:195], a[160:163], v[144:159]
  v_exp_f32 v14, v14
  v_exp_f32 v15, v15
  v_add_f32 v164, v164, v12
  v_add_f32 v165, v165, v13
  s_waitcnt lgkmcnt(3)
  v_mfma_f32_32x32x16_bf16 v[96:111], a[196:199], a[132:135], v[96:111]
  ds_read_b128 a[212:215], v160 offset:13312
  v_cvt_pk_bf16_f32 v6, v12, v13
  v_exp_f32 v24, v24
  v_max_f32 v168, v64, v65
  v_mfma_f32_32x32x16_bf16 v[112:127], a[196:199], a[164:167], v[112:127]
  v_exp_f32 v25, v25
  v_add_f32 v164, v164, v14
  v_add_f32 v165, v165, v15
  v_cvt_pk_bf16_f32 v7, v14, v15
  s_waitcnt lgkmcnt(3)
  v_mfma_f32_32x32x16_bf16 v[96:111], a[200:203], a[136:139], v[96:111]
  ds_read_b128 a[216:219], v160 offset:14336
  v_exp_f32 v26, v26
  v_exp_f32 v27, v27
  v_mfma_f32_32x32x16_bf16 v[112:127], a[200:203], a[168:171], v[112:127]
  v_add_f32 v166, v166, v24
  v_add_f32 v167, v167, v25
  v_cvt_pk_bf16_f32 v20, v24, v25
  v_exp_f32 v28, v28
  s_waitcnt lgkmcnt(3)
  v_mfma_f32_32x32x16_bf16 v[96:111], a[204:207], a[140:143], v[96:111]
  ds_read_b128 a[220:223], v160 offset:15360
  v_exp_f32 v29, v29
  v_add_f32 v166, v166, v26
  v_add_f32 v167, v167, v27
  v_mfma_f32_32x32x16_bf16 v[112:127], a[204:207], a[172:175], v[112:127]
  v_cvt_pk_bf16_f32 v21, v26, v27
  v_exp_f32 v30, v30
  v_exp_f32 v31, v31
  s_waitcnt lgkmcnt(3)
  v_mfma_f32_32x32x16_bf16 v[96:111], a[208:211], a[144:147], v[96:111]
  ds_read_b128 a[192:195], v161 offset:0
  v_add_f32 v166, v166, v28
  v_add_f32 v167, v167, v29
  v_cvt_pk_bf16_f32 v22, v28, v29
  v_add_f32 v166, v166, v30
  v_mfma_f32_32x32x16_bf16 v[112:127], a[208:211], a[176:179], v[112:127]
  v_add_f32 v167, v167, v31
  v_cvt_pk_bf16_f32 v23, v30, v31
  v_exp_f32 v32, v32
  v_max_f32 v169, v80, v81
  s_waitcnt lgkmcnt(3)
  v_mfma_f32_32x32x16_bf16 v[96:111], a[212:215], a[148:151], v[96:111]
  ds_read_b128 a[196:199], v161 offset:2048
  v_exp_f32 v33, v33
  v_exp_f32 v34, v34
  v_mfma_f32_32x32x16_bf16 v[112:127], a[212:215], a[180:183], v[112:127]
  v_exp_f32 v35, v35
  v_add_f32 v164, v164, v32
  v_add_f32 v165, v165, v33
  v_cvt_pk_bf16_f32 v32, v32, v33
  s_waitcnt lgkmcnt(3)
  v_mfma_f32_32x32x16_bf16 v[96:111], a[216:219], a[152:155], v[96:111]
  ds_read_b128 a[200:203], v161 offset:4096
  v_exp_f32 v36, v36
  v_exp_f32 v37, v37
  v_mfma_f32_32x32x16_bf16 v[112:127], a[216:219], a[184:187], v[112:127]
  v_add_f32 v164, v164, v34
  v_add_f32 v165, v165, v35
  v_cvt_pk_bf16_f32 v33, v34, v35
  v_exp_f32 v38, v38
  s_waitcnt lgkmcnt(3)
  v_mfma_f32_32x32x16_bf16 v[96:111], a[220:223], a[156:159], v[96:111]
  ds_read_b128 a[204:207], v161 offset:6144
  v_exp_f32 v39, v39
  v_add_f32 v164, v164, v36
  v_add_f32 v165, v165, v37
  v_mfma_f32_32x32x16_bf16 v[112:127], a[220:223], a[188:191], v[112:127]
  v_cvt_pk_bf16_f32 v34, v36, v37
  v_exp_f32 v48, v48
  v_exp_f32 v49, v49
  s_waitcnt lgkmcnt(3)
  v_mfma_f32_32x32x16_bf16 a[0:15], a[192:195], v[0:3], a[0:15]
  ds_read_b128 a[208:211], v161 offset:1024
  v_add_f32 v164, v164, v38
  v_add_f32 v165, v165, v39
  v_cvt_pk_bf16_f32 v35, v38, v39
  v_max3_f32 v168, v168, v66, v67
  v_mfma_f32_32x32x16_bf16 a[16:31], a[192:195], v[16:19], a[16:31]
  v_exp_f32 v50, v50
  v_exp_f32 v51, v51
  v_add_f32 v166, v166, v48
  v_add_f32 v167, v167, v49
  s_waitcnt lgkmcnt(3)
  v_mfma_f32_32x32x16_bf16 a[32:47], a[196:199], v[0:3], a[32:47]
  ds_read_b128 a[212:215], v161 offset:3072
  s_add_u32 s58, s52, 2
  s_and_b32 s58, s58, 3
  s_lshl_b32 s58, s58, 14
  s_add_u32 s58, s58, 0
  v_add_u32 v160, s58, v162
  v_cvt_pk_bf16_f32 v48, v48, v49
  v_mfma_f32_32x32x16_bf16 a[48:63], a[196:199], v[16:19], a[48:63]
  v_exp_f32 v52, v52
  v_exp_f32 v53, v53
  v_add_f32 v166, v166, v50
  v_add_f32 v167, v167, v51
  s_waitcnt lgkmcnt(3)
  v_mfma_f32_32x32x16_bf16 a[64:79], a[200:203], v[0:3], a[64:79]
  ds_read_b128 a[216:219], v161 offset:5120
  v_cvt_pk_bf16_f32 v49, v50, v51
  v_exp_f32 v54, v54
  v_max3_f32 v169, v169, v82, v83
  v_mfma_f32_32x32x16_bf16 a[80:95], a[200:203], v[16:19], a[80:95]
  v_exp_f32 v55, v55
  v_add_f32 v166, v166, v52
  v_add_f32 v167, v167, v53
  v_cvt_pk_bf16_f32 v50, v52, v53
  s_waitcnt lgkmcnt(3)
  v_mfma_f32_32x32x16_bf16 a[96:111], a[204:207], v[0:3], a[96:111]
  ds_read_b128 a[220:223], v161 offset:7168
  v_add_f32 v166, v166, v54
  v_add_f32 v167, v167, v55
  v_cvt_pk_bf16_f32 v51, v54, v55
  v_max3_f32 v168, v168, v68, v69
  v_mfma_f32_32x32x16_bf16 a[112:127], a[204:207], v[16:19], a[112:127]
  v_exp_f32 v40, v40
  v_exp_f32 v41, v41
  v_exp_f32 v42, v42
  s_waitcnt lgkmcnt(3)
  v_mfma_f32_32x32x16_bf16 a[0:15], a[208:211], v[4:7], a[0:15]
  ds_read_b128 a[192:195], v161 offset:8192
  v_exp_f32 v43, v43
  v_add_f32 v164, v164, v40
  v_add_f32 v165, v165, v41
  v_mfma_f32_32x32x16_bf16 a[16:31], a[208:211], v[20:23], a[16:31]
  v_cvt_pk_bf16_f32 v36, v40, v41
  v_exp_f32 v44, v44
  v_exp_f32 v45, v45
  s_waitcnt lgkmcnt(3)
  v_mfma_f32_32x32x16_bf16 a[32:47], a[212:215], v[4:7], a[32:47]
  ds_read_b128 a[196:199], v161 offset:10240
  v_add_f32 v164, v164, v42
  v_add_f32 v165, v165, v43
  v_cvt_pk_bf16_f32 v37, v42, v43
  v_max3_f32 v169, v169, v84, v85
  v_mfma_f32_32x32x16_bf16 a[48:63], a[212:215], v[20:23], a[48:63]
  v_exp_f32 v46, v46
  v_exp_f32 v47, v47
  v_add_f32 v164, v164, v44
  v_add_f32 v165, v165, v45
  s_waitcnt lgkmcnt(3)
  v_mfma_f32_32x32x16_bf16 a[64:79], a[216:219], v[4:7], a[64:79]
  ds_read_b128 a[200:203], v161 offset:12288
  v_cvt_pk_bf16_f32 v38, v44, v45
  v_exp_f32 v56, v56
  v_max3_f32 v168, v168, v70, v71
  v_mfma_f32_32x32x16_bf16 a[80:95], a[216:219], v[20:23], a[80:95]
  v_exp_f32 v57, v57
  v_add_f32 v164, v164, v46
  v_add_f32 v165, v165, v47
  v_cvt_pk_bf16_f32 v39, v46, v47
  s_waitcnt lgkmcnt(3)
  v_mfma_f32_32x32x16_bf16 a[96:111], a[220:223], v[4:7], a[96:111]
  ds_read_b128 a[204:207], v161 offset:14336
  v_exp_f32 v58, v58
  v_exp_f32 v59, v59
  v_mfma_f32_32x32x16_bf16 a[112:127], a[220:223], v[20:23], a[112:127]
  v_add_f32 v166, v166, v56
  v_add_f32 v167, v167, v57
  v_cvt_pk_bf16_f32 v52, v56, v57
  v_exp_f32 v60, v60
  s_waitcnt lgkmcnt(3)
  v_mfma_f32_32x32x16_bf16 a[0:15], a[192:195], v[32:35], a[0:15]
  ds_read_b128 a[208:211], v161 offset:9216
  v_exp_f32 v61, v61
  v_add_f32 v166, v166, v58
  v_add_f32 v167, v167, v59
  v_mfma_f32_32x32x16_bf16 a[16:31], a[192:195], v[48:51], a[16:31]
  v_cvt_pk_bf16_f32 v53, v58, v59
  v_exp_f32 v62, v62
  v_exp_f32 v63, v63
  s_waitcnt lgkmcnt(3)
  v_mfma_f32_32x32x16_bf16 a[32:47], a[196:199], v[32:35], a[32:47]
  ds_read_b128 a[212:215], v161 offset:11264
  v_add_f32 v166, v166, v60
  v_add_f32 v167, v167, v61
  v_cvt_pk_bf16_f32 v54, v60, v61
  v_add_f32 v166, v166, v62
  v_mfma_f32_32x32x16_bf16 a[48:63], a[196:199], v[48:51], a[48:63]
  v_add_f32 v167, v167, v63
  v_cvt_pk_bf16_f32 v55, v62, v63
  v_max3_f32 v169, v169, v86, v87
  v_max3_f32 v168, v168, v72, v73
  v_max3_f32 v169, v169, v88, v89
  s_waitcnt lgkmcnt(3)
  v_mfma_f32_32x32x16_bf16 a[64:79], a[200:203], v[32:35], a[64:79]
  ds_read_b128 a[216:219], v161 offset:13312
  v_max3_f32 v168, v168, v74, v75
  v_max3_f32 v169, v169, v90, v91
  v_max3_f32 v168, v168, v76, v77
  v_max3_f32 v169, v169, v92, v93
  v_mfma_f32_32x32x16_bf16 a[80:95], a[200:203], v[48:51], a[80:95]
  v_max3_f32 v168, v168, v78, v79
  v_max3_f32 v169, v169, v94, v95
  v_max3_f32 v168, v168, v96, v97
  v_max3_f32 v169, v169, v112, v113
  v_max3_f32 v168, v168, v98, v99
  v_max3_f32 v169, v169, v114, v115
  s_waitcnt vmcnt(8)
  s_barrier
  s_waitcnt lgkmcnt(3)
  v_mfma_f32_32x32x16_bf16 a[96:111], a[204:207], v[32:35], a[96:111]
  ds_read_b128 a[220:223], v161 offset:15360
  s_add_u32 s56, s52, 4
  s_and_b32 s57, s56, 3
  s_lshl_b32 s57, s57, 14
  s_add_u32 s57, s57, s55
  s_add_u32 m0, s57, 0
  s_cmp_lt_u32 s56, s50
  s_mul_i32 s56, s56, 16384
  s_cselect_b32 s56, s56, 0x10000000
  s_add_u32 s56, s56, s53
  buffer_load_dwordx4 v162, s[36:39], s56 offen offset:0 sc1 lds
  v_mfma_f32_32x32x16_bf16 a[112:127], a[204:207], v[48:51], a[112:127]
  buffer_load_dwordx4 v162, s[36:39], s56 offen offset:1024 sc1 lds
  v_max3_f32 v168, v168, v100, v101
  v_max3_f32 v169, v169, v116, v117
  v_max3_f32 v168, v168, v102, v103
  v_max3_f32 v169, v169, v118, v119
  s_waitcnt lgkmcnt(3)
  v_mfma_f32_32x32x16_bf16 a[0:15], a[208:211], v[36:39], a[0:15]
  ds_read_b128 a[192:195], v160 offset:0
  buffer_load_dwordx4 v162, s[36:39], s56 offen offset:2048 sc1 lds
  v_max3_f32 v168, v168, v104, v105
  v_max3_f32 v169, v169, v120, v121
  v_mfma_f32_32x32x16_bf16 a[16:31], a[208:211], v[52:55], a[16:31]
  buffer_load_dwordx4 v162, s[36:39], s56 offen offset:3072 sc1 lds
  v_max3_f32 v168, v168, v106, v107
  v_max3_f32 v169, v169, v122, v123
  v_max3_f32 v168, v168, v108, v109
  v_max3_f32 v169, v169, v124, v125
  s_waitcnt lgkmcnt(3)
  v_mfma_f32_32x32x16_bf16 a[32:47], a[212:215], v[36:39], a[32:47]
  ds_read_b128 a[196:199], v160 offset:1024
  s_add_u32 s56, s52, 3
  s_and_b32 s57, s56, 3
  s_lshl_b32 s57, s57, 14
  s_add_u32 s57, s57, s55
  s_add_u32 m0, s57, 65536
  s_cmp_lt_u32 s56, s50
  s_mul_i32 s56, s56, 16384
  s_cselect_b32 s56, s56, 0x10000000
  s_add_u32 s56, s56, s54
  buffer_load_dwordx4 v162, s[36:39], s56 offen offset:0 sc1 lds
  v_mfma_f32_32x32x16_bf16 a[48:63], a[212:215], v[52:55], a[48:63]
  buffer_load_dwordx4 v162, s[36:39], s56 offen offset:1024 sc1 lds
  v_max3_f32 v168, v168, v110, v111
  v_max3_f32 v169, v169, v126, v127
  s_waitcnt lgkmcnt(3)
  v_mfma_f32_32x32x16_bf16 a[64:79], a[216:219], v[36:39], a[64:79]
  ds_read_b128 a[200:203], v160 offset:2048
  buffer_load_dwordx4 v162, s[36:39], s56 offen offset:2048 sc1 lds
  v_mfma_f32_32x32x16_bf16 a[80:95], a[216:219], v[52:55], a[80:95]
  buffer_load_dwordx4 v162, s[36:39], s56 offen offset:3072 sc1 lds
  s_waitcnt lgkmcnt(3)
  v_mfma_f32_32x32x16_bf16 a[96:111], a[220:223], v[36:39], a[96:111]
  ds_read_b128 a[204:207], v160 offset:3072
  v_mfma_f32_32x32x16_bf16 a[112:127], a[220:223], v[52:55], a[112:127]
  s_add_u32 s52, s52, 1
  s_add_u32 s56, s52, 1
  s_cmp_eq_u32 s56, s51
  s_cbranch_scc1 AB_diag0
AB_chk0:
  v_max_f32 v170, v168, v169
  v_cmp_lt_f32 vcc, s59, v170
  s_nop 0
  s_cbranch_vccnz AB_rs0
AB_cont0:
  s_add_u32 s56, s52, 1
  s_cmp_ge_u32 s56, s51
  s_cbranch_scc1 AB_last1
  s_waitcnt lgkmcnt(3)
  v_mfma_f32_32x32x16_bf16 v[0:15], a[192:195], a[128:131], v[128:143]
  ds_read_b128 a[208:211], v160 offset:4096
  v_exp_f32 v64, v64
  v_exp_f32 v65, v65
  v_mfma_f32_32x32x16_bf16 v[16:31], a[192:195], a[160:163], v[144:159]
  v_exp_f32 v66, v66
  v_exp_f32 v67, v67
  v_add_f32 v164, v164, v64
  v_add_f32 v165, v165, v65
  s_waitcnt lgkmcnt(3)
  v_mfma_f32_32x32x16_bf16 v[0:15], a[196:199], a[132:135], v[0:15]
  ds_read_b128 a[212:215], v160 offset:5120
  s_add_u32 s58, s52, 0
  s_and_b32 s58, s58, 3
  s_lshl_b32 s58, s58, 14
  s_add_u32 s58, s58, 65536
  v_add_u32 v161, s58, v162
  v_cvt_pk_bf16_f32 v64, v64, v65
  v_mfma_f32_32x32x16_bf16 v[16:31], a[196:199], a[164:167], v[16:31]
  v_exp_f32 v68, v68
  v_exp_f32 v69, v69
  v_add_f32 v164, v164, v66
  v_add_f32 v165, v165, v67
  s_waitcnt lgkmcnt(3)
  v_mfma_f32_32x32x16_bf16 v[0:15], a[200:203], a[136:139], v[0:15]
  ds_read_b128 a[216:219], v160 offset:6144
  v_cvt_pk_bf16_f32 v65, v66, v67
  v_exp_f32 v70, v70
  v_mfma_f32_32x32x16_bf16 v[16:31], a[200:203], a[168:171], v[16:31]
  v_exp_f32 v71, v71
  v_add_f32 v164, v164, v68
  v_add_f32 v165, v165, v69
  v_cvt_pk_bf16_f32 v66, v68, v69
  s_waitcnt lgkmcnt(3)
  v_mfma_f32_32x32x16_bf16 v[0:15], a[204:207], a[140:143], v[0:15]
  ds_read_b128 a[220:223], v160 offset:7168
  v_exp_f32 v80, v80
  v_exp_f32 v81, v81
  v_mfma_f32_32x32x16_bf16 v[16:31], a[204:207], a[172:175], v[16:31]
  v_add_f32 v164, v164, v70
  v_add_f32 v165, v165, v71
  v_cvt_pk_bf16_f32 v67, v70, v71
  v_exp_f32 v82, v82
  s_waitcnt lgkmcnt(3)
  v_mfma_f32_32x32x16_bf16 v[0:15], a[208:211], a[144:147], v[0:15]
  ds_read_b128 a[192:195], v160 offset:8192
  v_exp_f32 v83, v83
  v_add_f32 v166, v166, v80
  v_add_f32 v167, v167, v81
  v_mfma_f32_32x32x16_bf16 v[16:31], a[208:211], a[176:179], v[16:31]
  v_cvt_pk_bf16_f32 v80, v80, v81
  v_exp_f32 v84, v84
  v_exp_f32 v85, v85
  s_waitcnt lgkmcnt(3)
  v_mfma_f32_32x32x16_bf16 v[0:15], a[212:215], a[148:151], v[0:15]
  ds_read_b128 a[196:199], v160 offset:9216
  v_add_f32 v166, v166, v82
  v_add_f32 v167, v167, v83
  v_cvt_pk_bf16_f32 v81, v82, v83
  v_mfma_f32_32x32x16_bf16 v[16:31], a[212:215], a[180:183], v[16:31]
  v_exp_f32 v86, v86
  v_exp_f32 v87, v87
  v_add_f32 v166, v166, v84
  v_add_f32 v167, v167, v85
  s_waitcnt lgkmcnt(3)
  v_mfma_f32_32x32x16_bf16 v[0:15], a[216:219], a[152:155], v[0:15]
  ds_read_b128 a[200:203], v160 offset:10240
  v_cvt_pk_bf16_f32 v82, v84, v85
  v_add_f32 v166, v166, v86
  v_add_f32 v167, v167, v87
  v_cvt_pk_bf16_f32 v83, v86, v87
  v_mfma_f32_32x32x16_bf16 v[16:31], a[216:219], a[184:187], v[16:31]
  v_exp_f32 v72, v72
  v_exp_f32 v73, v73
  v_exp_f32 v74, v74
  s_waitcnt lgkmcnt(3)
  v_mfma_f32_32x32x16_bf16 v[0:15], a[220:223], a[156:159], v[0:15]
  ds_read_b128 a[204:207], v160 offset:11264
  v_exp_f32 v75, v75
  v_add_f32 v164, v164, v72
  v_add_f32 v165, v165, v73
  v_mfma_f32_32x32x16_bf16 v[16:31], a[220:223], a[188:191], v[16:31]
  v_cvt_pk_bf16_f32 v68, v72, v73
  v_exp_f32 v76, v76
  v_exp_f32 v77, v77
  s_waitcnt lgkmcnt(3)
  v_mfma_f32_32x32x16_bf16 v[32:47], a[192:195], a[128:131], v[128:143]
  ds_read_b128 a[208:211], v160 offset:12288
  v_add_f32 v164, v164, v74
  v_add_f32 v165, v165, v75
  v_cvt_pk_bf16_f32 v69, v74, v75
  v_mfma_f32_32x32x16_bf16 v[48:63], a[192:195], a[160:163], v[144:159]
  v_exp_f32 v78, v78
  v_exp_f32 v79, v79
  v_add_f32 v164, v164, v76
  v_add_f32 v165, v165, v77
  s_waitcnt lgkmcnt(3)
  v_mfma_f32_32x32x16_bf16 v[32:47], a[196:199], a[132:135], v[32:47]
  ds_read_b128 a[212:215], v160 offset:13312
  v_cvt_pk_bf16_f32 v70, v76, v77
  v_exp_f32 v88, v88
  v_max_f32 v168, v0, v1
  v_mfma_f32_32x32x16_bf16 v[48:63], a[196:199], a[164:167], v[48:63]
  v_exp_f32 v89, v89
  v_add_f32 v164, v164, v78
  v_add_f32 v165, v165, v79
  v_cvt_pk_bf16_f32 v71, v78, v79
  s_waitcnt lgkmcnt(3)
  v_mfma_f32_32x32x16_bf16 v[32:47], a[200:203], a[136:139], v[32:47]
  ds_read_b128 a[216:219], v160 offset:14336
  v_exp_f32 v90, v90
  v_exp_f32 v91, v91
  v_mfma_f32_32x32x16_bf16 v[48:63], a[200:203], a[168:171], v[48:63]
  v_add_f32 v166, v166, v88
  v_add_f32 v167, v167, v89
  v_cvt_pk_bf16_f32 v84, v88, v89
  v_exp_f32 v92, v92
  s_waitcnt lgkmcnt(3)
  v_mfma_f32_32x32x16_bf16 v[32:47], a[204:207], a[140:143], v[32:47]
  ds_read_b128 a[220:223], v160 offset:15360
  v_exp_f32 v93, v93
  v_add_f32 v166, v166, v90
  v_add_f32 v167, v167, v91
  v_mfma_f32_32x32x16_bf16 v[48:63], a[204:207], a[172:175], v[48:63]
  v_cvt_pk_bf16_f32 v85, v90, v91
  v_exp_f32 v94, v94
  v_exp_f32 v95, v95
  s_waitcnt lgkmcnt(3)
  v_mfma_f32_32x32x16_bf16 v[32:47], a[208:211], a[144:147], v[32:47]
  ds_read_b128 a[192:195], v161 offset:0
  v_add_f32 v166, v166, v92
  v_add_f32 v167, v167, v93
  v_cvt_pk_bf16_f32 v86, v92, v93
  v_add_f32 v166, v166, v94
  v_mfma_f32_32x32x16_bf16 v[48:63], a[208:211], a[176:179], v[48:63]
  v_add_f32 v167, v167, v95
  v_cvt_pk_bf16_f32 v87, v94, v95
  v_exp_f32 v96, v96
  v_max_f32 v169, v16, v17
  s_waitcnt lgkmcnt(3)
  v_mfma_f32_32x32x16_bf16 v[32:47], a[212:215], a[148:151], v[32:47]
  ds_read_b128 a[196:199], v161 offset:2048
  v_exp_f32 v97, v97
  v_exp_f32 v98, v98
  v_mfma_f32_32x32x16_bf16 v[48:63], a[212:215], a[180:183], v[48:63]
  v_exp_f32 v99, v99
  v_add_f32 v164, v164, v96
  v_add_f32 v165, v165, v97
  v_cvt_pk_bf16_f32 v96, v96, v97
  s_waitcnt lgkmcnt(3)
  v_mfma_f32_32x32x16_bf16 v[32:47], a[216:219], a[152:155], v[32:47]
  ds_read_b128 a[200:203], v161 offset:4096
  v_exp_f32 v100, v100
  v_exp_f32 v101, v101
  v_mfma_f32_32x32x16_bf16 v[48:63], a[216:219], a[184:187], v[48:63]
  v_add_f32 v164, v164, v98
  v_add_f32 v165, v165, v99
  v_cvt_pk_bf16_f32 v97, v98, v99
  v_exp_f32 v102, v102
  s_waitcnt lgkmcnt(3)
  v_mfma_f32_32x32x16_bf16 v[32:47], a[220:223], a[156:159], v[32:47]
  ds_read_b128 a[204:207], v161 offset:6144
  v_exp_f32 v103, v103
  v_add_f32 v164, v164, v100
  v_add_f32 v165, v165, v101
  v_mfma_f32_32x32x16_bf16 v[48:63], a[220:223], a[188:191], v[48:63]
  v_cvt_pk_bf16_f32 v98, v100, v101
  v_exp_f32 v112, v112
  v_exp_f32 v113, v113
  s_waitcnt lgkmcnt(3)
  v_mfma_f32_32x32x16_bf16 a[0:15], a[192:195], v[64:67], a[0:15]
  ds_read_b128 a[208:211], v161 offset:1024
  v_add_f32 v164, v164, v102
  v_add_f32 v165, v165, v103
  v_cvt_pk_bf16_f32 v99, v102, v103
  v_max3_f32 v168, v168, v2, v3
  v_mfma_f32_32x32x16_bf16 a[16:31], a[192:195], v[80:83], a[16:31]
  v_exp_f32 v114, v114
  v_exp_f32 v115, v115
  v_add_f32 v166, v166, v112
  v_add_f32 v167, v167, v113
  s_waitcnt lgkmcnt(3)
  v_mfma_f32_32x32x16_bf16 a[32:47], a[196:199], v[64:67], a[32:47]
  ds_read_b128 a[212:215], v161 offset:3072
  s_add_u32 s58, s52, 2
  s_and_b32 s58, s58, 3
  s_lshl_b32 s58, s58, 14
  s_add_u32 s58, s58, 0
  v_add_u32 v160, s58, v162
  v_cvt_pk_bf16_f32 v112, v112, v113
  v_mfma_f32_32x32x16_bf16 a[48:63], a[196:199], v[80:83], a[48:63]
  v_exp_f32 v116, v116
  v_exp_f32 v117, v117
  v_add_f32 v166, v166, v114
  v_add_f32 v167, v167, v115
  s_waitcnt lgkmcnt(3)
  v_mfma_f32_32x32x16_bf16 a[64:79], a[200:203], v[64:67], a[64:79]
  ds_read_b128 a[216:219], v161 offset:5120
  v_cvt_pk_bf16_f32 v113, v114, v115
  v_exp_f32 v118, v118
  v_max3_f32 v169, v169, v18, v19
  v_mfma_f32_32x32x16_bf16 a[80:95], a[200:203], v[80:83], a[80:95]
  v_exp_f32 v119, v119
  v_add_f32 v166, v166, v116
  v_add_f32 v167, v167, v117
  v_cvt_pk_bf16_f32 v114, v116, v117
  s_waitcnt lgkmcnt(3)
  v_mfma_f32_32x32x16_bf16 a[96:111], a[204:207], v[64:67], a[96:111]
  ds_read_b128 a[220:223], v161 offset:7168
  v_add_f32 v166, v166, v118
  v_add_f32 v167, v167, v119
  v_cvt_pk_bf16_f32 v115, v118, v119
  v_max3_f32 v168, v168, v4, v5
  v_mfma_f32_32x32x16_bf16 a[112:127], a[204:207], v[80:83], a[112:127]
  v_exp_f32 v104, v104
  v_exp_f32 v105, v105
  v_exp_f32 v106, v106
  s_waitcnt lgkmcnt(3)
  v_mfma_f32_32x32x16_bf16 a[0:15], a[208:211], v[68:71], a[0:15]
  ds_read_b128 a[192:195], v161 offset:8192
  v_exp_f32 v107, v107
  v_add_f32 v164, v164, v104
  v_add_f32 v165, v165, v105
  v_mfma_f32_32x32x16_bf16 a[16:31], a[208:211], v[84:87], a[16:31]
  v_cvt_pk_bf16_f32 v100, v104, v105
  v_exp_f32 v108, v108
  v_exp_f32 v109, v109
  s_waitcnt lgkmcnt(3)
  v_mfma_f32_32x32x16_bf16 a[32:47], a[212:215], v[68:71], a[32:47]
  ds_read_b128 a[196:199], v161 offset:10240
  v_add_f32 v164, v164, v106
  v_add_f32 v165, v165, v107
  v_cvt_pk_bf16_f32 v101, v106, v107
  v_max3_f32 v169, v169, v20, v21
  v_mfma_f32_32x32x16_bf16 a[48:63], a[212:215], v[84:87], a[48:63]
  v_exp_f32 v110, v110
  v_exp_f32 v111, v111
  v_add_f32 v164, v164, v108
  v_add_f32 v165, v165, v109
  s_waitcnt lgkmcnt(3)
  v_mfma_f32_32x32x16_bf16 a[64:79], a[216:219], v[68:71], a[64:79]
  ds_read_b128 a[200:203], v161 offset:12288
  v_cvt_pk_bf16_f32 v102, v108, v109
  v_exp_f32 v120, v120
  v_max3_f32 v168, v168, v6, v7
  v_mfma_f32_32x32x16_bf16 a[80:95], a[216:219], v[84:87], a[80:95]
  v_exp_f32 v121, v121
  v_add_f32 v164, v164, v110
  v_add_f32 v165, v165, v111
  v_cvt_pk_bf16_f32 v103, v110, v111
  s_waitcnt lgkmcnt(3)
  v_mfma_f32_32x32x16_bf16 a[96:111], a[220:223], v[68:71], a[96:111]
  ds_read_b128 a[204:207], v161 offset:14336
  v_exp_f32 v122, v122
  v_exp_f32 v123, v123
  v_mfma_f32_32x32x16_bf16 a[112:127], a[220:223], v[84:87], a[112:127]
  v_add_f32 v166, v166, v120
  v_add_f32 v167, v167, v121
  v_cvt_pk_bf16_f32 v116, v120, v121
  v_exp_f32 v124, v124
  s_waitcnt lgkmcnt(3)
  v_mfma_f32_32x32x16_bf16 a[0:15], a[192:195], v[96:99], a[0:15]
  ds_read_b128 a[208:211], v161 offset:9216
  v_exp_f32 v125, v125
  v_add_f32 v166, v166, v122
  v_add_f32 v167, v167, v123
  v_mfma_f32_32x32x16_bf16 a[16:31], a[192:195], v[112:115], a[16:31]
  v_cvt_pk_bf16_f32 v117, v122, v123
  v_exp_f32 v126, v126
  v_exp_f32 v127, v127
  s_waitcnt lgkmcnt(3)
  v_mfma_f32_32x32x16_bf16 a[32:47], a[196:199], v[96:99], a[32:47]
  ds_read_b128 a[212:215], v161 offset:11264
  v_add_f32 v166, v166, v124
  v_add_f32 v167, v167, v125
  v_cvt_pk_bf16_f32 v118, v124, v125
  v_add_f32 v166, v166, v126
  v_mfma_f32_32x32x16_bf16 a[48:63], a[196:199], v[112:115], a[48:63]
  v_add_f32 v167, v167, v127
  v_cvt_pk_bf16_f32 v119, v126, v127
  v_max3_f32 v169, v169, v22, v23
  v_max3_f32 v168, v168, v8, v9
  v_max3_f32 v169, v169, v24, v25
  s_waitcnt lgkmcnt(3)
  v_mfma_f32_32x32x16_bf16 a[64:79], a[200:203], v[96:99], a[64:79]
  ds_read_b128 a[216:219], v161 offset:13312
  v_max3_f32 v168, v168, v10, v11
  v_max3_f32 v169, v169, v26, v27
  v_max3_f32 v168, v168, v12, v13
  v_max3_f32 v169, v169, v28, v29
  v_mfma_f32_32x32x16_bf16 a[80:95], a[200:203], v[112:115], a[80:95]
  v_max3_f32 v168, v168, v14, v15
  v_max3_f32 v169, v169, v30, v31
  v_max3_f32 v168, v168, v32, v33
  v_max3_f32 v169, v169, v48, v49
  v_max3_f32 v168, v168, v34, v35
  v_max3_f32 v169, v169, v50, v51
  s_waitcnt vmcnt(8)
  s_barrier
  s_waitcnt lgkmcnt(3)
  v_mfma_f32_32x32x16_bf16 a[96:111], a[204:207], v[96:99], a[96:111]
  ds_read_b128 a[220:223], v161 offset:15360
  s_add_u32 s56, s52, 4
  s_and_b32 s57, s56, 3
  s_lshl_b32 s57, s57, 14
  s_add_u32 s57, s57, s55
  s_add_u32 m0, s57, 0
  s_cmp_lt_u32 s56, s50
  s_mul_i32 s56, s56, 16384
  s_cselect_b32 s56, s56, 0x10000000
  s_add_u32 s56, s56, s53
  buffer_load_dwordx4 v162, s[36:39], s56 offen offset:0 sc1 lds
  v_mfma_f32_32x32x16_bf16 a[112:127], a[204:207], v[112:115], a[112:127]
  buffer_load_dwordx4 v162, s[36:39], s56 offen offset:1024 sc1 lds
  v_max3_f32 v168, v168, v36, v37
  v_max3_f32 v169, v169, v52, v53
  v_max3_f32 v168, v168, v38, v39
  v_max3_f32 v169, v169, v54, v55
  s_waitcnt lgkmcnt(3)
  v_mfma_f32_32x32x16_bf16 a[0:15], a[208:211], v[100:103], a[0:15]
  ds_read_b128 a[192:195], v160 offset:0
  buffer_load_dwordx4 v162, s[36:39], s56 offen offset:2048 sc1 lds
  v_max3_f32 v168, v168, v40, v41
  v_max3_f32 v169, v169, v56, v57
  v_mfma_f32_32x32x16_bf16 a[16:31], a[208:211], v[116:119], a[16:31]
  buffer_load_dwordx4 v162, s[36:39], s56 offen offset:3072 sc1 lds
  v_max3_f32 v168, v168, v42, v43
  v_max3_f32 v169, v169, v58, v59
  v_max3_f32 v168, v168, v44, v45
  v_max3_f32 v169, v169, v60, v61
  s_waitcnt lgkmcnt(3)
  v_mfma_f32_32x32x16_bf16 a[32:47], a[212:215], v[100:103], a[32:47]
  ds_read_b128 a[196:199], v160 offset:1024
  s_add_u32 s56, s52, 3
  s_and_b32 s57, s56, 3
  s_lshl_b32 s57, s57, 14
  s_add_u32 s57, s57, s55
  s_add_u32 m0, s57, 65536
  s_cmp_lt_u32 s56, s50
  s_mul_i32 s56, s56, 16384
  s_cselect_b32 s56, s56, 0x10000000
  s_add_u32 s56, s56, s54
  buffer_load_dwordx4 v162, s[36:39], s56 offen offset:0 sc1 lds
  v_mfma_f32_32x32x16_bf16 a[48:63], a[212:215], v[116:119], a[48:63]
  buffer_load_dwordx4 v162, s[36:39], s56 offen offset:1024 sc1 lds
  v_max3_f32 v168, v168, v46, v47
  v_max3_f32 v169, v169, v62, v63
  s_waitcnt lgkmcnt(3)
  v_mfma_f32_32x32x16_bf16 a[64:79], a[216:219], v[100:103], a[64:79]
  ds_read_b128 a[200:203], v160 offset:2048
  buffer_load_dwordx4 v162, s[36:39], s56 offen offset:2048 sc1 lds
  v_mfma_f32_32x32x16_bf16 a[80:95], a[216:219], v[116:119], a[80:95]
  buffer_load_dwordx4 v162, s[36:39], s56 offen offset:3072 sc1 lds
  s_waitcnt lgkmcnt(3)
  v_mfma_f32_32x32x16_bf16 a[96:111], a[220:223], v[100:103], a[96:111]
  ds_read_b128 a[204:207], v160 offset:3072
  v_mfma_f32_32x32x16_bf16 a[112:127], a[220:223], v[116:119], a[112:127]
  s_add_u32 s52, s52, 1
  s_add_u32 s56, s52, 1
  s_cmp_eq_u32 s56, s51
  s_cbranch_scc1 AB_diag1
AB_chk1:
  v_max_f32 v170, v168, v169
  v_cmp_lt_f32 vcc, s59, v170
  s_nop 0
  s_cbranch_vccnz AB_rs1
AB_cont1:
  s_branch AB_loop
AB_diag0:
  v_mov_b32 v170, 0xf149f2ca
  v_cmp_gt_i32 vcc, 0, v163
  v_mov_b32 v96, v170
  s_nop 0
  v_cndmask_b32 v64, v64, v170, vcc
  v_cndmask_b32 v112, v112, v170, vcc
  v_cmp_gt_i32 vcc, 1, v163
  v_mov_b32 v97, v170
  s_nop 0
  v_cndmask_b32 v65, v65, v170, vcc
  v_cndmask_b32 v113, v113, v170, vcc
  v_cmp_gt_i32 vcc, 2, v163
  v_mov_b32 v98, v170
  s_nop 0
  v_cndmask_b32 v66, v66, v170, vcc
  v_cndmask_b32 v114, v114, v170, vcc
  v_cmp_gt_i32 vcc, 3, v163
  v_mov_b32 v99, v170
  s_nop 0
  v_cndmask_b32 v67, v67, v170, vcc
  v_cndmask_b32 v115, v115, v170, vcc
  v_cmp_gt_i32 vcc, 8, v163
  v_mov_b32 v100, v170
  s_nop 0
  v_cndmask_b32 v68, v68, v170, vcc
  v_cndmask_b32 v116, v116, v170, vcc
  v_cmp_gt_i32 vcc, 9, v163
  v_mov_b32 v101, v170
  s_nop 0
  v_cndmask_b32 v69, v69, v170, vcc
  v_cndmask_b32 v117, v117, v170, vcc
  v_cmp_gt_i32 vcc, 10, v163
  v_mov_b32 v102, v170
  s_nop 0
  v_cndmask_b32 v70, v70, v170, vcc
  v_cndmask_b32 v118, v118, v170, vcc
  v_cmp_gt_i32 vcc, 11, v163
  v_mov_b32 v103, v170
  s_nop 0
  v_cndmask_b32 v71, v71, v170, vcc
  v_cndmask_b32 v119, v119, v170, vcc
  v_cmp_gt_i32 vcc, 16, v163
  v_mov_b32 v104, v170
  s_nop 0
  v_cndmask_b32 v72, v72, v170, vcc
  v_cndmask_b32 v120, v120, v170, vcc
  v_cmp_gt_i32 vcc, 17, v163
  v_mov_b32 v105, v170
  s_nop 0
  v_cndmask_b32 v73, v73, v170, vcc
  v_cndmask_b32 v121, v121, v170, vcc
  v_cmp_gt_i32 vcc, 18, v163
  v_mov_b32 v106, v170
  s_nop 0
  v_cndmask_b32 v74, v74, v170, vcc
  v_cndmask_b32 v122, v122, v170, vcc
  v_cmp_gt_i32 vcc, 19, v163
  v_mov_b32 v107, v170
  s_nop 0
  v_cndmask_b32 v75, v75, v170, vcc
  v_cndmask_b32 v123, v123, v170, vcc
  v_cmp_gt_i32 vcc, 24, v163
  v_mov_b32 v108, v170
  s_nop 0
  v_cndmask_b32 v76, v76, v170, vcc
  v_cndmask_b32 v124, v124, v170, vcc
  v_cmp_gt_i32 vcc, 25, v163
  v_mov_b32 v109, v170
  s_nop 0
  v_cndmask_b32 v77, v77, v170, vcc
  v_cndmask_b32 v125, v125, v170, vcc
  v_cmp_gt_i32 vcc, 26, v163
  v_mov_b32 v110, v170
  s_nop 0
  v_cndmask_b32 v78, v78, v170, vcc
  v_cndmask_b32 v126, v126, v170, vcc
  v_cmp_gt_i32 vcc, 27, v163
  v_mov_b32 v111, v170
  s_nop 0
  v_cndmask_b32 v79, v79, v170, vcc
  v_cndmask_b32 v127, v127, v170, vcc
  v_max_f32 v168, v64, v65
  v_max_f32 v169, v80, v81
  v_max3_f32 v168, v168, v66, v67
  v_max3_f32 v169, v169, v82, v83
  v_max3_f32 v168, v168, v68, v69
  v_max3_f32 v169, v169, v84, v85
  v_max3_f32 v168, v168, v70, v71
  v_max3_f32 v169, v169, v86, v87
  v_max3_f32 v168, v168, v72, v73
  v_max3_f32 v169, v169, v88, v89
  v_max3_f32 v168, v168, v74, v75
  v_max3_f32 v169, v169, v90, v91
  v_max3_f32 v168, v168, v76, v77
  v_max3_f32 v169, v169, v92, v93
  v_max3_f32 v168, v168, v78, v79
  v_max3_f32 v169, v169, v94, v95
  v_max3_f32 v168, v168, v96, v97
  v_max3_f32 v169, v169, v112, v113
  v_max3_f32 v168, v168, v98, v99
  v_max3_f32 v169, v169, v114, v115
  v_max3_f32 v168, v168, v100, v101
  v_max3_f32 v169, v169, v116, v117
  v_max3_f32 v168, v168, v102, v103
  v_max3_f32 v169, v169, v118, v119
  v_max3_f32 v168, v168, v104, v105
  v_max3_f32 v169, v169, v120, v121
  v_max3_f32 v168, v168, v106, v107
  v_max3_f32 v169, v169, v122, v123
  v_max3_f32 v168, v168, v108, v109
  v_max3_f32 v169, v169, v124, v125
  v_max3_f32 v168, v168, v110, v111
  v_max3_f32 v169, v169, v126, v127
  s_branch AB_chk0
AB_rs0:
  v_mov_b32 v170, v168
  s_nop 1
  v_permlane32_swap_b32 v170, v168
  v_max_f32 v170, v170, v168
  v_max_f32 v170, 0, v170
  v_sub_f32 v64, v64, v170
  v_sub_f32 v65, v65, v170
  v_sub_f32 v66, v66, v170
  v_sub_f32 v67, v67, v170
  v_sub_f32 v68, v68, v170
  v_sub_f32 v69, v69, v170
  v_sub_f32 v70, v70, v170
  v_sub_f32 v71, v71, v170
  v_sub_f32 v72, v72, v170
  v_sub_f32 v73, v73, v170
  v_sub_f32 v74, v74, v170
  v_sub_f32 v75, v75, v170
  v_sub_f32 v76, v76, v170
  v_sub_f32 v77, v77, v170
  v_sub_f32 v78, v78, v170
  v_sub_f32 v79, v79, v170
  v_sub_f32 v96, v96, v170
  v_sub_f32 v97, v97, v170
  v_sub_f32 v98, v98, v170
  v_sub_f32 v99, v99, v170
  v_sub_f32 v100, v100, v170
  v_sub_f32 v101, v101, v170
  v_sub_f32 v102, v102, v170
  v_sub_f32 v103, v103, v170
  v_sub_f32 v104, v104, v170
  v_sub_f32 v105, v105, v170
  v_sub_f32 v106, v106, v170
  v_sub_f32 v107, v107, v170
  v_sub_f32 v108, v108, v170
  v_sub_f32 v109, v109, v170
  v_sub_f32 v110, v110, v170
  v_sub_f32 v111, v111, v170
  v_sub_f32 v128, v128, v170
  v_sub_f32 v129, v129, v170
  v_sub_f32 v130, v130, v170
  v_sub_f32 v131, v131, v170
  v_sub_f32 v132, v132, v170
  v_sub_f32 v133, v133, v170
  v_sub_f32 v134, v134, v170
  v_sub_f32 v135, v135, v170
  v_sub_f32 v136, v136, v170
  v_sub_f32 v137, v137, v170
  v_sub_f32 v138, v138, v170
  v_sub_f32 v139, v139, v170
  v_sub_f32 v140, v140, v170
  v_sub_f32 v141, v141, v170
  v_sub_f32 v142, v142, v170
  v_sub_f32 v143, v143, v170
  v_exp_f32 v170, -v170
  s_nop 0
  v_mul_f32 v164, v164, v170
  v_mul_f32 v165, v165, v170
  v_accvgpr_read_b32 v192, a0
  v_accvgpr_read_b32 v193, a1
  v_accvgpr_read_b32 v194, a2
  v_accvgpr_read_b32 v195, a3
  v_accvgpr_read_b32 v196, a4
  v_accvgpr_read_b32 v197, a5
  v_accvgpr_read_b32 v198, a6
  v_accvgpr_read_b32 v199, a7
  v_accvgpr_read_b32 v200, a8
  v_accvgpr_read_b32 v201, a9
  v_accvgpr_read_b32 v202, a10
  v_accvgpr_read_b32 v203, a11
  v_accvgpr_read_b32 v204, a12
  v_accvgpr_read_b32 v205, a13
  v_accvgpr_read_b32 v206, a14
  v_accvgpr_read_b32 v207, a15
  v_mul_f32 v192, v192, v170
  v_mul_f32 v193, v193, v170
  v_mul_f32 v194, v194, v170
  v_mul_f32 v195, v195, v170
  v_mul_f32 v196, v196, v170
  v_mul_f32 v197, v197, v170
  v_mul_f32 v198, v198, v170
  v_mul_f32 v199, v199, v170
  v_mul_f32 v200, v200, v170
  v_mul_f32 v201, v201, v170
  v_mul_f32 v202, v202, v170
  v_mul_f32 v203, v203, v170
  v_mul_f32 v204, v204, v170
  v_mul_f32 v205, v205, v170
  v_mul_f32 v206, v206, v170
  v_mul_f32 v207, v207, v170
  v_accvgpr_write_b32 a0, v192
  v_accvgpr_write_b32 a1, v193
  v_accvgpr_write_b32 a2, v194
  v_accvgpr_write_b32 a3, v195
  v_accvgpr_write_b32 a4, v196
  v_accvgpr_write_b32 a5, v197
  v_accvgpr_write_b32 a6, v198
  v_accvgpr_write_b32 a7, v199
  v_accvgpr_write_b32 a8, v200
  v_accvgpr_write_b32 a9, v201
  v_accvgpr_write_b32 a10, v202
  v_accvgpr_write_b32 a11, v203
  v_accvgpr_write_b32 a12, v204
  v_accvgpr_write_b32 a13, v205
  v_accvgpr_write_b32 a14, v206
  v_accvgpr_write_b32 a15, v207
  v_accvgpr_read_b32 v192, a32
  v_accvgpr_read_b32 v193, a33
  v_accvgpr_read_b32 v194, a34
  v_accvgpr_read_b32 v195, a35
  v_accvgpr_read_b32 v196, a36
  v_accvgpr_read_b32 v197, a37
  v_accvgpr_read_b32 v198, a38
  v_accvgpr_read_b32 v199, a39
  v_accvgpr_read_b32 v200, a40
  v_accvgpr_read_b32 v201, a41
  v_accvgpr_read_b32 v202, a42
  v_accvgpr_read_b32 v203, a43
  v_accvgpr_read_b32 v204, a44
  v_accvgpr_read_b32 v205, a45
  v_accvgpr_read_b32 v206, a46
  v_accvgpr_read_b32 v207, a47
  v_mul_f32 v192, v192, v170
  v_mul_f32 v193, v193, v170
  v_mul_f32 v194, v194, v170
  v_mul_f32 v195, v195, v170
  v_mul_f32 v196, v196, v170
  v_mul_f32 v197, v197, v170
  v_mul_f32 v198, v198, v170
  v_mul_f32 v199, v199, v170
  v_mul_f32 v200, v200, v170
  v_mul_f32 v201, v201, v170
  v_mul_f32 v202, v202, v170
  v_mul_f32 v203, v203, v170
  v_mul_f32 v204, v204, v170
  v_mul_f32 v205, v205, v170
  v_mul_f32 v206, v206, v170
  v_mul_f32 v207, v207, v170
  v_accvgpr_write_b32 a32, v192
  v_accvgpr_write_b32 a33, v193
  v_accvgpr_write_b32 a34, v194
  v_accvgpr_write_b32 a35, v195
  v_accvgpr_write_b32 a36, v196
  v_accvgpr_write_b32 a37, v197
  v_accvgpr_write_b32 a38, v198
  v_accvgpr_write_b32 a39, v199
  v_accvgpr_write_b32 a40, v200
  v_accvgpr_write_b32 a41, v201
  v_accvgpr_write_b32 a42, v202
  v_accvgpr_write_b32 a43, v203
  v_accvgpr_write_b32 a44, v204
  v_accvgpr_write_b32 a45, v205
  v_accvgpr_write_b32 a46, v206
  v_accvgpr_write_b32 a47, v207
  v_accvgpr_read_b32 v192, a64
  v_accvgpr_read_b32 v193, a65
  v_accvgpr_read_b32 v194, a66
  v_accvgpr_read_b32 v195, a67
  v_accvgpr_read_b32 v196, a68
  v_accvgpr_read_b32 v197, a69
  v_accvgpr_read_b32 v198, a70
  v_accvgpr_read_b32 v199, a71
  v_accvgpr_read_b32 v200, a72
  v_accvgpr_read_b32 v201, a73
  v_accvgpr_read_b32 v202, a74
  v_accvgpr_read_b32 v203, a75
  v_accvgpr_read_b32 v204, a76
  v_accvgpr_read_b32 v205, a77
  v_accvgpr_read_b32 v206, a78
  v_accvgpr_read_b32 v207, a79
  v_mul_f32 v192, v192, v170
  v_mul_f32 v193, v193, v170
  v_mul_f32 v194, v194, v170
  v_mul_f32 v195, v195, v170
  v_mul_f32 v196, v196, v170
  v_mul_f32 v197, v197, v170
  v_mul_f32 v198, v198, v170
  v_mul_f32 v199, v199, v170
  v_mul_f32 v200, v200, v170
  v_mul_f32 v201, v201, v170
  v_mul_f32 v202, v202, v170
  v_mul_f32 v203, v203, v170
  v_mul_f32 v204, v204, v170
  v_mul_f32 v205, v205, v170
  v_mul_f32 v206, v206, v170
  v_mul_f32 v207, v207, v170
  v_accvgpr_write_b32 a64, v192
  v_accvgpr_write_b32 a65, v193
  v_accvgpr_write_b32 a66, v194
  v_accvgpr_write_b32 a67, v195
  v_accvgpr_write_b32 a68, v196
  v_accvgpr_write_b32 a69, v197
  v_accvgpr_write_b32 a70, v198
  v_accvgpr_write_b32 a71, v199
  v_accvgpr_write_b32 a72, v200
  v_accvgpr_write_b32 a73, v201
  v_accvgpr_write_b32 a74, v202
  v_accvgpr_write_b32 a75, v203
  v_accvgpr_write_b32 a76, v204
  v_accvgpr_write_b32 a77, v205
  v_accvgpr_write_b32 a78, v206
  v_accvgpr_write_b32 a79, v207
  v_accvgpr_read_b32 v192, a96
  v_accvgpr_read_b32 v193, a97
  v_accvgpr_read_b32 v194, a98
  v_accvgpr_read_b32 v195, a99
  v_accvgpr_read_b32 v196, a100
  v_accvgpr_read_b32 v197, a101
  v_accvgpr_read_b32 v198, a102
  v_accvgpr_read_b32 v199, a103
  v_accvgpr_read_b32 v200, a104
  v_accvgpr_read_b32 v201, a105
  v_accvgpr_read_b32 v202, a106
  v_accvgpr_read_b32 v203, a107
  v_accvgpr_read_b32 v204, a108
  v_accvgpr_read_b32 v205, a109
  v_accvgpr_read_b32 v206, a110
  v_accvgpr_read_b32 v207, a111
  v_mul_f32 v192, v192, v170
  v_mul_f32 v193, v193, v170
  v_mul_f32 v194, v194, v170
  v_mul_f32 v195, v195, v170
  v_mul_f32 v196, v196, v170
  v_mul_f32 v197, v197, v170
  v_mul_f32 v198, v198, v170
  v_mul_f32 v199, v199, v170
  v_mul_f32 v200, v200, v170
  v_mul_f32 v201, v201, v170
  v_mul_f32 v202, v202, v170
  v_mul_f32 v203, v203, v170
  v_mul_f32 v204, v204, v170
  v_mul_f32 v205, v205, v170
  v_mul_f32 v206, v206, v170
  v_mul_f32 v207, v207, v170
  v_accvgpr_write_b32 a96, v192
  v_accvgpr_write_b32 a97, v193
  v_accvgpr_write_b32 a98, v194
  v_accvgpr_write_b32 a99, v195
  v_accvgpr_write_b32 a100, v196
  v_accvgpr_write_b32 a101, v197
  v_accvgpr_write_b32 a102, v198
  v_accvgpr_write_b32 a103, v199
  v_accvgpr_write_b32 a104, v200
  v_accvgpr_write_b32 a105, v201
  v_accvgpr_write_b32 a106, v202
  v_accvgpr_write_b32 a107, v203
  v_accvgpr_write_b32 a108, v204
  v_accvgpr_write_b32 a109, v205
  v_accvgpr_write_b32 a110, v206
  v_accvgpr_write_b32 a111, v207
  v_mov_b32 v171, v169
  s_nop 1
  v_permlane32_swap_b32 v171, v169
  v_max_f32 v171, v171, v169
  v_max_f32 v171, 0, v171
  v_sub_f32 v80, v80, v171
  v_sub_f32 v81, v81, v171
  v_sub_f32 v82, v82, v171
  v_sub_f32 v83, v83, v171
  v_sub_f32 v84, v84, v171
  v_sub_f32 v85, v85, v171
  v_sub_f32 v86, v86, v171
  v_sub_f32 v87, v87, v171
  v_sub_f32 v88, v88, v171
  v_sub_f32 v89, v89, v171
  v_sub_f32 v90, v90, v171
  v_sub_f32 v91, v91, v171
  v_sub_f32 v92, v92, v171
  v_sub_f32 v93, v93, v171
  v_sub_f32 v94, v94, v171
  v_sub_f32 v95, v95, v171
  v_sub_f32 v112, v112, v171
  v_sub_f32 v113, v113, v171
  v_sub_f32 v114, v114, v171
  v_sub_f32 v115, v115, v171
  v_sub_f32 v116, v116, v171
  v_sub_f32 v117, v117, v171
  v_sub_f32 v118, v118, v171
  v_sub_f32 v119, v119, v171
  v_sub_f32 v120, v120, v171
  v_sub_f32 v121, v121, v171
  v_sub_f32 v122, v122, v171
  v_sub_f32 v123, v123, v171
  v_sub_f32 v124, v124, v171
  v_sub_f32 v125, v125, v171
  v_sub_f32 v126, v126, v171
  v_sub_f32 v127, v127, v171
  v_sub_f32 v144, v144, v171
  v_sub_f32 v145, v145, v171
  v_sub_f32 v146, v146, v171
  v_sub_f32 v147, v147, v171
  v_sub_f32 v148, v148, v171
  v_sub_f32 v149, v149, v171
  v_sub_f32 v150, v150, v171
  v_sub_f32 v151, v151, v171
  v_sub_f32 v152, v152, v171
  v_sub_f32 v153, v153, v171
  v_sub_f32 v154, v154, v171
  v_sub_f32 v155, v155, v171
  v_sub_f32 v156, v156, v171
  v_sub_f32 v157, v157, v171
  v_sub_f32 v158, v158, v171
  v_sub_f32 v159, v159, v171
  v_exp_f32 v171, -v171
  s_nop 0
  v_mul_f32 v166, v166, v171
  v_mul_f32 v167, v167, v171
  v_accvgpr_read_b32 v192, a16
  v_accvgpr_read_b32 v193, a17
  v_accvgpr_read_b32 v194, a18
  v_accvgpr_read_b32 v195, a19
  v_accvgpr_read_b32 v196, a20
  v_accvgpr_read_b32 v197, a21
  v_accvgpr_read_b32 v198, a22
  v_accvgpr_read_b32 v199, a23
  v_accvgpr_read_b32 v200, a24
  v_accvgpr_read_b32 v201, a25
  v_accvgpr_read_b32 v202, a26
  v_accvgpr_read_b32 v203, a27
  v_accvgpr_read_b32 v204, a28
  v_accvgpr_read_b32 v205, a29
  v_accvgpr_read_b32 v206, a30
  v_accvgpr_read_b32 v207, a31
  v_mul_f32 v192, v192, v171
  v_mul_f32 v193, v193, v171
  v_mul_f32 v194, v194, v171
  v_mul_f32 v195, v195, v171
  v_mul_f32 v196, v196, v171
  v_mul_f32 v197, v197, v171
  v_mul_f32 v198, v198, v171
  v_mul_f32 v199, v199, v171
  v_mul_f32 v200, v200, v171
  v_mul_f32 v201, v201, v171
  v_mul_f32 v202, v202, v171
  v_mul_f32 v203, v203, v171
  v_mul_f32 v204, v204, v171
  v_mul_f32 v205, v205, v171
  v_mul_f32 v206, v206, v171
  v_mul_f32 v207, v207, v171
  v_accvgpr_write_b32 a16, v192
  v_accvgpr_write_b32 a17, v193
  v_accvgpr_write_b32 a18, v194
  v_accvgpr_write_b32 a19, v195
  v_accvgpr_write_b32 a20, v196
  v_accvgpr_write_b32 a21, v197
  v_accvgpr_write_b32 a22, v198
  v_accvgpr_write_b32 a23, v199
  v_accvgpr_write_b32 a24, v200
  v_accvgpr_write_b32 a25, v201
  v_accvgpr_write_b32 a26, v202
  v_accvgpr_write_b32 a27, v203
  v_accvgpr_write_b32 a28, v204
  v_accvgpr_write_b32 a29, v205
  v_accvgpr_write_b32 a30, v206
  v_accvgpr_write_b32 a31, v207
  v_accvgpr_read_b32 v192, a48
  v_accvgpr_read_b32 v193, a49
  v_accvgpr_read_b32 v194, a50
  v_accvgpr_read_b32 v195, a51
  v_accvgpr_read_b32 v196, a52
  v_accvgpr_read_b32 v197, a53
  v_accvgpr_read_b32 v198, a54
  v_accvgpr_read_b32 v199, a55
  v_accvgpr_read_b32 v200, a56
  v_accvgpr_read_b32 v201, a57
  v_accvgpr_read_b32 v202, a58
  v_accvgpr_read_b32 v203, a59
  v_accvgpr_read_b32 v204, a60
  v_accvgpr_read_b32 v205, a61
  v_accvgpr_read_b32 v206, a62
  v_accvgpr_read_b32 v207, a63
  v_mul_f32 v192, v192, v171
  v_mul_f32 v193, v193, v171
  v_mul_f32 v194, v194, v171
  v_mul_f32 v195, v195, v171
  v_mul_f32 v196, v196, v171
  v_mul_f32 v197, v197, v171
  v_mul_f32 v198, v198, v171
  v_mul_f32 v199, v199, v171
  v_mul_f32 v200, v200, v171
  v_mul_f32 v201, v201, v171
  v_mul_f32 v202, v202, v171
  v_mul_f32 v203, v203, v171
  v_mul_f32 v204, v204, v171
  v_mul_f32 v205, v205, v171
  v_mul_f32 v206, v206, v171
  v_mul_f32 v207, v207, v171
  v_accvgpr_write_b32 a48, v192
  v_accvgpr_write_b32 a49, v193
  v_accvgpr_write_b32 a50, v194
  v_accvgpr_write_b32 a51, v195
  v_accvgpr_write_b32 a52, v196
  v_accvgpr_write_b32 a53, v197
  v_accvgpr_write_b32 a54, v198
  v_accvgpr_write_b32 a55, v199
  v_accvgpr_write_b32 a56, v200
  v_accvgpr_write_b32 a57, v201
  v_accvgpr_write_b32 a58, v202
  v_accvgpr_write_b32 a59, v203
  v_accvgpr_write_b32 a60, v204
  v_accvgpr_write_b32 a61, v205
  v_accvgpr_write_b32 a62, v206
  v_accvgpr_write_b32 a63, v207
  v_accvgpr_read_b32 v192, a80
  v_accvgpr_read_b32 v193, a81
  v_accvgpr_read_b32 v194, a82
  v_accvgpr_read_b32 v195, a83
  v_accvgpr_read_b32 v196, a84
  v_accvgpr_read_b32 v197, a85
  v_accvgpr_read_b32 v198, a86
  v_accvgpr_read_b32 v199, a87
  v_accvgpr_read_b32 v200, a88
  v_accvgpr_read_b32 v201, a89
  v_accvgpr_read_b32 v202, a90
  v_accvgpr_read_b32 v203, a91
  v_accvgpr_read_b32 v204, a92
  v_accvgpr_read_b32 v205, a93
  v_accvgpr_read_b32 v206, a94
  v_accvgpr_read_b32 v207, a95
  v_mul_f32 v192, v192, v171
  v_mul_f32 v193, v193, v171
  v_mul_f32 v194, v194, v171
  v_mul_f32 v195, v195, v171
  v_mul_f32 v196, v196, v171
  v_mul_f32 v197, v197, v171
  v_mul_f32 v198, v198, v171
  v_mul_f32 v199, v199, v171
  v_mul_f32 v200, v200, v171
  v_mul_f32 v201, v201, v171
  v_mul_f32 v202, v202, v171
  v_mul_f32 v203, v203, v171
  v_mul_f32 v204, v204, v171
  v_mul_f32 v205, v205, v171
  v_mul_f32 v206, v206, v171
  v_mul_f32 v207, v207, v171
  v_accvgpr_write_b32 a80, v192
  v_accvgpr_write_b32 a81, v193
  v_accvgpr_write_b32 a82, v194
  v_accvgpr_write_b32 a83, v195
  v_accvgpr_write_b32 a84, v196
  v_accvgpr_write_b32 a85, v197
  v_accvgpr_write_b32 a86, v198
  v_accvgpr_write_b32 a87, v199
  v_accvgpr_write_b32 a88, v200
  v_accvgpr_write_b32 a89, v201
  v_accvgpr_write_b32 a90, v202
  v_accvgpr_write_b32 a91, v203
  v_accvgpr_write_b32 a92, v204
  v_accvgpr_write_b32 a93, v205
  v_accvgpr_write_b32 a94, v206
  v_accvgpr_write_b32 a95, v207
  v_accvgpr_read_b32 v192, a112
  v_accvgpr_read_b32 v193, a113
  v_accvgpr_read_b32 v194, a114
  v_accvgpr_read_b32 v195, a115
  v_accvgpr_read_b32 v196, a116
  v_accvgpr_read_b32 v197, a117
  v_accvgpr_read_b32 v198, a118
  v_accvgpr_read_b32 v199, a119
  v_accvgpr_read_b32 v200, a120
  v_accvgpr_read_b32 v201, a121
  v_accvgpr_read_b32 v202, a122
  v_accvgpr_read_b32 v203, a123
  v_accvgpr_read_b32 v204, a124
  v_accvgpr_read_b32 v205, a125
  v_accvgpr_read_b32 v206, a126
  v_accvgpr_read_b32 v207, a127
  v_mul_f32 v192, v192, v171
  v_mul_f32 v193, v193, v171
  v_mul_f32 v194, v194, v171
  v_mul_f32 v195, v195, v171
  v_mul_f32 v196, v196, v171
  v_mul_f32 v197, v197, v171
  v_mul_f32 v198, v198, v171
  v_mul_f32 v199, v199, v171
  v_mul_f32 v200, v200, v171
  v_mul_f32 v201, v201, v171
  v_mul_f32 v202, v202, v171
  v_mul_f32 v203, v203, v171
  v_mul_f32 v204, v204, v171
  v_mul_f32 v205, v205, v171
  v_mul_f32 v206, v206, v171
  v_mul_f32 v207, v207, v171
  v_accvgpr_write_b32 a112, v192
  v_accvgpr_write_b32 a113, v193
  v_accvgpr_write_b32 a114, v194
  v_accvgpr_write_b32 a115, v195
  v_accvgpr_write_b32 a116, v196
  v_accvgpr_write_b32 a117, v197
  v_accvgpr_write_b32 a118, v198
  v_accvgpr_write_b32 a119, v199
  v_accvgpr_write_b32 a120, v200
  v_accvgpr_write_b32 a121, v201
  v_accvgpr_write_b32 a122, v202
  v_accvgpr_write_b32 a123, v203
  v_accvgpr_write_b32 a124, v204
  v_accvgpr_write_b32 a125, v205
  v_accvgpr_write_b32 a126, v206
  v_accvgpr_write_b32 a127, v207
  s_branch AB_cont0
AB_diag1:
  v_mov_b32 v170, 0xf149f2ca
  v_cmp_gt_i32 vcc, 0, v163
  v_mov_b32 v32, v170
  s_nop 0
  v_cndmask_b32 v0, v0, v170, vcc
  v_cndmask_b32 v48, v48, v170, vcc
  v_cmp_gt_i32 vcc, 1, v163
  v_mov_b32 v33, v170
  s_nop 0
  v_cndmask_b32 v1, v1, v170, vcc
  v_cndmask_b32 v49, v49, v170, vcc
  v_cmp_gt_i32 vcc, 2, v163
  v_mov_b32 v34, v170
  s_nop 0
  v_cndmask_b32 v2, v2, v170, vcc
  v_cndmask_b32 v50, v50, v170, vcc
  v_cmp_gt_i32 vcc, 3, v163
  v_mov_b32 v35, v170
  s_nop 0
  v_cndmask_b32 v3, v3, v170, vcc
  v_cndmask_b32 v51, v51, v170, vcc
  v_cmp_gt_i32 vcc, 8, v163
  v_mov_b32 v36, v170
  s_nop 0
  v_cndmask_b32 v4, v4, v170, vcc
  v_cndmask_b32 v52, v52, v170, vcc
  v_cmp_gt_i32 vcc, 9, v163
  v_mov_b32 v37, v170
  s_nop 0
  v_cndmask_b32 v5, v5, v170, vcc
  v_cndmask_b32 v53, v53, v170, vcc
  v_cmp_gt_i32 vcc, 10, v163
  v_mov_b32 v38, v170
  s_nop 0
  v_cndmask_b32 v6, v6, v170, vcc
  v_cndmask_b32 v54, v54, v170, vcc
  v_cmp_gt_i32 vcc, 11, v163
  v_mov_b32 v39, v170
  s_nop 0
  v_cndmask_b32 v7, v7, v170, vcc
  v_cndmask_b32 v55, v55, v170, vcc
  v_cmp_gt_i32 vcc, 16, v163
  v_mov_b32 v40, v170
  s_nop 0
  v_cndmask_b32 v8, v8, v170, vcc
  v_cndmask_b32 v56, v56, v170, vcc
  v_cmp_gt_i32 vcc, 17, v163
  v_mov_b32 v41, v170
  s_nop 0
  v_cndmask_b32 v9, v9, v170, vcc
  v_cndmask_b32 v57, v57, v170, vcc
  v_cmp_gt_i32 vcc, 18, v163
  v_mov_b32 v42, v170
  s_nop 0
  v_cndmask_b32 v10, v10, v170, vcc
  v_cndmask_b32 v58, v58, v170, vcc
  v_cmp_gt_i32 vcc, 19, v163
  v_mov_b32 v43, v170
  s_nop 0
  v_cndmask_b32 v11, v11, v170, vcc
  v_cndmask_b32 v59, v59, v170, vcc
  v_cmp_gt_i32 vcc, 24, v163
  v_mov_b32 v44, v170
  s_nop 0
  v_cndmask_b32 v12, v12, v170, vcc
  v_cndmask_b32 v60, v60, v170, vcc
  v_cmp_gt_i32 vcc, 25, v163
  v_mov_b32 v45, v170
  s_nop 0
  v_cndmask_b32 v13, v13, v170, vcc
  v_cndmask_b32 v61, v61, v170, vcc
  v_cmp_gt_i32 vcc, 26, v163
  v_mov_b32 v46, v170
  s_nop 0
  v_cndmask_b32 v14, v14, v170, vcc
  v_cndmask_b32 v62, v62, v170, vcc
  v_cmp_gt_i32 vcc, 27, v163
  v_mov_b32 v47, v170
  s_nop 0
  v_cndmask_b32 v15, v15, v170, vcc
  v_cndmask_b32 v63, v63, v170, vcc
  v_max_f32 v168, v0, v1
  v_max_f32 v169, v16, v17
  v_max3_f32 v168, v168, v2, v3
  v_max3_f32 v169, v169, v18, v19
  v_max3_f32 v168, v168, v4, v5
  v_max3_f32 v169, v169, v20, v21
  v_max3_f32 v168, v168, v6, v7
  v_max3_f32 v169, v169, v22, v23
  v_max3_f32 v168, v168, v8, v9
  v_max3_f32 v169, v169, v24, v25
  v_max3_f32 v168, v168, v10, v11
  v_max3_f32 v169, v169, v26, v27
  v_max3_f32 v168, v168, v12, v13
  v_max3_f32 v169, v169, v28, v29
  v_max3_f32 v168, v168, v14, v15
  v_max3_f32 v169, v169, v30, v31
  v_max3_f32 v168, v168, v32, v33
  v_max3_f32 v169, v169, v48, v49
  v_max3_f32 v168, v168, v34, v35
  v_max3_f32 v169, v169, v50, v51
  v_max3_f32 v168, v168, v36, v37
  v_max3_f32 v169, v169, v52, v53
  v_max3_f32 v168, v168, v38, v39
  v_max3_f32 v169, v169, v54, v55
  v_max3_f32 v168, v168, v40, v41
  v_max3_f32 v169, v169, v56, v57
  v_max3_f32 v168, v168, v42, v43
  v_max3_f32 v169, v169, v58, v59
  v_max3_f32 v168, v168, v44, v45
  v_max3_f32 v169, v169, v60, v61
  v_max3_f32 v168, v168, v46, v47
  v_max3_f32 v169, v169, v62, v63
  s_branch AB_chk1
AB_rs1:
  v_mov_b32 v170, v168
  s_nop 1
  v_permlane32_swap_b32 v170, v168
  v_max_f32 v170, v170, v168
  v_max_f32 v170, 0, v170
  v_sub_f32 v0, v0, v170
  v_sub_f32 v1, v1, v170
  v_sub_f32 v2, v2, v170
  v_sub_f32 v3, v3, v170
  v_sub_f32 v4, v4, v170
  v_sub_f32 v5, v5, v170
  v_sub_f32 v6, v6, v170
  v_sub_f32 v7, v7, v170
  v_sub_f32 v8, v8, v170
  v_sub_f32 v9, v9, v170
  v_sub_f32 v10, v10, v170
  v_sub_f32 v11, v11, v170
  v_sub_f32 v12, v12, v170
  v_sub_f32 v13, v13, v170
  v_sub_f32 v14, v14, v170
  v_sub_f32 v15, v15, v170
  v_sub_f32 v32, v32, v170
  v_sub_f32 v33, v33, v170
  v_sub_f32 v34, v34, v170
  v_sub_f32 v35, v35, v170
  v_sub_f32 v36, v36, v170
  v_sub_f32 v37, v37, v170
  v_sub_f32 v38, v38, v170
  v_sub_f32 v39, v39, v170
  v_sub_f32 v40, v40, v170
  v_sub_f32 v41, v41, v170
  v_sub_f32 v42, v42, v170
  v_sub_f32 v43, v43, v170
  v_sub_f32 v44, v44, v170
  v_sub_f32 v45, v45, v170
  v_sub_f32 v46, v46, v170
  v_sub_f32 v47, v47, v170
  v_sub_f32 v128, v128, v170
  v_sub_f32 v129, v129, v170
  v_sub_f32 v130, v130, v170
  v_sub_f32 v131, v131, v170
  v_sub_f32 v132, v132, v170
  v_sub_f32 v133, v133, v170
  v_sub_f32 v134, v134, v170
  v_sub_f32 v135, v135, v170
  v_sub_f32 v136, v136, v170
  v_sub_f32 v137, v137, v170
  v_sub_f32 v138, v138, v170
  v_sub_f32 v139, v139, v170
  v_sub_f32 v140, v140, v170
  v_sub_f32 v141, v141, v170
  v_sub_f32 v142, v142, v170
  v_sub_f32 v143, v143, v170
  v_exp_f32 v170, -v170
  s_nop 0
  v_mul_f32 v164, v164, v170
  v_mul_f32 v165, v165, v170
  v_accvgpr_read_b32 v192, a0
  v_accvgpr_read_b32 v193, a1
  v_accvgpr_read_b32 v194, a2
  v_accvgpr_read_b32 v195, a3
  v_accvgpr_read_b32 v196, a4
  v_accvgpr_read_b32 v197, a5
  v_accvgpr_read_b32 v198, a6
  v_accvgpr_read_b32 v199, a7
  v_accvgpr_read_b32 v200, a8
  v_accvgpr_read_b32 v201, a9
  v_accvgpr_read_b32 v202, a10
  v_accvgpr_read_b32 v203, a11
  v_accvgpr_read_b32 v204, a12
  v_accvgpr_read_b32 v205, a13
  v_accvgpr_read_b32 v206, a14
  v_accvgpr_read_b32 v207, a15
  v_mul_f32 v192, v192, v170
  v_mul_f32 v193, v193, v170
  v_mul_f32 v194, v194, v170
  v_mul_f32 v195, v195, v170
  v_mul_f32 v196, v196, v170
  v_mul_f32 v197, v197, v170
  v_mul_f32 v198, v198, v170
  v_mul_f32 v199, v199, v170
  v_mul_f32 v200, v200, v170
  v_mul_f32 v201, v201, v170
  v_mul_f32 v202, v202, v170
  v_mul_f32 v203, v203, v170
  v_mul_f32 v204, v204, v170
  v_mul_f32 v205, v205, v170
  v_mul_f32 v206, v206, v170
  v_mul_f32 v207, v207, v170
  v_accvgpr_write_b32 a0, v192
  v_accvgpr_write_b32 a1, v193
  v_accvgpr_write_b32 a2, v194
  v_accvgpr_write_b32 a3, v195
  v_accvgpr_write_b32 a4, v196
  v_accvgpr_write_b32 a5, v197
  v_accvgpr_write_b32 a6, v198
  v_accvgpr_write_b32 a7, v199
  v_accvgpr_write_b32 a8, v200
  v_accvgpr_write_b32 a9, v201
  v_accvgpr_write_b32 a10, v202
  v_accvgpr_write_b32 a11, v203
  v_accvgpr_write_b32 a12, v204
  v_accvgpr_write_b32 a13, v205
  v_accvgpr_write_b32 a14, v206
  v_accvgpr_write_b32 a15, v207
  v_accvgpr_read_b32 v192, a32
  v_accvgpr_read_b32 v193, a33
  v_accvgpr_read_b32 v194, a34
  v_accvgpr_read_b32 v195, a35
  v_accvgpr_read_b32 v196, a36
  v_accvgpr_read_b32 v197, a37
  v_accvgpr_read_b32 v198, a38
  v_accvgpr_read_b32 v199, a39
  v_accvgpr_read_b32 v200, a40
  v_accvgpr_read_b32 v201, a41
  v_accvgpr_read_b32 v202, a42
  v_accvgpr_read_b32 v203, a43
  v_accvgpr_read_b32 v204, a44
  v_accvgpr_read_b32 v205, a45
  v_accvgpr_read_b32 v206, a46
  v_accvgpr_read_b32 v207, a47
  v_mul_f32 v192, v192, v170
  v_mul_f32 v193, v193, v170
  v_mul_f32 v194, v194, v170
  v_mul_f32 v195, v195, v170
  v_mul_f32 v196, v196, v170
  v_mul_f32 v197, v197, v170
  v_mul_f32 v198, v198, v170
  v_mul_f32 v199, v199, v170
  v_mul_f32 v200, v200, v170
  v_mul_f32 v201, v201, v170
  v_mul_f32 v202, v202, v170
  v_mul_f32 v203, v203, v170
  v_mul_f32 v204, v204, v170
  v_mul_f32 v205, v205, v170
  v_mul_f32 v206, v206, v170
  v_mul_f32 v207, v207, v170
  v_accvgpr_write_b32 a32, v192
  v_accvgpr_write_b32 a33, v193
  v_accvgpr_write_b32 a34, v194
  v_accvgpr_write_b32 a35, v195
  v_accvgpr_write_b32 a36, v196
  v_accvgpr_write_b32 a37, v197
  v_accvgpr_write_b32 a38, v198
  v_accvgpr_write_b32 a39, v199
  v_accvgpr_write_b32 a40, v200
  v_accvgpr_write_b32 a41, v201
  v_accvgpr_write_b32 a42, v202
  v_accvgpr_write_b32 a43, v203
  v_accvgpr_write_b32 a44, v204
  v_accvgpr_write_b32 a45, v205
  v_accvgpr_write_b32 a46, v206
  v_accvgpr_write_b32 a47, v207
  v_accvgpr_read_b32 v192, a64
  v_accvgpr_read_b32 v193, a65
  v_accvgpr_read_b32 v194, a66
  v_accvgpr_read_b32 v195, a67
  v_accvgpr_read_b32 v196, a68
  v_accvgpr_read_b32 v197, a69
  v_accvgpr_read_b32 v198, a70
  v_accvgpr_read_b32 v199, a71
  v_accvgpr_read_b32 v200, a72
  v_accvgpr_read_b32 v201, a73
  v_accvgpr_read_b32 v202, a74
  v_accvgpr_read_b32 v203, a75
  v_accvgpr_read_b32 v204, a76
  v_accvgpr_read_b32 v205, a77
  v_accvgpr_read_b32 v206, a78
  v_accvgpr_read_b32 v207, a79
  v_mul_f32 v192, v192, v170
  v_mul_f32 v193, v193, v170
  v_mul_f32 v194, v194, v170
  v_mul_f32 v195, v195, v170
  v_mul_f32 v196, v196, v170
  v_mul_f32 v197, v197, v170
  v_mul_f32 v198, v198, v170
  v_mul_f32 v199, v199, v170
  v_mul_f32 v200, v200, v170
  v_mul_f32 v201, v201, v170
  v_mul_f32 v202, v202, v170
  v_mul_f32 v203, v203, v170
  v_mul_f32 v204, v204, v170
  v_mul_f32 v205, v205, v170
  v_mul_f32 v206, v206, v170
  v_mul_f32 v207, v207, v170
  v_accvgpr_write_b32 a64, v192
  v_accvgpr_write_b32 a65, v193
  v_accvgpr_write_b32 a66, v194
  v_accvgpr_write_b32 a67, v195
  v_accvgpr_write_b32 a68, v196
  v_accvgpr_write_b32 a69, v197
  v_accvgpr_write_b32 a70, v198
  v_accvgpr_write_b32 a71, v199
  v_accvgpr_write_b32 a72, v200
  v_accvgpr_write_b32 a73, v201
  v_accvgpr_write_b32 a74, v202
  v_accvgpr_write_b32 a75, v203
  v_accvgpr_write_b32 a76, v204
  v_accvgpr_write_b32 a77, v205
  v_accvgpr_write_b32 a78, v206
  v_accvgpr_write_b32 a79, v207
  v_accvgpr_read_b32 v192, a96
  v_accvgpr_read_b32 v193, a97
  v_accvgpr_read_b32 v194, a98
  v_accvgpr_read_b32 v195, a99
  v_accvgpr_read_b32 v196, a100
  v_accvgpr_read_b32 v197, a101
  v_accvgpr_read_b32 v198, a102
  v_accvgpr_read_b32 v199, a103
  v_accvgpr_read_b32 v200, a104
  v_accvgpr_read_b32 v201, a105
  v_accvgpr_read_b32 v202, a106
  v_accvgpr_read_b32 v203, a107
  v_accvgpr_read_b32 v204, a108
  v_accvgpr_read_b32 v205, a109
  v_accvgpr_read_b32 v206, a110
  v_accvgpr_read_b32 v207, a111
  v_mul_f32 v192, v192, v170
  v_mul_f32 v193, v193, v170
  v_mul_f32 v194, v194, v170
  v_mul_f32 v195, v195, v170
  v_mul_f32 v196, v196, v170
  v_mul_f32 v197, v197, v170
  v_mul_f32 v198, v198, v170
  v_mul_f32 v199, v199, v170
  v_mul_f32 v200, v200, v170
  v_mul_f32 v201, v201, v170
  v_mul_f32 v202, v202, v170
  v_mul_f32 v203, v203, v170
  v_mul_f32 v204, v204, v170
  v_mul_f32 v205, v205, v170
  v_mul_f32 v206, v206, v170
  v_mul_f32 v207, v207, v170
  v_accvgpr_write_b32 a96, v192
  v_accvgpr_write_b32 a97, v193
  v_accvgpr_write_b32 a98, v194
  v_accvgpr_write_b32 a99, v195
  v_accvgpr_write_b32 a100, v196
  v_accvgpr_write_b32 a101, v197
  v_accvgpr_write_b32 a102, v198
  v_accvgpr_write_b32 a103, v199
  v_accvgpr_write_b32 a104, v200
  v_accvgpr_write_b32 a105, v201
  v_accvgpr_write_b32 a106, v202
  v_accvgpr_write_b32 a107, v203
  v_accvgpr_write_b32 a108, v204
  v_accvgpr_write_b32 a109, v205
  v_accvgpr_write_b32 a110, v206
  v_accvgpr_write_b32 a111, v207
  v_mov_b32 v171, v169
  s_nop 1
  v_permlane32_swap_b32 v171, v169
  v_max_f32 v171, v171, v169
  v_max_f32 v171, 0, v171
  v_sub_f32 v16, v16, v171
  v_sub_f32 v17, v17, v171
  v_sub_f32 v18, v18, v171
  v_sub_f32 v19, v19, v171
  v_sub_f32 v20, v20, v171
  v_sub_f32 v21, v21, v171
  v_sub_f32 v22, v22, v171
  v_sub_f32 v23, v23, v171
  v_sub_f32 v24, v24, v171
  v_sub_f32 v25, v25, v171
  v_sub_f32 v26, v26, v171
  v_sub_f32 v27, v27, v171
  v_sub_f32 v28, v28, v171
  v_sub_f32 v29, v29, v171
  v_sub_f32 v30, v30, v171
  v_sub_f32 v31, v31, v171
  v_sub_f32 v48, v48, v171
  v_sub_f32 v49, v49, v171
  v_sub_f32 v50, v50, v171
  v_sub_f32 v51, v51, v171
  v_sub_f32 v52, v52, v171
  v_sub_f32 v53, v53, v171
  v_sub_f32 v54, v54, v171
  v_sub_f32 v55, v55, v171
  v_sub_f32 v56, v56, v171
  v_sub_f32 v57, v57, v171
  v_sub_f32 v58, v58, v171
  v_sub_f32 v59, v59, v171
  v_sub_f32 v60, v60, v171
  v_sub_f32 v61, v61, v171
  v_sub_f32 v62, v62, v171
  v_sub_f32 v63, v63, v171
  v_sub_f32 v144, v144, v171
  v_sub_f32 v145, v145, v171
  v_sub_f32 v146, v146, v171
  v_sub_f32 v147, v147, v171
  v_sub_f32 v148, v148, v171
  v_sub_f32 v149, v149, v171
  v_sub_f32 v150, v150, v171
  v_sub_f32 v151, v151, v171
  v_sub_f32 v152, v152, v171
  v_sub_f32 v153, v153, v171
  v_sub_f32 v154, v154, v171
  v_sub_f32 v155, v155, v171
  v_sub_f32 v156, v156, v171
  v_sub_f32 v157, v157, v171
  v_sub_f32 v158, v158, v171
  v_sub_f32 v159, v159, v171
  v_exp_f32 v171, -v171
  s_nop 0
  v_mul_f32 v166, v166, v171
  v_mul_f32 v167, v167, v171
  v_accvgpr_read_b32 v192, a16
  v_accvgpr_read_b32 v193, a17
  v_accvgpr_read_b32 v194, a18
  v_accvgpr_read_b32 v195, a19
  v_accvgpr_read_b32 v196, a20
  v_accvgpr_read_b32 v197, a21
  v_accvgpr_read_b32 v198, a22
  v_accvgpr_read_b32 v199, a23
  v_accvgpr_read_b32 v200, a24
  v_accvgpr_read_b32 v201, a25
  v_accvgpr_read_b32 v202, a26
  v_accvgpr_read_b32 v203, a27
  v_accvgpr_read_b32 v204, a28
  v_accvgpr_read_b32 v205, a29
  v_accvgpr_read_b32 v206, a30
  v_accvgpr_read_b32 v207, a31
  v_mul_f32 v192, v192, v171
  v_mul_f32 v193, v193, v171
  v_mul_f32 v194, v194, v171
  v_mul_f32 v195, v195, v171
  v_mul_f32 v196, v196, v171
  v_mul_f32 v197, v197, v171
  v_mul_f32 v198, v198, v171
  v_mul_f32 v199, v199, v171
  v_mul_f32 v200, v200, v171
  v_mul_f32 v201, v201, v171
  v_mul_f32 v202, v202, v171
  v_mul_f32 v203, v203, v171
  v_mul_f32 v204, v204, v171
  v_mul_f32 v205, v205, v171
  v_mul_f32 v206, v206, v171
  v_mul_f32 v207, v207, v171
  v_accvgpr_write_b32 a16, v192
  v_accvgpr_write_b32 a17, v193
  v_accvgpr_write_b32 a18, v194
  v_accvgpr_write_b32 a19, v195
  v_accvgpr_write_b32 a20, v196
  v_accvgpr_write_b32 a21, v197
  v_accvgpr_write_b32 a22, v198
  v_accvgpr_write_b32 a23, v199
  v_accvgpr_write_b32 a24, v200
  v_accvgpr_write_b32 a25, v201
  v_accvgpr_write_b32 a26, v202
  v_accvgpr_write_b32 a27, v203
  v_accvgpr_write_b32 a28, v204
  v_accvgpr_write_b32 a29, v205
  v_accvgpr_write_b32 a30, v206
  v_accvgpr_write_b32 a31, v207
  v_accvgpr_read_b32 v192, a48
  v_accvgpr_read_b32 v193, a49
  v_accvgpr_read_b32 v194, a50
  v_accvgpr_read_b32 v195, a51
  v_accvgpr_read_b32 v196, a52
  v_accvgpr_read_b32 v197, a53
  v_accvgpr_read_b32 v198, a54
  v_accvgpr_read_b32 v199, a55
  v_accvgpr_read_b32 v200, a56
  v_accvgpr_read_b32 v201, a57
  v_accvgpr_read_b32 v202, a58
  v_accvgpr_read_b32 v203, a59
  v_accvgpr_read_b32 v204, a60
  v_accvgpr_read_b32 v205, a61
  v_accvgpr_read_b32 v206, a62
  v_accvgpr_read_b32 v207, a63
  v_mul_f32 v192, v192, v171
  v_mul_f32 v193, v193, v171
  v_mul_f32 v194, v194, v171
  v_mul_f32 v195, v195, v171
  v_mul_f32 v196, v196, v171
  v_mul_f32 v197, v197, v171
  v_mul_f32 v198, v198, v171
  v_mul_f32 v199, v199, v171
  v_mul_f32 v200, v200, v171
  v_mul_f32 v201, v201, v171
  v_mul_f32 v202, v202, v171
  v_mul_f32 v203, v203, v171
  v_mul_f32 v204, v204, v171
  v_mul_f32 v205, v205, v171
  v_mul_f32 v206, v206, v171
  v_mul_f32 v207, v207, v171
  v_accvgpr_write_b32 a48, v192
  v_accvgpr_write_b32 a49, v193
  v_accvgpr_write_b32 a50, v194
  v_accvgpr_write_b32 a51, v195
  v_accvgpr_write_b32 a52, v196
  v_accvgpr_write_b32 a53, v197
  v_accvgpr_write_b32 a54, v198
  v_accvgpr_write_b32 a55, v199
  v_accvgpr_write_b32 a56, v200
  v_accvgpr_write_b32 a57, v201
  v_accvgpr_write_b32 a58, v202
  v_accvgpr_write_b32 a59, v203
  v_accvgpr_write_b32 a60, v204
  v_accvgpr_write_b32 a61, v205
  v_accvgpr_write_b32 a62, v206
  v_accvgpr_write_b32 a63, v207
  v_accvgpr_read_b32 v192, a80
  v_accvgpr_read_b32 v193, a81
  v_accvgpr_read_b32 v194, a82
  v_accvgpr_read_b32 v195, a83
  v_accvgpr_read_b32 v196, a84
  v_accvgpr_read_b32 v197, a85
  v_accvgpr_read_b32 v198, a86
  v_accvgpr_read_b32 v199, a87
  v_accvgpr_read_b32 v200, a88
  v_accvgpr_read_b32 v201, a89
  v_accvgpr_read_b32 v202, a90
  v_accvgpr_read_b32 v203, a91
  v_accvgpr_read_b32 v204, a92
  v_accvgpr_read_b32 v205, a93
  v_accvgpr_read_b32 v206, a94
  v_accvgpr_read_b32 v207, a95
  v_mul_f32 v192, v192, v171
  v_mul_f32 v193, v193, v171
  v_mul_f32 v194, v194, v171
  v_mul_f32 v195, v195, v171
  v_mul_f32 v196, v196, v171
  v_mul_f32 v197, v197, v171
  v_mul_f32 v198, v198, v171
  v_mul_f32 v199, v199, v171
  v_mul_f32 v200, v200, v171
  v_mul_f32 v201, v201, v171
  v_mul_f32 v202, v202, v171
  v_mul_f32 v203, v203, v171
  v_mul_f32 v204, v204, v171
  v_mul_f32 v205, v205, v171
  v_mul_f32 v206, v206, v171
  v_mul_f32 v207, v207, v171
  v_accvgpr_write_b32 a80, v192
  v_accvgpr_write_b32 a81, v193
  v_accvgpr_write_b32 a82, v194
  v_accvgpr_write_b32 a83, v195
  v_accvgpr_write_b32 a84, v196
  v_accvgpr_write_b32 a85, v197
  v_accvgpr_write_b32 a86, v198
  v_accvgpr_write_b32 a87, v199
  v_accvgpr_write_b32 a88, v200
  v_accvgpr_write_b32 a89, v201
  v_accvgpr_write_b32 a90, v202
  v_accvgpr_write_b32 a91, v203
  v_accvgpr_write_b32 a92, v204
  v_accvgpr_write_b32 a93, v205
  v_accvgpr_write_b32 a94, v206
  v_accvgpr_write_b32 a95, v207
  v_accvgpr_read_b32 v192, a112
  v_accvgpr_read_b32 v193, a113
  v_accvgpr_read_b32 v194, a114
  v_accvgpr_read_b32 v195, a115
  v_accvgpr_read_b32 v196, a116
  v_accvgpr_read_b32 v197, a117
  v_accvgpr_read_b32 v198, a118
  v_accvgpr_read_b32 v199, a119
  v_accvgpr_read_b32 v200, a120
  v_accvgpr_read_b32 v201, a121
  v_accvgpr_read_b32 v202, a122
  v_accvgpr_read_b32 v203, a123
  v_accvgpr_read_b32 v204, a124
  v_accvgpr_read_b32 v205, a125
  v_accvgpr_read_b32 v206, a126
  v_accvgpr_read_b32 v207, a127
  v_mul_f32 v192, v192, v171
  v_mul_f32 v193, v193, v171
  v_mul_f32 v194, v194, v171
  v_mul_f32 v195, v195, v171
  v_mul_f32 v196, v196, v171
  v_mul_f32 v197, v197, v171
  v_mul_f32 v198, v198, v171
  v_mul_f32 v199, v199, v171
  v_mul_f32 v200, v200, v171
  v_mul_f32 v201, v201, v171
  v_mul_f32 v202, v202, v171
  v_mul_f32 v203, v203, v171
  v_mul_f32 v204, v204, v171
  v_mul_f32 v205, v205, v171
  v_mul_f32 v206, v206, v171
  v_mul_f32 v207, v207, v171
  v_accvgpr_write_b32 a112, v192
  v_accvgpr_write_b32 a113, v193
  v_accvgpr_write_b32 a114, v194
  v_accvgpr_write_b32 a115, v195
  v_accvgpr_write_b32 a116, v196
  v_accvgpr_write_b32 a117, v197
  v_accvgpr_write_b32 a118, v198
  v_accvgpr_write_b32 a119, v199
  v_accvgpr_write_b32 a120, v200
  v_accvgpr_write_b32 a121, v201
  v_accvgpr_write_b32 a122, v202
  v_accvgpr_write_b32 a123, v203
  v_accvgpr_write_b32 a124, v204
  v_accvgpr_write_b32 a125, v205
  v_accvgpr_write_b32 a126, v206
  v_accvgpr_write_b32 a127, v207
  s_branch AB_cont1
AB_last0:
  s_add_u32 s58, s52, 0
  s_and_b32 s58, s58, 3
  s_lshl_b32 s58, s58, 14
  s_add_u32 s58, s58, 65536
  v_add_u32 v161, s58, v162
  s_waitcnt lgkmcnt(0)
  ds_read_b128 a[192:195], v161 offset:0
  ds_read_b128 a[196:199], v161 offset:2048
  ds_read_b128 a[200:203], v161 offset:4096
  ds_read_b128 a[204:207], v161 offset:6144
  v_exp_f32 v0, v0
  v_exp_f32 v1, v1
  v_exp_f32 v2, v2
  v_exp_f32 v3, v3
  v_add_f32 v164, v164, v0
  v_add_f32 v165, v165, v1
  v_cvt_pk_bf16_f32 v0, v0, v1
  v_exp_f32 v4, v4
  v_exp_f32 v5, v5
  v_add_f32 v164, v164, v2
  v_add_f32 v165, v165, v3
  v_cvt_pk_bf16_f32 v1, v2, v3
  v_exp_f32 v6, v6
  v_exp_f32 v7, v7
  v_add_f32 v164, v164, v4
  v_add_f32 v165, v165, v5
  v_cvt_pk_bf16_f32 v2, v4, v5
  v_exp_f32 v16, v16
  v_exp_f32 v17, v17
  v_add_f32 v164, v164, v6
  v_add_f32 v165, v165, v7
  v_cvt_pk_bf16_f32 v3, v6, v7
  v_exp_f32 v18, v18
  v_exp_f32 v19, v19
  v_add_f32 v166, v166, v16
  v_add_f32 v167, v167, v17
  v_cvt_pk_bf16_f32 v16, v16, v17
  v_exp_f32 v20, v20
  v_exp_f32 v21, v21
  v_add_f32 v166, v166, v18
  v_add_f32 v167, v167, v19
  v_cvt_pk_bf16_f32 v17, v18, v19
  v_exp_f32 v22, v22
  v_exp_f32 v23, v23
  v_add_f32 v166, v166, v20
  v_add_f32 v167, v167, v21
  v_cvt_pk_bf16_f32 v18, v20, v21
  v_add_f32 v166, v166, v22
  v_add_f32 v167, v167, v23
  v_cvt_pk_bf16_f32 v19, v22, v23
  s_waitcnt lgkmcnt(3)
  v_mfma_f32_32x32x16_bf16 a[0:15], a[192:195], v[0:3], a[0:15]
  ds_read_b128 a[208:211], v161 offset:1024
  v_exp_f32 v8, v8
  v_exp_f32 v9, v9
  v_exp_f32 v10, v10
  v_mfma_f32_32x32x16_bf16 a[16:31], a[192:195], v[16:19], a[16:31]
  v_exp_f32 v11, v11
  v_add_f32 v164, v164, v8
  v_add_f32 v165, v165, v9
  v_cvt_pk_bf16_f32 v4, v8, v9
  v_exp_f32 v12, v12
  s_waitcnt lgkmcnt(3)
  v_mfma_f32_32x32x16_bf16 a[32:47], a[196:199], v[0:3], a[32:47]
  ds_read_b128 a[212:215], v161 offset:3072
  v_exp_f32 v13, v13
  v_add_f32 v164, v164, v10
  v_add_f32 v165, v165, v11
  v_cvt_pk_bf16_f32 v5, v10, v11
  v_exp_f32 v14, v14
  v_mfma_f32_32x32x16_bf16 a[48:63], a[196:199], v[16:19], a[48:63]
  v_exp_f32 v15, v15
  v_add_f32 v164, v164, v12
  v_add_f32 v165, v165, v13
  v_cvt_pk_bf16_f32 v6, v12, v13
  v_exp_f32 v24, v24
  s_waitcnt lgkmcnt(3)
  v_mfma_f32_32x32x16_bf16 a[64:79], a[200:203], v[0:3], a[64:79]
  ds_read_b128 a[216:219], v161 offset:5120
  v_exp_f32 v25, v25
  v_add_f32 v164, v164, v14
  v_add_f32 v165, v165, v15
  v_cvt_pk_bf16_f32 v7, v14, v15
  v_exp_f32 v26, v26
  v_mfma_f32_32x32x16_bf16 a[80:95], a[200:203], v[16:19], a[80:95]
  v_exp_f32 v27, v27
  v_add_f32 v166, v166, v24
  v_add_f32 v167, v167, v25
  v_cvt_pk_bf16_f32 v20, v24, v25
  v_exp_f32 v28, v28
  s_waitcnt lgkmcnt(3)
  v_mfma_f32_32x32x16_bf16 a[96:111], a[204:207], v[0:3], a[96:111]
  ds_read_b128 a[220:223], v161 offset:7168
  v_exp_f32 v29, v29
  v_add_f32 v166, v166, v26
  v_add_f32 v167, v167, v27
  v_cvt_pk_bf16_f32 v21, v26, v27
  v_exp_f32 v30, v30
  v_mfma_f32_32x32x16_bf16 a[112:127], a[204:207], v[16:19], a[112:127]
  v_exp_f32 v31, v31
  v_add_f32 v166, v166, v28
  v_add_f32 v167, v167, v29
  v_cvt_pk_bf16_f32 v22, v28, v29
  v_add_f32 v166, v166, v30
  v_add_f32 v167, v167, v31
  v_cvt_pk_bf16_f32 v23, v30, v31
  s_waitcnt lgkmcnt(3)
  v_mfma_f32_32x32x16_bf16 a[0:15], a[208:211], v[4:7], a[0:15]
  ds_read_b128 a[192:195], v161 offset:8192
  v_exp_f32 v32, v32
  v_exp_f32 v33, v33
  v_exp_f32 v34, v34
  v_mfma_f32_32x32x16_bf16 a[16:31], a[208:211], v[20:23], a[16:31]
  v_exp_f32 v35, v35
  v_add_f32 v164, v164, v32
  v_add_f32 v165, v165, v33
  v_cvt_pk_bf16_f32 v32, v32, v33
  v_exp_f32 v36, v36
  s_waitcnt lgkmcnt(3)
  v_mfma_f32_32x32x16_bf16 a[32:47], a[212:215], v[4:7], a[32:47]
  ds_read_b128 a[196:199], v161 offset:10240
  v_exp_f32 v37, v37
  v_add_f32 v164, v164, v34
  v_add_f32 v165, v165, v35
  v_cvt_pk_bf16_f32 v33, v34, v35
  v_exp_f32 v38, v38
  v_mfma_f32_32x32x16_bf16 a[48:63], a[212:215], v[20:23], a[48:63]
  v_exp_f32 v39, v39
  v_add_f32 v164, v164, v36
  v_add_f32 v165, v165, v37
  v_cvt_pk_bf16_f32 v34, v36, v37
  v_exp_f32 v48, v48
  s_waitcnt lgkmcnt(3)
  v_mfma_f32_32x32x16_bf16 a[64:79], a[216:219], v[4:7], a[64:79]
  ds_read_b128 a[200:203], v161 offset:12288
  v_exp_f32 v49, v49
  v_add_f32 v164, v164, v38
  v_add_f32 v165, v165, v39
  v_cvt_pk_bf16_f32 v35, v38, v39
  v_exp_f32 v50, v50
  v_mfma_f32_32x32x16_bf16 a[80:95], a[216:219], v[20:23], a[80:95]
  v_exp_f32 v51, v51
  v_add_f32 v166, v166, v48
  v_add_f32 v167, v167, v49
  v_cvt_pk_bf16_f32 v48, v48, v49
  v_exp_f32 v52, v52
  s_waitcnt lgkmcnt(3)
  v_mfma_f32_32x32x16_bf16 a[96:111], a[220:223], v[4:7], a[96:111]
  ds_read_b128 a[204:207], v161 offset:14336
  v_exp_f32 v53, v53
  v_add_f32 v166, v166, v50
  v_add_f32 v167, v167, v51
  v_cvt_pk_bf16_f32 v49, v50, v51
  v_exp_f32 v54, v54
  v_mfma_f32_32x32x16_bf16 a[112:127], a[220:223], v[20:23], a[112:127]
  v_exp_f32 v55, v55
  v_add_f32 v166, v166, v52
  v_add_f32 v167, v167, v53
  v_cvt_pk_bf16_f32 v50, v52, v53
  v_add_f32 v166, v166, v54
  v_add_f32 v167, v167, v55
  v_cvt_pk_bf16_f32 v51, v54, v55
  s_waitcnt lgkmcnt(3)
  v_mfma_f32_32x32x16_bf16 a[0:15], a[192:195], v[32:35], a[0:15]
  ds_read_b128 a[208:211], v161 offset:9216
  v_exp_f32 v40, v40
  v_exp_f32 v41, v41
  v_exp_f32 v42, v42
  v_mfma_f32_32x32x16_bf16 a[16:31], a[192:195], v[48:51], a[16:31]
  v_exp_f32 v43, v43
  v_add_f32 v164, v164, v40
  v_add_f32 v165, v165, v41
  v_cvt_pk_bf16_f32 v36, v40, v41
  v_exp_f32 v44, v44
  s_waitcnt lgkmcnt(3)
  v_mfma_f32_32x32x16_bf16 a[32:47], a[196:199], v[32:35], a[32:47]
  ds_read_b128 a[212:215], v161 offset:11264
  v_exp_f32 v45, v45
  v_add_f32 v164, v164, v42
  v_add_f32 v165, v165, v43
  v_cvt_pk_bf16_f32 v37, v42, v43
  v_exp_f32 v46, v46
  v_mfma_f32_32x32x16_bf16 a[48:63], a[196:199], v[48:51], a[48:63]
  v_exp_f32 v47, v47
  v_add_f32 v164, v164, v44
  v_add_f32 v165, v165, v45
  v_cvt_pk_bf16_f32 v38, v44, v45
  v_exp_f32 v56, v56
  s_waitcnt lgkmcnt(3)
  v_mfma_f32_32x32x16_bf16 a[64:79], a[200:203], v[32:35], a[64:79]
  ds_read_b128 a[216:219], v161 offset:13312
  v_exp_f32 v57, v57
  v_add_f32 v164, v164, v46
  v_add_f32 v165, v165, v47
  v_cvt_pk_bf16_f32 v39, v46, v47
  v_exp_f32 v58, v58
  v_mfma_f32_32x32x16_bf16 a[80:95], a[200:203], v[48:51], a[80:95]
  v_exp_f32 v59, v59
  v_add_f32 v166, v166, v56
  v_add_f32 v167, v167, v57
  v_cvt_pk_bf16_f32 v52, v56, v57
  v_exp_f32 v60, v60
  s_waitcnt lgkmcnt(3)
  v_mfma_f32_32x32x16_bf16 a[96:111], a[204:207], v[32:35], a[96:111]
  ds_read_b128 a[220:223], v161 offset:15360
  v_exp_f32 v61, v61
  v_add_f32 v166, v166, v58
  v_add_f32 v167, v167, v59
  v_cvt_pk_bf16_f32 v53, v58, v59
  v_exp_f32 v62, v62
  v_mfma_f32_32x32x16_bf16 a[112:127], a[204:207], v[48:51], a[112:127]
  v_exp_f32 v63, v63
  v_add_f32 v166, v166, v60
  v_add_f32 v167, v167, v61
  v_cvt_pk_bf16_f32 v54, v60, v61
  v_add_f32 v166, v166, v62
  v_add_f32 v167, v167, v63
  v_cvt_pk_bf16_f32 v55, v62, v63
  s_waitcnt lgkmcnt(3)
  v_mfma_f32_32x32x16_bf16 a[0:15], a[208:211], v[36:39], a[0:15]
  v_mfma_f32_32x32x16_bf16 a[16:31], a[208:211], v[52:55], a[16:31]
  s_waitcnt lgkmcnt(2)
  v_mfma_f32_32x32x16_bf16 a[32:47], a[212:215], v[36:39], a[32:47]
  v_mfma_f32_32x32x16_bf16 a[48:63], a[212:215], v[52:55], a[48:63]
  s_waitcnt lgkmcnt(1)
  v_mfma_f32_32x32x16_bf16 a[64:79], a[216:219], v[36:39], a[64:79]
  v_mfma_f32_32x32x16_bf16 a[80:95], a[216:219], v[52:55], a[80:95]
  s_waitcnt lgkmcnt(0)
  v_mfma_f32_32x32x16_bf16 a[96:111], a[220:223], v[36:39], a[96:111]
  v_mfma_f32_32x32x16_bf16 a[112:127], a[220:223], v[52:55], a[112:127]
  s_branch AB_tail
AB_last1:
  s_add_u32 s58, s52, 0
  s_and_b32 s58, s58, 3
  s_lshl_b32 s58, s58, 14
  s_add_u32 s58, s58, 65536
  v_add_u32 v161, s58, v162
  s_waitcnt lgkmcnt(0)
  ds_read_b128 a[192:195], v161 offset:0
  ds_read_b128 a[196:199], v161 offset:2048
  ds_read_b128 a[200:203], v161 offset:4096
  ds_read_b128 a[204:207], v161 offset:6144
  v_exp_f32 v64, v64
  v_exp_f32 v65, v65
  v_exp_f32 v66, v66
  v_exp_f32 v67, v67
  v_add_f32 v164, v164, v64
  v_add_f32 v165, v165, v65
  v_cvt_pk_bf16_f32 v64, v64, v65
  v_exp_f32 v68, v68
  v_exp_f32 v69, v69
  v_add_f32 v164, v164, v66
  v_add_f32 v165, v165, v67
  v_cvt_pk_bf16_f32 v65, v66, v67
  v_exp_f32 v70, v70
  v_exp_f32 v71, v71
  v_add_f32 v164, v164, v68
  v_add_f32 v165, v165, v69
  v_cvt_pk_bf16_f32 v66, v68, v69
  v_exp_f32 v80, v80
  v_exp_f32 v81, v81
  v_add_f32 v164, v164, v70
  v_add_f32 v165, v165, v71
  v_cvt_pk_bf16_f32 v67, v70, v71
  v_exp_f32 v82, v82
  v_exp_f32 v83, v83
  v_add_f32 v166, v166, v80
  v_add_f32 v167, v167, v81
  v_cvt_pk_bf16_f32 v80, v80, v81
  v_exp_f32 v84, v84
  v_exp_f32 v85, v85
  v_add_f32 v166, v166, v82
  v_add_f32 v167, v167, v83
  v_cvt_pk_bf16_f32 v81, v82, v83
  v_exp_f32 v86, v86
  v_exp_f32 v87, v87
  v_add_f32 v166, v166, v84
  v_add_f32 v167, v167, v85
  v_cvt_pk_bf16_f32 v82, v84, v85
  v_add_f32 v166, v166, v86
  v_add_f32 v167, v167, v87
  v_cvt_pk_bf16_f32 v83, v86, v87
  s_waitcnt lgkmcnt(3)
  v_mfma_f32_32x32x16_bf16 a[0:15], a[192:195], v[64:67], a[0:15]
  ds_read_b128 a[208:211], v161 offset:1024
  v_exp_f32 v72, v72
  v_exp_f32 v73, v73
  v_exp_f32 v74, v74
  v_mfma_f32_32x32x16_bf16 a[16:31], a[192:195], v[80:83], a[16:31]
  v_exp_f32 v75, v75
  v_add_f32 v164, v164, v72
  v_add_f32 v165, v165, v73
  v_cvt_pk_bf16_f32 v68, v72, v73
  v_exp_f32 v76, v76
  s_waitcnt lgkmcnt(3)
  v_mfma_f32_32x32x16_bf16 a[32:47], a[196:199], v[64:67], a[32:47]
  ds_read_b128 a[212:215], v161 offset:3072
  v_exp_f32 v77, v77
  v_add_f32 v164, v164, v74
  v_add_f32 v165, v165, v75
  v_cvt_pk_bf16_f32 v69, v74, v75
  v_exp_f32 v78, v78
  v_mfma_f32_32x32x16_bf16 a[48:63], a[196:199], v[80:83], a[48:63]
  v_exp_f32 v79, v79
  v_add_f32 v164, v164, v76
  v_add_f32 v165, v165, v77
  v_cvt_pk_bf16_f32 v70, v76, v77
  v_exp_f32 v88, v88
  s_waitcnt lgkmcnt(3)
  v_mfma_f32_32x32x16_bf16 a[64:79], a[200:203], v[64:67], a[64:79]
  ds_read_b128 a[216:219], v161 offset:5120
  v_exp_f32 v89, v89
  v_add_f32 v164, v164, v78
  v_add_f32 v165, v165, v79
  v_cvt_pk_bf16_f32 v71, v78, v79
  v_exp_f32 v90, v90
  v_mfma_f32_32x32x16_bf16 a[80:95], a[200:203], v[80:83], a[80:95]
  v_exp_f32 v91, v91
  v_add_f32 v166, v166, v88
  v_add_f32 v167, v167, v89
  v_cvt_pk_bf16_f32 v84, v88, v89
  v_exp_f32 v92, v92
  s_waitcnt lgkmcnt(3)
  v_mfma_f32_32x32x16_bf16 a[96:111], a[204:207], v[64:67], a[96:111]
  ds_read_b128 a[220:223], v161 offset:7168
  v_exp_f32 v93, v93
  v_add_f32 v166, v166, v90
  v_add_f32 v167, v167, v91
  v_cvt_pk_bf16_f32 v85, v90, v91
  v_exp_f32 v94, v94
  v_mfma_f32_32x32x16_bf16 a[112:127], a[204:207], v[80:83], a[112:127]
  v_exp_f32 v95, v95
  v_add_f32 v166, v166, v92
  v_add_f32 v167, v167, v93
  v_cvt_pk_bf16_f32 v86, v92, v93
  v_add_f32 v166, v166, v94
  v_add_f32 v167, v167, v95
  v_cvt_pk_bf16_f32 v87, v94, v95
  s_waitcnt lgkmcnt(3)
  v_mfma_f32_32x32x16_bf16 a[0:15], a[208:211], v[68:71], a[0:15]
  ds_read_b128 a[192:195], v161 offset:8192
  v_exp_f32 v96, v96
  v_exp_f32 v97, v97
  v_exp_f32 v98, v98
  v_mfma_f32_32x32x16_bf16 a[16:31], a[208:211], v[84:87], a[16:31]
  v_exp_f32 v99, v99
  v_add_f32 v164, v164, v96
  v_add_f32 v165, v165, v97
  v_cvt_pk_bf16_f32 v96, v96, v97
  v_exp_f32 v100, v100
  s_waitcnt lgkmcnt(3)
  v_mfma_f32_32x32x16_bf16 a[32:47], a[212:215], v[68:71], a[32:47]
  ds_read_b128 a[196:199], v161 offset:10240
  v_exp_f32 v101, v101
  v_add_f32 v164, v164, v98
  v_add_f32 v165, v165, v99
  v_cvt_pk_bf16_f32 v97, v98, v99
  v_exp_f32 v102, v102
  v_mfma_f32_32x32x16_bf16 a[48:63], a[212:215], v[84:87], a[48:63]
  v_exp_f32 v103, v103
  v_add_f32 v164, v164, v100
  v_add_f32 v165, v165, v101
  v_cvt_pk_bf16_f32 v98, v100, v101
  v_exp_f32 v112, v112
  s_waitcnt lgkmcnt(3)
  v_mfma_f32_32x32x16_bf16 a[64:79], a[216:219], v[68:71], a[64:79]
  ds_read_b128 a[200:203], v161 offset:12288
  v_exp_f32 v113, v113
  v_add_f32 v164, v164, v102
  v_add_f32 v165, v165, v103
  v_cvt_pk_bf16_f32 v99, v102, v103
  v_exp_f32 v114, v114
  v_mfma_f32_32x32x16_bf16 a[80:95], a[216:219], v[84:87], a[80:95]
  v_exp_f32 v115, v115
  v_add_f32 v166, v166, v112
  v_add_f32 v167, v167, v113
  v_cvt_pk_bf16_f32 v112, v112, v113
  v_exp_f32 v116, v116
  s_waitcnt lgkmcnt(3)
  v_mfma_f32_32x32x16_bf16 a[96:111], a[220:223], v[68:71], a[96:111]
  ds_read_b128 a[204:207], v161 offset:14336
  v_exp_f32 v117, v117
  v_add_f32 v166, v166, v114
  v_add_f32 v167, v167, v115
  v_cvt_pk_bf16_f32 v113, v114, v115
  v_exp_f32 v118, v118
  v_mfma_f32_32x32x16_bf16 a[112:127], a[220:223], v[84:87], a[112:127]
  v_exp_f32 v119, v119
  v_add_f32 v166, v166, v116
  v_add_f32 v167, v167, v117
  v_cvt_pk_bf16_f32 v114, v116, v117
  v_add_f32 v166, v166, v118
  v_add_f32 v167, v167, v119
  v_cvt_pk_bf16_f32 v115, v118, v119
  s_waitcnt lgkmcnt(3)
  v_mfma_f32_32x32x16_bf16 a[0:15], a[192:195], v[96:99], a[0:15]
  ds_read_b128 a[208:211], v161 offset:9216
  v_exp_f32 v104, v104
  v_exp_f32 v105, v105
  v_exp_f32 v106, v106
  v_mfma_f32_32x32x16_bf16 a[16:31], a[192:195], v[112:115], a[16:31]
  v_exp_f32 v107, v107
  v_add_f32 v164, v164, v104
  v_add_f32 v165, v165, v105
  v_cvt_pk_bf16_f32 v100, v104, v105
  v_exp_f32 v108, v108
  s_waitcnt lgkmcnt(3)
  v_mfma_f32_32x32x16_bf16 a[32:47], a[196:199], v[96:99], a[32:47]
  ds_read_b128 a[212:215], v161 offset:11264
  v_exp_f32 v109, v109
  v_add_f32 v164, v164, v106
  v_add_f32 v165, v165, v107
  v_cvt_pk_bf16_f32 v101, v106, v107
  v_exp_f32 v110, v110
  v_mfma_f32_32x32x16_bf16 a[48:63], a[196:199], v[112:115], a[48:63]
  v_exp_f32 v111, v111
  v_add_f32 v164, v164, v108
  v_add_f32 v165, v165, v109
  v_cvt_pk_bf16_f32 v102, v108, v109
  v_exp_f32 v120, v120
  s_waitcnt lgkmcnt(3)
  v_mfma_f32_32x32x16_bf16 a[64:79], a[200:203], v[96:99], a[64:79]
  ds_read_b128 a[216:219], v161 offset:13312
  v_exp_f32 v121, v121
  v_add_f32 v164, v164, v110
  v_add_f32 v165, v165, v111
  v_cvt_pk_bf16_f32 v103, v110, v111
  v_exp_f32 v122, v122
  v_mfma_f32_32x32x16_bf16 a[80:95], a[200:203], v[112:115], a[80:95]
  v_exp_f32 v123, v123
  v_add_f32 v166, v166, v120
  v_add_f32 v167, v167, v121
  v_cvt_pk_bf16_f32 v116, v120, v121
  v_exp_f32 v124, v124
  s_waitcnt lgkmcnt(3)
  v_mfma_f32_32x32x16_bf16 a[96:111], a[204:207], v[96:99], a[96:111]
  ds_read_b128 a[220:223], v161 offset:15360
  v_exp_f32 v125, v125
  v_add_f32 v166, v166, v122
  v_add_f32 v167, v167, v123
  v_cvt_pk_bf16_f32 v117, v122, v123
  v_exp_f32 v126, v126
  v_mfma_f32_32x32x16_bf16 a[112:127], a[204:207], v[112:115], a[112:127]
  v_exp_f32 v127, v127
  v_add_f32 v166, v166, v124
  v_add_f32 v167, v167, v125
  v_cvt_pk_bf16_f32 v118, v124, v125
  v_add_f32 v166, v166, v126
  v_add_f32 v167, v167, v127
  v_cvt_pk_bf16_f32 v119, v126, v127
  s_waitcnt lgkmcnt(3)
  v_mfma_f32_32x32x16_bf16 a[0:15], a[208:211], v[100:103], a[0:15]
  v_mfma_f32_32x32x16_bf16 a[16:31], a[208:211], v[116:119], a[16:31]
  s_waitcnt lgkmcnt(2)
  v_mfma_f32_32x32x16_bf16 a[32:47], a[212:215], v[100:103], a[32:47]
  v_mfma_f32_32x32x16_bf16 a[48:63], a[212:215], v[116:119], a[48:63]
  s_waitcnt lgkmcnt(1)
  v_mfma_f32_32x32x16_bf16 a[64:79], a[216:219], v[100:103], a[64:79]
  v_mfma_f32_32x32x16_bf16 a[80:95], a[216:219], v[116:119], a[80:95]
  s_waitcnt lgkmcnt(0)
  v_mfma_f32_32x32x16_bf16 a[96:111], a[220:223], v[100:103], a[96:111]
  v_mfma_f32_32x32x16_bf16 a[112:127], a[220:223], v[116:119], a[112:127]
AB_tail:
  s_cmp_eq_u32 s40, 3
  s_cbranch_scc1 AB_ep
  s_waitcnt vmcnt(8)
  s_barrier
  s_add_u32 s56, s52, 3
  s_and_b32 s57, s56, 3
  s_lshl_b32 s57, s57, 14
  s_add_u32 s57, s57, s55
  s_add_u32 m0, s57, 65536
  s_cmp_lt_u32 s56, s50
  s_mul_i32 s56, s56, 16384
  s_cselect_b32 s56, s56, 0x10000000
  s_add_u32 s56, s56, s54
  buffer_load_dwordx4 v162, s[36:39], s56 offen offset:0 sc1 lds
  buffer_load_dwordx4 v162, s[36:39], s56 offen offset:1024 sc1 lds
  buffer_load_dwordx4 v162, s[36:39], s56 offen offset:2048 sc1 lds
  buffer_load_dwordx4 v162, s[36:39], s56 offen offset:3072 sc1 lds
AB_ep:
  v_add_f32 v170, v164, v165
  v_mov_b32 v171, v170
  s_nop 1
  v_permlane32_swap_b32 v170, v171
  v_add_f32 v170, v170, v171
  v_rcp_f32 v170, v170
  v_add_f32 v172, v166, v167
  v_mov_b32 v173, v172
  s_nop 1
  v_permlane32_swap_b32 v172, v173
  v_add_f32 v172, v172, v173
  v_rcp_f32 v172, v172
  s_add_u32 s56, s60, 0
  v_accvgpr_read_b32 v192, a0
  v_accvgpr_read_b32 v193, a1
  v_accvgpr_read_b32 v194, a2
  v_accvgpr_read_b32 v195, a3
  v_accvgpr_read_b32 v196, a4
  v_accvgpr_read_b32 v197, a5
  v_accvgpr_read_b32 v198, a6
  v_accvgpr_read_b32 v199, a7
  v_accvgpr_read_b32 v200, a8
  v_accvgpr_read_b32 v201, a9
  v_accvgpr_read_b32 v202, a10
  v_accvgpr_read_b32 v203, a11
  v_accvgpr_read_b32 v204, a12
  v_accvgpr_read_b32 v205, a13
  v_accvgpr_read_b32 v206, a14
  v_accvgpr_read_b32 v207, a15
  v_pk_mul_f32 v[192:193], v[192:193], v[170:171] op_sel_hi:[1,0]
  v_pk_mul_f32 v[194:195], v[194:195], v[170:171] op_sel_hi:[1,0]
  v_pk_mul_f32 v[196:197], v[196:197], v[170:171] op_sel_hi:[1,0]
  v_pk_mul_f32 v[198:199], v[198:199], v[170:171] op_sel_hi:[1,0]
  v_pk_mul_f32 v[200:201], v[200:201], v[170:171] op_sel_hi:[1,0]
  v_pk_mul_f32 v[202:203], v[202:203], v[170:171] op_sel_hi:[1,0]
  v_pk_mul_f32 v[204:205], v[204:205], v[170:171] op_sel_hi:[1,0]
  v_pk_mul_f32 v[206:207], v[206:207], v[170:171] op_sel_hi:[1,0]
  v_cvt_pk_bf16_f32 v192, v192, v193
  v_cvt_pk_bf16_f32 v193, v194, v195
  v_cvt_pk_bf16_f32 v194, v196, v197
  v_cvt_pk_bf16_f32 v195, v198, v199
  v_cvt_pk_bf16_f32 v196, v200, v201
  v_cvt_pk_bf16_f32 v197, v202, v203
  v_cvt_pk_bf16_f32 v198, v204, v205
  v_cvt_pk_bf16_f32 v199, v206, v207
  buffer_store_dwordx4 v[192:195], v162, s[36:39], s56 offen offset:0 sc1
  buffer_store_dwordx4 v[196:199], v162, s[36:39], s56 offen offset:1024 sc1
  v_accvgpr_read_b32 v208, a32
  v_accvgpr_read_b32 v209, a33
  v_accvgpr_read_b32 v210, a34
  v_accvgpr_read_b32 v211, a35
  v_accvgpr_read_b32 v212, a36
  v_accvgpr_read_b32 v213, a37
  v_accvgpr_read_b32 v214, a38
  v_accvgpr_read_b32 v215, a39
  v_accvgpr_read_b32 v216, a40
  v_accvgpr_read_b32 v217, a41
  v_accvgpr_read_b32 v218, a42
  v_accvgpr_read_b32 v219, a43
  v_accvgpr_read_b32 v220, a44
  v_accvgpr_read_b32 v221, a45
  v_accvgpr_read_b32 v222, a46
  v_accvgpr_read_b32 v223, a47
  v_pk_mul_f32 v[208:209], v[208:209], v[170:171] op_sel_hi:[1,0]
  v_pk_mul_f32 v[210:211], v[210:211], v[170:171] op_sel_hi:[1,0]
  v_pk_mul_f32 v[212:213], v[212:213], v[170:171] op_sel_hi:[1,0]
  v_pk_mul_f32 v[214:215], v[214:215], v[170:171] op_sel_hi:[1,0]
  v_pk_mul_f32 v[216:217], v[216:217], v[170:171] op_sel_hi:[1,0]
  v_pk_mul_f32 v[218:219], v[218:219], v[170:171] op_sel_hi:[1,0]
  v_pk_mul_f32 v[220:221], v[220:221], v[170:171] op_sel_hi:[1,0]
  v_pk_mul_f32 v[222:223], v[222:223], v[170:171] op_sel_hi:[1,0]
  v_cvt_pk_bf16_f32 v208, v208, v209
  v_cvt_pk_bf16_f32 v209, v210, v211
  v_cvt_pk_bf16_f32 v210, v212, v213
  v_cvt_pk_bf16_f32 v211, v214, v215
  v_cvt_pk_bf16_f32 v212, v216, v217
  v_cvt_pk_bf16_f32 v213, v218, v219
  v_cvt_pk_bf16_f32 v214, v220, v221
  v_cvt_pk_bf16_f32 v215, v222, v223
  buffer_store_dwordx4 v[208:211], v162, s[36:39], s56 offen offset:2048 sc1
  buffer_store_dwordx4 v[212:215], v162, s[36:39], s56 offen offset:3072 sc1
  s_add_u32 s56, s60, 4096
  v_accvgpr_read_b32 v192, a64
  v_accvgpr_read_b32 v193, a65
  v_accvgpr_read_b32 v194, a66
  v_accvgpr_read_b32 v195, a67
  v_accvgpr_read_b32 v196, a68
  v_accvgpr_read_b32 v197, a69
  v_accvgpr_read_b32 v198, a70
  v_accvgpr_read_b32 v199, a71
  v_accvgpr_read_b32 v200, a72
  v_accvgpr_read_b32 v201, a73
  v_accvgpr_read_b32 v202, a74
  v_accvgpr_read_b32 v203, a75
  v_accvgpr_read_b32 v204, a76
  v_accvgpr_read_b32 v205, a77
  v_accvgpr_read_b32 v206, a78
  v_accvgpr_read_b32 v207, a79
  v_pk_mul_f32 v[192:193], v[192:193], v[170:171] op_sel_hi:[1,0]
  v_pk_mul_f32 v[194:195], v[194:195], v[170:171] op_sel_hi:[1,0]
  v_pk_mul_f32 v[196:197], v[196:197], v[170:171] op_sel_hi:[1,0]
  v_pk_mul_f32 v[198:199], v[198:199], v[170:171] op_sel_hi:[1,0]
  v_pk_mul_f32 v[200:201], v[200:201], v[170:171] op_sel_hi:[1,0]
  v_pk_mul_f32 v[202:203], v[202:203], v[170:171] op_sel_hi:[1,0]
  v_pk_mul_f32 v[204:205], v[204:205], v[170:171] op_sel_hi:[1,0]
  v_pk_mul_f32 v[206:207], v[206:207], v[170:171] op_sel_hi:[1,0]
  v_cvt_pk_bf16_f32 v192, v192, v193
  v_cvt_pk_bf16_f32 v193, v194, v195
  v_cvt_pk_bf16_f32 v194, v196, v197
  v_cvt_pk_bf16_f32 v195, v198, v199
  v_cvt_pk_bf16_f32 v196, v200, v201
  v_cvt_pk_bf16_f32 v197, v202, v203
  v_cvt_pk_bf16_f32 v198, v204, v205
  v_cvt_pk_bf16_f32 v199, v206, v207
  buffer_store_dwordx4 v[192:195], v162, s[36:39], s56 offen offset:0 sc1
  buffer_store_dwordx4 v[196:199], v162, s[36:39], s56 offen offset:1024 sc1
  v_accvgpr_read_b32 v208, a96
  v_accvgpr_read_b32 v209, a97
  v_accvgpr_read_b32 v210, a98
  v_accvgpr_read_b32 v211, a99
  v_accvgpr_read_b32 v212, a100
  v_accvgpr_read_b32 v213, a101
  v_accvgpr_read_b32 v214, a102
  v_accvgpr_read_b32 v215, a103
  v_accvgpr_read_b32 v216, a104
  v_accvgpr_read_b32 v217, a105
  v_accvgpr_read_b32 v218, a106
  v_accvgpr_read_b32 v219, a107
  v_accvgpr_read_b32 v220, a108
  v_accvgpr_read_b32 v221, a109
  v_accvgpr_read_b32 v222, a110
  v_accvgpr_read_b32 v223, a111
  v_pk_mul_f32 v[208:209], v[208:209], v[170:171] op_sel_hi:[1,0]
  v_pk_mul_f32 v[210:211], v[210:211], v[170:171] op_sel_hi:[1,0]
  v_pk_mul_f32 v[212:213], v[212:213], v[170:171] op_sel_hi:[1,0]
  v_pk_mul_f32 v[214:215], v[214:215], v[170:171] op_sel_hi:[1,0]
  v_pk_mul_f32 v[216:217], v[216:217], v[170:171] op_sel_hi:[1,0]
  v_pk_mul_f32 v[218:219], v[218:219], v[170:171] op_sel_hi:[1,0]
  v_pk_mul_f32 v[220:221], v[220:221], v[170:171] op_sel_hi:[1,0]
  v_pk_mul_f32 v[222:223], v[222:223], v[170:171] op_sel_hi:[1,0]
  v_cvt_pk_bf16_f32 v208, v208, v209
  v_cvt_pk_bf16_f32 v209, v210, v211
  v_cvt_pk_bf16_f32 v210, v212, v213
  v_cvt_pk_bf16_f32 v211, v214, v215
  v_cvt_pk_bf16_f32 v212, v216, v217
  v_cvt_pk_bf16_f32 v213, v218, v219
  v_cvt_pk_bf16_f32 v214, v220, v221
  v_cvt_pk_bf16_f32 v215, v222, v223
  buffer_store_dwordx4 v[208:211], v162, s[36:39], s56 offen offset:2048 sc1
  buffer_store_dwordx4 v[212:215], v162, s[36:39], s56 offen offset:3072 sc1
  s_add_u32 s56, s60, 262144
  v_accvgpr_read_b32 v192, a16
  v_accvgpr_read_b32 v193, a17
  v_accvgpr_read_b32 v194, a18
  v_accvgpr_read_b32 v195, a19
  v_accvgpr_read_b32 v196, a20
  v_accvgpr_read_b32 v197, a21
  v_accvgpr_read_b32 v198, a22
  v_accvgpr_read_b32 v199, a23
  v_accvgpr_read_b32 v200, a24
  v_accvgpr_read_b32 v201, a25
  v_accvgpr_read_b32 v202, a26
  v_accvgpr_read_b32 v203, a27
  v_accvgpr_read_b32 v204, a28
  v_accvgpr_read_b32 v205, a29
  v_accvgpr_read_b32 v206, a30
  v_accvgpr_read_b32 v207, a31
  v_pk_mul_f32 v[192:193], v[192:193], v[172:173] op_sel_hi:[1,0]
  v_pk_mul_f32 v[194:195], v[194:195], v[172:173] op_sel_hi:[1,0]
  v_pk_mul_f32 v[196:197], v[196:197], v[172:173] op_sel_hi:[1,0]
  v_pk_mul_f32 v[198:199], v[198:199], v[172:173] op_sel_hi:[1,0]
  v_pk_mul_f32 v[200:201], v[200:201], v[172:173] op_sel_hi:[1,0]
  v_pk_mul_f32 v[202:203], v[202:203], v[172:173] op_sel_hi:[1,0]
  v_pk_mul_f32 v[204:205], v[204:205], v[172:173] op_sel_hi:[1,0]
  v_pk_mul_f32 v[206:207], v[206:207], v[172:173] op_sel_hi:[1,0]
  v_cvt_pk_bf16_f32 v192, v192, v193
  v_cvt_pk_bf16_f32 v193, v194, v195
  v_cvt_pk_bf16_f32 v194, v196, v197
  v_cvt_pk_bf16_f32 v195, v198, v199
  v_cvt_pk_bf16_f32 v196, v200, v201
  v_cvt_pk_bf16_f32 v197, v202, v203
  v_cvt_pk_bf16_f32 v198, v204, v205
  v_cvt_pk_bf16_f32 v199, v206, v207
  buffer_store_dwordx4 v[192:195], v162, s[36:39], s56 offen offset:0 sc1
  buffer_store_dwordx4 v[196:199], v162, s[36:39], s56 offen offset:1024 sc1
  v_accvgpr_read_b32 v208, a48
  v_accvgpr_read_b32 v209, a49
  v_accvgpr_read_b32 v210, a50
  v_accvgpr_read_b32 v211, a51
  v_accvgpr_read_b32 v212, a52
  v_accvgpr_read_b32 v213, a53
  v_accvgpr_read_b32 v214, a54
  v_accvgpr_read_b32 v215, a55
  v_accvgpr_read_b32 v216, a56
  v_accvgpr_read_b32 v217, a57
  v_accvgpr_read_b32 v218, a58
  v_accvgpr_read_b32 v219, a59
  v_accvgpr_read_b32 v220, a60
  v_accvgpr_read_b32 v221, a61
  v_accvgpr_read_b32 v222, a62
  v_accvgpr_read_b32 v223, a63
  v_pk_mul_f32 v[208:209], v[208:209], v[172:173] op_sel_hi:[1,0]
  v_pk_mul_f32 v[210:211], v[210:211], v[172:173] op_sel_hi:[1,0]
  v_pk_mul_f32 v[212:213], v[212:213], v[172:173] op_sel_hi:[1,0]
  v_pk_mul_f32 v[214:215], v[214:215], v[172:173] op_sel_hi:[1,0]
  v_pk_mul_f32 v[216:217], v[216:217], v[172:173] op_sel_hi:[1,0]
  v_pk_mul_f32 v[218:219], v[218:219], v[172:173] op_sel_hi:[1,0]
  v_pk_mul_f32 v[220:221], v[220:221], v[172:173] op_sel_hi:[1,0]
  v_pk_mul_f32 v[222:223], v[222:223], v[172:173] op_sel_hi:[1,0]
  v_cvt_pk_bf16_f32 v208, v208, v209
  v_cvt_pk_bf16_f32 v209, v210, v211
  v_cvt_pk_bf16_f32 v210, v212, v213
  v_cvt_pk_bf16_f32 v211, v214, v215
  v_cvt_pk_bf16_f32 v212, v216, v217
  v_cvt_pk_bf16_f32 v213, v218, v219
  v_cvt_pk_bf16_f32 v214, v220, v221
  v_cvt_pk_bf16_f32 v215, v222, v223
  buffer_store_dwordx4 v[208:211], v162, s[36:39], s56 offen offset:2048 sc1
  buffer_store_dwordx4 v[212:215], v162, s[36:39], s56 offen offset:3072 sc1
  s_add_u32 s56, s60, 266240
  v_accvgpr_read_b32 v192, a80
  v_accvgpr_read_b32 v193, a81
  v_accvgpr_read_b32 v194, a82
  v_accvgpr_read_b32 v195, a83
  v_accvgpr_read_b32 v196, a84
  v_accvgpr_read_b32 v197, a85
  v_accvgpr_read_b32 v198, a86
  v_accvgpr_read_b32 v199, a87
  v_accvgpr_read_b32 v200, a88
  v_accvgpr_read_b32 v201, a89
  v_accvgpr_read_b32 v202, a90
  v_accvgpr_read_b32 v203, a91
  v_accvgpr_read_b32 v204, a92
  v_accvgpr_read_b32 v205, a93
  v_accvgpr_read_b32 v206, a94
  v_accvgpr_read_b32 v207, a95
  v_pk_mul_f32 v[192:193], v[192:193], v[172:173] op_sel_hi:[1,0]
  v_pk_mul_f32 v[194:195], v[194:195], v[172:173] op_sel_hi:[1,0]
  v_pk_mul_f32 v[196:197], v[196:197], v[172:173] op_sel_hi:[1,0]
  v_pk_mul_f32 v[198:199], v[198:199], v[172:173] op_sel_hi:[1,0]
  v_pk_mul_f32 v[200:201], v[200:201], v[172:173] op_sel_hi:[1,0]
  v_pk_mul_f32 v[202:203], v[202:203], v[172:173] op_sel_hi:[1,0]
  v_pk_mul_f32 v[204:205], v[204:205], v[172:173] op_sel_hi:[1,0]
  v_pk_mul_f32 v[206:207], v[206:207], v[172:173] op_sel_hi:[1,0]
  v_cvt_pk_bf16_f32 v192, v192, v193
  v_cvt_pk_bf16_f32 v193, v194, v195
  v_cvt_pk_bf16_f32 v194, v196, v197
  v_cvt_pk_bf16_f32 v195, v198, v199
  v_cvt_pk_bf16_f32 v196, v200, v201
  v_cvt_pk_bf16_f32 v197, v202, v203
  v_cvt_pk_bf16_f32 v198, v204, v205
  v_cvt_pk_bf16_f32 v199, v206, v207
  buffer_store_dwordx4 v[192:195], v162, s[36:39], s56 offen offset:0 sc1
  buffer_store_dwordx4 v[196:199], v162, s[36:39], s56 offen offset:1024 sc1
  v_accvgpr_read_b32 v208, a112
  v_accvgpr_read_b32 v209, a113
  v_accvgpr_read_b32 v210, a114
  v_accvgpr_read_b32 v211, a115
  v_accvgpr_read_b32 v212, a116
  v_accvgpr_read_b32 v213, a117
  v_accvgpr_read_b32 v214, a118
  v_accvgpr_read_b32 v215, a119
  v_accvgpr_read_b32 v216, a120
  v_accvgpr_read_b32 v217, a121
  v_accvgpr_read_b32 v218, a122
  v_accvgpr_read_b32 v219, a123
  v_accvgpr_read_b32 v220, a124
  v_accvgpr_read_b32 v221, a125
  v_accvgpr_read_b32 v222, a126
  v_accvgpr_read_b32 v223, a127
  v_pk_mul_f32 v[208:209], v[208:209], v[172:173] op_sel_hi:[1,0]
  v_pk_mul_f32 v[210:211], v[210:211], v[172:173] op_sel_hi:[1,0]
  v_pk_mul_f32 v[212:213], v[212:213], v[172:173] op_sel_hi:[1,0]
  v_pk_mul_f32 v[214:215], v[214:215], v[172:173] op_sel_hi:[1,0]
  v_pk_mul_f32 v[216:217], v[216:217], v[172:173] op_sel_hi:[1,0]
  v_pk_mul_f32 v[218:219], v[218:219], v[172:173] op_sel_hi:[1,0]
  v_pk_mul_f32 v[220:221], v[220:221], v[172:173] op_sel_hi:[1,0]
  v_pk_mul_f32 v[222:223], v[222:223], v[172:173] op_sel_hi:[1,0]
  v_cvt_pk_bf16_f32 v208, v208, v209
  v_cvt_pk_bf16_f32 v209, v210, v211
  v_cvt_pk_bf16_f32 v210, v212, v213
  v_cvt_pk_bf16_f32 v211, v214, v215
  v_cvt_pk_bf16_f32 v212, v216, v217
  v_cvt_pk_bf16_f32 v213, v218, v219
  v_cvt_pk_bf16_f32 v214, v220, v221
  v_cvt_pk_bf16_f32 v215, v222, v223
  buffer_store_dwordx4 v[208:211], v162, s[36:39], s56 offen offset:2048 sc1
  buffer_store_dwordx4 v[212:215], v162, s[36:39], s56 offen offset:3072 sc1
  s_cmp_ge_u32 s40, 2
  s_cbranch_scc1 AB_end
  s_waitcnt vmcnt(16)
  s_barrier
  s_cmp_ge_u32 s40, 1
  s_cbranch_scc1 AB_end
  s_barrier
AB_end:
  s_add_u32 s81, s49, 64
  s_mov_b32 s82, 1
  s_branch L_jobend
L_attna:
  s_bfe_u32 s48, s90, 0x30003
  s_bfe_u32 s49, s90, 0x60006
  s_bfe_u32 s50, s90, 0x7000c
  s_bfe_u32 s51, s90, 0x40013
  s_bitcmp1_b32 s90, 23
  s_cbranch_scc1 L_attnak
  v_lshlrev_b32 v128, 4, v255
  v_and_b32 v129, 7, v255
  v_lshlrev_b32 v129, 4, v129
  v_lshrrev_b32 v132, 5, v255
  v_lshl_add_u32 v130, v132, 9, v129
  v_lshl_add_u32 v129, v132, 8, v129
  v_add_u32 v129, 128, v129
  v_and_b32 v132, 8, v255
  v_add_u32 v130, v130, v132
  v_bfe_u32 v132, v255, 4, 1
  v_lshl_add_u32 v130, v132, 2, v130
  v_and_b32 v131, 31, v255
  v_lshrrev_b32 v132, 5, v255
  v_lshlrev_b32 v132, 2, v132
  v_sub_u32 v131, v131, v132
  v_mov_b64 v[2:3], 0
  v_mov_b64 v[6:7], 0
  v_mov_b64 v[10:11], 0
  v_mov_b64 v[14:15], 0
  v_mov_b64 v[18:19], 0
  v_mov_b64 v[22:23], 0
  v_mov_b64 v[26:27], 0
  v_mov_b64 v[30:31], 0
  s_lshl_b32 s57, s48, 2
  s_add_u32 s57, s57, s40
  s_mov_b32 s59, -1
  s_mov_b32 s68, 0
AA_loop:
  s_mov_b32 s58, s49
  s_lshr_b32 s44, s58, 1
  s_or_b32 s44, s44, 3
  s_cmp_eq_u32 s44, s59
  s_cbranch_scc1 Lx_50
  s_mov_b32 s59, s44
  s_add_u32 s44, s44, 133
  s_mov_b32 s45, 0x1020
  s_mov_b32 s46, 0x1020
  s_cmp_lg_u32 s40, 0
  s_cbranch_scc1 Lw_52
  s_lshl_b32 s44, s44, 7
  s_mov_b64 exec, 15
Lw_51:
  buffer_load_dword v252, v253, s[36:39], s44 offen sc1
  s_waitcnt vmcnt(0)
  v_and_b32 v252, s45, v252
  v_cmp_gt_u32 vcc, s46, v252
  s_nop 0
  s_cbranch_vccz Lw_51x
  s_add_u32 s91, s91, 1
  s_cmp_gt_u32 s91, 0x20000
  s_cbranch_scc1 L_abort
  s_sleep 16
  s_branch Lw_51
Lw_51x:
  s_mov_b64 exec, -1
Lw_52:
  s_barrier
Lx_50:
  s_mul_i32 s52, s57, 0x86000
  s_lshl_b32 s55, s58, 13
  s_add_u32 s52, s52, s55
  s_add_u32 s55, s52, 0x0
  buffer_load_dwordx4 a[0:3], v128, s[36:39], s55 offen offset:0 sc1
  buffer_load_dwordx4 a[4:7], v128, s[36:39], s55 offen offset:1024 sc1
  buffer_load_dwordx4 a[8:11], v128, s[36:39], s55 offen offset:2048 sc1
  buffer_load_dwordx4 a[12:15], v128, s[36:39], s55 offen offset:3072 sc1
  s_add_u32 s55, s52, 0x1000
  buffer_load_dwordx4 a[16:19], v128, s[36:39], s55 offen offset:0 sc1
  buffer_load_dwordx4 a[20:23], v128, s[36:39], s55 offen offset:1024 sc1
  buffer_load_dwordx4 a[24:27], v128, s[36:39], s55 offen offset:2048 sc1
  buffer_load_dwordx4 a[28:31], v128, s[36:39], s55 offen offset:3072 sc1
  s_add_u32 s55, s52, 0x1100000
  buffer_load_dwordx4 a[32:35], v128, s[36:39], s55 offen offset:0 sc1
  buffer_load_dwordx4 a[36:39], v128, s[36:39], s55 offen offset:1024 sc1
  buffer_load_dwordx4 a[40:43], v128, s[36:39], s55 offen offset:2048 sc1
  buffer_load_dwordx4 a[44:47], v128, s[36:39], s55 offen offset:3072 sc1
  s_add_u32 s55, s52, 0x1101000
  buffer_load_dwordx4 a[48:51], v128, s[36:39], s55 offen offset:0 sc1
  buffer_load_dwordx4 a[52:55], v128, s[36:39], s55 offen offset:1024 sc1
  buffer_load_dwordx4 a[56:59], v128, s[36:39], s55 offen offset:2048 sc1
  buffer_load_dwordx4 a[60:63], v128, s[36:39], s55 offen offset:3072 sc1
  s_add_u32 s55, s52, 0x2200000
  buffer_load_dwordx4 a[64:67], v128, s[36:39], s55 offen offset:0 sc1
  buffer_load_dwordx4 a[68:71], v128, s[36:39], s55 offen offset:1024 sc1
  buffer_load_dwordx4 a[72:75], v128, s[36:39], s55 offen offset:2048 sc1
  buffer_load_dwordx4 a[76:79], v128, s[36:39], s55 offen offset:3072 sc1
  s_add_u32 s55, s52, 0x2201000
  buffer_load_dwordx4 a[80:83], v128, s[36:39], s55 offen offset:0 sc1
  buffer_load_dwordx4 a[84:87], v128, s[36:39], s55 offen offset:1024 sc1
  buffer_load_dwordx4 a[88:91], v128, s[36:39], s55 offen offset:2048 sc1
  buffer_load_dwordx4 a[92:95], v128, s[36:39], s55 offen offset:3072 sc1
  s_mul_i32 s54, s49, 262144
  s_lshl_b32 s56, s57, 13
  s_add_u32 s54, s54, s56
  s_add_u32 s54, s54, 0x8c00000
  s_waitcnt vmcnt(0)
  v_mfma_f32_32x32x16_bf16 v[32:47], a[32:35], a[0:3], 0
  v_mfma_f32_32x32x16_bf16 v[32:47], a[36:39], a[4:7], v[32:47]
  v_mfma_f32_32x32x16_bf16 v[32:47], a[40:43], a[8:11], v[32:47]
  v_mfma_f32_32x32x16_bf16 v[32:47], a[44:47], a[12:15], v[32:47]
  v_mfma_f32_32x32x16_bf16 v[32:47], a[48:51], a[16:19], v[32:47]
  v_mfma_f32_32x32x16_bf16 v[32:47], a[52:55], a[20:23], v[32:47]
  v_mfma_f32_32x32x16_bf16 v[32:47], a[56:59], a[24:27], v[32:47]
  v_mfma_f32_32x32x16_bf16 v[32:47], a[60:63], a[28:31], v[32:47]
  v_mov_b32 v134, 0xf149f2ca
  v_cmp_gt_i32 s[60:61], 0, v131
  v_cmp_gt_i32 s[62:63], 1, v131
  v_cmp_gt_i32 s[64:65], 2, v131
  v_cmp_gt_i32 s[66:67], 3, v131
  s_nop 6
  v_cndmask_b32 v32, v32, v134, s[60:61]
  v_cmp_gt_i32 s[60:61], 8, v131
  v_cndmask_b32 v33, v33, v134, s[62:63]
  v_cmp_gt_i32 s[62:63], 9, v131
  v_cndmask_b32 v34, v34, v134, s[64:65]
  v_cmp_gt_i32 s[64:65], 10, v131
  v_cndmask_b32 v35, v35, v134, s[66:67]
  v_cmp_gt_i32 s[66:67], 11, v131
  v_cndmask_b32 v36, v36, v134, s[60:61]
  v_cmp_gt_i32 s[60:61], 16, v131
  v_cndmask_b32 v37, v37, v134, s[62:63]
  v_cmp_gt_i32 s[62:63], 17, v131
  v_cndmask_b32 v38, v38, v134, s[64:65]
  v_cmp_gt_i32 s[64:65], 18, v131
  v_cndmask_b32 v39, v39, v134, s[66:67]
  v_cmp_gt_i32 s[66:67], 19, v131
  v_cndmask_b32 v40, v40, v134, s[60:61]
  v_cmp_gt_i32 s[60:61], 24, v131
  v_cndmask_b32 v41, v41, v134, s[62:63]
  v_cmp_gt_i32 s[62:63], 25, v131
  v_cndmask_b32 v42, v42, v134, s[64:65]
  v_cmp_gt_i32 s[64:65], 26, v131
  v_cndmask_b32 v43, v43, v134, s[66:67]
  v_cmp_gt_i32 s[66:67], 27, v131
  v_cndmask_b32 v44, v44, v134, s[60:61]
  v_cndmask_b32 v45, v45, v134, s[62:63]
  v_cndmask_b32 v46, v46, v134, s[64:65]
  v_cndmask_b32 v47, v47, v134, s[66:67]
  v_max_f32 v132, v32, v33
  v_max3_f32 v132, v132, v34, v35
  v_max3_f32 v132, v132, v36, v37
  v_max3_f32 v132, v132, v38, v39
  v_max3_f32 v132, v132, v40, v41
  v_max3_f32 v132, v132, v42, v43
  v_max3_f32 v132, v132, v44, v45
  v_max3_f32 v132, v132, v46, v47
  v_mov_b32 v133, v132
  s_nop 1
  v_permlane32_swap_b32 v132, v133
  v_max_f32 v132, v132, v133
  v_sub_f32 v32, v32, v132
  v_sub_f32 v33, v33, v132
  v_sub_f32 v34, v34, v132
  v_sub_f32 v35, v35, v132
  v_sub_f32 v36, v36, v132
  v_sub_f32 v37, v37, v132
  v_sub_f32 v38, v38, v132
  v_sub_f32 v39, v39, v132
  v_sub_f32 v40, v40, v132
  v_sub_f32 v41, v41, v132
  v_sub_f32 v42, v42, v132
  v_sub_f32 v43, v43, v132
  v_sub_f32 v44, v44, v132
  v_sub_f32 v45, v45, v132
  v_sub_f32 v46, v46, v132
  v_sub_f32 v47, v47, v132
  v_exp_f32 v32, v32
  v_exp_f32 v33, v33
  v_exp_f32 v34, v34
  v_exp_f32 v35, v35
  v_exp_f32 v36, v36
  v_exp_f32 v37, v37
  v_exp_f32 v38, v38
  v_exp_f32 v39, v39
  v_exp_f32 v40, v40
  v_exp_f32 v41, v41
  v_exp_f32 v42, v42
  v_exp_f32 v43, v43
  v_exp_f32 v44, v44
  v_exp_f32 v45, v45
  v_exp_f32 v46, v46
  v_exp_f32 v47, v47
  v_add_f32 v136, v32, v33
  v_add_f32 v136, v136, v34
  v_add_f32 v136, v136, v35
  v_add_f32 v136, v136, v36
  v_add_f32 v136, v136, v37
  v_add_f32 v136, v136, v38
  v_add_f32 v136, v136, v39
  v_add_f32 v136, v136, v40
  v_add_f32 v136, v136, v41
  v_add_f32 v136, v136, v42
  v_add_f32 v136, v136, v43
  v_add_f32 v136, v136, v44
  v_add_f32 v136, v136, v45
  v_add_f32 v136, v136, v46
  v_add_f32 v136, v136, v47
  v_cvt_pk_bf16_f32 v32, v32, v33
  v_cvt_pk_bf16_f32 v33, v34, v35
  v_cvt_pk_bf16_f32 v34, v36, v37
  v_cvt_pk_bf16_f32 v35, v38, v39
  v_cvt_pk_bf16_f32 v36, v40, v41
  v_cvt_pk_bf16_f32 v37, v42, v43
  v_cvt_pk_bf16_f32 v38, v44, v45
  v_cvt_pk_bf16_f32 v39, v46, v47
  v_mfma_f32_32x32x16_bf16 v[64:79], a[64:67], v[32:35], 0
  s_nop 0
  v_mfma_f32_32x32x16_bf16 v[64:79], a[68:71], v[36:39], v[64:79]
  v_mfma_f32_32x32x16_bf16 v[80:95], a[72:75], v[32:35], 0
  v_mfma_f32_32x32x16_bf16 v[80:95], a[76:79], v[36:39], v[80:95]
  v_mfma_f32_32x32x16_bf16 v[96:111], a[80:83], v[32:35], 0
  v_mfma_f32_32x32x16_bf16 v[96:111], a[84:87], v[36:39], v[96:111]
  v_mfma_f32_32x32x16_bf16 v[112:127], a[88:91], v[32:35], 0
  v_mfma_f32_32x32x16_bf16 v[112:127], a[92:95], v[36:39], v[112:127]
  s_add_u32 s46, s49, 3
  s_cmp_le_u32 s46, s68
  s_cbranch_scc1 Lm_53
  s_mov_b32 s45, 0xff
  s_cmp_ge_u32 s49, 62
  s_cbranch_scc1 Lm_53f
  s_mov_b32 s44, 1
  s_cmp_lg_u32 s40, 0
  s_cbranch_scc1 Lw_55
  s_lshl_b32 s44, s44, 7
  s_mov_b64 exec, 1
Lw_54:
  buffer_load_dword v252, v253, s[36:39], s44 offen sc1
  s_waitcnt vmcnt(0)
  v_and_b32 v252, s45, v252
  v_cmp_gt_u32 vcc, s46, v252
  s_nop 0
  s_cbranch_vccz Lw_54x
  s_add_u32 s91, s91, 1
  s_cmp_gt_u32 s91, 0x20000
  s_cbranch_scc1 L_abort
  s_sleep 6
  s_branch Lw_54
Lw_54x:
  v_readfirstlane_b32 s68, v252
  s_mov_b64 exec, -1
Lw_55:
  s_branch Lm_53
Lm_53f:
  s_lshl_b32 s44, s48, 2
  s_add_u32 s44, s44, 200
  s_cmp_lg_u32 s40, 0
  s_cbranch_scc1 Lw_57
  s_lshl_b32 s44, s44, 7
  s_mov_b64 exec, 15
Lw_56:
  buffer_load_dword v252, v253, s[36:39], s44 offen sc1
  s_waitcnt vmcnt(0)
  v_and_b32 v252, s45, v252
  v_cmp_gt_u32 vcc, s46, v252
  s_nop 0
  s_cbranch_vccz Lw_56x
  s_add_u32 s91, s91, 1
  s_cmp_gt_u32 s91, 0x20000
  s_cbranch_scc1 L_abort
  s_sleep 2
  s_branch Lw_56
Lw_56x:
  v_readfirstlane_b32 s68, v252
  s_mov_b64 exec, -1
Lw_57:
Lm_53:
  s_barrier
  s_mul_i32 s53, s57, 0x41000
  s_lshl_b32 s55, s49, 12
  s_add_u32 s53, s53, s55
  s_add_u32 s55, s53, 0x6800000
  buffer_load_dwordx4 a[96:99], v129, s[36:39], s55 offen offset:0 sc1
  buffer_load_dwordx4 a[100:103], v129, s[36:39], s55 offen offset:512 sc1
  buffer_load_dwordx4 a[104:107], v129, s[36:39], s55 offen offset:1024 sc1
  buffer_load_dwordx4 a[108:111], v129, s[36:39], s55 offen offset:1536 sc1
  buffer_load_dwordx4 a[112:115], v129, s[36:39], s55 offen offset:2048 sc1
  buffer_load_dwordx4 a[116:119], v129, s[36:39], s55 offen offset:2560 sc1
  buffer_load_dwordx4 a[120:123], v129, s[36:39], s55 offen offset:3072 sc1
  buffer_load_dwordx4 a[124:127], v129, s[36:39], s55 offen offset:3584 sc1
  s_add_u32 s55, s53, 0x6801000
  buffer_load_dword v0, v130, s[36:39], s55 offen offset:0 sc1
  buffer_load_dword v1, v130, s[36:39], s55 offen offset:256 sc1
  buffer_load_dword v4, v130, s[36:39], s55 offen offset:1024 sc1
  buffer_load_dword v5, v130, s[36:39], s55 offen offset:1280 sc1
  buffer_load_dword v8, v130, s[36:39], s55 offen offset:2048 sc1
  buffer_load_dword v9, v130, s[36:39], s55 offen offset:2304 sc1
  buffer_load_dword v12, v130, s[36:39], s55 offen offset:3072 sc1
  buffer_load_dword v13, v130, s[36:39], s55 offen offset:3328 sc1
  s_waitcnt vmcnt(15)
  v_mfma_f32_32x32x16_bf16 v[48:63], a[96:99], a[0:3], 0
  s_waitcnt vmcnt(14)
  v_mfma_f32_32x32x16_bf16 v[48:63], a[100:103], a[4:7], v[48:63]
  s_waitcnt vmcnt(13)
  v_mfma_f32_32x32x16_bf16 v[48:63], a[104:107], a[8:11], v[48:63]
  s_waitcnt vmcnt(12)
  v_mfma_f32_32x32x16_bf16 v[48:63], a[108:111], a[12:15], v[48:63]
  s_waitcnt vmcnt(11)
  v_mfma_f32_32x32x16_bf16 v[48:63], a[112:115], a[16:19], v[48:63]
  s_waitcnt vmcnt(10)
  v_mfma_f32_32x32x16_bf16 v[48:63], a[116:119], a[20:23], v[48:63]
  s_waitcnt vmcnt(9)
  v_mfma_f32_32x32x16_bf16 v[48:63], a[120:123], a[24:27], v[48:63]
  s_waitcnt vmcnt(8)
  v_mfma_f32_32x32x16_bf16 v[48:63], a[124:127], a[28:31], v[48:63]
  s_nop 11
  v_max3_f32 v134, v132, v48, v49
  v_max3_f32 v134, v134, v50, v51
  v_mov_b32 v133, v134
  s_nop 1
  v_permlane32_swap_b32 v134, v133
  v_max_f32 v134, v134, v133
  v_sub_f32 v48, v48, v134
  v_sub_f32 v49, v49, v134
  v_sub_f32 v50, v50, v134
  v_sub_f32 v51, v51, v134
  v_sub_f32 v138, v132, v134
  v_exp_f32 v48, v48
  v_exp_f32 v49, v49
  v_exp_f32 v50, v50
  v_exp_f32 v51, v51
  v_exp_f32 v138, v138
  v_cvt_pk_bf16_f32 v52, v48, v49
  v_cvt_pk_bf16_f32 v53, v50, v51
  v_mov_b64 v[54:55], 0
  s_waitcnt vmcnt(0)
  s_nop 0
  v_mfma_f32_32x32x16_bf16 v[140:155], v[0:3], v[52:55], 0
  v_mfma_f32_32x32x16_bf16 v[156:171], v[4:7], v[52:55], 0
  v_mfma_f32_32x32x16_bf16 v[172:187], v[8:11], v[52:55], 0
  v_mfma_f32_32x32x16_bf16 v[188:203], v[12:15], v[52:55], 0
  v_fma_f32 v136, v136, v138, v48
  v_add_f32 v49, v49, v50
  v_add_f32 v136, v136, v51
  v_add_f32 v136, v136, v49
  v_mov_b32 v133, v136
  s_nop 1
  v_permlane32_swap_b32 v136, v133
  v_add_f32 v136, v136, v133
  v_rcp_f32 v136, v136
  s_add_u32 s55, s54, 0
  v_pk_fma_f32 v[64:65], v[64:65], v[138:139], v[140:141] op_sel_hi:[1,0,1]
  v_pk_fma_f32 v[66:67], v[66:67], v[138:139], v[142:143] op_sel_hi:[1,0,1]
  v_pk_fma_f32 v[68:69], v[68:69], v[138:139], v[144:145] op_sel_hi:[1,0,1]
  v_pk_fma_f32 v[70:71], v[70:71], v[138:139], v[146:147] op_sel_hi:[1,0,1]
  v_pk_fma_f32 v[72:73], v[72:73], v[138:139], v[148:149] op_sel_hi:[1,0,1]
  v_pk_fma_f32 v[74:75], v[74:75], v[138:139], v[150:151] op_sel_hi:[1,0,1]
  v_pk_fma_f32 v[76:77], v[76:77], v[138:139], v[152:153] op_sel_hi:[1,0,1]
  v_pk_fma_f32 v[78:79], v[78:79], v[138:139], v[154:155] op_sel_hi:[1,0,1]
  v_pk_mul_f32 v[64:65], v[64:65], v[136:137] op_sel_hi:[1,0]
  v_pk_mul_f32 v[66:67], v[66:67], v[136:137] op_sel_hi:[1,0]
  v_pk_mul_f32 v[68:69], v[68:69], v[136:137] op_sel_hi:[1,0]
  v_pk_mul_f32 v[70:71], v[70:71], v[136:137] op_sel_hi:[1,0]
  v_pk_mul_f32 v[72:73], v[72:73], v[136:137] op_sel_hi:[1,0]
  v_pk_mul_f32 v[74:75], v[74:75], v[136:137] op_sel_hi:[1,0]
  v_pk_mul_f32 v[76:77], v[76:77], v[136:137] op_sel_hi:[1,0]
  v_pk_mul_f32 v[78:79], v[78:79], v[136:137] op_sel_hi:[1,0]
  v_cvt_pk_bf16_f32 v64, v64, v65
  v_cvt_pk_bf16_f32 v65, v66, v67
  v_cvt_pk_bf16_f32 v66, v68, v69
  v_cvt_pk_bf16_f32 v67, v70, v71
  v_cvt_pk_bf16_f32 v68, v72, v73
  v_cvt_pk_bf16_f32 v69, v74, v75
  v_cvt_pk_bf16_f32 v70, v76, v77
  v_cvt_pk_bf16_f32 v71, v78, v79
  buffer_store_dwordx4 v[64:67], v128, s[36:39], s55 offen offset:0 sc1
  buffer_store_dwordx4 v[68:71], v128, s[36:39], s55 offen offset:1024 sc1
  v_pk_fma_f32 v[80:81], v[80:81], v[138:139], v[156:157] op_sel_hi:[1,0,1]
  v_pk_fma_f32 v[82:83], v[82:83], v[138:139], v[158:159] op_sel_hi:[1,0,1]
  v_pk_fma_f32 v[84:85], v[84:85], v[138:139], v[160:161] op_sel_hi:[1,0,1]
  v_pk_fma_f32 v[86:87], v[86:87], v[138:139], v[162:163] op_sel_hi:[1,0,1]
  v_pk_fma_f32 v[88:89], v[88:89], v[138:139], v[164:165] op_sel_hi:[1,0,1]
  v_pk_fma_f32 v[90:91], v[90:91], v[138:139], v[166:167] op_sel_hi:[1,0,1]
  v_pk_fma_f32 v[92:93], v[92:93], v[138:139], v[168:169] op_sel_hi:[1,0,1]
  v_pk_fma_f32 v[94:95], v[94:95], v[138:139], v[170:171] op_sel_hi:[1,0,1]
  v_pk_mul_f32 v[80:81], v[80:81], v[136:137] op_sel_hi:[1,0]
  v_pk_mul_f32 v[82:83], v[82:83], v[136:137] op_sel_hi:[1,0]
  v_pk_mul_f32 v[84:85], v[84:85], v[136:137] op_sel_hi:[1,0]
  v_pk_mul_f32 v[86:87], v[86:87], v[136:137] op_sel_hi:[1,0]
  v_pk_mul_f32 v[88:89], v[88:89], v[136:137] op_sel_hi:[1,0]
  v_pk_mul_f32 v[90:91], v[90:91], v[136:137] op_sel_hi:[1,0]
  v_pk_mul_f32 v[92:93], v[92:93], v[136:137] op_sel_hi:[1,0]
  v_pk_mul_f32 v[94:95], v[94:95], v[136:137] op_sel_hi:[1,0]
  v_cvt_pk_bf16_f32 v80, v80, v81
  v_cvt_pk_bf16_f32 v81, v82, v83
  v_cvt_pk_bf16_f32 v82, v84, v85
  v_cvt_pk_bf16_f32 v83, v86, v87
  v_cvt_pk_bf16_f32 v84, v88, v89
  v_cvt_pk_bf16_f32 v85, v90, v91
  v_cvt_pk_bf16_f32 v86, v92, v93
  v_cvt_pk_bf16_f32 v87, v94, v95
  buffer_store_dwordx4 v[80:83], v128, s[36:39], s55 offen offset:2048 sc1
  buffer_store_dwordx4 v[84:87], v128, s[36:39], s55 offen offset:3072 sc1
  s_add_u32 s55, s54, 4096
  v_pk_fma_f32 v[96:97], v[96:97], v[138:139], v[172:173] op_sel_hi:[1,0,1]
  v_pk_fma_f32 v[98:99], v[98:99], v[138:139], v[174:175] op_sel_hi:[1,0,1]
  v_pk_fma_f32 v[100:101], v[100:101], v[138:139], v[176:177] op_sel_hi:[1,0,1]
  v_pk_fma_f32 v[102:103], v[102:103], v[138:139], v[178:179] op_sel_hi:[1,0,1]
  v_pk_fma_f32 v[104:105], v[104:105], v[138:139], v[180:181] op_sel_hi:[1,0,1]
  v_pk_fma_f32 v[106:107], v[106:107], v[138:139], v[182:183] op_sel_hi:[1,0,1]
  v_pk_fma_f32 v[108:109], v[108:109], v[138:139], v[184:185] op_sel_hi:[1,0,1]
  v_pk_fma_f32 v[110:111], v[110:111], v[138:139], v[186:187] op_sel_hi:[1,0,1]
  v_pk_mul_f32 v[96:97], v[96:97], v[136:137] op_sel_hi:[1,0]
  v_pk_mul_f32 v[98:99], v[98:99], v[136:137] op_sel_hi:[1,0]
  v_pk_mul_f32 v[100:101], v[100:101], v[136:137] op_sel_hi:[1,0]
  v_pk_mul_f32 v[102:103], v[102:103], v[136:137] op_sel_hi:[1,0]
  v_pk_mul_f32 v[104:105], v[104:105], v[136:137] op_sel_hi:[1,0]
  v_pk_mul_f32 v[106:107], v[106:107], v[136:137] op_sel_hi:[1,0]
  v_pk_mul_f32 v[108:109], v[108:109], v[136:137] op_sel_hi:[1,0]
  v_pk_mul_f32 v[110:111], v[110:111], v[136:137] op_sel_hi:[1,0]
  v_cvt_pk_bf16_f32 v96, v96, v97
  v_cvt_pk_bf16_f32 v97, v98, v99
  v_cvt_pk_bf16_f32 v98, v100, v101
  v_cvt_pk_bf16_f32 v99, v102, v103
  v_cvt_pk_bf16_f32 v100, v104, v105
  v_cvt_pk_bf16_f32 v101, v106, v107
  v_cvt_pk_bf16_f32 v102, v108, v109
  v_cvt_pk_bf16_f32 v103, v110, v111
  buffer_store_dwordx4 v[96:99], v128, s[36:39], s55 offen offset:0 sc1
  buffer_store_dwordx4 v[100:103], v128, s[36:39], s55 offen offset:1024 sc1
  v_pk_fma_f32 v[112:113], v[112:113], v[138:139], v[188:189] op_sel_hi:[1,0,1]
  v_pk_fma_f32 v[114:115], v[114:115], v[138:139], v[190:191] op_sel_hi:[1,0,1]
  v_pk_fma_f32 v[116:117], v[116:117], v[138:139], v[192:193] op_sel_hi:[1,0,1]
  v_pk_fma_f32 v[118:119], v[118:119], v[138:139], v[194:195] op_sel_hi:[1,0,1]
  v_pk_fma_f32 v[120:121], v[120:121], v[138:139], v[196:197] op_sel_hi:[1,0,1]
  v_pk_fma_f32 v[122:123], v[122:123], v[138:139], v[198:199] op_sel_hi:[1,0,1]
  v_pk_fma_f32 v[124:125], v[124:125], v[138:139], v[200:201] op_sel_hi:[1,0,1]
  v_pk_fma_f32 v[126:127], v[126:127], v[138:139], v[202:203] op_sel_hi:[1,0,1]
  v_pk_mul_f32 v[112:113], v[112:113], v[136:137] op_sel_hi:[1,0]
  v_pk_mul_f32 v[114:115], v[114:115], v[136:137] op_sel_hi:[1,0]
  v_pk_mul_f32 v[116:117], v[116:117], v[136:137] op_sel_hi:[1,0]
  v_pk_mul_f32 v[118:119], v[118:119], v[136:137] op_sel_hi:[1,0]
  v_pk_mul_f32 v[120:121], v[120:121], v[136:137] op_sel_hi:[1,0]
  v_pk_mul_f32 v[122:123], v[122:123], v[136:137] op_sel_hi:[1,0]
  v_pk_mul_f32 v[124:125], v[124:125], v[136:137] op_sel_hi:[1,0]
  v_pk_mul_f32 v[126:127], v[126:127], v[136:137] op_sel_hi:[1,0]
  v_cvt_pk_bf16_f32 v112, v112, v113
  v_cvt_pk_bf16_f32 v113, v114, v115
  v_cvt_pk_bf16_f32 v114, v116, v117
  v_cvt_pk_bf16_f32 v115, v118, v119
  v_cvt_pk_bf16_f32 v116, v120, v121
  v_cvt_pk_bf16_f32 v117, v122, v123
  v_cvt_pk_bf16_f32 v118, v124, v125
  v_cvt_pk_bf16_f32 v119, v126, v127
  buffer_store_dwordx4 v[112:115], v128, s[36:39], s55 offen offset:2048 sc1
  buffer_store_dwordx4 v[116:119], v128, s[36:39], s55 offen offset:3072 sc1
  s_add_u32 s55, s49, 72
  s_mov_b32 s56, 1
  s_waitcnt vmcnt(0)
  s_barrier
  s_cmp_lg_u32 s40, 0
  s_cbranch_scc1 Ls_58
  s_cmp_eq_u32 s56, 0
  s_cbranch_scc1 Ls_58
  s_lshl_b32 s47, s55, 7
  s_add_u32 s47, s47, 0x8a00000
  v_mov_b32 v250, s56
  s_mov_b64 exec, 1
  buffer_atomic_add v250, off, s[36:39], s47
  s_mov_b64 exec, -1
Ls_58:
  s_add_u32 s49, s49, s51
  s_sub_u32 s50, s50, 1
  s_cmp_lg_u32 s50, 0
  s_cbranch_scc1 AA_loop
  s_mov_b32 s81, 7
  s_mov_b32 s82, 0
  s_branch L_jobend
L_attnak:
  v_lshlrev_b32 v128, 4, v255
  v_and_b32 v129, 7, v255
  v_lshlrev_b32 v129, 4, v129
  v_lshrrev_b32 v132, 5, v255
  v_lshl_add_u32 v130, v132, 9, v129
  v_lshl_add_u32 v129, v132, 8, v129
  v_add_u32 v129, 128, v129
  v_and_b32 v132, 8, v255
  v_add_u32 v130, v130, v132
  v_bfe_u32 v132, v255, 4, 1
  v_lshl_add_u32 v130, v132, 2, v130
  v_and_b32 v131, 31, v255
  v_lshrrev_b32 v132, 5, v255
  v_lshlrev_b32 v132, 2, v132
  v_sub_u32 v131, v131, v132
  v_mov_b64 v[2:3], 0
  v_mov_b64 v[6:7], 0
  v_mov_b64 v[10:11], 0
  v_mov_b64 v[14:15], 0
  v_mov_b64 v[18:19], 0
  v_mov_b64 v[22:23], 0
  v_mov_b64 v[26:27], 0
  v_mov_b64 v[30:31], 0
  s_lshl_b32 s57, s48, 2
  s_add_u32 s57, s57, s40
  s_mov_b32 s59, -1
  s_mov_b32 s68, 0
  s_sub_u32 s58, s50, 1
  s_mul_i32 s58, s58, s51
  s_add_u32 s58, s58, s49
  s_add_u32 s46, s58, 3
  s_cmp_le_u32 s46, s68
  s_cbranch_scc1 Lm_59
  s_mov_b32 s45, 0xff
  s_cmp_ge_u32 s58, 62
  s_cbranch_scc1 Lm_59f
  s_mov_b32 s44, 1
  s_cmp_lg_u32 s40, 0
  s_cbranch_scc1 Lw_61
  s_lshl_b32 s44, s44, 7
  s_mov_b64 exec, 1
Lw_60:
  buffer_load_dword v252, v253, s[36:39], s44 offen sc1
  s_waitcnt vmcnt(0)
  v_and_b32 v252, s45, v252
  v_cmp_gt_u32 vcc, s46, v252
  s_nop 0
  s_cbranch_vccz Lw_60x
  s_add_u32 s91, s91, 1
  s_cmp_gt_u32 s91, 0x20000
  s_cbranch_scc1 L_abort
  s_sleep 6
  s_branch Lw_60
Lw_60x:
  v_readfirstlane_b32 s68, v252
  s_mov_b64 exec, -1
Lw_61:
  s_branch Lm_59
Lm_59f:
  s_lshl_b32 s44, s48, 2
  s_add_u32 s44, s44, 200
  s_cmp_lg_u32 s40, 0
  s_cbranch_scc1 Lw_63
  s_lshl_b32 s44, s44, 7
  s_mov_b64 exec, 15
Lw_62:
  buffer_load_dword v252, v253, s[36:39], s44 offen sc1
  s_waitcnt vmcnt(0)
  v_and_b32 v252, s45, v252
  v_cmp_gt_u32 vcc, s46, v252
  s_nop 0
  s_cbranch_vccz Lw_62x
  s_add_u32 s91, s91, 1
  s_cmp_gt_u32 s91, 0x20000
  s_cbranch_scc1 L_abort
  s_sleep 2
  s_branch Lw_62
Lw_62x:
  v_readfirstlane_b32 s68, v252
  s_mov_b64 exec, -1
Lw_63:
Lm_59:
  s_barrier
  s_mov_b32 s58, s49
  s_mov_b32 s69, 0
  s_lshr_b32 s44, s58, 1
  s_or_b32 s44, s44, 3
  s_cmp_eq_u32 s44, s59
  s_cbranch_scc1 Lx_64
  s_mov_b32 s59, s44
  s_add_u32 s44, s44, 133
  s_mov_b32 s45, 0x1020
  s_mov_b32 s46, 0x1020
  s_cmp_lg_u32 s40, 0
  s_cbranch_scc1 Lw_66
  s_lshl_b32 s44, s44, 7
  s_mov_b64 exec, 15
Lw_65:
  buffer_load_dword v252, v253, s[36:39], s44 offen sc1
  s_waitcnt vmcnt(0)
  v_and_b32 v252, s45, v252
  v_cmp_gt_u32 vcc, s46, v252
  s_nop 0
  s_cbranch_vccz Lw_65x
  s_add_u32 s91, s91, 1
  s_cmp_gt_u32 s91, 0x20000
  s_cbranch_scc1 L_abort
  s_sleep 16
  s_branch Lw_65
Lw_65x:
  s_mov_b64 exec, -1
Lw_66:
  s_barrier
Lx_64:
  s_mul_i32 s52, s57, 0x86000
  s_lshl_b32 s55, s58, 13
  s_add_u32 s52, s52, s55
  s_add_u32 s55, s52, 0x0
  buffer_load_dwordx4 a[0:3], v128, s[36:39], s55 offen offset:0 sc1
  buffer_load_dwordx4 a[4:7], v128, s[36:39], s55 offen offset:1024 sc1
  buffer_load_dwordx4 a[8:11], v128, s[36:39], s55 offen offset:2048 sc1
  buffer_load_dwordx4 a[12:15], v128, s[36:39], s55 offen offset:3072 sc1
  s_add_u32 s55, s52, 0x1000
  buffer_load_dwordx4 a[16:19], v128, s[36:39], s55 offen offset:0 sc1
  buffer_load_dwordx4 a[20:23], v128, s[36:39], s55 offen offset:1024 sc1
  buffer_load_dwordx4 a[24:27], v128, s[36:39], s55 offen offset:2048 sc1
  buffer_load_dwordx4 a[28:31], v128, s[36:39], s55 offen offset:3072 sc1
  s_add_u32 s55, s52, 0x1100000
  buffer_load_dwordx4 a[32:35], v128, s[36:39], s55 offen offset:0 sc1
  buffer_load_dwordx4 a[36:39], v128, s[36:39], s55 offen offset:1024 sc1
  buffer_load_dwordx4 a[40:43], v128, s[36:39], s55 offen offset:2048 sc1
  buffer_load_dwordx4 a[44:47], v128, s[36:39], s55 offen offset:3072 sc1
  s_add_u32 s55, s52, 0x1101000
  buffer_load_dwordx4 a[48:51], v128, s[36:39], s55 offen offset:0 sc1
  buffer_load_dwordx4 a[52:55], v128, s[36:39], s55 offen offset:1024 sc1
  buffer_load_dwordx4 a[56:59], v128, s[36:39], s55 offen offset:2048 sc1
  buffer_load_dwordx4 a[60:63], v128, s[36:39], s55 offen offset:3072 sc1
  s_add_u32 s55, s52, 0x2200000
  buffer_load_dwordx4 a[64:67], v128, s[36:39], s55 offen offset:0 sc1
  buffer_load_dwordx4 a[68:71], v128, s[36:39], s55 offen offset:1024 sc1
  buffer_load_dwordx4 a[72:75], v128, s[36:39], s55 offen offset:2048 sc1
  buffer_load_dwordx4 a[76:79], v128, s[36:39], s55 offen offset:3072 sc1
  s_add_u32 s55, s52, 0x2201000
  buffer_load_dwordx4 a[80:83], v128, s[36:39], s55 offen offset:0 sc1
  buffer_load_dwordx4 a[84:87], v128, s[36:39], s55 offen offset:1024 sc1
  buffer_load_dwordx4 a[88:91], v128, s[36:39], s55 offen offset:2048 sc1
  buffer_load_dwordx4 a[92:95], v128, s[36:39], s55 offen offset:3072 sc1
  s_mul_i32 s53, s57, 0x41000
  s_lshl_b32 s55, s58, 12
  s_add_u32 s53, s53, s55
  s_add_u32 s55, s53, 0x6800000
  buffer_load_dwordx4 a[96:99], v129, s[36:39], s55 offen offset:0 sc1
  buffer_load_dwordx4 a[100:103], v129, s[36:39], s55 offen offset:512 sc1
  buffer_load_dwordx4 a[104:107], v129, s[36:39], s55 offen offset:1024 sc1
  buffer_load_dwordx4 a[108:111], v129, s[36:39], s55 offen offset:1536 sc1
  buffer_load_dwordx4 a[112:115], v129, s[36:39], s55 offen offset:2048 sc1
  buffer_load_dwordx4 a[116:119], v129, s[36:39], s55 offen offset:2560 sc1
  buffer_load_dwordx4 a[120:123], v129, s[36:39], s55 offen offset:3072 sc1
  buffer_load_dwordx4 a[124:127], v129, s[36:39], s55 offen offset:3584 sc1
  s_add_u32 s55, s53, 0x6801000
  buffer_load_dword v0, v130, s[36:39], s55 offen offset:0 sc1
  buffer_load_dword v1, v130, s[36:39], s55 offen offset:256 sc1
  buffer_load_dword v4, v130, s[36:39], s55 offen offset:1024 sc1
  buffer_load_dword v5, v130, s[36:39], s55 offen offset:1280 sc1
  buffer_load_dword v8, v130, s[36:39], s55 offen offset:2048 sc1
  buffer_load_dword v9, v130, s[36:39], s55 offen offset:2304 sc1
  buffer_load_dword v12, v130, s[36:39], s55 offen offset:3072 sc1
  buffer_load_dword v13, v130, s[36:39], s55 offen offset:3328 sc1
  s_waitcnt vmcnt(0)
AK_loop:
  s_waitcnt vmcnt(8)
  s_barrier
  s_mul_i32 s55, s51, 2
  s_sub_u32 s55, s49, s55
  s_add_u32 s55, s55, 72
  s_cmp_ge_u32 s69, 2
  s_cselect_b32 s56, 1, 0
  s_cmp_lg_u32 s40, 0
  s_cbranch_scc1 Ls_67
  s_cmp_eq_u32 s56, 0
  s_cbranch_scc1 Ls_67
  s_lshl_b32 s47, s55, 7
  s_add_u32 s47, s47, 0x8a00000
  v_mov_b32 v250, s56
  s_mov_b64 exec, 1
  buffer_atomic_add v250, off, s[36:39], s47
  s_mov_b64 exec, -1
Ls_67:
  s_add_u32 s58, s49, s51
  s_cmp_le_u32 s50, 1
  s_cbranch_scc1 AK_nl0
  s_lshr_b32 s44, s58, 1
  s_or_b32 s44, s44, 3
  s_cmp_eq_u32 s44, s59
  s_cbranch_scc1 Lx_68
  s_mov_b32 s59, s44
  s_add_u32 s44, s44, 133
  s_mov_b32 s45, 0x1020
  s_mov_b32 s46, 0x1020
  s_cmp_lg_u32 s40, 0
  s_cbranch_scc1 Lw_70
  s_lshl_b32 s44, s44, 7
  s_mov_b64 exec, 15
Lw_69:
  buffer_load_dword v252, v253, s[36:39], s44 offen sc1
  s_waitcnt vmcnt(0)
  v_and_b32 v252, s45, v252
  v_cmp_gt_u32 vcc, s46, v252
  s_nop 0
  s_cbranch_vccz Lw_69x
  s_add_u32 s91, s91, 1
  s_cmp_gt_u32 s91, 0x20000
  s_cbranch_scc1 L_abort
  s_sleep 16
  s_branch Lw_69
Lw_69x:
  s_mov_b64 exec, -1
Lw_70:
  s_barrier
Lx_68:
  s_mul_i32 s52, s57, 0x86000
  s_lshl_b32 s55, s58, 13
  s_add_u32 s52, s52, s55
  s_add_u32 s55, s52, 0x0
  buffer_load_dwordx4 a[128:131], v128, s[36:39], s55 offen offset:0 sc1
  buffer_load_dwordx4 a[132:135], v128, s[36:39], s55 offen offset:1024 sc1
  buffer_load_dwordx4 a[136:139], v128, s[36:39], s55 offen offset:2048 sc1
  buffer_load_dwordx4 a[140:143], v128, s[36:39], s55 offen offset:3072 sc1
  s_add_u32 s55, s52, 0x1000
  buffer_load_dwordx4 a[144:147], v128, s[36:39], s55 offen offset:0 sc1
  buffer_load_dwordx4 a[148:151], v128, s[36:39], s55 offen offset:1024 sc1
  buffer_load_dwordx4 a[152:155], v128, s[36:39], s55 offen offset:2048 sc1
  buffer_load_dwordx4 a[156:159], v128, s[36:39], s55 offen offset:3072 sc1
  s_add_u32 s55, s52, 0x1100000
  buffer_load_dwordx4 a[160:163], v128, s[36:39], s55 offen offset:0 sc1
  buffer_load_dwordx4 a[164:167], v128, s[36:39], s55 offen offset:1024 sc1
  buffer_load_dwordx4 a[168:171], v128, s[36:39], s55 offen offset:2048 sc1
  buffer_load_dwordx4 a[172:175], v128, s[36:39], s55 offen offset:3072 sc1
  s_add_u32 s55, s52, 0x1101000
  buffer_load_dwordx4 a[176:179], v128, s[36:39], s55 offen offset:0 sc1
  buffer_load_dwordx4 a[180:183], v128, s[36:39], s55 offen offset:1024 sc1
  buffer_load_dwordx4 a[184:187], v128, s[36:39], s55 offen offset:2048 sc1
  buffer_load_dwordx4 a[188:191], v128, s[36:39], s55 offen offset:3072 sc1
  s_add_u32 s55, s52, 0x2200000
  buffer_load_dwordx4 a[192:195], v128, s[36:39], s55 offen offset:0 sc1
  buffer_load_dwordx4 a[196:199], v128, s[36:39], s55 offen offset:1024 sc1
  buffer_load_dwordx4 a[200:203], v128, s[36:39], s55 offen offset:2048 sc1
  buffer_load_dwordx4 a[204:207], v128, s[36:39], s55 offen offset:3072 sc1
  s_add_u32 s55, s52, 0x2201000
  buffer_load_dwordx4 a[208:211], v128, s[36:39], s55 offen offset:0 sc1
  buffer_load_dwordx4 a[212:215], v128, s[36:39], s55 offen offset:1024 sc1
  buffer_load_dwordx4 a[216:219], v128, s[36:39], s55 offen offset:2048 sc1
  buffer_load_dwordx4 a[220:223], v128, s[36:39], s55 offen offset:3072 sc1
  s_mul_i32 s53, s57, 0x41000
  s_lshl_b32 s55, s58, 12
  s_add_u32 s53, s53, s55
  s_add_u32 s55, s53, 0x6800000
  buffer_load_dwordx4 a[224:227], v129, s[36:39], s55 offen offset:0 sc1
  buffer_load_dwordx4 a[228:231], v129, s[36:39], s55 offen offset:512 sc1
  buffer_load_dwordx4 a[232:235], v129, s[36:39], s55 offen offset:1024 sc1
  buffer_load_dwordx4 a[236:239], v129, s[36:39], s55 offen offset:1536 sc1
  buffer_load_dwordx4 a[240:243], v129, s[36:39], s55 offen offset:2048 sc1
  buffer_load_dwordx4 a[244:247], v129, s[36:39], s55 offen offset:2560 sc1
  buffer_load_dwordx4 a[248:251], v129, s[36:39], s55 offen offset:3072 sc1
  buffer_load_dwordx4 a[252:255], v129, s[36:39], s55 offen offset:3584 sc1
  s_add_u32 s55, s53, 0x6801000
  buffer_load_dword v16, v130, s[36:39], s55 offen offset:0 sc1
  buffer_load_dword v17, v130, s[36:39], s55 offen offset:256 sc1
  buffer_load_dword v20, v130, s[36:39], s55 offen offset:1024 sc1
  buffer_load_dword v21, v130, s[36:39], s55 offen offset:1280 sc1
  buffer_load_dword v24, v130, s[36:39], s55 offen offset:2048 sc1
  buffer_load_dword v25, v130, s[36:39], s55 offen offset:2304 sc1
  buffer_load_dword v28, v130, s[36:39], s55 offen offset:3072 sc1
  buffer_load_dword v29, v130, s[36:39], s55 offen offset:3328 sc1
AK_nl0:
  s_mul_i32 s54, s49, 262144
  s_lshl_b32 s56, s57, 13
  s_add_u32 s54, s54, s56
  s_add_u32 s54, s54, 0x8c00000
  v_mfma_f32_32x32x16_bf16 v[32:47], a[32:35], a[0:3], 0
  v_mfma_f32_32x32x16_bf16 v[32:47], a[36:39], a[4:7], v[32:47]
  v_mfma_f32_32x32x16_bf16 v[32:47], a[40:43], a[8:11], v[32:47]
  v_mfma_f32_32x32x16_bf16 v[32:47], a[44:47], a[12:15], v[32:47]
  v_mfma_f32_32x32x16_bf16 v[32:47], a[48:51], a[16:19], v[32:47]
  v_mfma_f32_32x32x16_bf16 v[32:47], a[52:55], a[20:23], v[32:47]
  v_mfma_f32_32x32x16_bf16 v[32:47], a[56:59], a[24:27], v[32:47]
  v_mfma_f32_32x32x16_bf16 v[32:47], a[60:63], a[28:31], v[32:47]
  v_mov_b32 v134, 0xf149f2ca
  v_cmp_gt_i32 s[60:61], 0, v131
  v_cmp_gt_i32 s[62:63], 1, v131
  v_cmp_gt_i32 s[64:65], 2, v131
  v_cmp_gt_i32 s[66:67], 3, v131
  s_nop 6
  v_cndmask_b32 v32, v32, v134, s[60:61]
  v_cmp_gt_i32 s[60:61], 8, v131
  v_cndmask_b32 v33, v33, v134, s[62:63]
  v_cmp_gt_i32 s[62:63], 9, v131
  v_cndmask_b32 v34, v34, v134, s[64:65]
  v_cmp_gt_i32 s[64:65], 10, v131
  v_cndmask_b32 v35, v35, v134, s[66:67]
  v_cmp_gt_i32 s[66:67], 11, v131
  v_cndmask_b32 v36, v36, v134, s[60:61]
  v_cmp_gt_i32 s[60:61], 16, v131
  v_cndmask_b32 v37, v37, v134, s[62:63]
  v_cmp_gt_i32 s[62:63], 17, v131
  v_cndmask_b32 v38, v38, v134, s[64:65]
  v_cmp_gt_i32 s[64:65], 18, v131
  v_cndmask_b32 v39, v39, v134, s[66:67]
  v_cmp_gt_i32 s[66:67], 19, v131
  v_cndmask_b32 v40, v40, v134, s[60:61]
  v_cmp_gt_i32 s[60:61], 24, v131
  v_cndmask_b32 v41, v41, v134, s[62:63]
  v_cmp_gt_i32 s[62:63], 25, v131
  v_cndmask_b32 v42, v42, v134, s[64:65]
  v_cmp_gt_i32 s[64:65], 26, v131
  v_cndmask_b32 v43, v43, v134, s[66:67]
  v_cmp_gt_i32 s[66:67], 27, v131
  v_cndmask_b32 v44, v44, v134, s[60:61]
  v_cndmask_b32 v45, v45, v134, s[62:63]
  v_cndmask_b32 v46, v46, v134, s[64:65]
  v_cndmask_b32 v47, v47, v134, s[66:67]
  v_max_f32 v132, v32, v33
  v_max3_f32 v132, v132, v34, v35
  v_max3_f32 v132, v132, v36, v37
  v_max3_f32 v132, v132, v38, v39
  v_max3_f32 v132, v132, v40, v41
  v_max3_f32 v132, v132, v42, v43
  v_max3_f32 v132, v132, v44, v45
  v_max3_f32 v132, v132, v46, v47
  v_mfma_f32_32x32x16_bf16 v[48:63], a[96:99], a[0:3], 0
  v_mfma_f32_32x32x16_bf16 v[48:63], a[100:103], a[4:7], v[48:63]
  v_mfma_f32_32x32x16_bf16 v[48:63], a[104:107], a[8:11], v[48:63]
  v_mfma_f32_32x32x16_bf16 v[48:63], a[108:111], a[12:15], v[48:63]
  v_mfma_f32_32x32x16_bf16 v[48:63], a[112:115], a[16:19], v[48:63]
  v_mfma_f32_32x32x16_bf16 v[48:63], a[116:119], a[20:23], v[48:63]
  v_mfma_f32_32x32x16_bf16 v[48:63], a[120:123], a[24:27], v[48:63]
  v_mfma_f32_32x32x16_bf16 v[48:63], a[124:127], a[28:31], v[48:63]
  s_nop 11
  v_max3_f32 v132, v132, v48, v49
  v_max3_f32 v132, v132, v50, v51
  v_mov_b32 v133, v132
  s_nop 1
  v_permlane32_swap_b32 v132, v133
  v_max_f32 v132, v132, v133
  v_sub_f32 v32, v32, v132
  v_sub_f32 v33, v33, v132
  v_sub_f32 v34, v34, v132
  v_sub_f32 v35, v35, v132
  v_sub_f32 v36, v36, v132
  v_sub_f32 v37, v37, v132
  v_sub_f32 v38, v38, v132
  v_sub_f32 v39, v39, v132
  v_sub_f32 v40, v40, v132
  v_sub_f32 v41, v41, v132
  v_sub_f32 v42, v42, v132
  v_sub_f32 v43, v43, v132
  v_sub_f32 v44, v44, v132
  v_sub_f32 v45, v45, v132
  v_sub_f32 v46, v46, v132
  v_sub_f32 v47, v47, v132
  v_sub_f32 v48, v48, v132
  v_sub_f32 v49, v49, v132
  v_sub_f32 v50, v50, v132
  v_sub_f32 v51, v51, v132
  v_exp_f32 v32, v32
  v_exp_f32 v33, v33
  v_exp_f32 v34, v34
  v_exp_f32 v35, v35
  v_exp_f32 v36, v36
  v_exp_f32 v37, v37
  v_exp_f32 v38, v38
  v_exp_f32 v39, v39
  v_exp_f32 v40, v40
  v_exp_f32 v41, v41
  v_exp_f32 v42, v42
  v_exp_f32 v43, v43
  v_exp_f32 v44, v44
  v_exp_f32 v45, v45
  v_exp_f32 v46, v46
  v_exp_f32 v47, v47
  v_exp_f32 v48, v48
  v_exp_f32 v49, v49
  v_exp_f32 v50, v50
  v_exp_f32 v51, v51
  v_add_f32 v132, v32, v33
  v_add_f32 v132, v132, v34
  v_add_f32 v132, v132, v35
  v_add_f32 v132, v132, v36
  v_add_f32 v132, v132, v37
  v_add_f32 v132, v132, v38
  v_add_f32 v132, v132, v39
  v_add_f32 v132, v132, v40
  v_add_f32 v132, v132, v41
  v_add_f32 v132, v132, v42
  v_add_f32 v132, v132, v43
  v_add_f32 v132, v132, v44
  v_add_f32 v132, v132, v45
  v_add_f32 v132, v132, v46
  v_add_f32 v132, v132, v47
  v_add_f32 v132, v132, v48
  v_add_f32 v132, v132, v49
  v_add_f32 v132, v132, v50
  v_add_f32 v132, v132, v51
  v_cvt_pk_bf16_f32 v32, v32, v33
  v_cvt_pk_bf16_f32 v33, v34, v35
  v_cvt_pk_bf16_f32 v34, v36, v37
  v_cvt_pk_bf16_f32 v35, v38, v39
  v_cvt_pk_bf16_f32 v36, v40, v41
  v_cvt_pk_bf16_f32 v37, v42, v43
  v_cvt_pk_bf16_f32 v38, v44, v45
  v_cvt_pk_bf16_f32 v39, v46, v47
  v_cvt_pk_bf16_f32 v48, v48, v49
  v_cvt_pk_bf16_f32 v49, v50, v51
  v_mov_b64 v[50:51], 0
  s_nop 1
  v_mfma_f32_32x32x16_bf16 v[64:79], v[0:3], v[48:51], 0
  v_mfma_f32_32x32x16_bf16 v[80:95], v[4:7], v[48:51], 0
  v_mfma_f32_32x32x16_bf16 v[96:111], v[8:11], v[48:51], 0
  v_mfma_f32_32x32x16_bf16 v[112:127], v[12:15], v[48:51], 0
  v_mov_b32 v133, v132
  s_nop 1
  v_permlane32_swap_b32 v132, v133
  v_add_f32 v132, v132, v133
  v_rcp_f32 v132, v132
  v_mfma_f32_32x32x16_bf16 v[64:79], a[64:67], v[32:35], v[64:79]
  v_mfma_f32_32x32x16_bf16 v[64:79], a[68:71], v[36:39], v[64:79]
  v_mfma_f32_32x32x16_bf16 v[80:95], a[72:75], v[32:35], v[80:95]
  v_mfma_f32_32x32x16_bf16 v[80:95], a[76:79], v[36:39], v[80:95]
  v_mfma_f32_32x32x16_bf16 v[96:111], a[80:83], v[32:35], v[96:111]
  v_mfma_f32_32x32x16_bf16 v[96:111], a[84:87], v[36:39], v[96:111]
  v_mfma_f32_32x32x16_bf16 v[112:127], a[88:91], v[32:35], v[112:127]
  v_mfma_f32_32x32x16_bf16 v[112:127], a[92:95], v[36:39], v[112:127]
  s_add_u32 s55, s54, 0
  v_pk_mul_f32 v[64:65], v[64:65], v[132:133] op_sel_hi:[1,0]
  v_pk_mul_f32 v[66:67], v[66:67], v[132:133] op_sel_hi:[1,0]
  v_pk_mul_f32 v[68:69], v[68:69], v[132:133] op_sel_hi:[1,0]
  v_pk_mul_f32 v[70:71], v[70:71], v[132:133] op_sel_hi:[1,0]
  v_pk_mul_f32 v[72:73], v[72:73], v[132:133] op_sel_hi:[1,0]
  v_pk_mul_f32 v[74:75], v[74:75], v[132:133] op_sel_hi:[1,0]
  v_pk_mul_f32 v[76:77], v[76:77], v[132:133] op_sel_hi:[1,0]
  v_pk_mul_f32 v[78:79], v[78:79], v[132:133] op_sel_hi:[1,0]
  v_cvt_pk_bf16_f32 v64, v64, v65
  v_cvt_pk_bf16_f32 v65, v66, v67
  v_cvt_pk_bf16_f32 v66, v68, v69
  v_cvt_pk_bf16_f32 v67, v70, v71
  v_cvt_pk_bf16_f32 v68, v72, v73
  v_cvt_pk_bf16_f32 v69, v74, v75
  v_cvt_pk_bf16_f32 v70, v76, v77
  v_cvt_pk_bf16_f32 v71, v78, v79
  buffer_store_dwordx4 v[64:67], v128, s[36:39], s55 offen offset:0 sc1
  buffer_store_dwordx4 v[68:71], v128, s[36:39], s55 offen offset:1024 sc1
  v_pk_mul_f32 v[80:81], v[80:81], v[132:133] op_sel_hi:[1,0]
  v_pk_mul_f32 v[82:83], v[82:83], v[132:133] op_sel_hi:[1,0]
  v_pk_mul_f32 v[84:85], v[84:85], v[132:133] op_sel_hi:[1,0]
  v_pk_mul_f32 v[86:87], v[86:87], v[132:133] op_sel_hi:[1,0]
  v_pk_mul_f32 v[88:89], v[88:89], v[132:133] op_sel_hi:[1,0]
  v_pk_mul_f32 v[90:91], v[90:91], v[132:133] op_sel_hi:[1,0]
  v_pk_mul_f32 v[92:93], v[92:93], v[132:133] op_sel_hi:[1,0]
  v_pk_mul_f32 v[94:95], v[94:95], v[132:133] op_sel_hi:[1,0]
  v_cvt_pk_bf16_f32 v80, v80, v81
  v_cvt_pk_bf16_f32 v81, v82, v83
  v_cvt_pk_bf16_f32 v82, v84, v85
  v_cvt_pk_bf16_f32 v83, v86, v87
  v_cvt_pk_bf16_f32 v84, v88, v89
  v_cvt_pk_bf16_f32 v85, v90, v91
  v_cvt_pk_bf16_f32 v86, v92, v93
  v_cvt_pk_bf16_f32 v87, v94, v95
  buffer_store_dwordx4 v[80:83], v128, s[36:39], s55 offen offset:2048 sc1
  buffer_store_dwordx4 v[84:87], v128, s[36:39], s55 offen offset:3072 sc1
  s_add_u32 s55, s54, 4096
  v_pk_mul_f32 v[96:97], v[96:97], v[132:133] op_sel_hi:[1,0]
  v_pk_mul_f32 v[98:99], v[98:99], v[132:133] op_sel_hi:[1,0]
  v_pk_mul_f32 v[100:101], v[100:101], v[132:133] op_sel_hi:[1,0]
  v_pk_mul_f32 v[102:103], v[102:103], v[132:133] op_sel_hi:[1,0]
  v_pk_mul_f32 v[104:105], v[104:105], v[132:133] op_sel_hi:[1,0]
  v_pk_mul_f32 v[106:107], v[106:107], v[132:133] op_sel_hi:[1,0]
  v_pk_mul_f32 v[108:109], v[108:109], v[132:133] op_sel_hi:[1,0]
  v_pk_mul_f32 v[110:111], v[110:111], v[132:133] op_sel_hi:[1,0]
  v_cvt_pk_bf16_f32 v96, v96, v97
  v_cvt_pk_bf16_f32 v97, v98, v99
  v_cvt_pk_bf16_f32 v98, v100, v101
  v_cvt_pk_bf16_f32 v99, v102, v103
  v_cvt_pk_bf16_f32 v100, v104, v105
  v_cvt_pk_bf16_f32 v101, v106, v107
  v_cvt_pk_bf16_f32 v102, v108, v109
  v_cvt_pk_bf16_f32 v103, v110, v111
  buffer_store_dwordx4 v[96:99], v128, s[36:39], s55 offen offset:0 sc1
  buffer_store_dwordx4 v[100:103], v128, s[36:39], s55 offen offset:1024 sc1
  v_pk_mul_f32 v[112:113], v[112:113], v[132:133] op_sel_hi:[1,0]
  v_pk_mul_f32 v[114:115], v[114:115], v[132:133] op_sel_hi:[1,0]
  v_pk_mul_f32 v[116:117], v[116:117], v[132:133] op_sel_hi:[1,0]
  v_pk_mul_f32 v[118:119], v[118:119], v[132:133] op_sel_hi:[1,0]
  v_pk_mul_f32 v[120:121], v[120:121], v[132:133] op_sel_hi:[1,0]
  v_pk_mul_f32 v[122:123], v[122:123], v[132:133] op_sel_hi:[1,0]
  v_pk_mul_f32 v[124:125], v[124:125], v[132:133] op_sel_hi:[1,0]
  v_pk_mul_f32 v[126:127], v[126:127], v[132:133] op_sel_hi:[1,0]
  v_cvt_pk_bf16_f32 v112, v112, v113
  v_cvt_pk_bf16_f32 v113, v114, v115
  v_cvt_pk_bf16_f32 v114, v116, v117
  v_cvt_pk_bf16_f32 v115, v118, v119
  v_cvt_pk_bf16_f32 v116, v120, v121
  v_cvt_pk_bf16_f32 v117, v122, v123
  v_cvt_pk_bf16_f32 v118, v124, v125
  v_cvt_pk_bf16_f32 v119, v126, v127
  buffer_store_dwordx4 v[112:115], v128, s[36:39], s55 offen offset:2048 sc1
  buffer_store_dwordx4 v[116:119], v128, s[36:39], s55 offen offset:3072 sc1
  s_mov_b32 s49, s58
  s_add_u32 s69, s69, 1
  s_sub_u32 s50, s50, 1
  s_cmp_eq_u32 s50, 0
  s_cbranch_scc1 AK_end
  s_waitcnt vmcnt(8)
  s_barrier
  s_mul_i32 s55, s51, 2
  s_sub_u32 s55, s49, s55
  s_add_u32 s55, s55, 72
  s_cmp_ge_u32 s69, 2
  s_cselect_b32 s56, 1, 0
  s_cmp_lg_u32 s40, 0
  s_cbranch_scc1 Ls_71
  s_cmp_eq_u32 s56, 0
  s_cbranch_scc1 Ls_71
  s_lshl_b32 s47, s55, 7
  s_add_u32 s47, s47, 0x8a00000
  v_mov_b32 v250, s56
  s_mov_b64 exec, 1
  buffer_atomic_add v250, off, s[36:39], s47
  s_mov_b64 exec, -1
Ls_71:
  s_add_u32 s58, s49, s51
  s_cmp_le_u32 s50, 1
  s_cbranch_scc1 AK_nl1
  s_lshr_b32 s44, s58, 1
  s_or_b32 s44, s44, 3
  s_cmp_eq_u32 s44, s59
  s_cbranch_scc1 Lx_72
  s_mov_b32 s59, s44
  s_add_u32 s44, s44, 133
  s_mov_b32 s45, 0x1020
  s_mov_b32 s46, 0x1020
  s_cmp_lg_u32 s40, 0
  s_cbranch_scc1 Lw_74
  s_lshl_b32 s44, s44, 7
  s_mov_b64 exec, 15
Lw_73:
  buffer_load_dword v252, v253, s[36:39], s44 offen sc1
  s_waitcnt vmcnt(0)
  v_and_b32 v252, s45, v252
  v_cmp_gt_u32 vcc, s46, v252
  s_nop 0
  s_cbranch_vccz Lw_73x
  s_add_u32 s91, s91, 1
  s_cmp_gt_u32 s91, 0x20000
  s_cbranch_scc1 L_abort
  s_sleep 16
  s_branch Lw_73
Lw_73x:
  s_mov_b64 exec, -1
Lw_74:
  s_barrier
Lx_72:
  s_mul_i32 s52, s57, 0x86000
  s_lshl_b32 s55, s58, 13
  s_add_u32 s52, s52, s55
  s_add_u32 s55, s52, 0x0
  buffer_load_dwordx4 a[0:3], v128, s[36:39], s55 offen offset:0 sc1
  buffer_load_dwordx4 a[4:7], v128, s[36:39], s55 offen offset:1024 sc1
  buffer_load_dwordx4 a[8:11], v128, s[36:39], s55 offen offset:2048 sc1
  buffer_load_dwordx4 a[12:15], v128, s[36:39], s55 offen offset:3072 sc1
  s_add_u32 s55, s52, 0x1000
  buffer_load_dwordx4 a[16:19], v128, s[36:39], s55 offen offset:0 sc1
  buffer_load_dwordx4 a[20:23], v128, s[36:39], s55 offen offset:1024 sc1
  buffer_load_dwordx4 a[24:27], v128, s[36:39], s55 offen offset:2048 sc1
  buffer_load_dwordx4 a[28:31], v128, s[36:39], s55 offen offset:3072 sc1
  s_add_u32 s55, s52, 0x1100000
  buffer_load_dwordx4 a[32:35], v128, s[36:39], s55 offen offset:0 sc1
  buffer_load_dwordx4 a[36:39], v128, s[36:39], s55 offen offset:1024 sc1
  buffer_load_dwordx4 a[40:43], v128, s[36:39], s55 offen offset:2048 sc1
  buffer_load_dwordx4 a[44:47], v128, s[36:39], s55 offen offset:3072 sc1
  s_add_u32 s55, s52, 0x1101000
  buffer_load_dwordx4 a[48:51], v128, s[36:39], s55 offen offset:0 sc1
  buffer_load_dwordx4 a[52:55], v128, s[36:39], s55 offen offset:1024 sc1
  buffer_load_dwordx4 a[56:59], v128, s[36:39], s55 offen offset:2048 sc1
  buffer_load_dwordx4 a[60:63], v128, s[36:39], s55 offen offset:3072 sc1
  s_add_u32 s55, s52, 0x2200000
  buffer_load_dwordx4 a[64:67], v128, s[36:39], s55 offen offset:0 sc1
  buffer_load_dwordx4 a[68:71], v128, s[36:39], s55 offen offset:1024 sc1
  buffer_load_dwordx4 a[72:75], v128, s[36:39], s55 offen offset:2048 sc1
  buffer_load_dwordx4 a[76:79], v128, s[36:39], s55 offen offset:3072 sc1
  s_add_u32 s55, s52, 0x2201000
  buffer_load_dwordx4 a[80:83], v128, s[36:39], s55 offen offset:0 sc1
  buffer_load_dwordx4 a[84:87], v128, s[36:39], s55 offen offset:1024 sc1
  buffer_load_dwordx4 a[88:91], v128, s[36:39], s55 offen offset:2048 sc1
  buffer_load_dwordx4 a[92:95], v128, s[36:39], s55 offen offset:3072 sc1
  s_mul_i32 s53, s57, 0x41000
  s_lshl_b32 s55, s58, 12
  s_add_u32 s53, s53, s55
  s_add_u32 s55, s53, 0x6800000
  buffer_load_dwordx4 a[96:99], v129, s[36:39], s55 offen offset:0 sc1
  buffer_load_dwordx4 a[100:103], v129, s[36:39], s55 offen offset:512 sc1
  buffer_load_dwordx4 a[104:107], v129, s[36:39], s55 offen offset:1024 sc1
  buffer_load_dwordx4 a[108:111], v129, s[36:39], s55 offen offset:1536 sc1
  buffer_load_dwordx4 a[112:115], v129, s[36:39], s55 offen offset:2048 sc1
  buffer_load_dwordx4 a[116:119], v129, s[36:39], s55 offen offset:2560 sc1
  buffer_load_dwordx4 a[120:123], v129, s[36:39], s55 offen offset:3072 sc1
  buffer_load_dwordx4 a[124:127], v129, s[36:39], s55 offen offset:3584 sc1
  s_add_u32 s55, s53, 0x6801000
  buffer_load_dword v0, v130, s[36:39], s55 offen offset:0 sc1
  buffer_load_dword v1, v130, s[36:39], s55 offen offset:256 sc1
  buffer_load_dword v4, v130, s[36:39], s55 offen offset:1024 sc1
  buffer_load_dword v5, v130, s[36:39], s55 offen offset:1280 sc1
  buffer_load_dword v8, v130, s[36:39], s55 offen offset:2048 sc1
  buffer_load_dword v9, v130, s[36:39], s55 offen offset:2304 sc1
  buffer_load_dword v12, v130, s[36:39], s55 offen offset:3072 sc1
  buffer_load_dword v13, v130, s[36:39], s55 offen offset:3328 sc1
AK_nl1:
  s_mul_i32 s54, s49, 262144
  s_lshl_b32 s56, s57, 13
  s_add_u32 s54, s54, s56
  s_add_u32 s54, s54, 0x8c00000
  v_mfma_f32_32x32x16_bf16 v[32:47], a[160:163], a[128:131], 0
  v_mfma_f32_32x32x16_bf16 v[32:47], a[164:167], a[132:135], v[32:47]
  v_mfma_f32_32x32x16_bf16 v[32:47], a[168:171], a[136:139], v[32:47]
  v_mfma_f32_32x32x16_bf16 v[32:47], a[172:175], a[140:143], v[32:47]
  v_mfma_f32_32x32x16_bf16 v[32:47], a[176:179], a[144:147], v[32:47]
  v_mfma_f32_32x32x16_bf16 v[32:47], a[180:183], a[148:151], v[32:47]
  v_mfma_f32_32x32x16_bf16 v[32:47], a[184:187], a[152:155], v[32:47]
  v_mfma_f32_32x32x16_bf16 v[32:47], a[188:191], a[156:159], v[32:47]
  v_mov_b32 v134, 0xf149f2ca
  v_cmp_gt_i32 s[60:61], 0, v131
  v_cmp_gt_i32 s[62:63], 1, v131
  v_cmp_gt_i32 s[64:65], 2, v131
  v_cmp_gt_i32 s[66:67], 3, v131
  s_nop 6
  v_cndmask_b32 v32, v32, v134, s[60:61]
  v_cmp_gt_i32 s[60:61], 8, v131
  v_cndmask_b32 v33, v33, v134, s[62:63]
  v_cmp_gt_i32 s[62:63], 9, v131
  v_cndmask_b32 v34, v34, v134, s[64:65]
  v_cmp_gt_i32 s[64:65], 10, v131
  v_cndmask_b32 v35, v35, v134, s[66:67]
  v_cmp_gt_i32 s[66:67], 11, v131
  v_cndmask_b32 v36, v36, v134, s[60:61]
  v_cmp_gt_i32 s[60:61], 16, v131
  v_cndmask_b32 v37, v37, v134, s[62:63]
  v_cmp_gt_i32 s[62:63], 17, v131
  v_cndmask_b32 v38, v38, v134, s[64:65]
  v_cmp_gt_i32 s[64:65], 18, v131
  v_cndmask_b32 v39, v39, v134, s[66:67]
  v_cmp_gt_i32 s[66:67], 19, v131
  v_cndmask_b32 v40, v40, v134, s[60:61]
  v_cmp_gt_i32 s[60:61], 24, v131
  v_cndmask_b32 v41, v41, v134, s[62:63]
  v_cmp_gt_i32 s[62:63], 25, v131
  v_cndmask_b32 v42, v42, v134, s[64:65]
  v_cmp_gt_i32 s[64:65], 26, v131
  v_cndmask_b32 v43, v43, v134, s[66:67]
  v_cmp_gt_i32 s[66:67], 27, v131
  v_cndmask_b32 v44, v44, v134, s[60:61]
  v_cndmask_b32 v45, v45, v134, s[62:63]
  v_cndmask_b32 v46, v46, v134, s[64:65]
  v_cndmask_b32 v47, v47, v134, s[66:67]
  v_max_f32 v132, v32, v33
  v_max3_f32 v132, v132, v34, v35
  v_max3_f32 v132, v132, v36, v37
  v_max3_f32 v132, v132, v38, v39
  v_max3_f32 v132, v132, v40, v41
  v_max3_f32 v132, v132, v42, v43
  v_max3_f32 v132, v132, v44, v45
  v_max3_f32 v132, v132, v46, v47
  v_mfma_f32_32x32x16_bf16 v[48:63], a[224:227], a[128:131], 0
  v_mfma_f32_32x32x16_bf16 v[48:63], a[228:231], a[132:135], v[48:63]
  v_mfma_f32_32x32x16_bf16 v[48:63], a[232:235], a[136:139], v[48:63]
  v_mfma_f32_32x32x16_bf16 v[48:63], a[236:239], a[140:143], v[48:63]
  v_mfma_f32_32x32x16_bf16 v[48:63], a[240:243], a[144:147], v[48:63]
  v_mfma_f32_32x32x16_bf16 v[48:63], a[244:247], a[148:151], v[48:63]
  v_mfma_f32_32x32x16_bf16 v[48:63], a[248:251], a[152:155], v[48:63]
  v_mfma_f32_32x32x16_bf16 v[48:63], a[252:255], a[156:159], v[48:63]
  s_nop 11
  v_max3_f32 v132, v132, v48, v49
  v_max3_f32 v132, v132, v50, v51
  v_mov_b32 v133, v132
  s_nop 1
  v_permlane32_swap_b32 v132, v133
  v_max_f32 v132, v132, v133
  v_sub_f32 v32, v32, v132
  v_sub_f32 v33, v33, v132
  v_sub_f32 v34, v34, v132
  v_sub_f32 v35, v35, v132
  v_sub_f32 v36, v36, v132
  v_sub_f32 v37, v37, v132
  v_sub_f32 v38, v38, v132
  v_sub_f32 v39, v39, v132
  v_sub_f32 v40, v40, v132
  v_sub_f32 v41, v41, v132
  v_sub_f32 v42, v42, v132
  v_sub_f32 v43, v43, v132
  v_sub_f32 v44, v44, v132
  v_sub_f32 v45, v45, v132
  v_sub_f32 v46, v46, v132
  v_sub_f32 v47, v47, v132
  v_sub_f32 v48, v48, v132
  v_sub_f32 v49, v49, v132
  v_sub_f32 v50, v50, v132
  v_sub_f32 v51, v51, v132
  v_exp_f32 v32, v32
  v_exp_f32 v33, v33
  v_exp_f32 v34, v34
  v_exp_f32 v35, v35
  v_exp_f32 v36, v36
  v_exp_f32 v37, v37
  v_exp_f32 v38, v38
  v_exp_f32 v39, v39
  v_exp_f32 v40, v40
  v_exp_f32 v41, v41
  v_exp_f32 v42, v42
  v_exp_f32 v43, v43
  v_exp_f32 v44, v44
  v_exp_f32 v45, v45
  v_exp_f32 v46, v46
  v_exp_f32 v47, v47
  v_exp_f32 v48, v48
  v_exp_f32 v49, v49
  v_exp_f32 v50, v50
  v_exp_f32 v51, v51
  v_add_f32 v132, v32, v33
  v_add_f32 v132, v132, v34
  v_add_f32 v132, v132, v35
  v_add_f32 v132, v132, v36
  v_add_f32 v132, v132, v37
  v_add_f32 v132, v132, v38
  v_add_f32 v132, v132, v39
  v_add_f32 v132, v132, v40
  v_add_f32 v132, v132, v41
  v_add_f32 v132, v132, v42
  v_add_f32 v132, v132, v43
  v_add_f32 v132, v132, v44
  v_add_f32 v132, v132, v45
  v_add_f32 v132, v132, v46
  v_add_f32 v132, v132, v47
  v_add_f32 v132, v132, v48
  v_add_f32 v132, v132, v49
  v_add_f32 v132, v132, v50
  v_add_f32 v132, v132, v51
  v_cvt_pk_bf16_f32 v32, v32, v33
  v_cvt_pk_bf16_f32 v33, v34, v35
  v_cvt_pk_bf16_f32 v34, v36, v37
  v_cvt_pk_bf16_f32 v35, v38, v39
  v_cvt_pk_bf16_f32 v36, v40, v41
  v_cvt_pk_bf16_f32 v37, v42, v43
  v_cvt_pk_bf16_f32 v38, v44, v45
  v_cvt_pk_bf16_f32 v39, v46, v47
  v_cvt_pk_bf16_f32 v48, v48, v49
  v_cvt_pk_bf16_f32 v49, v50, v51
  v_mov_b64 v[50:51], 0
  s_nop 1
  v_mfma_f32_32x32x16_bf16 v[64:79], v[16:19], v[48:51], 0
  v_mfma_f32_32x32x16_bf16 v[80:95], v[20:23], v[48:51], 0
  v_mfma_f32_32x32x16_bf16 v[96:111], v[24:27], v[48:51], 0
  v_mfma_f32_32x32x16_bf16 v[112:127], v[28:31], v[48:51], 0
  v_mov_b32 v133, v132
  s_nop 1
  v_permlane32_swap_b32 v132, v133
  v_add_f32 v132, v132, v133
  v_rcp_f32 v132, v132
  v_mfma_f32_32x32x16_bf16 v[64:79], a[192:195], v[32:35], v[64:79]
  v_mfma_f32_32x32x16_bf16 v[64:79], a[196:199], v[36:39], v[64:79]
  v_mfma_f32_32x32x16_bf16 v[80:95], a[200:203], v[32:35], v[80:95]
  v_mfma_f32_32x32x16_bf16 v[80:95], a[204:207], v[36:39], v[80:95]
  v_mfma_f32_32x32x16_bf16 v[96:111], a[208:211], v[32:35], v[96:111]
  v_mfma_f32_32x32x16_bf16 v[96:111], a[212:215], v[36:39], v[96:111]
  v_mfma_f32_32x32x16_bf16 v[112:127], a[216:219], v[32:35], v[112:127]
  v_mfma_f32_32x32x16_bf16 v[112:127], a[220:223], v[36:39], v[112:127]
  s_add_u32 s55, s54, 0
  v_pk_mul_f32 v[64:65], v[64:65], v[132:133] op_sel_hi:[1,0]
  v_pk_mul_f32 v[66:67], v[66:67], v[132:133] op_sel_hi:[1,0]
  v_pk_mul_f32 v[68:69], v[68:69], v[132:133] op_sel_hi:[1,0]
  v_pk_mul_f32 v[70:71], v[70:71], v[132:133] op_sel_hi:[1,0]
  v_pk_mul_f32 v[72:73], v[72:73], v[132:133] op_sel_hi:[1,0]
  v_pk_mul_f32 v[74:75], v[74:75], v[132:133] op_sel_hi:[1,0]
  v_pk_mul_f32 v[76:77], v[76:77], v[132:133] op_sel_hi:[1,0]
  v_pk_mul_f32 v[78:79], v[78:79], v[132:133] op_sel_hi:[1,0]
  v_cvt_pk_bf16_f32 v64, v64, v65
  v_cvt_pk_bf16_f32 v65, v66, v67
  v_cvt_pk_bf16_f32 v66, v68, v69
  v_cvt_pk_bf16_f32 v67, v70, v71
  v_cvt_pk_bf16_f32 v68, v72, v73
  v_cvt_pk_bf16_f32 v69, v74, v75
  v_cvt_pk_bf16_f32 v70, v76, v77
  v_cvt_pk_bf16_f32 v71, v78, v79
  buffer_store_dwordx4 v[64:67], v128, s[36:39], s55 offen offset:0 sc1
  buffer_store_dwordx4 v[68:71], v128, s[36:39], s55 offen offset:1024 sc1
  v_pk_mul_f32 v[80:81], v[80:81], v[132:133] op_sel_hi:[1,0]
  v_pk_mul_f32 v[82:83], v[82:83], v[132:133] op_sel_hi:[1,0]
  v_pk_mul_f32 v[84:85], v[84:85], v[132:133] op_sel_hi:[1,0]
  v_pk_mul_f32 v[86:87], v[86:87], v[132:133] op_sel_hi:[1,0]
  v_pk_mul_f32 v[88:89], v[88:89], v[132:133] op_sel_hi:[1,0]
  v_pk_mul_f32 v[90:91], v[90:91], v[132:133] op_sel_hi:[1,0]
  v_pk_mul_f32 v[92:93], v[92:93], v[132:133] op_sel_hi:[1,0]
  v_pk_mul_f32 v[94:95], v[94:95], v[132:133] op_sel_hi:[1,0]
  v_cvt_pk_bf16_f32 v80, v80, v81
  v_cvt_pk_bf16_f32 v81, v82, v83
  v_cvt_pk_bf16_f32 v82, v84, v85
  v_cvt_pk_bf16_f32 v83, v86, v87
  v_cvt_pk_bf16_f32 v84, v88, v89
  v_cvt_pk_bf16_f32 v85, v90, v91
  v_cvt_pk_bf16_f32 v86, v92, v93
  v_cvt_pk_bf16_f32 v87, v94, v95
  buffer_store_dwordx4 v[80:83], v128, s[36:39], s55 offen offset:2048 sc1
  buffer_store_dwordx4 v[84:87], v128, s[36:39], s55 offen offset:3072 sc1
  s_add_u32 s55, s54, 4096
  v_pk_mul_f32 v[96:97], v[96:97], v[132:133] op_sel_hi:[1,0]
  v_pk_mul_f32 v[98:99], v[98:99], v[132:133] op_sel_hi:[1,0]
  v_pk_mul_f32 v[100:101], v[100:101], v[132:133] op_sel_hi:[1,0]
  v_pk_mul_f32 v[102:103], v[102:103], v[132:133] op_sel_hi:[1,0]
  v_pk_mul_f32 v[104:105], v[104:105], v[132:133] op_sel_hi:[1,0]
  v_pk_mul_f32 v[106:107], v[106:107], v[132:133] op_sel_hi:[1,0]
  v_pk_mul_f32 v[108:109], v[108:109], v[132:133] op_sel_hi:[1,0]
  v_pk_mul_f32 v[110:111], v[110:111], v[132:133] op_sel_hi:[1,0]
  v_cvt_pk_bf16_f32 v96, v96, v97
  v_cvt_pk_bf16_f32 v97, v98, v99
  v_cvt_pk_bf16_f32 v98, v100, v101
  v_cvt_pk_bf16_f32 v99, v102, v103
  v_cvt_pk_bf16_f32 v100, v104, v105
  v_cvt_pk_bf16_f32 v101, v106, v107
  v_cvt_pk_bf16_f32 v102, v108, v109
  v_cvt_pk_bf16_f32 v103, v110, v111
  buffer_store_dwordx4 v[96:99], v128, s[36:39], s55 offen offset:0 sc1
  buffer_store_dwordx4 v[100:103], v128, s[36:39], s55 offen offset:1024 sc1
  v_pk_mul_f32 v[112:113], v[112:113], v[132:133] op_sel_hi:[1,0]
  v_pk_mul_f32 v[114:115], v[114:115], v[132:133] op_sel_hi:[1,0]
  v_pk_mul_f32 v[116:117], v[116:117], v[132:133] op_sel_hi:[1,0]
  v_pk_mul_f32 v[118:119], v[118:119], v[132:133] op_sel_hi:[1,0]
  v_pk_mul_f32 v[120:121], v[120:121], v[132:133] op_sel_hi:[1,0]
  v_pk_mul_f32 v[122:123], v[122:123], v[132:133] op_sel_hi:[1,0]
  v_pk_mul_f32 v[124:125], v[124:125], v[132:133] op_sel_hi:[1,0]
  v_pk_mul_f32 v[126:127], v[126:127], v[132:133] op_sel_hi:[1,0]
  v_cvt_pk_bf16_f32 v112, v112, v113
  v_cvt_pk_bf16_f32 v113, v114, v115
  v_cvt_pk_bf16_f32 v114, v116, v117
  v_cvt_pk_bf16_f32 v115, v118, v119
  v_cvt_pk_bf16_f32 v116, v120, v121
  v_cvt_pk_bf16_f32 v117, v122, v123
  v_cvt_pk_bf16_f32 v118, v124, v125
  v_cvt_pk_bf16_f32 v119, v126, v127
  buffer_store_dwordx4 v[112:115], v128, s[36:39], s55 offen offset:2048 sc1
  buffer_store_dwordx4 v[116:119], v128, s[36:39], s55 offen offset:3072 sc1
  s_mov_b32 s49, s58
  s_add_u32 s69, s69, 1
  s_sub_u32 s50, s50, 1
  s_cmp_eq_u32 s50, 0
  s_cbranch_scc1 AK_end
  s_branch AK_loop
AK_end:
  s_waitcnt vmcnt(0)
  s_barrier
  s_mul_i32 s55, s51, 2
  s_sub_u32 s55, s49, s55
  s_add_u32 s55, s55, 72
  s_cmp_ge_u32 s69, 2
  s_cselect_b32 s56, 1, 0
  s_cmp_lg_u32 s40, 0
  s_cbranch_scc1 Ls_75
  s_cmp_eq_u32 s56, 0
  s_cbranch_scc1 Ls_75
  s_lshl_b32 s47, s55, 7
  s_add_u32 s47, s47, 0x8a00000
  v_mov_b32 v250, s56
  s_mov_b64 exec, 1
  buffer_atomic_add v250, off, s[36:39], s47
  s_mov_b64 exec, -1
Ls_75:
  s_mul_i32 s55, s51, 1
  s_sub_u32 s55, s49, s55
  s_add_u32 s55, s55, 72
  s_cmp_ge_u32 s69, 1
  s_cselect_b32 s56, 1, 0
  s_cmp_lg_u32 s40, 0
  s_cbranch_scc1 Ls_76
  s_cmp_eq_u32 s56, 0
  s_cbranch_scc1 Ls_76
  s_lshl_b32 s47, s55, 7
  s_add_u32 s47, s47, 0x8a00000
  v_mov_b32 v250, s56
  s_mov_b64 exec, 1
  buffer_atomic_add v250, off, s[36:39], s47
  s_mov_b64 exec, -1
Ls_76:
  s_mov_b32 s81, 7
  s_mov_b32 s82, 0
  s_branch L_jobend
L_oproj:
  s_bfe_u32 s58, s90, 0x10003
  s_bfe_u32 s56, s90, 0x40004
  s_bfe_u32 s57, s90, 0x20008
  s_lshl_b32 s61, s40, 12
  v_lshlrev_b32 v128, 4, v255
  v_lshrrev_b32 v144, 4, v255
  v_lshlrev_b32 v145, 2, v144
  v_and_b32 v129, 15, v255
  v_xor_b32 v129, v129, v145
  v_lshlrev_b32 v129, 4, v129
  v_lshl_add_u32 v129, v144, 10, v129
  v_add_u32 v130, 3072, v129
  v_add_u32 v131, 6144, v129
  v_add_u32 v132, 9216, v129
  v_bfe_u32 v144, v255, 2, 2
  v_lshlrev_b32 v145, 6, v144
  v_lshl_add_u32 v145, v144, 8, v145
  v_lshrrev_b32 v144, 5, v255
  v_lshl_add_u32 v145, v144, 10, v145
  v_bfe_u32 v144, v255, 4, 1
  v_lshl_add_u32 v145, v144, 5, v145
  v_and_b32 v144, 3, v255
  v_lshl_add_u32 v133, v144, 3, v145
  v_xor_b32 v134, 64, v133
  v_xor_b32 v135, 128, v133
  v_xor_b32 v136, 192, v133
  v_add_u32 v137, 0x10000, v133
  v_add_u32 v138, 0x10000, v134
  v_add_u32 v139, 0x10000, v135
  v_add_u32 v140, 0x10000, v136
  v_and_b32 v144, 31, v255
  v_lshlrev_b32 v144, 11, v144
  v_lshrrev_b32 v145, 5, v255
  v_lshl_add_u32 v144, v145, 4, v144
  s_lshl_b32 s63, s40, 16
  v_add_u32 v141, s63, v144
  s_mov_b32 s52, s30
  s_and_b32 s53, s31, 0xffff
  s_mov_b32 s54, 0x400000
  s_mov_b32 s55, 0x20000
  s_mov_b32 s48, s14
  s_and_b32 s49, s15, 0xffff
  s_mov_b32 s50, 0x400000
  s_mov_b32 s51, 0x20000
  s_mov_b32 s45, 0xff
  s_cmp_eq_u32 s58, 0
  s_cbranch_scc1 L_opA
  s_lshr_b32 s44, s56, 1
  s_add_u32 s44, s44, 64
  s_mov_b32 s46, 32
  s_cmp_lg_u32 s40, 0
  s_cbranch_scc1 Lw_78
  s_lshl_b32 s44, s44, 7
  s_mov_b64 exec, 1
Lw_77:
  buffer_load_dword v252, v253, s[36:39], s44 offen sc1
  s_waitcnt vmcnt(0)
  v_and_b32 v252, s45, v252
  v_cmp_gt_u32 vcc, s46, v252
  s_nop 0
  s_cbranch_vccz Lw_77x
  s_add_u32 s91, s91, 1
  s_cmp_gt_u32 s91, 0x20000
  s_cbranch_scc1 L_abort
  s_sleep 16
  s_branch Lw_77
Lw_77x:
  s_mov_b64 exec, -1
Lw_78:
  s_branch L_opgo
L_opA:
  s_lshl_b32 s44, s56, 2
  s_add_u32 s44, s44, 72
  s_mov_b32 s46, 8
  s_cmp_lg_u32 s40, 0
  s_cbranch_scc1 Lw_80
  s_lshl_b32 s44, s44, 7
  s_mov_b64 exec, 15
Lw_79:
  buffer_load_dword v252, v253, s[36:39], s44 offen sc1
  s_waitcnt vmcnt(0)
  v_and_b32 v252, s45, v252
  v_cmp_gt_u32 vcc, s46, v252
  s_nop 0
  s_cbranch_vccz Lw_79x
  s_add_u32 s91, s91, 1
  s_cmp_gt_u32 s91, 0x20000
  s_cbranch_scc1 L_abort
  s_sleep 16
  s_branch Lw_79
Lw_79x:
  s_mov_b64 exec, -1
Lw_80:
L_opgo:
  s_bitcmp1_b32 s90, 11
  s_cbranch_scc1 L_oph
  s_mov_b32 s59, 0xa000000
  s_cmp_eq_u32 s58, 0
  s_cselect_b64 s[48:49], s[14:15], s[28:29]
  s_cselect_b32 s59, 0x8c00000, s59
  s_and_b32 s49, s49, 0xffff
  s_lshl_b32 s63, s56, 2
  s_add_u32 s63, s63, s40
  s_mul_i32 s63, s63, 262144
  s_add_u32 s59, s59, s63
  s_lshl_b32 s60, s40, 14
  s_lshl_b32 s63, s57, 8
  s_add_u32 s60, s60, s63
  s_mov_b32 s62, 0
  s_and_b32 s68, s57, 0
  s_and_b32 s63, s56, 0
  s_xor_b32 s68, s68, s63
  s_mov_b32 s66, s59
  s_mov_b32 s67, s60
  s_lshl_b32 s63, s68, 15
  s_add_u32 s59, s59, s63
  s_lshl_b32 s63, s68, 19
  s_add_u32 s60, s60, s63
  s_barrier
  s_add_u32 m0, s61, 0
  buffer_load_dwordx4 a[0:3], v128, s[36:39], s59 offen offset:0 sc1
  buffer_load_dwordx4 a[4:7], v128, s[36:39], s59 offen offset:1024 sc1
  buffer_load_dwordx4 a[8:11], v128, s[36:39], s59 offen offset:2048 sc1
  buffer_load_dwordx4 a[12:15], v128, s[36:39], s59 offen offset:3072 sc1
  s_add_u32 s59, s59, 4096
  buffer_load_dwordx4 v129, s[48:51], s60 offen offset:0  lds
  buffer_load_dwordx4 v130, s[48:51], s60 offen offset:1024  lds
  buffer_load_dwordx4 v131, s[48:51], s60 offen offset:2048  lds
  buffer_load_dwordx4 v132, s[48:51], s60 offen offset:3072  lds
  s_add_u32 s60, s60, 65536
  s_add_u32 m0, s61, 16384
  buffer_load_dwordx4 a[16:19], v128, s[36:39], s59 offen offset:0 sc1
  buffer_load_dwordx4 a[20:23], v128, s[36:39], s59 offen offset:1024 sc1
  buffer_load_dwordx4 a[24:27], v128, s[36:39], s59 offen offset:2048 sc1
  buffer_load_dwordx4 a[28:31], v128, s[36:39], s59 offen offset:3072 sc1
  s_add_u32 s59, s59, 4096
  buffer_load_dwordx4 v129, s[48:51], s60 offen offset:0  lds
  buffer_load_dwordx4 v130, s[48:51], s60 offen offset:1024  lds
  buffer_load_dwordx4 v131, s[48:51], s60 offen offset:2048  lds
  buffer_load_dwordx4 v132, s[48:51], s60 offen offset:3072  lds
  s_add_u32 s60, s60, 65536
  s_add_u32 m0, s61, 32768
  buffer_load_dwordx4 a[32:35], v128, s[36:39], s59 offen offset:0 sc1
  buffer_load_dwordx4 a[36:39], v128, s[36:39], s59 offen offset:1024 sc1
  buffer_load_dwordx4 a[40:43], v128, s[36:39], s59 offen offset:2048 sc1
  buffer_load_dwordx4 a[44:47], v128, s[36:39], s59 offen offset:3072 sc1
  s_add_u32 s59, s59, 4096
  buffer_load_dwordx4 v129, s[48:51], s60 offen offset:0  lds
  buffer_load_dwordx4 v130, s[48:51], s60 offen offset:1024  lds
  buffer_load_dwordx4 v131, s[48:51], s60 offen offset:2048  lds
  buffer_load_dwordx4 v132, s[48:51], s60 offen offset:3072  lds
  s_add_u32 s60, s60, 65536
  s_add_u32 m0, s61, 49152
  buffer_load_dwordx4 a[48:51], v128, s[36:39], s59 offen offset:0 sc1
  buffer_load_dwordx4 a[52:55], v128, s[36:39], s59 offen offset:1024 sc1
  buffer_load_dwordx4 a[56:59], v128, s[36:39], s59 offen offset:2048 sc1
  buffer_load_dwordx4 a[60:63], v128, s[36:39], s59 offen offset:3072 sc1
  s_add_u32 s59, s59, 4096
  buffer_load_dwordx4 v129, s[48:51], s60 offen offset:0  lds
  buffer_load_dwordx4 v130, s[48:51], s60 offen offset:1024  lds
  buffer_load_dwordx4 v131, s[48:51], s60 offen offset:2048  lds
  buffer_load_dwordx4 v132, s[48:51], s60 offen offset:3072  lds
  s_add_u32 s60, s60, 65536
  s_add_u32 m0, s61, 65536
  buffer_load_dwordx4 a[64:67], v128, s[36:39], s59 offen offset:0 sc1
  buffer_load_dwordx4 a[68:71], v128, s[36:39], s59 offen offset:1024 sc1
  buffer_load_dwordx4 a[72:75], v128, s[36:39], s59 offen offset:2048 sc1
  buffer_load_dwordx4 a[76:79], v128, s[36:39], s59 offen offset:3072 sc1
  s_add_u32 s59, s59, 4096
  buffer_load_dwordx4 v129, s[48:51], s60 offen offset:0  lds
  buffer_load_dwordx4 v130, s[48:51], s60 offen offset:1024  lds
  buffer_load_dwordx4 v131, s[48:51], s60 offen offset:2048  lds
  buffer_load_dwordx4 v132, s[48:51], s60 offen offset:3072  lds
  s_add_u32 s60, s60, 65536
  s_add_u32 m0, s61, 81920
  buffer_load_dwordx4 a[80:83], v128, s[36:39], s59 offen offset:0 sc1
  buffer_load_dwordx4 a[84:87], v128, s[36:39], s59 offen offset:1024 sc1
  buffer_load_dwordx4 a[88:91], v128, s[36:39], s59 offen offset:2048 sc1
  buffer_load_dwordx4 a[92:95], v128, s[36:39], s59 offen offset:3072 sc1
  s_add_u32 s59, s59, 4096
  buffer_load_dwordx4 v129, s[48:51], s60 offen offset:0  lds
  buffer_load_dwordx4 v130, s[48:51], s60 offen offset:1024  lds
  buffer_load_dwordx4 v131, s[48:51], s60 offen offset:2048  lds
  buffer_load_dwordx4 v132, s[48:51], s60 offen offset:3072  lds
  s_add_u32 s60, s60, 65536
  s_add_u32 m0, s61, 98304
  buffer_load_dwordx4 a[96:99], v128, s[36:39], s59 offen offset:0 sc1
  buffer_load_dwordx4 a[100:103], v128, s[36:39], s59 offen offset:1024 sc1
  v_mov_b64 v[0:1], 0
  v_mov_b64 v[2:3], 0
  v_mov_b64 v[4:5], 0
  v_mov_b64 v[6:7], 0
  v_mov_b64 v[8:9], 0
  v_mov_b64 v[10:11], 0
  v_mov_b64 v[12:13], 0
  v_mov_b64 v[14:15], 0
  v_mov_b64 v[16:17], 0
  v_mov_b64 v[18:19], 0
  v_mov_b64 v[20:21], 0
  v_mov_b64 v[22:23], 0
  v_mov_b64 v[24:25], 0
  v_mov_b64 v[26:27], 0
  v_mov_b64 v[28:29], 0
  v_mov_b64 v[30:31], 0
  v_mov_b64 v[32:33], 0
  v_mov_b64 v[34:35], 0
  v_mov_b64 v[36:37], 0
  v_mov_b64 v[38:39], 0
  v_mov_b64 v[40:41], 0
  v_mov_b64 v[42:43], 0
  v_mov_b64 v[44:45], 0
  v_mov_b64 v[46:47], 0
  v_mov_b64 v[48:49], 0
  v_mov_b64 v[50:51], 0
  v_mov_b64 v[52:53], 0
  v_mov_b64 v[54:55], 0
  v_mov_b64 v[56:57], 0
  v_mov_b64 v[58:59], 0
  v_mov_b64 v[60:61], 0
  v_mov_b64 v[62:63], 0
  s_waitcnt vmcnt(42)
  s_barrier
  ds_read_b64_tr_b16 v[64:65], v133 offset:0
  ds_read_b64_tr_b16 v[66:67], v133 offset:2048
  ds_read_b64_tr_b16 v[68:69], v134 offset:0
  ds_read_b64_tr_b16 v[70:71], v134 offset:2048
  ds_read_b64_tr_b16 v[72:73], v135 offset:0
  ds_read_b64_tr_b16 v[74:75], v135 offset:2048
  ds_read_b64_tr_b16 v[76:77], v136 offset:0
  ds_read_b64_tr_b16 v[78:79], v136 offset:2048
OP_loop:
  s_waitcnt lgkmcnt(6)
  v_mfma_f32_32x32x16_bf16 v[0:15], v[64:67], a[0:3], v[0:15]
  ds_read_b64_tr_b16 v[80:81], v133 offset:4096
  ds_read_b64_tr_b16 v[82:83], v133 offset:6144
  buffer_load_dwordx4 a[104:107], v128, s[36:39], s59 offen offset:2048 sc1
  s_waitcnt lgkmcnt(6)
  v_mfma_f32_32x32x16_bf16 v[16:31], v[68:71], a[0:3], v[16:31]
  ds_read_b64_tr_b16 v[84:85], v134 offset:4096
  ds_read_b64_tr_b16 v[86:87], v134 offset:6144
  s_waitcnt lgkmcnt(6)
  v_mfma_f32_32x32x16_bf16 v[32:47], v[72:75], a[0:3], v[32:47]
  ds_read_b64_tr_b16 v[88:89], v135 offset:4096
  ds_read_b64_tr_b16 v[90:91], v135 offset:6144
  buffer_load_dwordx4 a[108:111], v128, s[36:39], s59 offen offset:3072 sc1
  s_add_u32 s59, s59, 4096
  s_waitcnt lgkmcnt(6)
  v_mfma_f32_32x32x16_bf16 v[48:63], v[76:79], a[0:3], v[48:63]
  ds_read_b64_tr_b16 v[92:93], v136 offset:4096
  ds_read_b64_tr_b16 v[94:95], v136 offset:6144
  s_waitcnt lgkmcnt(6)
  v_mfma_f32_32x32x16_bf16 v[0:15], v[80:83], a[4:7], v[0:15]
  ds_read_b64_tr_b16 v[96:97], v133 offset:8192
  ds_read_b64_tr_b16 v[98:99], v133 offset:10240
  buffer_load_dwordx4 v129, s[48:51], s60 offen offset:0  lds
  s_waitcnt lgkmcnt(6)
  v_mfma_f32_32x32x16_bf16 v[16:31], v[84:87], a[4:7], v[16:31]
  ds_read_b64_tr_b16 v[100:101], v134 offset:8192
  ds_read_b64_tr_b16 v[102:103], v134 offset:10240
  s_waitcnt lgkmcnt(6)
  v_mfma_f32_32x32x16_bf16 v[32:47], v[88:91], a[4:7], v[32:47]
  ds_read_b64_tr_b16 v[104:105], v135 offset:8192
  ds_read_b64_tr_b16 v[106:107], v135 offset:10240
  buffer_load_dwordx4 v130, s[48:51], s60 offen offset:1024  lds
  s_waitcnt lgkmcnt(6)
  v_mfma_f32_32x32x16_bf16 v[48:63], v[92:95], a[4:7], v[48:63]
  ds_read_b64_tr_b16 v[108:109], v136 offset:8192
  ds_read_b64_tr_b16 v[110:111], v136 offset:10240
  s_waitcnt lgkmcnt(6)
  v_mfma_f32_32x32x16_bf16 v[0:15], v[96:99], a[8:11], v[0:15]
  ds_read_b64_tr_b16 v[112:113], v133 offset:12288
  ds_read_b64_tr_b16 v[114:115], v133 offset:14336
  buffer_load_dwordx4 v131, s[48:51], s60 offen offset:2048  lds
  s_waitcnt lgkmcnt(6)
  v_mfma_f32_32x32x16_bf16 v[16:31], v[100:103], a[8:11], v[16:31]
  ds_read_b64_tr_b16 v[116:117], v134 offset:12288
  ds_read_b64_tr_b16 v[118:119], v134 offset:14336
  s_waitcnt lgkmcnt(6)
  v_mfma_f32_32x32x16_bf16 v[32:47], v[104:107], a[8:11], v[32:47]
  ds_read_b64_tr_b16 v[120:121], v135 offset:12288
  ds_read_b64_tr_b16 v[122:123], v135 offset:14336
  buffer_load_dwordx4 v132, s[48:51], s60 offen offset:3072  lds
  s_add_u32 s60, s60, 65536
  s_waitcnt lgkmcnt(6)
  v_mfma_f32_32x32x16_bf16 v[48:63], v[108:111], a[8:11], v[48:63]
  ds_read_b64_tr_b16 v[124:125], v136 offset:12288
  ds_read_b64_tr_b16 v[126:127], v136 offset:14336
  s_waitcnt vmcnt(40)
  s_barrier
  s_waitcnt lgkmcnt(6)
  v_mfma_f32_32x32x16_bf16 v[0:15], v[112:115], a[12:15], v[0:15]
  ds_read_b64_tr_b16 v[64:65], v133 offset:16384
  ds_read_b64_tr_b16 v[66:67], v133 offset:18432
  s_add_u32 m0, s61, 114688
  buffer_load_dwordx4 a[112:115], v128, s[36:39], s59 offen offset:0 sc1
  s_waitcnt lgkmcnt(6)
  v_mfma_f32_32x32x16_bf16 v[16:31], v[116:119], a[12:15], v[16:31]
  ds_read_b64_tr_b16 v[68:69], v134 offset:16384
  ds_read_b64_tr_b16 v[70:71], v134 offset:18432
  s_waitcnt lgkmcnt(6)
  v_mfma_f32_32x32x16_bf16 v[32:47], v[120:123], a[12:15], v[32:47]
  ds_read_b64_tr_b16 v[72:73], v135 offset:16384
  ds_read_b64_tr_b16 v[74:75], v135 offset:18432
  buffer_load_dwordx4 a[116:119], v128, s[36:39], s59 offen offset:1024 sc1
  s_waitcnt lgkmcnt(6)
  v_mfma_f32_32x32x16_bf16 v[48:63], v[124:127], a[12:15], v[48:63]
  ds_read_b64_tr_b16 v[76:77], v136 offset:16384
  ds_read_b64_tr_b16 v[78:79], v136 offset:18432
  s_waitcnt lgkmcnt(6)
  v_mfma_f32_32x32x16_bf16 v[0:15], v[64:67], a[16:19], v[0:15]
  ds_read_b64_tr_b16 v[80:81], v133 offset:20480
  ds_read_b64_tr_b16 v[82:83], v133 offset:22528
  buffer_load_dwordx4 a[120:123], v128, s[36:39], s59 offen offset:2048 sc1
  s_waitcnt lgkmcnt(6)
  v_mfma_f32_32x32x16_bf16 v[16:31], v[68:71], a[16:19], v[16:31]
  ds_read_b64_tr_b16 v[84:85], v134 offset:20480
  ds_read_b64_tr_b16 v[86:87], v134 offset:22528
  s_waitcnt lgkmcnt(6)
  v_mfma_f32_32x32x16_bf16 v[32:47], v[72:75], a[16:19], v[32:47]
  ds_read_b64_tr_b16 v[88:89], v135 offset:20480
  ds_read_b64_tr_b16 v[90:91], v135 offset:22528
  buffer_load_dwordx4 a[124:127], v128, s[36:39], s59 offen offset:3072 sc1
  s_add_u32 s59, s59, 4096
  s_waitcnt lgkmcnt(6)
  v_mfma_f32_32x32x16_bf16 v[48:63], v[76:79], a[16:19], v[48:63]
  ds_read_b64_tr_b16 v[92:93], v136 offset:20480
  ds_read_b64_tr_b16 v[94:95], v136 offset:22528
  s_waitcnt lgkmcnt(6)
  v_mfma_f32_32x32x16_bf16 v[0:15], v[80:83], a[20:23], v[0:15]
  ds_read_b64_tr_b16 v[96:97], v133 offset:24576
  ds_read_b64_tr_b16 v[98:99], v133 offset:26624
  buffer_load_dwordx4 v129, s[48:51], s60 offen offset:0  lds
  s_waitcnt lgkmcnt(6)
  v_mfma_f32_32x32x16_bf16 v[16:31], v[84:87], a[20:23], v[16:31]
  ds_read_b64_tr_b16 v[100:101], v134 offset:24576
  ds_read_b64_tr_b16 v[102:103], v134 offset:26624
  s_waitcnt lgkmcnt(6)
  v_mfma_f32_32x32x16_bf16 v[32:47], v[88:91], a[20:23], v[32:47]
  ds_read_b64_tr_b16 v[104:105], v135 offset:24576
  ds_read_b64_tr_b16 v[106:107], v135 offset:26624
  buffer_load_dwordx4 v130, s[48:51], s60 offen offset:1024  lds
  s_waitcnt lgkmcnt(6)
  v_mfma_f32_32x32x16_bf16 v[48:63], v[92:95], a[20:23], v[48:63]
  ds_read_b64_tr_b16 v[108:109], v136 offset:24576
  ds_read_b64_tr_b16 v[110:111], v136 offset:26624
  s_waitcnt lgkmcnt(6)
  v_mfma_f32_32x32x16_bf16 v[0:15], v[96:99], a[24:27], v[0:15]
  ds_read_b64_tr_b16 v[112:113], v133 offset:28672
  ds_read_b64_tr_b16 v[114:115], v133 offset:30720
  buffer_load_dwordx4 v131, s[48:51], s60 offen offset:2048  lds
  s_waitcnt lgkmcnt(6)
  v_mfma_f32_32x32x16_bf16 v[16:31], v[100:103], a[24:27], v[16:31]
  ds_read_b64_tr_b16 v[116:117], v134 offset:28672
  ds_read_b64_tr_b16 v[118:119], v134 offset:30720
  s_waitcnt lgkmcnt(6)
  v_mfma_f32_32x32x16_bf16 v[32:47], v[104:107], a[24:27], v[32:47]
  ds_read_b64_tr_b16 v[120:121], v135 offset:28672
  ds_read_b64_tr_b16 v[122:123], v135 offset:30720
  buffer_load_dwordx4 v132, s[48:51], s60 offen offset:3072  lds
  s_add_u32 s60, s60, 65536
  s_waitcnt lgkmcnt(6)
  v_mfma_f32_32x32x16_bf16 v[48:63], v[108:111], a[24:27], v[48:63]
  ds_read_b64_tr_b16 v[124:125], v136 offset:28672
  ds_read_b64_tr_b16 v[126:127], v136 offset:30720
  s_waitcnt vmcnt(40)
  s_barrier
  s_add_u32 s63, s62, 1
  s_xor_b32 s63, s63, s68
  s_lshl_b32 s64, s63, 15
  s_add_u32 s59, s66, s64
  s_lshl_b32 s64, s63, 19
  s_add_u32 s60, s67, s64
  s_cmp_eq_u32 s62, 7
  s_cselect_b32 s59, 0x10000000, s59
  s_waitcnt lgkmcnt(6)
  v_mfma_f32_32x32x16_bf16 v[0:15], v[112:115], a[28:31], v[0:15]
  ds_read_b64_tr_b16 v[64:65], v133 offset:32768
  ds_read_b64_tr_b16 v[66:67], v133 offset:34816
  s_add_u32 m0, s61, 0
  buffer_load_dwordx4 a[0:3], v128, s[36:39], s59 offen offset:0 sc1
  s_waitcnt lgkmcnt(6)
  v_mfma_f32_32x32x16_bf16 v[16:31], v[116:119], a[28:31], v[16:31]
  ds_read_b64_tr_b16 v[68:69], v134 offset:32768
  ds_read_b64_tr_b16 v[70:71], v134 offset:34816
  s_waitcnt lgkmcnt(6)
  v_mfma_f32_32x32x16_bf16 v[32:47], v[120:123], a[28:31], v[32:47]
  ds_read_b64_tr_b16 v[72:73], v135 offset:32768
  ds_read_b64_tr_b16 v[74:75], v135 offset:34816
  buffer_load_dwordx4 a[4:7], v128, s[36:39], s59 offen offset:1024 sc1
  s_waitcnt lgkmcnt(6)
  v_mfma_f32_32x32x16_bf16 v[48:63], v[124:127], a[28:31], v[48:63]
  ds_read_b64_tr_b16 v[76:77], v136 offset:32768
  ds_read_b64_tr_b16 v[78:79], v136 offset:34816
  s_waitcnt lgkmcnt(6)
  v_mfma_f32_32x32x16_bf16 v[0:15], v[64:67], a[32:35], v[0:15]
  ds_read_b64_tr_b16 v[80:81], v133 offset:36864
  ds_read_b64_tr_b16 v[82:83], v133 offset:38912
  buffer_load_dwordx4 a[8:11], v128, s[36:39], s59 offen offset:2048 sc1
  s_waitcnt lgkmcnt(6)
  v_mfma_f32_32x32x16_bf16 v[16:31], v[68:71], a[32:35], v[16:31]
  ds_read_b64_tr_b16 v[84:85], v134 offset:36864
  ds_read_b64_tr_b16 v[86:87], v134 offset:38912
  s_waitcnt lgkmcnt(6)
  v_mfma_f32_32x32x16_bf16 v[32:47], v[72:75], a[32:35], v[32:47]
  ds_read_b64_tr_b16 v[88:89], v135 offset:36864
  ds_read_b64_tr_b16 v[90:91], v135 offset:38912
  buffer_load_dwordx4 a[12:15], v128, s[36:39], s59 offen offset:3072 sc1
  s_add_u32 s59, s59, 4096
  s_waitcnt lgkmcnt(6)
  v_mfma_f32_32x32x16_bf16 v[48:63], v[76:79], a[32:35], v[48:63]
  ds_read_b64_tr_b16 v[92:93], v136 offset:36864
  ds_read_b64_tr_b16 v[94:95], v136 offset:38912
  s_waitcnt lgkmcnt(6)
  v_mfma_f32_32x32x16_bf16 v[0:15], v[80:83], a[36:39], v[0:15]
  ds_read_b64_tr_b16 v[96:97], v133 offset:40960
  ds_read_b64_tr_b16 v[98:99], v133 offset:43008
  buffer_load_dwordx4 v129, s[48:51], s60 offen offset:0  lds
  s_waitcnt lgkmcnt(6)
  v_mfma_f32_32x32x16_bf16 v[16:31], v[84:87], a[36:39], v[16:31]
  ds_read_b64_tr_b16 v[100:101], v134 offset:40960
  ds_read_b64_tr_b16 v[102:103], v134 offset:43008
  s_waitcnt lgkmcnt(6)
  v_mfma_f32_32x32x16_bf16 v[32:47], v[88:91], a[36:39], v[32:47]
  ds_read_b64_tr_b16 v[104:105], v135 offset:40960
  ds_read_b64_tr_b16 v[106:107], v135 offset:43008
  buffer_load_dwordx4 v130, s[48:51], s60 offen offset:1024  lds
  s_waitcnt lgkmcnt(6)
  v_mfma_f32_32x32x16_bf16 v[48:63], v[92:95], a[36:39], v[48:63]
  ds_read_b64_tr_b16 v[108:109], v136 offset:40960
  ds_read_b64_tr_b16 v[110:111], v136 offset:43008
  s_waitcnt lgkmcnt(6)
  v_mfma_f32_32x32x16_bf16 v[0:15], v[96:99], a[40:43], v[0:15]
  ds_read_b64_tr_b16 v[112:113], v133 offset:45056
  ds_read_b64_tr_b16 v[114:115], v133 offset:47104
  buffer_load_dwordx4 v131, s[48:51], s60 offen offset:2048  lds
  s_waitcnt lgkmcnt(6)
  v_mfma_f32_32x32x16_bf16 v[16:31], v[100:103], a[40:43], v[16:31]
  ds_read_b64_tr_b16 v[116:117], v134 offset:45056
  ds_read_b64_tr_b16 v[118:119], v134 offset:47104
  s_waitcnt lgkmcnt(6)
  v_mfma_f32_32x32x16_bf16 v[32:47], v[104:107], a[40:43], v[32:47]
  ds_read_b64_tr_b16 v[120:121], v135 offset:45056
  ds_read_b64_tr_b16 v[122:123], v135 offset:47104
  buffer_load_dwordx4 v132, s[48:51], s60 offen offset:3072  lds
  s_add_u32 s60, s60, 65536
  s_waitcnt lgkmcnt(6)
  v_mfma_f32_32x32x16_bf16 v[48:63], v[108:111], a[40:43], v[48:63]
  ds_read_b64_tr_b16 v[124:125], v136 offset:45056
  ds_read_b64_tr_b16 v[126:127], v136 offset:47104
  s_waitcnt vmcnt(40)
  s_barrier
  s_waitcnt lgkmcnt(6)
  v_mfma_f32_32x32x16_bf16 v[0:15], v[112:115], a[44:47], v[0:15]
  ds_read_b64_tr_b16 v[64:65], v133 offset:49152
  ds_read_b64_tr_b16 v[66:67], v133 offset:51200
  s_add_u32 m0, s61, 16384
  buffer_load_dwordx4 a[16:19], v128, s[36:39], s59 offen offset:0 sc1
  s_waitcnt lgkmcnt(6)
  v_mfma_f32_32x32x16_bf16 v[16:31], v[116:119], a[44:47], v[16:31]
  ds_read_b64_tr_b16 v[68:69], v134 offset:49152
  ds_read_b64_tr_b16 v[70:71], v134 offset:51200
  s_waitcnt lgkmcnt(6)
  v_mfma_f32_32x32x16_bf16 v[32:47], v[120:123], a[44:47], v[32:47]
  ds_read_b64_tr_b16 v[72:73], v135 offset:49152
  ds_read_b64_tr_b16 v[74:75], v135 offset:51200
  buffer_load_dwordx4 a[20:23], v128, s[36:39], s59 offen offset:1024 sc1
  s_waitcnt lgkmcnt(6)
  v_mfma_f32_32x32x16_bf16 v[48:63], v[124:127], a[44:47], v[48:63]
  ds_read_b64_tr_b16 v[76:77], v136 offset:49152
  ds_read_b64_tr_b16 v[78:79], v136 offset:51200
  s_waitcnt lgkmcnt(6)
  v_mfma_f32_32x32x16_bf16 v[0:15], v[64:67], a[48:51], v[0:15]
  ds_read_b64_tr_b16 v[80:81], v133 offset:53248
  ds_read_b64_tr_b16 v[82:83], v133 offset:55296
  buffer_load_dwordx4 a[24:27], v128, s[36:39], s59 offen offset:2048 sc1
  s_waitcnt lgkmcnt(6)
  v_mfma_f32_32x32x16_bf16 v[16:31], v[68:71], a[48:51], v[16:31]
  ds_read_b64_tr_b16 v[84:85], v134 offset:53248
  ds_read_b64_tr_b16 v[86:87], v134 offset:55296
  s_waitcnt lgkmcnt(6)
  v_mfma_f32_32x32x16_bf16 v[32:47], v[72:75], a[48:51], v[32:47]
  ds_read_b64_tr_b16 v[88:89], v135 offset:53248
  ds_read_b64_tr_b16 v[90:91], v135 offset:55296
  buffer_load_dwordx4 a[28:31], v128, s[36:39], s59 offen offset:3072 sc1
  s_add_u32 s59, s59, 4096
  s_waitcnt lgkmcnt(6)
  v_mfma_f32_32x32x16_bf16 v[48:63], v[76:79], a[48:51], v[48:63]
  ds_read_b64_tr_b16 v[92:93], v136 offset:53248
  ds_read_b64_tr_b16 v[94:95], v136 offset:55296
  s_waitcnt lgkmcnt(6)
  v_mfma_f32_32x32x16_bf16 v[0:15], v[80:83], a[52:55], v[0:15]
  ds_read_b64_tr_b16 v[96:97], v133 offset:57344
  ds_read_b64_tr_b16 v[98:99], v133 offset:59392
  buffer_load_dwordx4 v129, s[48:51], s60 offen offset:0  lds
  s_waitcnt lgkmcnt(6)
  v_mfma_f32_32x32x16_bf16 v[16:31], v[84:87], a[52:55], v[16:31]
  ds_read_b64_tr_b16 v[100:101], v134 offset:57344
  ds_read_b64_tr_b16 v[102:103], v134 offset:59392
  s_waitcnt lgkmcnt(6)
  v_mfma_f32_32x32x16_bf16 v[32:47], v[88:91], a[52:55], v[32:47]
  ds_read_b64_tr_b16 v[104:105], v135 offset:57344
  ds_read_b64_tr_b16 v[106:107], v135 offset:59392
  buffer_load_dwordx4 v130, s[48:51], s60 offen offset:1024  lds
  s_waitcnt lgkmcnt(6)
  v_mfma_f32_32x32x16_bf16 v[48:63], v[92:95], a[52:55], v[48:63]
  ds_read_b64_tr_b16 v[108:109], v136 offset:57344
  ds_read_b64_tr_b16 v[110:111], v136 offset:59392
  s_waitcnt lgkmcnt(6)
  v_mfma_f32_32x32x16_bf16 v[0:15], v[96:99], a[56:59], v[0:15]
  ds_read_b64_tr_b16 v[112:113], v133 offset:61440
  ds_read_b64_tr_b16 v[114:115], v133 offset:63488
  buffer_load_dwordx4 v131, s[48:51], s60 offen offset:2048  lds
  s_waitcnt lgkmcnt(6)
  v_mfma_f32_32x32x16_bf16 v[16:31], v[100:103], a[56:59], v[16:31]
  ds_read_b64_tr_b16 v[116:117], v134 offset:61440
  ds_read_b64_tr_b16 v[118:119], v134 offset:63488
  s_waitcnt lgkmcnt(6)
  v_mfma_f32_32x32x16_bf16 v[32:47], v[104:107], a[56:59], v[32:47]
  ds_read_b64_tr_b16 v[120:121], v135 offset:61440
  ds_read_b64_tr_b16 v[122:123], v135 offset:63488
  buffer_load_dwordx4 v132, s[48:51], s60 offen offset:3072  lds
  s_add_u32 s60, s60, 65536
  s_waitcnt lgkmcnt(6)
  v_mfma_f32_32x32x16_bf16 v[48:63], v[108:111], a[56:59], v[48:63]
  ds_read_b64_tr_b16 v[124:125], v136 offset:61440
  ds_read_b64_tr_b16 v[126:127], v136 offset:63488
  s_waitcnt vmcnt(40)
  s_barrier
  s_waitcnt lgkmcnt(6)
  v_mfma_f32_32x32x16_bf16 v[0:15], v[112:115], a[60:63], v[0:15]
  ds_read_b64_tr_b16 v[64:65], v137 offset:0
  ds_read_b64_tr_b16 v[66:67], v137 offset:2048
  s_add_u32 m0, s61, 32768
  buffer_load_dwordx4 a[32:35], v128, s[36:39], s59 offen offset:0 sc1
  s_waitcnt lgkmcnt(6)
  v_mfma_f32_32x32x16_bf16 v[16:31], v[116:119], a[60:63], v[16:31]
  ds_read_b64_tr_b16 v[68:69], v138 offset:0
  ds_read_b64_tr_b16 v[70:71], v138 offset:2048
  s_waitcnt lgkmcnt(6)
  v_mfma_f32_32x32x16_bf16 v[32:47], v[120:123], a[60:63], v[32:47]
  ds_read_b64_tr_b16 v[72:73], v139 offset:0
  ds_read_b64_tr_b16 v[74:75], v139 offset:2048
  buffer_load_dwordx4 a[36:39], v128, s[36:39], s59 offen offset:1024 sc1
  s_waitcnt lgkmcnt(6)
  v_mfma_f32_32x32x16_bf16 v[48:63], v[124:127], a[60:63], v[48:63]
  ds_read_b64_tr_b16 v[76:77], v140 offset:0
  ds_read_b64_tr_b16 v[78:79], v140 offset:2048
  s_waitcnt lgkmcnt(6)
  v_mfma_f32_32x32x16_bf16 v[0:15], v[64:67], a[64:67], v[0:15]
  ds_read_b64_tr_b16 v[80:81], v137 offset:4096
  ds_read_b64_tr_b16 v[82:83], v137 offset:6144
  buffer_load_dwordx4 a[40:43], v128, s[36:39], s59 offen offset:2048 sc1
  s_waitcnt lgkmcnt(6)
  v_mfma_f32_32x32x16_bf16 v[16:31], v[68:71], a[64:67], v[16:31]
  ds_read_b64_tr_b16 v[84:85], v138 offset:4096
  ds_read_b64_tr_b16 v[86:87], v138 offset:6144
  s_waitcnt lgkmcnt(6)
  v_mfma_f32_32x32x16_bf16 v[32:47], v[72:75], a[64:67], v[32:47]
  ds_read_b64_tr_b16 v[88:89], v139 offset:4096
  ds_read_b64_tr_b16 v[90:91], v139 offset:6144
  buffer_load_dwordx4 a[44:47], v128, s[36:39], s59 offen offset:3072 sc1
  s_add_u32 s59, s59, 4096
  s_waitcnt lgkmcnt(6)
  v_mfma_f32_32x32x16_bf16 v[48:63], v[76:79], a[64:67], v[48:63]
  ds_read_b64_tr_b16 v[92:93], v140 offset:4096
  ds_read_b64_tr_b16 v[94:95], v140 offset:6144
  s_waitcnt lgkmcnt(6)
  v_mfma_f32_32x32x16_bf16 v[0:15], v[80:83], a[68:71], v[0:15]
  ds_read_b64_tr_b16 v[96:97], v137 offset:8192
  ds_read_b64_tr_b16 v[98:99], v137 offset:10240
  buffer_load_dwordx4 v129, s[48:51], s60 offen offset:0  lds
  s_waitcnt lgkmcnt(6)
  v_mfma_f32_32x32x16_bf16 v[16:31], v[84:87], a[68:71], v[16:31]
  ds_read_b64_tr_b16 v[100:101], v138 offset:8192
  ds_read_b64_tr_b16 v[102:103], v138 offset:10240
  s_waitcnt lgkmcnt(6)
  v_mfma_f32_32x32x16_bf16 v[32:47], v[88:91], a[68:71], v[32:47]
  ds_read_b64_tr_b16 v[104:105], v139 offset:8192
  ds_read_b64_tr_b16 v[106:107], v139 offset:10240
  buffer_load_dwordx4 v130, s[48:51], s60 offen offset:1024  lds
  s_waitcnt lgkmcnt(6)
  v_mfma_f32_32x32x16_bf16 v[48:63], v[92:95], a[68:71], v[48:63]
  ds_read_b64_tr_b16 v[108:109], v140 offset:8192
  ds_read_b64_tr_b16 v[110:111], v140 offset:10240
  s_waitcnt lgkmcnt(6)
  v_mfma_f32_32x32x16_bf16 v[0:15], v[96:99], a[72:75], v[0:15]
  ds_read_b64_tr_b16 v[112:113], v137 offset:12288
  ds_read_b64_tr_b16 v[114:115], v137 offset:14336
  buffer_load_dwordx4 v131, s[48:51], s60 offen offset:2048  lds
  s_waitcnt lgkmcnt(6)
  v_mfma_f32_32x32x16_bf16 v[16:31], v[100:103], a[72:75], v[16:31]
  ds_read_b64_tr_b16 v[116:117], v138 offset:12288
  ds_read_b64_tr_b16 v[118:119], v138 offset:14336
  s_waitcnt lgkmcnt(6)
  v_mfma_f32_32x32x16_bf16 v[32:47], v[104:107], a[72:75], v[32:47]
  ds_read_b64_tr_b16 v[120:121], v139 offset:12288
  ds_read_b64_tr_b16 v[122:123], v139 offset:14336
  buffer_load_dwordx4 v132, s[48:51], s60 offen offset:3072  lds
  s_add_u32 s60, s60, 65536
  s_waitcnt lgkmcnt(6)
  v_mfma_f32_32x32x16_bf16 v[48:63], v[108:111], a[72:75], v[48:63]
  ds_read_b64_tr_b16 v[124:125], v140 offset:12288
  ds_read_b64_tr_b16 v[126:127], v140 offset:14336
  s_waitcnt vmcnt(40)
  s_barrier
  s_waitcnt lgkmcnt(6)
  v_mfma_f32_32x32x16_bf16 v[0:15], v[112:115], a[76:79], v[0:15]
  ds_read_b64_tr_b16 v[64:65], v137 offset:16384
  ds_read_b64_tr_b16 v[66:67], v137 offset:18432
  s_add_u32 m0, s61, 49152
  buffer_load_dwordx4 a[48:51], v128, s[36:39], s59 offen offset:0 sc1
  s_waitcnt lgkmcnt(6)
  v_mfma_f32_32x32x16_bf16 v[16:31], v[116:119], a[76:79], v[16:31]
  ds_read_b64_tr_b16 v[68:69], v138 offset:16384
  ds_read_b64_tr_b16 v[70:71], v138 offset:18432
  s_waitcnt lgkmcnt(6)
  v_mfma_f32_32x32x16_bf16 v[32:47], v[120:123], a[76:79], v[32:47]
  ds_read_b64_tr_b16 v[72:73], v139 offset:16384
  ds_read_b64_tr_b16 v[74:75], v139 offset:18432
  buffer_load_dwordx4 a[52:55], v128, s[36:39], s59 offen offset:1024 sc1
  s_waitcnt lgkmcnt(6)
  v_mfma_f32_32x32x16_bf16 v[48:63], v[124:127], a[76:79], v[48:63]
  ds_read_b64_tr_b16 v[76:77], v140 offset:16384
  ds_read_b64_tr_b16 v[78:79], v140 offset:18432
  s_waitcnt lgkmcnt(6)
  v_mfma_f32_32x32x16_bf16 v[0:15], v[64:67], a[80:83], v[0:15]
  ds_read_b64_tr_b16 v[80:81], v137 offset:20480
  ds_read_b64_tr_b16 v[82:83], v137 offset:22528
  buffer_load_dwordx4 a[56:59], v128, s[36:39], s59 offen offset:2048 sc1
  s_waitcnt lgkmcnt(6)
  v_mfma_f32_32x32x16_bf16 v[16:31], v[68:71], a[80:83], v[16:31]
  ds_read_b64_tr_b16 v[84:85], v138 offset:20480
  ds_read_b64_tr_b16 v[86:87], v138 offset:22528
  s_waitcnt lgkmcnt(6)
  v_mfma_f32_32x32x16_bf16 v[32:47], v[72:75], a[80:83], v[32:47]
  ds_read_b64_tr_b16 v[88:89], v139 offset:20480
  ds_read_b64_tr_b16 v[90:91], v139 offset:22528
  buffer_load_dwordx4 a[60:63], v128, s[36:39], s59 offen offset:3072 sc1
  s_add_u32 s59, s59, 4096
  s_waitcnt lgkmcnt(6)
  v_mfma_f32_32x32x16_bf16 v[48:63], v[76:79], a[80:83], v[48:63]
  ds_read_b64_tr_b16 v[92:93], v140 offset:20480
  ds_read_b64_tr_b16 v[94:95], v140 offset:22528
  s_waitcnt lgkmcnt(6)
  v_mfma_f32_32x32x16_bf16 v[0:15], v[80:83], a[84:87], v[0:15]
  ds_read_b64_tr_b16 v[96:97], v137 offset:24576
  ds_read_b64_tr_b16 v[98:99], v137 offset:26624
  buffer_load_dwordx4 v129, s[48:51], s60 offen offset:0  lds
  s_waitcnt lgkmcnt(6)
  v_mfma_f32_32x32x16_bf16 v[16:31], v[84:87], a[84:87], v[16:31]
  ds_read_b64_tr_b16 v[100:101], v138 offset:24576
  ds_read_b64_tr_b16 v[102:103], v138 offset:26624
  s_waitcnt lgkmcnt(6)
  v_mfma_f32_32x32x16_bf16 v[32:47], v[88:91], a[84:87], v[32:47]
  ds_read_b64_tr_b16 v[104:105], v139 offset:24576
  ds_read_b64_tr_b16 v[106:107], v139 offset:26624
  buffer_load_dwordx4 v130, s[48:51], s60 offen offset:1024  lds
  s_waitcnt lgkmcnt(6)
  v_mfma_f32_32x32x16_bf16 v[48:63], v[92:95], a[84:87], v[48:63]
  ds_read_b64_tr_b16 v[108:109], v140 offset:24576
  ds_read_b64_tr_b16 v[110:111], v140 offset:26624
  s_waitcnt lgkmcnt(6)
  v_mfma_f32_32x32x16_bf16 v[0:15], v[96:99], a[88:91], v[0:15]
  ds_read_b64_tr_b16 v[112:113], v137 offset:28672
  ds_read_b64_tr_b16 v[114:115], v137 offset:30720
  buffer_load_dwordx4 v131, s[48:51], s60 offen offset:2048  lds
  s_waitcnt lgkmcnt(6)
  v_mfma_f32_32x32x16_bf16 v[16:31], v[100:103], a[88:91], v[16:31]
  ds_read_b64_tr_b16 v[116:117], v138 offset:28672
  ds_read_b64_tr_b16 v[118:119], v138 offset:30720
  s_waitcnt lgkmcnt(6)
  v_mfma_f32_32x32x16_bf16 v[32:47], v[104:107], a[88:91], v[32:47]
  ds_read_b64_tr_b16 v[120:121], v139 offset:28672
  ds_read_b64_tr_b16 v[122:123], v139 offset:30720
  buffer_load_dwordx4 v132, s[48:51], s60 offen offset:3072  lds
  s_add_u32 s60, s60, 65536
  s_waitcnt lgkmcnt(6)
  v_mfma_f32_32x32x16_bf16 v[48:63], v[108:111], a[88:91], v[48:63]
  ds_read_b64_tr_b16 v[124:125], v140 offset:28672
  ds_read_b64_tr_b16 v[126:127], v140 offset:30720
  s_waitcnt vmcnt(40)
  s_barrier
  s_waitcnt lgkmcnt(6)
  v_mfma_f32_32x32x16_bf16 v[0:15], v[112:115], a[92:95], v[0:15]
  ds_read_b64_tr_b16 v[64:65], v137 offset:32768
  ds_read_b64_tr_b16 v[66:67], v137 offset:34816
  s_add_u32 m0, s61, 65536
  buffer_load_dwordx4 a[64:67], v128, s[36:39], s59 offen offset:0 sc1
  s_waitcnt lgkmcnt(6)
  v_mfma_f32_32x32x16_bf16 v[16:31], v[116:119], a[92:95], v[16:31]
  ds_read_b64_tr_b16 v[68:69], v138 offset:32768
  ds_read_b64_tr_b16 v[70:71], v138 offset:34816
  s_waitcnt lgkmcnt(6)
  v_mfma_f32_32x32x16_bf16 v[32:47], v[120:123], a[92:95], v[32:47]
  ds_read_b64_tr_b16 v[72:73], v139 offset:32768
  ds_read_b64_tr_b16 v[74:75], v139 offset:34816
  buffer_load_dwordx4 a[68:71], v128, s[36:39], s59 offen offset:1024 sc1
  s_waitcnt lgkmcnt(6)
  v_mfma_f32_32x32x16_bf16 v[48:63], v[124:127], a[92:95], v[48:63]
  ds_read_b64_tr_b16 v[76:77], v140 offset:32768
  ds_read_b64_tr_b16 v[78:79], v140 offset:34816
  s_waitcnt lgkmcnt(6)
  v_mfma_f32_32x32x16_bf16 v[0:15], v[64:67], a[96:99], v[0:15]
  ds_read_b64_tr_b16 v[80:81], v137 offset:36864
  ds_read_b64_tr_b16 v[82:83], v137 offset:38912
  buffer_load_dwordx4 a[72:75], v128, s[36:39], s59 offen offset:2048 sc1
  s_waitcnt lgkmcnt(6)
  v_mfma_f32_32x32x16_bf16 v[16:31], v[68:71], a[96:99], v[16:31]
  ds_read_b64_tr_b16 v[84:85], v138 offset:36864
  ds_read_b64_tr_b16 v[86:87], v138 offset:38912
  s_waitcnt lgkmcnt(6)
  v_mfma_f32_32x32x16_bf16 v[32:47], v[72:75], a[96:99], v[32:47]
  ds_read_b64_tr_b16 v[88:89], v139 offset:36864
  ds_read_b64_tr_b16 v[90:91], v139 offset:38912
  buffer_load_dwordx4 a[76:79], v128, s[36:39], s59 offen offset:3072 sc1
  s_add_u32 s59, s59, 4096
  s_waitcnt lgkmcnt(6)
  v_mfma_f32_32x32x16_bf16 v[48:63], v[76:79], a[96:99], v[48:63]
  ds_read_b64_tr_b16 v[92:93], v140 offset:36864
  ds_read_b64_tr_b16 v[94:95], v140 offset:38912
  s_waitcnt lgkmcnt(6)
  v_mfma_f32_32x32x16_bf16 v[0:15], v[80:83], a[100:103], v[0:15]
  ds_read_b64_tr_b16 v[96:97], v137 offset:40960
  ds_read_b64_tr_b16 v[98:99], v137 offset:43008
  buffer_load_dwordx4 v129, s[48:51], s60 offen offset:0  lds
  s_waitcnt lgkmcnt(6)
  v_mfma_f32_32x32x16_bf16 v[16:31], v[84:87], a[100:103], v[16:31]
  ds_read_b64_tr_b16 v[100:101], v138 offset:40960
  ds_read_b64_tr_b16 v[102:103], v138 offset:43008
  s_waitcnt lgkmcnt(6)
  v_mfma_f32_32x32x16_bf16 v[32:47], v[88:91], a[100:103], v[32:47]
  ds_read_b64_tr_b16 v[104:105], v139 offset:40960
  ds_read_b64_tr_b16 v[106:107], v139 offset:43008
  buffer_load_dwordx4 v130, s[48:51], s60 offen offset:1024  lds
  s_waitcnt lgkmcnt(6)
  v_mfma_f32_32x32x16_bf16 v[48:63], v[92:95], a[100:103], v[48:63]
  ds_read_b64_tr_b16 v[108:109], v140 offset:40960
  ds_read_b64_tr_b16 v[110:111], v140 offset:43008
  s_waitcnt lgkmcnt(6)
  v_mfma_f32_32x32x16_bf16 v[0:15], v[96:99], a[104:107], v[0:15]
  ds_read_b64_tr_b16 v[112:113], v137 offset:45056
  ds_read_b64_tr_b16 v[114:115], v137 offset:47104
  buffer_load_dwordx4 v131, s[48:51], s60 offen offset:2048  lds
  s_waitcnt lgkmcnt(6)
  v_mfma_f32_32x32x16_bf16 v[16:31], v[100:103], a[104:107], v[16:31]
  ds_read_b64_tr_b16 v[116:117], v138 offset:45056
  ds_read_b64_tr_b16 v[118:119], v138 offset:47104
  s_waitcnt lgkmcnt(6)
  v_mfma_f32_32x32x16_bf16 v[32:47], v[104:107], a[104:107], v[32:47]
  ds_read_b64_tr_b16 v[120:121], v139 offset:45056
  ds_read_b64_tr_b16 v[122:123], v139 offset:47104
  buffer_load_dwordx4 v132, s[48:51], s60 offen offset:3072  lds
  s_add_u32 s60, s60, 65536
  s_waitcnt lgkmcnt(6)
  v_mfma_f32_32x32x16_bf16 v[48:63], v[108:111], a[104:107], v[48:63]
  ds_read_b64_tr_b16 v[124:125], v140 offset:45056
  ds_read_b64_tr_b16 v[126:127], v140 offset:47104
  s_waitcnt vmcnt(40)
  s_barrier
  s_waitcnt lgkmcnt(6)
  v_mfma_f32_32x32x16_bf16 v[0:15], v[112:115], a[108:111], v[0:15]
  ds_read_b64_tr_b16 v[64:65], v137 offset:49152
  ds_read_b64_tr_b16 v[66:67], v137 offset:51200
  s_add_u32 m0, s61, 81920
  buffer_load_dwordx4 a[80:83], v128, s[36:39], s59 offen offset:0 sc1
  s_waitcnt lgkmcnt(6)
  v_mfma_f32_32x32x16_bf16 v[16:31], v[116:119], a[108:111], v[16:31]
  ds_read_b64_tr_b16 v[68:69], v138 offset:49152
  ds_read_b64_tr_b16 v[70:71], v138 offset:51200
  s_waitcnt lgkmcnt(6)
  v_mfma_f32_32x32x16_bf16 v[32:47], v[120:123], a[108:111], v[32:47]
  ds_read_b64_tr_b16 v[72:73], v139 offset:49152
  ds_read_b64_tr_b16 v[74:75], v139 offset:51200
  buffer_load_dwordx4 a[84:87], v128, s[36:39], s59 offen offset:1024 sc1
  s_waitcnt lgkmcnt(6)
  v_mfma_f32_32x32x16_bf16 v[48:63], v[124:127], a[108:111], v[48:63]
  ds_read_b64_tr_b16 v[76:77], v140 offset:49152
  ds_read_b64_tr_b16 v[78:79], v140 offset:51200
  s_waitcnt lgkmcnt(6)
  v_mfma_f32_32x32x16_bf16 v[0:15], v[64:67], a[112:115], v[0:15]
  ds_read_b64_tr_b16 v[80:81], v137 offset:53248
  ds_read_b64_tr_b16 v[82:83], v137 offset:55296
  buffer_load_dwordx4 a[88:91], v128, s[36:39], s59 offen offset:2048 sc1
  s_waitcnt lgkmcnt(6)
  v_mfma_f32_32x32x16_bf16 v[16:31], v[68:71], a[112:115], v[16:31]
  ds_read_b64_tr_b16 v[84:85], v138 offset:53248
  ds_read_b64_tr_b16 v[86:87], v138 offset:55296
  s_waitcnt lgkmcnt(6)
  v_mfma_f32_32x32x16_bf16 v[32:47], v[72:75], a[112:115], v[32:47]
  ds_read_b64_tr_b16 v[88:89], v139 offset:53248
  ds_read_b64_tr_b16 v[90:91], v139 offset:55296
  buffer_load_dwordx4 a[92:95], v128, s[36:39], s59 offen offset:3072 sc1
  s_add_u32 s59, s59, 4096
  s_waitcnt lgkmcnt(6)
  v_mfma_f32_32x32x16_bf16 v[48:63], v[76:79], a[112:115], v[48:63]
  ds_read_b64_tr_b16 v[92:93], v140 offset:53248
  ds_read_b64_tr_b16 v[94:95], v140 offset:55296
  s_waitcnt lgkmcnt(6)
  v_mfma_f32_32x32x16_bf16 v[0:15], v[80:83], a[116:119], v[0:15]
  ds_read_b64_tr_b16 v[96:97], v137 offset:57344
  ds_read_b64_tr_b16 v[98:99], v137 offset:59392
  buffer_load_dwordx4 v129, s[48:51], s60 offen offset:0  lds
  s_waitcnt lgkmcnt(6)
  v_mfma_f32_32x32x16_bf16 v[16:31], v[84:87], a[116:119], v[16:31]
  ds_read_b64_tr_b16 v[100:101], v138 offset:57344
  ds_read_b64_tr_b16 v[102:103], v138 offset:59392
  s_waitcnt lgkmcnt(6)
  v_mfma_f32_32x32x16_bf16 v[32:47], v[88:91], a[116:119], v[32:47]
  ds_read_b64_tr_b16 v[104:105], v139 offset:57344
  ds_read_b64_tr_b16 v[106:107], v139 offset:59392
  buffer_load_dwordx4 v130, s[48:51], s60 offen offset:1024  lds
  s_waitcnt lgkmcnt(6)
  v_mfma_f32_32x32x16_bf16 v[48:63], v[92:95], a[116:119], v[48:63]
  ds_read_b64_tr_b16 v[108:109], v140 offset:57344
  ds_read_b64_tr_b16 v[110:111], v140 offset:59392
  s_waitcnt lgkmcnt(6)
  v_mfma_f32_32x32x16_bf16 v[0:15], v[96:99], a[120:123], v[0:15]
  ds_read_b64_tr_b16 v[112:113], v137 offset:61440
  ds_read_b64_tr_b16 v[114:115], v137 offset:63488
  buffer_load_dwordx4 v131, s[48:51], s60 offen offset:2048  lds
  s_waitcnt lgkmcnt(6)
  v_mfma_f32_32x32x16_bf16 v[16:31], v[100:103], a[120:123], v[16:31]
  ds_read_b64_tr_b16 v[116:117], v138 offset:61440
  ds_read_b64_tr_b16 v[118:119], v138 offset:63488
  s_waitcnt lgkmcnt(6)
  v_mfma_f32_32x32x16_bf16 v[32:47], v[104:107], a[120:123], v[32:47]
  ds_read_b64_tr_b16 v[120:121], v139 offset:61440
  ds_read_b64_tr_b16 v[122:123], v139 offset:63488
  buffer_load_dwordx4 v132, s[48:51], s60 offen offset:3072  lds
  s_add_u32 s60, s60, 65536
  s_waitcnt lgkmcnt(6)
  v_mfma_f32_32x32x16_bf16 v[48:63], v[108:111], a[120:123], v[48:63]
  ds_read_b64_tr_b16 v[124:125], v140 offset:61440
  ds_read_b64_tr_b16 v[126:127], v140 offset:63488
  s_waitcnt vmcnt(40)
  s_barrier
  s_waitcnt lgkmcnt(6)
  v_mfma_f32_32x32x16_bf16 v[0:15], v[112:115], a[124:127], v[0:15]
  ds_read_b64_tr_b16 v[64:65], v133 offset:0
  ds_read_b64_tr_b16 v[66:67], v133 offset:2048
  s_add_u32 m0, s61, 98304
  buffer_load_dwordx4 a[96:99], v128, s[36:39], s59 offen offset:0 sc1
  s_waitcnt lgkmcnt(6)
  v_mfma_f32_32x32x16_bf16 v[16:31], v[116:119], a[124:127], v[16:31]
  ds_read_b64_tr_b16 v[68:69], v134 offset:0
  ds_read_b64_tr_b16 v[70:71], v134 offset:2048
  s_waitcnt lgkmcnt(6)
  v_mfma_f32_32x32x16_bf16 v[32:47], v[120:123], a[124:127], v[32:47]
  ds_read_b64_tr_b16 v[72:73], v135 offset:0
  ds_read_b64_tr_b16 v[74:75], v135 offset:2048
  buffer_load_dwordx4 a[100:103], v128, s[36:39], s59 offen offset:1024 sc1
  s_waitcnt lgkmcnt(6)
  v_mfma_f32_32x32x16_bf16 v[48:63], v[124:127], a[124:127], v[48:63]
  ds_read_b64_tr_b16 v[76:77], v136 offset:0
  ds_read_b64_tr_b16 v[78:79], v136 offset:2048
  s_add_u32 s62, s62, 1
  s_cmp_lt_u32 s62, 8
  s_cbranch_scc1 OP_loop
  s_lshl_b32 s63, s56, 18
  s_lshl_b32 s64, s57, 8
  s_add_u32 s63, s63, s64
  s_lshl_b32 s64, s58, 10
  s_add_u32 s63, s63, s64
  s_waitcnt lgkmcnt(0)
  v_cvt_pk_bf16_f32 v0, v0, v1
  v_cvt_pk_bf16_f32 v1, v2, v3
  v_cvt_pk_bf16_f32 v2, v4, v5
  v_cvt_pk_bf16_f32 v3, v6, v7
  v_cvt_pk_bf16_f32 v4, v8, v9
  v_cvt_pk_bf16_f32 v5, v10, v11
  v_cvt_pk_bf16_f32 v6, v12, v13
  v_cvt_pk_bf16_f32 v7, v14, v15
  v_permlane32_swap_b32 v0, v2
  v_permlane32_swap_b32 v1, v3
  v_permlane32_swap_b32 v4, v6
  v_permlane32_swap_b32 v5, v7
  buffer_store_dwordx4 v[0:3], v141, s[52:55], s63 offen offset:0
  buffer_store_dwordx4 v[4:7], v141, s[52:55], s63 offen offset:32
  v_cvt_pk_bf16_f32 v16, v16, v17
  v_cvt_pk_bf16_f32 v17, v18, v19
  v_cvt_pk_bf16_f32 v18, v20, v21
  v_cvt_pk_bf16_f32 v19, v22, v23
  v_cvt_pk_bf16_f32 v20, v24, v25
  v_cvt_pk_bf16_f32 v21, v26, v27
  v_cvt_pk_bf16_f32 v22, v28, v29
  v_cvt_pk_bf16_f32 v23, v30, v31
  v_permlane32_swap_b32 v16, v18
  v_permlane32_swap_b32 v17, v19
  v_permlane32_swap_b32 v20, v22
  v_permlane32_swap_b32 v21, v23
  buffer_store_dwordx4 v[16:19], v141, s[52:55], s63 offen offset:64
  buffer_store_dwordx4 v[20:23], v141, s[52:55], s63 offen offset:96
  v_cvt_pk_bf16_f32 v32, v32, v33
  v_cvt_pk_bf16_f32 v33, v34, v35
  v_cvt_pk_bf16_f32 v34, v36, v37
  v_cvt_pk_bf16_f32 v35, v38, v39
  v_cvt_pk_bf16_f32 v36, v40, v41
  v_cvt_pk_bf16_f32 v37, v42, v43
  v_cvt_pk_bf16_f32 v38, v44, v45
  v_cvt_pk_bf16_f32 v39, v46, v47
  v_permlane32_swap_b32 v32, v34
  v_permlane32_swap_b32 v33, v35
  v_permlane32_swap_b32 v36, v38
  v_permlane32_swap_b32 v37, v39
  buffer_store_dwordx4 v[32:35], v141, s[52:55], s63 offen offset:128
  buffer_store_dwordx4 v[36:39], v141, s[52:55], s63 offen offset:160
  v_cvt_pk_bf16_f32 v48, v48, v49
  v_cvt_pk_bf16_f32 v49, v50, v51
  v_cvt_pk_bf16_f32 v50, v52, v53
  v_cvt_pk_bf16_f32 v51, v54, v55
  v_cvt_pk_bf16_f32 v52, v56, v57
  v_cvt_pk_bf16_f32 v53, v58, v59
  v_cvt_pk_bf16_f32 v54, v60, v61
  v_cvt_pk_bf16_f32 v55, v62, v63
  v_permlane32_swap_b32 v48, v50
  v_permlane32_swap_b32 v49, v51
  v_permlane32_swap_b32 v52, v54
  v_permlane32_swap_b32 v53, v55
  buffer_store_dwordx4 v[48:51], v141, s[52:55], s63 offen offset:192
  buffer_store_dwordx4 v[52:55], v141, s[52:55], s63 offen offset:224
  s_mov_b32 s81, 7
  s_mov_b32 s82, 0
  s_branch L_jobend
L_oph:
  s_bfe_u32 s65, s90, 0x1000a
  v_lshrrev_b32 v144, 3, v255
  v_lshlrev_b32 v144, 10, v144
  v_bfe_u32 v145, v255, 4, 1
  v_lshlrev_b32 v145, 2, v145
  v_and_b32 v146, 7, v255
  v_xor_b32 v145, v145, v146
  v_lshl_add_u32 v129, v145, 4, v144
  v_add_u32 v130, 7168, v129
  v_add_u32 v131, 14336, v129
  v_add_u32 v132, 21504, v129
  v_bfe_u32 v144, v255, 2, 2
  v_lshlrev_b32 v145, 7, v144
  v_lshrrev_b32 v144, 5, v255
  v_lshl_add_u32 v145, v144, 9, v145
  v_bfe_u32 v144, v255, 3, 1
  v_lshl_add_u32 v145, v144, 6, v145
  v_bfe_u32 v144, v255, 4, 1
  v_lshl_add_u32 v145, v144, 5, v145
  v_and_b32 v144, 3, v255
  v_lshl_add_u32 v133, v144, 3, v145
  v_xor_b32 v134, 64, v133
  v_add_u32 v135, 0x10000, v133
  v_add_u32 v136, 0x10000, v134
  s_mov_b32 s59, 0xa000000
  s_cmp_eq_u32 s58, 0
  s_cselect_b64 s[48:49], s[14:15], s[28:29]
  s_cselect_b32 s59, 0x8c00000, s59
  s_and_b32 s49, s49, 0xffff
  s_lshl_b32 s63, s56, 2
  s_add_u32 s63, s63, s40
  s_mul_i32 s63, s63, 262144
  s_add_u32 s59, s59, s63
  s_lshl_b32 s57, s57, 1
  s_add_u32 s57, s57, s65
  s_lshl_b32 s57, s57, 7
  s_lshl_b32 s60, s40, 15
  s_add_u32 s60, s60, s57
  s_mov_b32 s62, 0
  s_and_b32 s68, s56, 0
  s_mov_b32 s66, s59
  s_mov_b32 s67, s60
  s_lshl_b32 s63, s68, 16
  s_add_u32 s59, s59, s63
  s_lshl_b32 s63, s68, 20
  s_add_u32 s60, s60, s63
  s_barrier
  s_add_u32 m0, s61, 0
  buffer_load_dwordx4 a[0:3], v128, s[36:39], s59 offen offset:0 sc1
  buffer_load_dwordx4 a[4:7], v128, s[36:39], s59 offen offset:1024 sc1
  buffer_load_dwordx4 a[8:11], v128, s[36:39], s59 offen offset:2048 sc1
  buffer_load_dwordx4 a[12:15], v128, s[36:39], s59 offen offset:3072 sc1
  s_add_u32 s59, s59, 4096
  buffer_load_dwordx4 a[16:19], v128, s[36:39], s59 offen offset:0 sc1
  buffer_load_dwordx4 a[20:23], v128, s[36:39], s59 offen offset:1024 sc1
  buffer_load_dwordx4 a[24:27], v128, s[36:39], s59 offen offset:2048 sc1
  buffer_load_dwordx4 a[28:31], v128, s[36:39], s59 offen offset:3072 sc1
  s_add_u32 s59, s59, 4096
  buffer_load_dwordx4 v129, s[48:51], s60 offen offset:0 lds
  buffer_load_dwordx4 v130, s[48:51], s60 offen offset:1024 lds
  buffer_load_dwordx4 v131, s[48:51], s60 offen offset:2048 lds
  buffer_load_dwordx4 v132, s[48:51], s60 offen offset:3072 lds
  s_add_u32 s60, s60, 0x20000
  s_add_u32 m0, s61, 16384
  buffer_load_dwordx4 a[32:35], v128, s[36:39], s59 offen offset:0 sc1
  buffer_load_dwordx4 a[36:39], v128, s[36:39], s59 offen offset:1024 sc1
  buffer_load_dwordx4 a[40:43], v128, s[36:39], s59 offen offset:2048 sc1
  buffer_load_dwordx4 a[44:47], v128, s[36:39], s59 offen offset:3072 sc1
  s_add_u32 s59, s59, 4096
  buffer_load_dwordx4 a[48:51], v128, s[36:39], s59 offen offset:0 sc1
  buffer_load_dwordx4 a[52:55], v128, s[36:39], s59 offen offset:1024 sc1
  buffer_load_dwordx4 a[56:59], v128, s[36:39], s59 offen offset:2048 sc1
  buffer_load_dwordx4 a[60:63], v128, s[36:39], s59 offen offset:3072 sc1
  s_add_u32 s59, s59, 4096
  buffer_load_dwordx4 v129, s[48:51], s60 offen offset:0 lds
  buffer_load_dwordx4 v130, s[48:51], s60 offen offset:1024 lds
  buffer_load_dwordx4 v131, s[48:51], s60 offen offset:2048 lds
  buffer_load_dwordx4 v132, s[48:51], s60 offen offset:3072 lds
  s_add_u32 s60, s60, 0x20000
  s_add_u32 m0, s61, 32768
  buffer_load_dwordx4 a[64:67], v128, s[36:39], s59 offen offset:0 sc1
  buffer_load_dwordx4 a[68:71], v128, s[36:39], s59 offen offset:1024 sc1
  buffer_load_dwordx4 a[72:75], v128, s[36:39], s59 offen offset:2048 sc1
  buffer_load_dwordx4 a[76:79], v128, s[36:39], s59 offen offset:3072 sc1
  s_add_u32 s59, s59, 4096
  buffer_load_dwordx4 a[80:83], v128, s[36:39], s59 offen offset:0 sc1
  buffer_load_dwordx4 a[84:87], v128, s[36:39], s59 offen offset:1024 sc1
  buffer_load_dwordx4 a[88:91], v128, s[36:39], s59 offen offset:2048 sc1
  buffer_load_dwordx4 a[92:95], v128, s[36:39], s59 offen offset:3072 sc1
  s_add_u32 s59, s59, 4096
  buffer_load_dwordx4 v129, s[48:51], s60 offen offset:0 lds
  buffer_load_dwordx4 v130, s[48:51], s60 offen offset:1024 lds
  buffer_load_dwordx4 v131, s[48:51], s60 offen offset:2048 lds
  buffer_load_dwordx4 v132, s[48:51], s60 offen offset:3072 lds
  s_add_u32 s60, s60, 0x20000
  s_add_u32 m0, s61, 49152
  buffer_load_dwordx4 a[96:99], v128, s[36:39], s59 offen offset:0 sc1
  buffer_load_dwordx4 a[100:103], v128, s[36:39], s59 offen offset:1024 sc1
  buffer_load_dwordx4 a[104:107], v128, s[36:39], s59 offen offset:2048 sc1
  buffer_load_dwordx4 a[108:111], v128, s[36:39], s59 offen offset:3072 sc1
  s_add_u32 s59, s59, 4096
  buffer_load_dwordx4 a[112:115], v128, s[36:39], s59 offen offset:0 sc1
  buffer_load_dwordx4 a[116:119], v128, s[36:39], s59 offen offset:1024 sc1
  buffer_load_dwordx4 a[120:123], v128, s[36:39], s59 offen offset:2048 sc1
  buffer_load_dwordx4 a[124:127], v128, s[36:39], s59 offen offset:3072 sc1
  s_add_u32 s59, s59, 4096
  buffer_load_dwordx4 v129, s[48:51], s60 offen offset:0 lds
  buffer_load_dwordx4 v130, s[48:51], s60 offen offset:1024 lds
  buffer_load_dwordx4 v131, s[48:51], s60 offen offset:2048 lds
  buffer_load_dwordx4 v132, s[48:51], s60 offen offset:3072 lds
  s_add_u32 s60, s60, 0x20000
  s_add_u32 m0, s61, 65536
  buffer_load_dwordx4 a[128:131], v128, s[36:39], s59 offen offset:0 sc1
  buffer_load_dwordx4 a[132:135], v128, s[36:39], s59 offen offset:1024 sc1
  buffer_load_dwordx4 a[136:139], v128, s[36:39], s59 offen offset:2048 sc1
  v_mov_b64 v[0:1], 0
  v_mov_b64 v[2:3], 0
  v_mov_b64 v[4:5], 0
  v_mov_b64 v[6:7], 0
  v_mov_b64 v[8:9], 0
  v_mov_b64 v[10:11], 0
  v_mov_b64 v[12:13], 0
  v_mov_b64 v[14:15], 0
  v_mov_b64 v[16:17], 0
  v_mov_b64 v[18:19], 0
  v_mov_b64 v[20:21], 0
  v_mov_b64 v[22:23], 0
  v_mov_b64 v[24:25], 0
  v_mov_b64 v[26:27], 0
  v_mov_b64 v[28:29], 0
  v_mov_b64 v[30:31], 0
  s_waitcnt vmcnt(39)
  s_barrier
  ds_read_b64_tr_b16 v[64:65], v133 offset:0
  ds_read_b64_tr_b16 v[66:67], v133 offset:1024
  ds_read_b64_tr_b16 v[68:69], v134 offset:0
  ds_read_b64_tr_b16 v[70:71], v134 offset:1024
  ds_read_b64_tr_b16 v[72:73], v133 offset:2048
  ds_read_b64_tr_b16 v[74:75], v133 offset:3072
  ds_read_b64_tr_b16 v[76:77], v134 offset:2048
  ds_read_b64_tr_b16 v[78:79], v134 offset:3072
OH_loop:
  s_waitcnt lgkmcnt(4)
  v_mfma_f32_32x32x16_bf16 v[0:15], v[64:67], a[0:3], v[0:15]
  ds_read_b64_tr_b16 v[80:81], v133 offset:4096
  ds_read_b64_tr_b16 v[82:83], v133 offset:5120
  buffer_load_dwordx4 a[140:143], v128, s[36:39], s59 offen offset:3072 sc1
  v_mfma_f32_32x32x16_bf16 v[16:31], v[68:71], a[0:3], v[16:31]
  ds_read_b64_tr_b16 v[84:85], v134 offset:4096
  ds_read_b64_tr_b16 v[86:87], v134 offset:5120
  s_add_u32 s59, s59, 4096
  s_waitcnt lgkmcnt(4)
  v_mfma_f32_32x32x16_bf16 v[0:15], v[72:75], a[4:7], v[0:15]
  ds_read_b64_tr_b16 v[88:89], v133 offset:6144
  ds_read_b64_tr_b16 v[90:91], v133 offset:7168
  buffer_load_dwordx4 a[144:147], v128, s[36:39], s59 offen offset:0 sc1
  v_mfma_f32_32x32x16_bf16 v[16:31], v[76:79], a[4:7], v[16:31]
  ds_read_b64_tr_b16 v[92:93], v134 offset:6144
  ds_read_b64_tr_b16 v[94:95], v134 offset:7168
  buffer_load_dwordx4 a[148:151], v128, s[36:39], s59 offen offset:1024 sc1
  s_waitcnt lgkmcnt(4)
  v_mfma_f32_32x32x16_bf16 v[0:15], v[80:83], a[8:11], v[0:15]
  ds_read_b64_tr_b16 v[64:65], v133 offset:8192
  ds_read_b64_tr_b16 v[66:67], v133 offset:9216
  buffer_load_dwordx4 a[152:155], v128, s[36:39], s59 offen offset:2048 sc1
  v_mfma_f32_32x32x16_bf16 v[16:31], v[84:87], a[8:11], v[16:31]
  ds_read_b64_tr_b16 v[68:69], v134 offset:8192
  ds_read_b64_tr_b16 v[70:71], v134 offset:9216
  buffer_load_dwordx4 a[156:159], v128, s[36:39], s59 offen offset:3072 sc1
  s_waitcnt lgkmcnt(4)
  v_mfma_f32_32x32x16_bf16 v[0:15], v[88:91], a[12:15], v[0:15]
  ds_read_b64_tr_b16 v[72:73], v133 offset:10240
  ds_read_b64_tr_b16 v[74:75], v133 offset:11264
  s_add_u32 s59, s59, 4096
  v_mfma_f32_32x32x16_bf16 v[16:31], v[92:95], a[12:15], v[16:31]
  ds_read_b64_tr_b16 v[76:77], v134 offset:10240
  ds_read_b64_tr_b16 v[78:79], v134 offset:11264
  buffer_load_dwordx4 v129, s[48:51], s60 offen offset:0 lds
  s_waitcnt lgkmcnt(4)
  v_mfma_f32_32x32x16_bf16 v[0:15], v[64:67], a[16:19], v[0:15]
  ds_read_b64_tr_b16 v[80:81], v133 offset:12288
  ds_read_b64_tr_b16 v[82:83], v133 offset:13312
  buffer_load_dwordx4 v130, s[48:51], s60 offen offset:1024 lds
  v_mfma_f32_32x32x16_bf16 v[16:31], v[68:71], a[16:19], v[16:31]
  ds_read_b64_tr_b16 v[84:85], v134 offset:12288
  ds_read_b64_tr_b16 v[86:87], v134 offset:13312
  buffer_load_dwordx4 v131, s[48:51], s60 offen offset:2048 lds
  s_waitcnt lgkmcnt(4)
  v_mfma_f32_32x32x16_bf16 v[0:15], v[72:75], a[20:23], v[0:15]
  ds_read_b64_tr_b16 v[88:89], v133 offset:14336
  ds_read_b64_tr_b16 v[90:91], v133 offset:15360
  buffer_load_dwordx4 v132, s[48:51], s60 offen offset:3072 lds
  v_mfma_f32_32x32x16_bf16 v[16:31], v[76:79], a[20:23], v[16:31]
  ds_read_b64_tr_b16 v[92:93], v134 offset:14336
  ds_read_b64_tr_b16 v[94:95], v134 offset:15360
  s_add_u32 s60, s60, 0x20000
  s_waitcnt vmcnt(36)
  s_barrier
  s_waitcnt lgkmcnt(4)
  v_mfma_f32_32x32x16_bf16 v[0:15], v[80:83], a[24:27], v[0:15]
  ds_read_b64_tr_b16 v[64:65], v133 offset:16384
  ds_read_b64_tr_b16 v[66:67], v133 offset:17408
  s_add_u32 m0, s61, 81920
  v_mfma_f32_32x32x16_bf16 v[16:31], v[84:87], a[24:27], v[16:31]
  ds_read_b64_tr_b16 v[68:69], v134 offset:16384
  ds_read_b64_tr_b16 v[70:71], v134 offset:17408
  buffer_load_dwordx4 a[160:163], v128, s[36:39], s59 offen offset:0 sc1
  s_waitcnt lgkmcnt(4)
  v_mfma_f32_32x32x16_bf16 v[0:15], v[88:91], a[28:31], v[0:15]
  ds_read_b64_tr_b16 v[72:73], v133 offset:18432
  ds_read_b64_tr_b16 v[74:75], v133 offset:19456
  buffer_load_dwordx4 a[164:167], v128, s[36:39], s59 offen offset:1024 sc1
  v_mfma_f32_32x32x16_bf16 v[16:31], v[92:95], a[28:31], v[16:31]
  ds_read_b64_tr_b16 v[76:77], v134 offset:18432
  ds_read_b64_tr_b16 v[78:79], v134 offset:19456
  buffer_load_dwordx4 a[168:171], v128, s[36:39], s59 offen offset:2048 sc1
  s_waitcnt lgkmcnt(4)
  v_mfma_f32_32x32x16_bf16 v[0:15], v[64:67], a[32:35], v[0:15]
  ds_read_b64_tr_b16 v[80:81], v133 offset:20480
  ds_read_b64_tr_b16 v[82:83], v133 offset:21504
  buffer_load_dwordx4 a[172:175], v128, s[36:39], s59 offen offset:3072 sc1
  v_mfma_f32_32x32x16_bf16 v[16:31], v[68:71], a[32:35], v[16:31]
  ds_read_b64_tr_b16 v[84:85], v134 offset:20480
  ds_read_b64_tr_b16 v[86:87], v134 offset:21504
  s_add_u32 s59, s59, 4096
  s_waitcnt lgkmcnt(4)
  v_mfma_f32_32x32x16_bf16 v[0:15], v[72:75], a[36:39], v[0:15]
  ds_read_b64_tr_b16 v[88:89], v133 offset:22528
  ds_read_b64_tr_b16 v[90:91], v133 offset:23552
  buffer_load_dwordx4 a[176:179], v128, s[36:39], s59 offen offset:0 sc1
  v_mfma_f32_32x32x16_bf16 v[16:31], v[76:79], a[36:39], v[16:31]
  ds_read_b64_tr_b16 v[92:93], v134 offset:22528
  ds_read_b64_tr_b16 v[94:95], v134 offset:23552
  buffer_load_dwordx4 a[180:183], v128, s[36:39], s59 offen offset:1024 sc1
  s_waitcnt lgkmcnt(4)
  v_mfma_f32_32x32x16_bf16 v[0:15], v[80:83], a[40:43], v[0:15]
  ds_read_b64_tr_b16 v[64:65], v133 offset:24576
  ds_read_b64_tr_b16 v[66:67], v133 offset:25600
  buffer_load_dwordx4 a[184:187], v128, s[36:39], s59 offen offset:2048 sc1
  v_mfma_f32_32x32x16_bf16 v[16:31], v[84:87], a[40:43], v[16:31]
  ds_read_b64_tr_b16 v[68:69], v134 offset:24576
  ds_read_b64_tr_b16 v[70:71], v134 offset:25600
  buffer_load_dwordx4 a[188:191], v128, s[36:39], s59 offen offset:3072 sc1
  s_waitcnt lgkmcnt(4)
  v_mfma_f32_32x32x16_bf16 v[0:15], v[88:91], a[44:47], v[0:15]
  ds_read_b64_tr_b16 v[72:73], v133 offset:26624
  ds_read_b64_tr_b16 v[74:75], v133 offset:27648
  s_add_u32 s59, s59, 4096
  v_mfma_f32_32x32x16_bf16 v[16:31], v[92:95], a[44:47], v[16:31]
  ds_read_b64_tr_b16 v[76:77], v134 offset:26624
  ds_read_b64_tr_b16 v[78:79], v134 offset:27648
  buffer_load_dwordx4 v129, s[48:51], s60 offen offset:0 lds
  s_waitcnt lgkmcnt(4)
  v_mfma_f32_32x32x16_bf16 v[0:15], v[64:67], a[48:51], v[0:15]
  ds_read_b64_tr_b16 v[80:81], v133 offset:28672
  ds_read_b64_tr_b16 v[82:83], v133 offset:29696
  buffer_load_dwordx4 v130, s[48:51], s60 offen offset:1024 lds
  v_mfma_f32_32x32x16_bf16 v[16:31], v[68:71], a[48:51], v[16:31]
  ds_read_b64_tr_b16 v[84:85], v134 offset:28672
  ds_read_b64_tr_b16 v[86:87], v134 offset:29696
  buffer_load_dwordx4 v131, s[48:51], s60 offen offset:2048 lds
  s_waitcnt lgkmcnt(4)
  v_mfma_f32_32x32x16_bf16 v[0:15], v[72:75], a[52:55], v[0:15]
  ds_read_b64_tr_b16 v[88:89], v133 offset:30720
  ds_read_b64_tr_b16 v[90:91], v133 offset:31744
  buffer_load_dwordx4 v132, s[48:51], s60 offen offset:3072 lds
  v_mfma_f32_32x32x16_bf16 v[16:31], v[76:79], a[52:55], v[16:31]
  ds_read_b64_tr_b16 v[92:93], v134 offset:30720
  ds_read_b64_tr_b16 v[94:95], v134 offset:31744
  s_add_u32 s60, s60, 0x20000
  s_waitcnt vmcnt(36)
  s_barrier
  s_waitcnt lgkmcnt(4)
  v_mfma_f32_32x32x16_bf16 v[0:15], v[80:83], a[56:59], v[0:15]
  ds_read_b64_tr_b16 v[64:65], v133 offset:32768
  ds_read_b64_tr_b16 v[66:67], v133 offset:33792
  s_add_u32 m0, s61, 98304
  v_mfma_f32_32x32x16_bf16 v[16:31], v[84:87], a[56:59], v[16:31]
  ds_read_b64_tr_b16 v[68:69], v134 offset:32768
  ds_read_b64_tr_b16 v[70:71], v134 offset:33792
  buffer_load_dwordx4 a[192:195], v128, s[36:39], s59 offen offset:0 sc1
  s_waitcnt lgkmcnt(4)
  v_mfma_f32_32x32x16_bf16 v[0:15], v[88:91], a[60:63], v[0:15]
  ds_read_b64_tr_b16 v[72:73], v133 offset:34816
  ds_read_b64_tr_b16 v[74:75], v133 offset:35840
  buffer_load_dwordx4 a[196:199], v128, s[36:39], s59 offen offset:1024 sc1
  v_mfma_f32_32x32x16_bf16 v[16:31], v[92:95], a[60:63], v[16:31]
  ds_read_b64_tr_b16 v[76:77], v134 offset:34816
  ds_read_b64_tr_b16 v[78:79], v134 offset:35840
  buffer_load_dwordx4 a[200:203], v128, s[36:39], s59 offen offset:2048 sc1
  s_waitcnt lgkmcnt(4)
  v_mfma_f32_32x32x16_bf16 v[0:15], v[64:67], a[64:67], v[0:15]
  ds_read_b64_tr_b16 v[80:81], v133 offset:36864
  ds_read_b64_tr_b16 v[82:83], v133 offset:37888
  buffer_load_dwordx4 a[204:207], v128, s[36:39], s59 offen offset:3072 sc1
  v_mfma_f32_32x32x16_bf16 v[16:31], v[68:71], a[64:67], v[16:31]
  ds_read_b64_tr_b16 v[84:85], v134 offset:36864
  ds_read_b64_tr_b16 v[86:87], v134 offset:37888
  s_add_u32 s59, s59, 4096
  s_waitcnt lgkmcnt(4)
  v_mfma_f32_32x32x16_bf16 v[0:15], v[72:75], a[68:71], v[0:15]
  ds_read_b64_tr_b16 v[88:89], v133 offset:38912
  ds_read_b64_tr_b16 v[90:91], v133 offset:39936
  buffer_load_dwordx4 a[208:211], v128, s[36:39], s59 offen offset:0 sc1
  v_mfma_f32_32x32x16_bf16 v[16:31], v[76:79], a[68:71], v[16:31]
  ds_read_b64_tr_b16 v[92:93], v134 offset:38912
  ds_read_b64_tr_b16 v[94:95], v134 offset:39936
  buffer_load_dwordx4 a[212:215], v128, s[36:39], s59 offen offset:1024 sc1
  s_waitcnt lgkmcnt(4)
  v_mfma_f32_32x32x16_bf16 v[0:15], v[80:83], a[72:75], v[0:15]
  ds_read_b64_tr_b16 v[64:65], v133 offset:40960
  ds_read_b64_tr_b16 v[66:67], v133 offset:41984
  buffer_load_dwordx4 a[216:219], v128, s[36:39], s59 offen offset:2048 sc1
  v_mfma_f32_32x32x16_bf16 v[16:31], v[84:87], a[72:75], v[16:31]
  ds_read_b64_tr_b16 v[68:69], v134 offset:40960
  ds_read_b64_tr_b16 v[70:71], v134 offset:41984
  buffer_load_dwordx4 a[220:223], v128, s[36:39], s59 offen offset:3072 sc1
  s_waitcnt lgkmcnt(4)
  v_mfma_f32_32x32x16_bf16 v[0:15], v[88:91], a[76:79], v[0:15]
  ds_read_b64_tr_b16 v[72:73], v133 offset:43008
  ds_read_b64_tr_b16 v[74:75], v133 offset:44032
  s_add_u32 s59, s59, 4096
  v_mfma_f32_32x32x16_bf16 v[16:31], v[92:95], a[76:79], v[16:31]
  ds_read_b64_tr_b16 v[76:77], v134 offset:43008
  ds_read_b64_tr_b16 v[78:79], v134 offset:44032
  buffer_load_dwordx4 v129, s[48:51], s60 offen offset:0 lds
  s_waitcnt lgkmcnt(4)
  v_mfma_f32_32x32x16_bf16 v[0:15], v[64:67], a[80:83], v[0:15]
  ds_read_b64_tr_b16 v[80:81], v133 offset:45056
  ds_read_b64_tr_b16 v[82:83], v133 offset:46080
  buffer_load_dwordx4 v130, s[48:51], s60 offen offset:1024 lds
  v_mfma_f32_32x32x16_bf16 v[16:31], v[68:71], a[80:83], v[16:31]
  ds_read_b64_tr_b16 v[84:85], v134 offset:45056
  ds_read_b64_tr_b16 v[86:87], v134 offset:46080
  buffer_load_dwordx4 v131, s[48:51], s60 offen offset:2048 lds
  s_waitcnt lgkmcnt(4)
  v_mfma_f32_32x32x16_bf16 v[0:15], v[72:75], a[84:87], v[0:15]
  ds_read_b64_tr_b16 v[88:89], v133 offset:47104
  ds_read_b64_tr_b16 v[90:91], v133 offset:48128
  buffer_load_dwordx4 v132, s[48:51], s60 offen offset:3072 lds
  v_mfma_f32_32x32x16_bf16 v[16:31], v[76:79], a[84:87], v[16:31]
  ds_read_b64_tr_b16 v[92:93], v134 offset:47104
  ds_read_b64_tr_b16 v[94:95], v134 offset:48128
  s_add_u32 s60, s60, 0x20000
  s_waitcnt vmcnt(36)
  s_barrier
  s_waitcnt lgkmcnt(4)
  v_mfma_f32_32x32x16_bf16 v[0:15], v[80:83], a[88:91], v[0:15]
  ds_read_b64_tr_b16 v[64:65], v133 offset:49152
  ds_read_b64_tr_b16 v[66:67], v133 offset:50176
  s_add_u32 m0, s61, 114688
  v_mfma_f32_32x32x16_bf16 v[16:31], v[84:87], a[88:91], v[16:31]
  ds_read_b64_tr_b16 v[68:69], v134 offset:49152
  ds_read_b64_tr_b16 v[70:71], v134 offset:50176
  buffer_load_dwordx4 a[224:227], v128, s[36:39], s59 offen offset:0 sc1
  s_waitcnt lgkmcnt(4)
  v_mfma_f32_32x32x16_bf16 v[0:15], v[88:91], a[92:95], v[0:15]
  ds_read_b64_tr_b16 v[72:73], v133 offset:51200
  ds_read_b64_tr_b16 v[74:75], v133 offset:52224
  buffer_load_dwordx4 a[228:231], v128, s[36:39], s59 offen offset:1024 sc1
  v_mfma_f32_32x32x16_bf16 v[16:31], v[92:95], a[92:95], v[16:31]
  ds_read_b64_tr_b16 v[76:77], v134 offset:51200
  ds_read_b64_tr_b16 v[78:79], v134 offset:52224
  buffer_load_dwordx4 a[232:235], v128, s[36:39], s59 offen offset:2048 sc1
  s_waitcnt lgkmcnt(4)
  v_mfma_f32_32x32x16_bf16 v[0:15], v[64:67], a[96:99], v[0:15]
  ds_read_b64_tr_b16 v[80:81], v133 offset:53248
  ds_read_b64_tr_b16 v[82:83], v133 offset:54272
  buffer_load_dwordx4 a[236:239], v128, s[36:39], s59 offen offset:3072 sc1
  v_mfma_f32_32x32x16_bf16 v[16:31], v[68:71], a[96:99], v[16:31]
  ds_read_b64_tr_b16 v[84:85], v134 offset:53248
  ds_read_b64_tr_b16 v[86:87], v134 offset:54272
  s_add_u32 s59, s59, 4096
  s_waitcnt lgkmcnt(4)
  v_mfma_f32_32x32x16_bf16 v[0:15], v[72:75], a[100:103], v[0:15]
  ds_read_b64_tr_b16 v[88:89], v133 offset:55296
  ds_read_b64_tr_b16 v[90:91], v133 offset:56320
  buffer_load_dwordx4 a[240:243], v128, s[36:39], s59 offen offset:0 sc1
  v_mfma_f32_32x32x16_bf16 v[16:31], v[76:79], a[100:103], v[16:31]
  ds_read_b64_tr_b16 v[92:93], v134 offset:55296
  ds_read_b64_tr_b16 v[94:95], v134 offset:56320
  buffer_load_dwordx4 a[244:247], v128, s[36:39], s59 offen offset:1024 sc1
  s_waitcnt lgkmcnt(4)
  v_mfma_f32_32x32x16_bf16 v[0:15], v[80:83], a[104:107], v[0:15]
  ds_read_b64_tr_b16 v[64:65], v133 offset:57344
  ds_read_b64_tr_b16 v[66:67], v133 offset:58368
  buffer_load_dwordx4 a[248:251], v128, s[36:39], s59 offen offset:2048 sc1
  v_mfma_f32_32x32x16_bf16 v[16:31], v[84:87], a[104:107], v[16:31]
  ds_read_b64_tr_b16 v[68:69], v134 offset:57344
  ds_read_b64_tr_b16 v[70:71], v134 offset:58368
  buffer_load_dwordx4 a[252:255], v128, s[36:39], s59 offen offset:3072 sc1
  s_waitcnt lgkmcnt(4)
  v_mfma_f32_32x32x16_bf16 v[0:15], v[88:91], a[108:111], v[0:15]
  ds_read_b64_tr_b16 v[72:73], v133 offset:59392
  ds_read_b64_tr_b16 v[74:75], v133 offset:60416
  s_add_u32 s59, s59, 4096
  v_mfma_f32_32x32x16_bf16 v[16:31], v[92:95], a[108:111], v[16:31]
  ds_read_b64_tr_b16 v[76:77], v134 offset:59392
  ds_read_b64_tr_b16 v[78:79], v134 offset:60416
  buffer_load_dwordx4 v129, s[48:51], s60 offen offset:0 lds
  s_waitcnt lgkmcnt(4)
  v_mfma_f32_32x32x16_bf16 v[0:15], v[64:67], a[112:115], v[0:15]
  ds_read_b64_tr_b16 v[80:81], v133 offset:61440
  ds_read_b64_tr_b16 v[82:83], v133 offset:62464
  buffer_load_dwordx4 v130, s[48:51], s60 offen offset:1024 lds
  v_mfma_f32_32x32x16_bf16 v[16:31], v[68:71], a[112:115], v[16:31]
  ds_read_b64_tr_b16 v[84:85], v134 offset:61440
  ds_read_b64_tr_b16 v[86:87], v134 offset:62464
  buffer_load_dwordx4 v131, s[48:51], s60 offen offset:2048 lds
  s_waitcnt lgkmcnt(4)
  v_mfma_f32_32x32x16_bf16 v[0:15], v[72:75], a[116:119], v[0:15]
  ds_read_b64_tr_b16 v[88:89], v133 offset:63488
  ds_read_b64_tr_b16 v[90:91], v133 offset:64512
  buffer_load_dwordx4 v132, s[48:51], s60 offen offset:3072 lds
  v_mfma_f32_32x32x16_bf16 v[16:31], v[76:79], a[116:119], v[16:31]
  ds_read_b64_tr_b16 v[92:93], v134 offset:63488
  ds_read_b64_tr_b16 v[94:95], v134 offset:64512
  s_add_u32 s60, s60, 0x20000
  s_waitcnt vmcnt(36)
  s_barrier
  s_add_u32 s63, s62, 1
  s_xor_b32 s63, s63, s68
  s_lshl_b32 s64, s63, 16
  s_add_u32 s59, s66, s64
  s_lshl_b32 s64, s63, 20
  s_add_u32 s60, s67, s64
  s_cmp_eq_u32 s62, 3
  s_cselect_b32 s59, 0x10000000, s59
  s_waitcnt lgkmcnt(4)
  v_mfma_f32_32x32x16_bf16 v[0:15], v[80:83], a[120:123], v[0:15]
  ds_read_b64_tr_b16 v[64:65], v135 offset:0
  ds_read_b64_tr_b16 v[66:67], v135 offset:1024
  s_add_u32 m0, s61, 0
  v_mfma_f32_32x32x16_bf16 v[16:31], v[84:87], a[120:123], v[16:31]
  ds_read_b64_tr_b16 v[68:69], v136 offset:0
  ds_read_b64_tr_b16 v[70:71], v136 offset:1024
  buffer_load_dwordx4 a[0:3], v128, s[36:39], s59 offen offset:0 sc1
  s_waitcnt lgkmcnt(4)
  v_mfma_f32_32x32x16_bf16 v[0:15], v[88:91], a[124:127], v[0:15]
  ds_read_b64_tr_b16 v[72:73], v135 offset:2048
  ds_read_b64_tr_b16 v[74:75], v135 offset:3072
  buffer_load_dwordx4 a[4:7], v128, s[36:39], s59 offen offset:1024 sc1
  v_mfma_f32_32x32x16_bf16 v[16:31], v[92:95], a[124:127], v[16:31]
  ds_read_b64_tr_b16 v[76:77], v136 offset:2048
  ds_read_b64_tr_b16 v[78:79], v136 offset:3072
  buffer_load_dwordx4 a[8:11], v128, s[36:39], s59 offen offset:2048 sc1
  s_waitcnt lgkmcnt(4)
  v_mfma_f32_32x32x16_bf16 v[0:15], v[64:67], a[128:131], v[0:15]
  ds_read_b64_tr_b16 v[80:81], v135 offset:4096
  ds_read_b64_tr_b16 v[82:83], v135 offset:5120
  buffer_load_dwordx4 a[12:15], v128, s[36:39], s59 offen offset:3072 sc1
  v_mfma_f32_32x32x16_bf16 v[16:31], v[68:71], a[128:131], v[16:31]
  ds_read_b64_tr_b16 v[84:85], v136 offset:4096
  ds_read_b64_tr_b16 v[86:87], v136 offset:5120
  s_add_u32 s59, s59, 4096
  s_waitcnt lgkmcnt(4)
  v_mfma_f32_32x32x16_bf16 v[0:15], v[72:75], a[132:135], v[0:15]
  ds_read_b64_tr_b16 v[88:89], v135 offset:6144
  ds_read_b64_tr_b16 v[90:91], v135 offset:7168
  buffer_load_dwordx4 a[16:19], v128, s[36:39], s59 offen offset:0 sc1
  v_mfma_f32_32x32x16_bf16 v[16:31], v[76:79], a[132:135], v[16:31]
  ds_read_b64_tr_b16 v[92:93], v136 offset:6144
  ds_read_b64_tr_b16 v[94:95], v136 offset:7168
  buffer_load_dwordx4 a[20:23], v128, s[36:39], s59 offen offset:1024 sc1
  s_waitcnt lgkmcnt(4)
  v_mfma_f32_32x32x16_bf16 v[0:15], v[80:83], a[136:139], v[0:15]
  ds_read_b64_tr_b16 v[64:65], v135 offset:8192
  ds_read_b64_tr_b16 v[66:67], v135 offset:9216
  buffer_load_dwordx4 a[24:27], v128, s[36:39], s59 offen offset:2048 sc1
  v_mfma_f32_32x32x16_bf16 v[16:31], v[84:87], a[136:139], v[16:31]
  ds_read_b64_tr_b16 v[68:69], v136 offset:8192
  ds_read_b64_tr_b16 v[70:71], v136 offset:9216
  buffer_load_dwordx4 a[28:31], v128, s[36:39], s59 offen offset:3072 sc1
  s_waitcnt lgkmcnt(4)
  v_mfma_f32_32x32x16_bf16 v[0:15], v[88:91], a[140:143], v[0:15]
  ds_read_b64_tr_b16 v[72:73], v135 offset:10240
  ds_read_b64_tr_b16 v[74:75], v135 offset:11264
  s_add_u32 s59, s59, 4096
  v_mfma_f32_32x32x16_bf16 v[16:31], v[92:95], a[140:143], v[16:31]
  ds_read_b64_tr_b16 v[76:77], v136 offset:10240
  ds_read_b64_tr_b16 v[78:79], v136 offset:11264
  buffer_load_dwordx4 v129, s[48:51], s60 offen offset:0 lds
  s_waitcnt lgkmcnt(4)
  v_mfma_f32_32x32x16_bf16 v[0:15], v[64:67], a[144:147], v[0:15]
  ds_read_b64_tr_b16 v[80:81], v135 offset:12288
  ds_read_b64_tr_b16 v[82:83], v135 offset:13312
  buffer_load_dwordx4 v130, s[48:51], s60 offen offset:1024 lds
  v_mfma_f32_32x32x16_bf16 v[16:31], v[68:71], a[144:147], v[16:31]
  ds_read_b64_tr_b16 v[84:85], v136 offset:12288
  ds_read_b64_tr_b16 v[86:87], v136 offset:13312
  buffer_load_dwordx4 v131, s[48:51], s60 offen offset:2048 lds
  s_waitcnt lgkmcnt(4)
  v_mfma_f32_32x32x16_bf16 v[0:15], v[72:75], a[148:151], v[0:15]
  ds_read_b64_tr_b16 v[88:89], v135 offset:14336
  ds_read_b64_tr_b16 v[90:91], v135 offset:15360
  buffer_load_dwordx4 v132, s[48:51], s60 offen offset:3072 lds
  v_mfma_f32_32x32x16_bf16 v[16:31], v[76:79], a[148:151], v[16:31]
  ds_read_b64_tr_b16 v[92:93], v136 offset:14336
  ds_read_b64_tr_b16 v[94:95], v136 offset:15360
  s_add_u32 s60, s60, 0x20000
  s_waitcnt vmcnt(36)
  s_barrier
  s_waitcnt lgkmcnt(4)
  v_mfma_f32_32x32x16_bf16 v[0:15], v[80:83], a[152:155], v[0:15]
  ds_read_b64_tr_b16 v[64:65], v135 offset:16384
  ds_read_b64_tr_b16 v[66:67], v135 offset:17408
  s_add_u32 m0, s61, 16384
  v_mfma_f32_32x32x16_bf16 v[16:31], v[84:87], a[152:155], v[16:31]
  ds_read_b64_tr_b16 v[68:69], v136 offset:16384
  ds_read_b64_tr_b16 v[70:71], v136 offset:17408
  buffer_load_dwordx4 a[32:35], v128, s[36:39], s59 offen offset:0 sc1
  s_waitcnt lgkmcnt(4)
  v_mfma_f32_32x32x16_bf16 v[0:15], v[88:91], a[156:159], v[0:15]
  ds_read_b64_tr_b16 v[72:73], v135 offset:18432
  ds_read_b64_tr_b16 v[74:75], v135 offset:19456
  buffer_load_dwordx4 a[36:39], v128, s[36:39], s59 offen offset:1024 sc1
  v_mfma_f32_32x32x16_bf16 v[16:31], v[92:95], a[156:159], v[16:31]
  ds_read_b64_tr_b16 v[76:77], v136 offset:18432
  ds_read_b64_tr_b16 v[78:79], v136 offset:19456
  buffer_load_dwordx4 a[40:43], v128, s[36:39], s59 offen offset:2048 sc1
  s_waitcnt lgkmcnt(4)
  v_mfma_f32_32x32x16_bf16 v[0:15], v[64:67], a[160:163], v[0:15]
  ds_read_b64_tr_b16 v[80:81], v135 offset:20480
  ds_read_b64_tr_b16 v[82:83], v135 offset:21504
  buffer_load_dwordx4 a[44:47], v128, s[36:39], s59 offen offset:3072 sc1
  v_mfma_f32_32x32x16_bf16 v[16:31], v[68:71], a[160:163], v[16:31]
  ds_read_b64_tr_b16 v[84:85], v136 offset:20480
  ds_read_b64_tr_b16 v[86:87], v136 offset:21504
  s_add_u32 s59, s59, 4096
  s_waitcnt lgkmcnt(4)
  v_mfma_f32_32x32x16_bf16 v[0:15], v[72:75], a[164:167], v[0:15]
  ds_read_b64_tr_b16 v[88:89], v135 offset:22528
  ds_read_b64_tr_b16 v[90:91], v135 offset:23552
  buffer_load_dwordx4 a[48:51], v128, s[36:39], s59 offen offset:0 sc1
  v_mfma_f32_32x32x16_bf16 v[16:31], v[76:79], a[164:167], v[16:31]
  ds_read_b64_tr_b16 v[92:93], v136 offset:22528
  ds_read_b64_tr_b16 v[94:95], v136 offset:23552
  buffer_load_dwordx4 a[52:55], v128, s[36:39], s59 offen offset:1024 sc1
  s_waitcnt lgkmcnt(4)
  v_mfma_f32_32x32x16_bf16 v[0:15], v[80:83], a[168:171], v[0:15]
  ds_read_b64_tr_b16 v[64:65], v135 offset:24576
  ds_read_b64_tr_b16 v[66:67], v135 offset:25600
  buffer_load_dwordx4 a[56:59], v128, s[36:39], s59 offen offset:2048 sc1
  v_mfma_f32_32x32x16_bf16 v[16:31], v[84:87], a[168:171], v[16:31]
  ds_read_b64_tr_b16 v[68:69], v136 offset:24576
  ds_read_b64_tr_b16 v[70:71], v136 offset:25600
  buffer_load_dwordx4 a[60:63], v128, s[36:39], s59 offen offset:3072 sc1
  s_waitcnt lgkmcnt(4)
  v_mfma_f32_32x32x16_bf16 v[0:15], v[88:91], a[172:175], v[0:15]
  ds_read_b64_tr_b16 v[72:73], v135 offset:26624
  ds_read_b64_tr_b16 v[74:75], v135 offset:27648
  s_add_u32 s59, s59, 4096
  v_mfma_f32_32x32x16_bf16 v[16:31], v[92:95], a[172:175], v[16:31]
  ds_read_b64_tr_b16 v[76:77], v136 offset:26624
  ds_read_b64_tr_b16 v[78:79], v136 offset:27648
  buffer_load_dwordx4 v129, s[48:51], s60 offen offset:0 lds
  s_waitcnt lgkmcnt(4)
  v_mfma_f32_32x32x16_bf16 v[0:15], v[64:67], a[176:179], v[0:15]
  ds_read_b64_tr_b16 v[80:81], v135 offset:28672
  ds_read_b64_tr_b16 v[82:83], v135 offset:29696
  buffer_load_dwordx4 v130, s[48:51], s60 offen offset:1024 lds
  v_mfma_f32_32x32x16_bf16 v[16:31], v[68:71], a[176:179], v[16:31]
  ds_read_b64_tr_b16 v[84:85], v136 offset:28672
  ds_read_b64_tr_b16 v[86:87], v136 offset:29696
  buffer_load_dwordx4 v131, s[48:51], s60 offen offset:2048 lds
  s_waitcnt lgkmcnt(4)
  v_mfma_f32_32x32x16_bf16 v[0:15], v[72:75], a[180:183], v[0:15]
  ds_read_b64_tr_b16 v[88:89], v135 offset:30720
  ds_read_b64_tr_b16 v[90:91], v135 offset:31744
  buffer_load_dwordx4 v132, s[48:51], s60 offen offset:3072 lds
  v_mfma_f32_32x32x16_bf16 v[16:31], v[76:79], a[180:183], v[16:31]
  ds_read_b64_tr_b16 v[92:93], v136 offset:30720
  ds_read_b64_tr_b16 v[94:95], v136 offset:31744
  s_add_u32 s60, s60, 0x20000
  s_waitcnt vmcnt(36)
  s_barrier
  s_waitcnt lgkmcnt(4)
  v_mfma_f32_32x32x16_bf16 v[0:15], v[80:83], a[184:187], v[0:15]
  ds_read_b64_tr_b16 v[64:65], v135 offset:32768
  ds_read_b64_tr_b16 v[66:67], v135 offset:33792
  s_add_u32 m0, s61, 32768
  v_mfma_f32_32x32x16_bf16 v[16:31], v[84:87], a[184:187], v[16:31]
  ds_read_b64_tr_b16 v[68:69], v136 offset:32768
  ds_read_b64_tr_b16 v[70:71], v136 offset:33792
  buffer_load_dwordx4 a[64:67], v128, s[36:39], s59 offen offset:0 sc1
  s_waitcnt lgkmcnt(4)
  v_mfma_f32_32x32x16_bf16 v[0:15], v[88:91], a[188:191], v[0:15]
  ds_read_b64_tr_b16 v[72:73], v135 offset:34816
  ds_read_b64_tr_b16 v[74:75], v135 offset:35840
  buffer_load_dwordx4 a[68:71], v128, s[36:39], s59 offen offset:1024 sc1
  v_mfma_f32_32x32x16_bf16 v[16:31], v[92:95], a[188:191], v[16:31]
  ds_read_b64_tr_b16 v[76:77], v136 offset:34816
  ds_read_b64_tr_b16 v[78:79], v136 offset:35840
  buffer_load_dwordx4 a[72:75], v128, s[36:39], s59 offen offset:2048 sc1
  s_waitcnt lgkmcnt(4)
  v_mfma_f32_32x32x16_bf16 v[0:15], v[64:67], a[192:195], v[0:15]
  ds_read_b64_tr_b16 v[80:81], v135 offset:36864
  ds_read_b64_tr_b16 v[82:83], v135 offset:37888
  buffer_load_dwordx4 a[76:79], v128, s[36:39], s59 offen offset:3072 sc1
  v_mfma_f32_32x32x16_bf16 v[16:31], v[68:71], a[192:195], v[16:31]
  ds_read_b64_tr_b16 v[84:85], v136 offset:36864
  ds_read_b64_tr_b16 v[86:87], v136 offset:37888
  s_add_u32 s59, s59, 4096
  s_waitcnt lgkmcnt(4)
  v_mfma_f32_32x32x16_bf16 v[0:15], v[72:75], a[196:199], v[0:15]
  ds_read_b64_tr_b16 v[88:89], v135 offset:38912
  ds_read_b64_tr_b16 v[90:91], v135 offset:39936
  buffer_load_dwordx4 a[80:83], v128, s[36:39], s59 offen offset:0 sc1
  v_mfma_f32_32x32x16_bf16 v[16:31], v[76:79], a[196:199], v[16:31]
  ds_read_b64_tr_b16 v[92:93], v136 offset:38912
  ds_read_b64_tr_b16 v[94:95], v136 offset:39936
  buffer_load_dwordx4 a[84:87], v128, s[36:39], s59 offen offset:1024 sc1
  s_waitcnt lgkmcnt(4)
  v_mfma_f32_32x32x16_bf16 v[0:15], v[80:83], a[200:203], v[0:15]
  ds_read_b64_tr_b16 v[64:65], v135 offset:40960
  ds_read_b64_tr_b16 v[66:67], v135 offset:41984
  buffer_load_dwordx4 a[88:91], v128, s[36:39], s59 offen offset:2048 sc1
  v_mfma_f32_32x32x16_bf16 v[16:31], v[84:87], a[200:203], v[16:31]
  ds_read_b64_tr_b16 v[68:69], v136 offset:40960
  ds_read_b64_tr_b16 v[70:71], v136 offset:41984
  buffer_load_dwordx4 a[92:95], v128, s[36:39], s59 offen offset:3072 sc1
  s_waitcnt lgkmcnt(4)
  v_mfma_f32_32x32x16_bf16 v[0:15], v[88:91], a[204:207], v[0:15]
  ds_read_b64_tr_b16 v[72:73], v135 offset:43008
  ds_read_b64_tr_b16 v[74:75], v135 offset:44032
  s_add_u32 s59, s59, 4096
  v_mfma_f32_32x32x16_bf16 v[16:31], v[92:95], a[204:207], v[16:31]
  ds_read_b64_tr_b16 v[76:77], v136 offset:43008
  ds_read_b64_tr_b16 v[78:79], v136 offset:44032
  buffer_load_dwordx4 v129, s[48:51], s60 offen offset:0 lds
  s_waitcnt lgkmcnt(4)
  v_mfma_f32_32x32x16_bf16 v[0:15], v[64:67], a[208:211], v[0:15]
  ds_read_b64_tr_b16 v[80:81], v135 offset:45056
  ds_read_b64_tr_b16 v[82:83], v135 offset:46080
  buffer_load_dwordx4 v130, s[48:51], s60 offen offset:1024 lds
  v_mfma_f32_32x32x16_bf16 v[16:31], v[68:71], a[208:211], v[16:31]
  ds_read_b64_tr_b16 v[84:85], v136 offset:45056
  ds_read_b64_tr_b16 v[86:87], v136 offset:46080
  buffer_load_dwordx4 v131, s[48:51], s60 offen offset:2048 lds
  s_waitcnt lgkmcnt(4)
  v_mfma_f32_32x32x16_bf16 v[0:15], v[72:75], a[212:215], v[0:15]
  ds_read_b64_tr_b16 v[88:89], v135 offset:47104
  ds_read_b64_tr_b16 v[90:91], v135 offset:48128
  buffer_load_dwordx4 v132, s[48:51], s60 offen offset:3072 lds
  v_mfma_f32_32x32x16_bf16 v[16:31], v[76:79], a[212:215], v[16:31]
  ds_read_b64_tr_b16 v[92:93], v136 offset:47104
  ds_read_b64_tr_b16 v[94:95], v136 offset:48128
  s_add_u32 s60, s60, 0x20000
  s_waitcnt vmcnt(36)
  s_barrier
  s_waitcnt lgkmcnt(4)
  v_mfma_f32_32x32x16_bf16 v[0:15], v[80:83], a[216:219], v[0:15]
  ds_read_b64_tr_b16 v[64:65], v135 offset:49152
  ds_read_b64_tr_b16 v[66:67], v135 offset:50176
  s_add_u32 m0, s61, 49152
  v_mfma_f32_32x32x16_bf16 v[16:31], v[84:87], a[216:219], v[16:31]
  ds_read_b64_tr_b16 v[68:69], v136 offset:49152
  ds_read_b64_tr_b16 v[70:71], v136 offset:50176
  buffer_load_dwordx4 a[96:99], v128, s[36:39], s59 offen offset:0 sc1
  s_waitcnt lgkmcnt(4)
  v_mfma_f32_32x32x16_bf16 v[0:15], v[88:91], a[220:223], v[0:15]
  ds_read_b64_tr_b16 v[72:73], v135 offset:51200
  ds_read_b64_tr_b16 v[74:75], v135 offset:52224
  buffer_load_dwordx4 a[100:103], v128, s[36:39], s59 offen offset:1024 sc1
  v_mfma_f32_32x32x16_bf16 v[16:31], v[92:95], a[220:223], v[16:31]
  ds_read_b64_tr_b16 v[76:77], v136 offset:51200
  ds_read_b64_tr_b16 v[78:79], v136 offset:52224
  buffer_load_dwordx4 a[104:107], v128, s[36:39], s59 offen offset:2048 sc1
  s_waitcnt lgkmcnt(4)
  v_mfma_f32_32x32x16_bf16 v[0:15], v[64:67], a[224:227], v[0:15]
  ds_read_b64_tr_b16 v[80:81], v135 offset:53248
  ds_read_b64_tr_b16 v[82:83], v135 offset:54272
  buffer_load_dwordx4 a[108:111], v128, s[36:39], s59 offen offset:3072 sc1
  v_mfma_f32_32x32x16_bf16 v[16:31], v[68:71], a[224:227], v[16:31]
  ds_read_b64_tr_b16 v[84:85], v136 offset:53248
  ds_read_b64_tr_b16 v[86:87], v136 offset:54272
  s_add_u32 s59, s59, 4096
  s_waitcnt lgkmcnt(4)
  v_mfma_f32_32x32x16_bf16 v[0:15], v[72:75], a[228:231], v[0:15]
  ds_read_b64_tr_b16 v[88:89], v135 offset:55296
  ds_read_b64_tr_b16 v[90:91], v135 offset:56320
  buffer_load_dwordx4 a[112:115], v128, s[36:39], s59 offen offset:0 sc1
  v_mfma_f32_32x32x16_bf16 v[16:31], v[76:79], a[228:231], v[16:31]
  ds_read_b64_tr_b16 v[92:93], v136 offset:55296
  ds_read_b64_tr_b16 v[94:95], v136 offset:56320
  buffer_load_dwordx4 a[116:119], v128, s[36:39], s59 offen offset:1024 sc1
  s_waitcnt lgkmcnt(4)
  v_mfma_f32_32x32x16_bf16 v[0:15], v[80:83], a[232:235], v[0:15]
  ds_read_b64_tr_b16 v[64:65], v135 offset:57344
  ds_read_b64_tr_b16 v[66:67], v135 offset:58368
  buffer_load_dwordx4 a[120:123], v128, s[36:39], s59 offen offset:2048 sc1
  v_mfma_f32_32x32x16_bf16 v[16:31], v[84:87], a[232:235], v[16:31]
  ds_read_b64_tr_b16 v[68:69], v136 offset:57344
  ds_read_b64_tr_b16 v[70:71], v136 offset:58368
  buffer_load_dwordx4 a[124:127], v128, s[36:39], s59 offen offset:3072 sc1
  s_waitcnt lgkmcnt(4)
  v_mfma_f32_32x32x16_bf16 v[0:15], v[88:91], a[236:239], v[0:15]
  ds_read_b64_tr_b16 v[72:73], v135 offset:59392
  ds_read_b64_tr_b16 v[74:75], v135 offset:60416
  s_add_u32 s59, s59, 4096
  v_mfma_f32_32x32x16_bf16 v[16:31], v[92:95], a[236:239], v[16:31]
  ds_read_b64_tr_b16 v[76:77], v136 offset:59392
  ds_read_b64_tr_b16 v[78:79], v136 offset:60416
  buffer_load_dwordx4 v129, s[48:51], s60 offen offset:0 lds
  s_waitcnt lgkmcnt(4)
  v_mfma_f32_32x32x16_bf16 v[0:15], v[64:67], a[240:243], v[0:15]
  ds_read_b64_tr_b16 v[80:81], v135 offset:61440
  ds_read_b64_tr_b16 v[82:83], v135 offset:62464
  buffer_load_dwordx4 v130, s[48:51], s60 offen offset:1024 lds
  v_mfma_f32_32x32x16_bf16 v[16:31], v[68:71], a[240:243], v[16:31]
  ds_read_b64_tr_b16 v[84:85], v136 offset:61440
  ds_read_b64_tr_b16 v[86:87], v136 offset:62464
  buffer_load_dwordx4 v131, s[48:51], s60 offen offset:2048 lds
  s_waitcnt lgkmcnt(4)
  v_mfma_f32_32x32x16_bf16 v[0:15], v[72:75], a[244:247], v[0:15]
  ds_read_b64_tr_b16 v[88:89], v135 offset:63488
  ds_read_b64_tr_b16 v[90:91], v135 offset:64512
  buffer_load_dwordx4 v132, s[48:51], s60 offen offset:3072 lds
  v_mfma_f32_32x32x16_bf16 v[16:31], v[76:79], a[244:247], v[16:31]
  ds_read_b64_tr_b16 v[92:93], v136 offset:63488
  ds_read_b64_tr_b16 v[94:95], v136 offset:64512
  s_add_u32 s60, s60, 0x20000
  s_waitcnt vmcnt(36)
  s_barrier
  s_waitcnt lgkmcnt(4)
  v_mfma_f32_32x32x16_bf16 v[0:15], v[80:83], a[248:251], v[0:15]
  ds_read_b64_tr_b16 v[64:65], v133 offset:0
  ds_read_b64_tr_b16 v[66:67], v133 offset:1024
  s_add_u32 m0, s61, 65536
  v_mfma_f32_32x32x16_bf16 v[16:31], v[84:87], a[248:251], v[16:31]
  ds_read_b64_tr_b16 v[68:69], v134 offset:0
  ds_read_b64_tr_b16 v[70:71], v134 offset:1024
  buffer_load_dwordx4 a[128:131], v128, s[36:39], s59 offen offset:0 sc1
  s_waitcnt lgkmcnt(4)
  v_mfma_f32_32x32x16_bf16 v[0:15], v[88:91], a[252:255], v[0:15]
  ds_read_b64_tr_b16 v[72:73], v133 offset:2048
  ds_read_b64_tr_b16 v[74:75], v133 offset:3072
  buffer_load_dwordx4 a[132:135], v128, s[36:39], s59 offen offset:1024 sc1
  v_mfma_f32_32x32x16_bf16 v[16:31], v[92:95], a[252:255], v[16:31]
  ds_read_b64_tr_b16 v[76:77], v134 offset:2048
  ds_read_b64_tr_b16 v[78:79], v134 offset:3072
  buffer_load_dwordx4 a[136:139], v128, s[36:39], s59 offen offset:2048 sc1
  s_add_u32 s62, s62, 1
  s_cmp_lt_u32 s62, 4
  s_cbranch_scc1 OH_loop
  s_lshl_b32 s63, s56, 18
  s_add_u32 s63, s63, s57
  s_lshl_b32 s64, s58, 10
  s_add_u32 s63, s63, s64
  s_waitcnt lgkmcnt(0)
  v_cvt_pk_bf16_f32 v0, v0, v1
  v_cvt_pk_bf16_f32 v1, v2, v3
  v_cvt_pk_bf16_f32 v2, v4, v5
  v_cvt_pk_bf16_f32 v3, v6, v7
  v_cvt_pk_bf16_f32 v4, v8, v9
  v_cvt_pk_bf16_f32 v5, v10, v11
  v_cvt_pk_bf16_f32 v6, v12, v13
  v_cvt_pk_bf16_f32 v7, v14, v15
  v_permlane32_swap_b32 v0, v2
  v_permlane32_swap_b32 v1, v3
  v_permlane32_swap_b32 v4, v6
  v_permlane32_swap_b32 v5, v7
  buffer_store_dwordx4 v[0:3], v141, s[52:55], s63 offen offset:0
  buffer_store_dwordx4 v[4:7], v141, s[52:55], s63 offen offset:32
  v_cvt_pk_bf16_f32 v16, v16, v17
  v_cvt_pk_bf16_f32 v17, v18, v19
  v_cvt_pk_bf16_f32 v18, v20, v21
  v_cvt_pk_bf16_f32 v19, v22, v23
  v_cvt_pk_bf16_f32 v20, v24, v25
  v_cvt_pk_bf16_f32 v21, v26, v27
  v_cvt_pk_bf16_f32 v22, v28, v29
  v_cvt_pk_bf16_f32 v23, v30, v31
  v_permlane32_swap_b32 v16, v18
  v_permlane32_swap_b32 v17, v19
  v_permlane32_swap_b32 v20, v22
  v_permlane32_swap_b32 v21, v23
  buffer_store_dwordx4 v[16:19], v141, s[52:55], s63 offen offset:64
  buffer_store_dwordx4 v[20:23], v141, s[52:55], s63 offen offset:96
  s_mov_b32 s81, 7
  s_mov_b32 s82, 0
  s_branch L_jobend
L_ops:
  s_bfe_u32 s56, s90, 0x40003
  s_bfe_u32 s57, s90, 0x60007
  s_bfe_u32 s58, s90, 0x7000d
  s_bfe_u32 s59, s90, 0x40014
  s_bfe_u32 s64, s90, 0x10018
  s_mov_b32 s52, s30
  s_and_b32 s53, s31, 0xffff
  s_mov_b32 s54, 0x400000
  s_mov_b32 s55, 0x20000
  s_mov_b32 s48, s14
  s_and_b32 s49, s15, 0xffff
  s_mov_b32 s50, 0x400000
  s_mov_b32 s51, 0x20000
  s_lshl_b32 s63, s40, 15
  v_lshlrev_b32 v224, 4, v255
  v_lshrrev_b32 v232, 2, v255
  v_and_b32 v233, 3, v255
  v_lshlrev_b32 v233, 4, v233
  v_lshl_add_u32 v225, v232, 10, v233
  v_bfe_u32 v232, v255, 2, 2
  v_lshlrev_b32 v233, 6, v232
  v_lshrrev_b32 v232, 5, v255
  v_lshl_add_u32 v233, v232, 8, v233
  v_bfe_u32 v232, v255, 4, 1
  v_lshl_add_u32 v233, v232, 5, v233
  v_and_b32 v232, 3, v255
  v_lshl_add_u32 v233, v232, 3, v233
  v_add_u32 v226, s63, v233
  v_and_b32 v232, 15, v255
  v_lshlrev_b32 v232, 4, v232
  v_lshrrev_b32 v233, 5, v255
  v_lshl_add_u32 v232, v233, 9, v232
  v_bfe_u32 v233, v255, 4, 1
  v_lshl_add_u32 v232, v233, 10, v232
  s_lshl_b32 s60, s64, 8
  v_add_u32 v230, s60, v232
  v_and_b32 v232, 15, v255
  v_lshlrev_b32 v232, 11, v232
  v_lshrrev_b32 v233, 5, v255
  v_lshl_add_u32 v232, v233, 3, v232
  v_bfe_u32 v233, v255, 4, 1
  v_lshl_add_u32 v232, v233, 30, v232
  s_lshl_b32 s60, s40, 4
  s_lshl_b32 s61, s64, 15
  s_add_u32 s60, s60, s61
  v_add_u32 v227, s60, v232
  s_lshl_b32 s60, s40, 12
  v_add_u32 v228, s60, v224
  s_lshl_b32 s60, s40, 10
  v_and_b32 v232, 0x2f0, v224
  v_add_u32 v229, s60, v232
  s_mov_b32 s66, 0xffff0000
  s_mov_b32 s67, 0xffff0000
  s_lshl_b32 s61, s40, 20
  s_lshl_b32 s60, s56, 6
  s_add_u32 s61, s61, s60
  s_and_b32 s69, s56, 7
  s_lshl_b32 s69, s69, 13
  s_lshl_b32 s70, s69, 4
  s_barrier
  s_add_u32 m0, s63, 0
  s_add_u32 s60, s70, 0
  s_and_b32 s60, s60, 0xfffff
  s_add_u32 s60, s60, s61
  buffer_load_dwordx4 v225, s[48:51], s60 offen lds
  s_add_u32 m0, s63, 1024
  s_add_u32 s60, s70, 16384
  s_and_b32 s60, s60, 0xfffff
  s_add_u32 s60, s60, s61
  buffer_load_dwordx4 v225, s[48:51], s60 offen lds
  s_add_u32 m0, s63, 2048
  s_add_u32 s60, s70, 32768
  s_and_b32 s60, s60, 0xfffff
  s_add_u32 s60, s60, s61
  buffer_load_dwordx4 v225, s[48:51], s60 offen lds
  s_add_u32 m0, s63, 3072
  s_add_u32 s60, s70, 49152
  s_and_b32 s60, s60, 0xfffff
  s_add_u32 s60, s60, s61
  buffer_load_dwordx4 v225, s[48:51], s60 offen lds
  s_add_u32 m0, s63, 4096
  s_add_u32 s60, s70, 65536
  s_and_b32 s60, s60, 0xfffff
  s_add_u32 s60, s60, s61
  buffer_load_dwordx4 v225, s[48:51], s60 offen lds
  s_add_u32 m0, s63, 5120
  s_add_u32 s60, s70, 81920
  s_and_b32 s60, s60, 0xfffff
  s_add_u32 s60, s60, s61
  buffer_load_dwordx4 v225, s[48:51], s60 offen lds
  s_add_u32 m0, s63, 6144
  s_add_u32 s60, s70, 98304
  s_and_b32 s60, s60, 0xfffff
  s_add_u32 s60, s60, s61
  buffer_load_dwordx4 v225, s[48:51], s60 offen lds
  s_add_u32 m0, s63, 7168
  s_add_u32 s60, s70, 114688
  s_and_b32 s60, s60, 0xfffff
  s_add_u32 s60, s60, s61
  buffer_load_dwordx4 v225, s[48:51], s60 offen lds
  s_add_u32 m0, s63, 8192
  s_add_u32 s60, s70, 131072
  s_and_b32 s60, s60, 0xfffff
  s_add_u32 s60, s60, s61
  buffer_load_dwordx4 v225, s[48:51], s60 offen lds
  s_add_u32 m0, s63, 9216
  s_add_u32 s60, s70, 147456
  s_and_b32 s60, s60, 0xfffff
  s_add_u32 s60, s60, s61
  buffer_load_dwordx4 v225, s[48:51], s60 offen lds
  s_add_u32 m0, s63, 10240
  s_add_u32 s60, s70, 163840
  s_and_b32 s60, s60, 0xfffff
  s_add_u32 s60, s60, s61
  buffer_load_dwordx4 v225, s[48:51], s60 offen lds
  s_add_u32 m0, s63, 11264
  s_add_u32 s60, s70, 180224
  s_and_b32 s60, s60, 0xfffff
  s_add_u32 s60, s60, s61
  buffer_load_dwordx4 v225, s[48:51], s60 offen lds
  s_add_u32 m0, s63, 12288
  s_add_u32 s60, s70, 196608
  s_and_b32 s60, s60, 0xfffff
  s_add_u32 s60, s60, s61
  buffer_load_dwordx4 v225, s[48:51], s60 offen lds
  s_add_u32 m0, s63, 13312
  s_add_u32 s60, s70, 212992
  s_and_b32 s60, s60, 0xfffff
  s_add_u32 s60, s60, s61
  buffer_load_dwordx4 v225, s[48:51], s60 offen lds
  s_add_u32 m0, s63, 14336
  s_add_u32 s60, s70, 229376
  s_and_b32 s60, s60, 0xfffff
  s_add_u32 s60, s60, s61
  buffer_load_dwordx4 v225, s[48:51], s60 offen lds
  s_add_u32 m0, s63, 15360
  s_add_u32 s60, s70, 245760
  s_and_b32 s60, s60, 0xfffff
  s_add_u32 s60, s60, s61
  buffer_load_dwordx4 v225, s[48:51], s60 offen lds
  s_add_u32 m0, s63, 16384
  s_add_u32 s60, s70, 262144
  s_and_b32 s60, s60, 0xfffff
  s_add_u32 s60, s60, s61
  buffer_load_dwordx4 v225, s[48:51], s60 offen lds
  s_add_u32 m0, s63, 17408
  s_add_u32 s60, s70, 278528
  s_and_b32 s60, s60, 0xfffff
  s_add_u32 s60, s60, s61
  buffer_load_dwordx4 v225, s[48:51], s60 offen lds
  s_add_u32 m0, s63, 18432
  s_add_u32 s60, s70, 294912
  s_and_b32 s60, s60, 0xfffff
  s_add_u32 s60, s60, s61
  buffer_load_dwordx4 v225, s[48:51], s60 offen lds
  s_add_u32 m0, s63, 19456
  s_add_u32 s60, s70, 311296
  s_and_b32 s60, s60, 0xfffff
  s_add_u32 s60, s60, s61
  buffer_load_dwordx4 v225, s[48:51], s60 offen lds
  s_add_u32 m0, s63, 20480
  s_add_u32 s60, s70, 327680
  s_and_b32 s60, s60, 0xfffff
  s_add_u32 s60, s60, s61
  buffer_load_dwordx4 v225, s[48:51], s60 offen lds
  s_add_u32 m0, s63, 21504
  s_add_u32 s60, s70, 344064
  s_and_b32 s60, s60, 0xfffff
  s_add_u32 s60, s60, s61
  buffer_load_dwordx4 v225, s[48:51], s60 offen lds
  s_add_u32 m0, s63, 22528
  s_add_u32 s60, s70, 360448
  s_and_b32 s60, s60, 0xfffff
  s_add_u32 s60, s60, s61
  buffer_load_dwordx4 v225, s[48:51], s60 offen lds
  s_add_u32 m0, s63, 23552
  s_add_u32 s60, s70, 376832
  s_and_b32 s60, s60, 0xfffff
  s_add_u32 s60, s60, s61
  buffer_load_dwordx4 v225, s[48:51], s60 offen lds
  s_add_u32 m0, s63, 24576
  s_add_u32 s60, s70, 393216
  s_and_b32 s60, s60, 0xfffff
  s_add_u32 s60, s60, s61
  buffer_load_dwordx4 v225, s[48:51], s60 offen lds
  s_add_u32 m0, s63, 25600
  s_add_u32 s60, s70, 409600
  s_and_b32 s60, s60, 0xfffff
  s_add_u32 s60, s60, s61
  buffer_load_dwordx4 v225, s[48:51], s60 offen lds
  s_add_u32 m0, s63, 26624
  s_add_u32 s60, s70, 425984
  s_and_b32 s60, s60, 0xfffff
  s_add_u32 s60, s60, s61
  buffer_load_dwordx4 v225, s[48:51], s60 offen lds
  s_add_u32 m0, s63, 27648
  s_add_u32 s60, s70, 442368
  s_and_b32 s60, s60, 0xfffff
  s_add_u32 s60, s60, s61
  buffer_load_dwordx4 v225, s[48:51], s60 offen lds
  s_add_u32 m0, s63, 28672
  s_add_u32 s60, s70, 458752
  s_and_b32 s60, s60, 0xfffff
  s_add_u32 s60, s60, s61
  buffer_load_dwordx4 v225, s[48:51], s60 offen lds
  s_add_u32 m0, s63, 29696
  s_add_u32 s60, s70, 475136
  s_and_b32 s60, s60, 0xfffff
  s_add_u32 s60, s60, s61
  buffer_load_dwordx4 v225, s[48:51], s60 offen lds
  s_add_u32 m0, s63, 30720
  s_add_u32 s60, s70, 491520
  s_and_b32 s60, s60, 0xfffff
  s_add_u32 s60, s60, s61
  buffer_load_dwordx4 v225, s[48:51], s60 offen lds
  s_add_u32 m0, s63, 31744
  s_add_u32 s60, s70, 507904
  s_and_b32 s60, s60, 0xfffff
  s_add_u32 s60, s60, s61
  buffer_load_dwordx4 v225, s[48:51], s60 offen lds
  s_waitcnt vmcnt(24)
  ds_read_b64_tr_b16 a[0:1], v226 offset:0
  ds_read_b64_tr_b16 a[2:3], v226 offset:512
  ds_read_b64_tr_b16 a[4:5], v226 offset:1024
  ds_read_b64_tr_b16 a[6:7], v226 offset:1536
  ds_read_b64_tr_b16 a[8:9], v226 offset:2048
  ds_read_b64_tr_b16 a[10:11], v226 offset:2560
  ds_read_b64_tr_b16 a[12:13], v226 offset:3072
  ds_read_b64_tr_b16 a[14:15], v226 offset:3584
  s_waitcnt lgkmcnt(0)
  ds_read_b64_tr_b16 a[16:17], v226 offset:4096
  ds_read_b64_tr_b16 a[18:19], v226 offset:4608
  ds_read_b64_tr_b16 a[20:21], v226 offset:5120
  ds_read_b64_tr_b16 a[22:23], v226 offset:5632
  ds_read_b64_tr_b16 a[24:25], v226 offset:6144
  ds_read_b64_tr_b16 a[26:27], v226 offset:6656
  ds_read_b64_tr_b16 a[28:29], v226 offset:7168
  ds_read_b64_tr_b16 a[30:31], v226 offset:7680
  s_waitcnt lgkmcnt(0)
  s_add_u32 m0, s63, 0
  s_add_u32 s60, s70, 524288
  s_and_b32 s60, s60, 0xfffff
  s_add_u32 s60, s60, s61
  buffer_load_dwordx4 v225, s[48:51], s60 offen lds
  s_add_u32 m0, s63, 1024
  s_add_u32 s60, s70, 540672
  s_and_b32 s60, s60, 0xfffff
  s_add_u32 s60, s60, s61
  buffer_load_dwordx4 v225, s[48:51], s60 offen lds
  s_add_u32 m0, s63, 2048
  s_add_u32 s60, s70, 557056
  s_and_b32 s60, s60, 0xfffff
  s_add_u32 s60, s60, s61
  buffer_load_dwordx4 v225, s[48:51], s60 offen lds
  s_add_u32 m0, s63, 3072
  s_add_u32 s60, s70, 573440
  s_and_b32 s60, s60, 0xfffff
  s_add_u32 s60, s60, s61
  buffer_load_dwordx4 v225, s[48:51], s60 offen lds
  s_add_u32 m0, s63, 4096
  s_add_u32 s60, s70, 589824
  s_and_b32 s60, s60, 0xfffff
  s_add_u32 s60, s60, s61
  buffer_load_dwordx4 v225, s[48:51], s60 offen lds
  s_add_u32 m0, s63, 5120
  s_add_u32 s60, s70, 606208
  s_and_b32 s60, s60, 0xfffff
  s_add_u32 s60, s60, s61
  buffer_load_dwordx4 v225, s[48:51], s60 offen lds
  s_add_u32 m0, s63, 6144
  s_add_u32 s60, s70, 622592
  s_and_b32 s60, s60, 0xfffff
  s_add_u32 s60, s60, s61
  buffer_load_dwordx4 v225, s[48:51], s60 offen lds
  s_add_u32 m0, s63, 7168
  s_add_u32 s60, s70, 638976
  s_and_b32 s60, s60, 0xfffff
  s_add_u32 s60, s60, s61
  buffer_load_dwordx4 v225, s[48:51], s60 offen lds
  s_waitcnt vmcnt(24)
  ds_read_b64_tr_b16 a[32:33], v226 offset:8192
  ds_read_b64_tr_b16 a[34:35], v226 offset:8704
  ds_read_b64_tr_b16 a[36:37], v226 offset:9216
  ds_read_b64_tr_b16 a[38:39], v226 offset:9728
  ds_read_b64_tr_b16 a[40:41], v226 offset:10240
  ds_read_b64_tr_b16 a[42:43], v226 offset:10752
  ds_read_b64_tr_b16 a[44:45], v226 offset:11264
  ds_read_b64_tr_b16 a[46:47], v226 offset:11776
  s_waitcnt lgkmcnt(0)
  ds_read_b64_tr_b16 a[48:49], v226 offset:12288
  ds_read_b64_tr_b16 a[50:51], v226 offset:12800
  ds_read_b64_tr_b16 a[52:53], v226 offset:13312
  ds_read_b64_tr_b16 a[54:55], v226 offset:13824
  ds_read_b64_tr_b16 a[56:57], v226 offset:14336
  ds_read_b64_tr_b16 a[58:59], v226 offset:14848
  ds_read_b64_tr_b16 a[60:61], v226 offset:15360
  ds_read_b64_tr_b16 a[62:63], v226 offset:15872
  s_waitcnt lgkmcnt(0)
  s_add_u32 m0, s63, 8192
  s_add_u32 s60, s70, 655360
  s_and_b32 s60, s60, 0xfffff
  s_add_u32 s60, s60, s61
  buffer_load_dwordx4 v225, s[48:51], s60 offen lds
  s_add_u32 m0, s63, 9216
  s_add_u32 s60, s70, 671744
  s_and_b32 s60, s60, 0xfffff
  s_add_u32 s60, s60, s61
  buffer_load_dwordx4 v225, s[48:51], s60 offen lds
  s_add_u32 m0, s63, 10240
  s_add_u32 s60, s70, 688128
  s_and_b32 s60, s60, 0xfffff
  s_add_u32 s60, s60, s61
  buffer_load_dwordx4 v225, s[48:51], s60 offen lds
  s_add_u32 m0, s63, 11264
  s_add_u32 s60, s70, 704512
  s_and_b32 s60, s60, 0xfffff
  s_add_u32 s60, s60, s61
  buffer_load_dwordx4 v225, s[48:51], s60 offen lds
  s_add_u32 m0, s63, 12288
  s_add_u32 s60, s70, 720896
  s_and_b32 s60, s60, 0xfffff
  s_add_u32 s60, s60, s61
  buffer_load_dwordx4 v225, s[48:51], s60 offen lds
  s_add_u32 m0, s63, 13312
  s_add_u32 s60, s70, 737280
  s_and_b32 s60, s60, 0xfffff
  s_add_u32 s60, s60, s61
  buffer_load_dwordx4 v225, s[48:51], s60 offen lds
  s_add_u32 m0, s63, 14336
  s_add_u32 s60, s70, 753664
  s_and_b32 s60, s60, 0xfffff
  s_add_u32 s60, s60, s61
  buffer_load_dwordx4 v225, s[48:51], s60 offen lds
  s_add_u32 m0, s63, 15360
  s_add_u32 s60, s70, 770048
  s_and_b32 s60, s60, 0xfffff
  s_add_u32 s60, s60, s61
  buffer_load_dwordx4 v225, s[48:51], s60 offen lds
  s_waitcnt vmcnt(24)
  ds_read_b64_tr_b16 a[64:65], v226 offset:16384
  ds_read_b64_tr_b16 a[66:67], v226 offset:16896
  ds_read_b64_tr_b16 a[68:69], v226 offset:17408
  ds_read_b64_tr_b16 a[70:71], v226 offset:17920
  ds_read_b64_tr_b16 a[72:73], v226 offset:18432
  ds_read_b64_tr_b16 a[74:75], v226 offset:18944
  ds_read_b64_tr_b16 a[76:77], v226 offset:19456
  ds_read_b64_tr_b16 a[78:79], v226 offset:19968
  s_waitcnt lgkmcnt(0)
  ds_read_b64_tr_b16 a[80:81], v226 offset:20480
  ds_read_b64_tr_b16 a[82:83], v226 offset:20992
  ds_read_b64_tr_b16 a[84:85], v226 offset:21504
  ds_read_b64_tr_b16 a[86:87], v226 offset:22016
  ds_read_b64_tr_b16 a[88:89], v226 offset:22528
  ds_read_b64_tr_b16 a[90:91], v226 offset:23040
  ds_read_b64_tr_b16 a[92:93], v226 offset:23552
  ds_read_b64_tr_b16 a[94:95], v226 offset:24064
  s_waitcnt lgkmcnt(0)
  s_add_u32 m0, s63, 16384
  s_add_u32 s60, s70, 786432
  s_and_b32 s60, s60, 0xfffff
  s_add_u32 s60, s60, s61
  buffer_load_dwordx4 v225, s[48:51], s60 offen lds
  s_add_u32 m0, s63, 17408
  s_add_u32 s60, s70, 802816
  s_and_b32 s60, s60, 0xfffff
  s_add_u32 s60, s60, s61
  buffer_load_dwordx4 v225, s[48:51], s60 offen lds
  s_add_u32 m0, s63, 18432
  s_add_u32 s60, s70, 819200
  s_and_b32 s60, s60, 0xfffff
  s_add_u32 s60, s60, s61
  buffer_load_dwordx4 v225, s[48:51], s60 offen lds
  s_add_u32 m0, s63, 19456
  s_add_u32 s60, s70, 835584
  s_and_b32 s60, s60, 0xfffff
  s_add_u32 s60, s60, s61
  buffer_load_dwordx4 v225, s[48:51], s60 offen lds
  s_add_u32 m0, s63, 20480
  s_add_u32 s60, s70, 851968
  s_and_b32 s60, s60, 0xfffff
  s_add_u32 s60, s60, s61
  buffer_load_dwordx4 v225, s[48:51], s60 offen lds
  s_add_u32 m0, s63, 21504
  s_add_u32 s60, s70, 868352
  s_and_b32 s60, s60, 0xfffff
  s_add_u32 s60, s60, s61
  buffer_load_dwordx4 v225, s[48:51], s60 offen lds
  s_add_u32 m0, s63, 22528
  s_add_u32 s60, s70, 884736
  s_and_b32 s60, s60, 0xfffff
  s_add_u32 s60, s60, s61
  buffer_load_dwordx4 v225, s[48:51], s60 offen lds
  s_add_u32 m0, s63, 23552
  s_add_u32 s60, s70, 901120
  s_and_b32 s60, s60, 0xfffff
  s_add_u32 s60, s60, s61
  buffer_load_dwordx4 v225, s[48:51], s60 offen lds
  s_waitcnt vmcnt(24)
  ds_read_b64_tr_b16 a[96:97], v226 offset:24576
  ds_read_b64_tr_b16 a[98:99], v226 offset:25088
  ds_read_b64_tr_b16 a[100:101], v226 offset:25600
  ds_read_b64_tr_b16 a[102:103], v226 offset:26112
  ds_read_b64_tr_b16 a[104:105], v226 offset:26624
  ds_read_b64_tr_b16 a[106:107], v226 offset:27136
  ds_read_b64_tr_b16 a[108:109], v226 offset:27648
  ds_read_b64_tr_b16 a[110:111], v226 offset:28160
  s_waitcnt lgkmcnt(0)
  ds_read_b64_tr_b16 a[112:113], v226 offset:28672
  ds_read_b64_tr_b16 a[114:115], v226 offset:29184
  ds_read_b64_tr_b16 a[116:117], v226 offset:29696
  ds_read_b64_tr_b16 a[118:119], v226 offset:30208
  ds_read_b64_tr_b16 a[120:121], v226 offset:30720
  ds_read_b64_tr_b16 a[122:123], v226 offset:31232
  ds_read_b64_tr_b16 a[124:125], v226 offset:31744
  ds_read_b64_tr_b16 a[126:127], v226 offset:32256
  s_waitcnt lgkmcnt(0)
  s_add_u32 m0, s63, 24576
  s_add_u32 s60, s70, 917504
  s_and_b32 s60, s60, 0xfffff
  s_add_u32 s60, s60, s61
  buffer_load_dwordx4 v225, s[48:51], s60 offen lds
  s_add_u32 m0, s63, 25600
  s_add_u32 s60, s70, 933888
  s_and_b32 s60, s60, 0xfffff
  s_add_u32 s60, s60, s61
  buffer_load_dwordx4 v225, s[48:51], s60 offen lds
  s_add_u32 m0, s63, 26624
  s_add_u32 s60, s70, 950272
  s_and_b32 s60, s60, 0xfffff
  s_add_u32 s60, s60, s61
  buffer_load_dwordx4 v225, s[48:51], s60 offen lds
  s_add_u32 m0, s63, 27648
  s_add_u32 s60, s70, 966656
  s_and_b32 s60, s60, 0xfffff
  s_add_u32 s60, s60, s61
  buffer_load_dwordx4 v225, s[48:51], s60 offen lds
  s_add_u32 m0, s63, 28672
  s_add_u32 s60, s70, 983040
  s_and_b32 s60, s60, 0xfffff
  s_add_u32 s60, s60, s61
  buffer_load_dwordx4 v225, s[48:51], s60 offen lds
  s_add_u32 m0, s63, 29696
  s_add_u32 s60, s70, 999424
  s_and_b32 s60, s60, 0xfffff
  s_add_u32 s60, s60, s61
  buffer_load_dwordx4 v225, s[48:51], s60 offen lds
  s_add_u32 m0, s63, 30720
  s_add_u32 s60, s70, 1015808
  s_and_b32 s60, s60, 0xfffff
  s_add_u32 s60, s60, s61
  buffer_load_dwordx4 v225, s[48:51], s60 offen lds
  s_add_u32 m0, s63, 31744
  s_add_u32 s60, s70, 1032192
  s_and_b32 s60, s60, 0xfffff
  s_add_u32 s60, s60, s61
  buffer_load_dwordx4 v225, s[48:51], s60 offen lds
  s_waitcnt vmcnt(24)
  ds_read_b64_tr_b16 a[128:129], v226 offset:0
  ds_read_b64_tr_b16 a[130:131], v226 offset:512
  ds_read_b64_tr_b16 a[132:133], v226 offset:1024
  ds_read_b64_tr_b16 a[134:135], v226 offset:1536
  ds_read_b64_tr_b16 a[136:137], v226 offset:2048
  ds_read_b64_tr_b16 a[138:139], v226 offset:2560
  ds_read_b64_tr_b16 a[140:141], v226 offset:3072
  ds_read_b64_tr_b16 a[142:143], v226 offset:3584
  s_waitcnt lgkmcnt(0)
  ds_read_b64_tr_b16 a[144:145], v226 offset:4096
  ds_read_b64_tr_b16 a[146:147], v226 offset:4608
  ds_read_b64_tr_b16 a[148:149], v226 offset:5120
  ds_read_b64_tr_b16 a[150:151], v226 offset:5632
  ds_read_b64_tr_b16 a[152:153], v226 offset:6144
  ds_read_b64_tr_b16 a[154:155], v226 offset:6656
  ds_read_b64_tr_b16 a[156:157], v226 offset:7168
  ds_read_b64_tr_b16 a[158:159], v226 offset:7680
  s_waitcnt lgkmcnt(0)
  s_waitcnt vmcnt(16)
  ds_read_b64_tr_b16 a[160:161], v226 offset:8192
  ds_read_b64_tr_b16 a[162:163], v226 offset:8704
  ds_read_b64_tr_b16 a[164:165], v226 offset:9216
  ds_read_b64_tr_b16 a[166:167], v226 offset:9728
  ds_read_b64_tr_b16 a[168:169], v226 offset:10240
  ds_read_b64_tr_b16 a[170:171], v226 offset:10752
  ds_read_b64_tr_b16 a[172:173], v226 offset:11264
  ds_read_b64_tr_b16 a[174:175], v226 offset:11776
  s_waitcnt lgkmcnt(0)
  ds_read_b64_tr_b16 a[176:177], v226 offset:12288
  ds_read_b64_tr_b16 a[178:179], v226 offset:12800
  ds_read_b64_tr_b16 a[180:181], v226 offset:13312
  ds_read_b64_tr_b16 a[182:183], v226 offset:13824
  ds_read_b64_tr_b16 a[184:185], v226 offset:14336
  ds_read_b64_tr_b16 a[186:187], v226 offset:14848
  ds_read_b64_tr_b16 a[188:189], v226 offset:15360
  ds_read_b64_tr_b16 a[190:191], v226 offset:15872
  s_waitcnt lgkmcnt(0)
  s_waitcnt vmcnt(8)
  ds_read_b64_tr_b16 a[192:193], v226 offset:16384
  ds_read_b64_tr_b16 a[194:195], v226 offset:16896
  ds_read_b64_tr_b16 a[196:197], v226 offset:17408
  ds_read_b64_tr_b16 a[198:199], v226 offset:17920
  ds_read_b64_tr_b16 a[200:201], v226 offset:18432
  ds_read_b64_tr_b16 a[202:203], v226 offset:18944
  ds_read_b64_tr_b16 a[204:205], v226 offset:19456
  ds_read_b64_tr_b16 a[206:207], v226 offset:19968
  s_waitcnt lgkmcnt(0)
  ds_read_b64_tr_b16 a[208:209], v226 offset:20480
  ds_read_b64_tr_b16 a[210:211], v226 offset:20992
  ds_read_b64_tr_b16 a[212:213], v226 offset:21504
  ds_read_b64_tr_b16 a[214:215], v226 offset:22016
  ds_read_b64_tr_b16 a[216:217], v226 offset:22528
  ds_read_b64_tr_b16 a[218:219], v226 offset:23040
  ds_read_b64_tr_b16 a[220:221], v226 offset:23552
  ds_read_b64_tr_b16 a[222:223], v226 offset:24064
  s_waitcnt lgkmcnt(0)
  s_waitcnt vmcnt(0)
  ds_read_b64_tr_b16 a[224:225], v226 offset:24576
  ds_read_b64_tr_b16 a[226:227], v226 offset:25088
  ds_read_b64_tr_b16 a[228:229], v226 offset:25600
  ds_read_b64_tr_b16 a[230:231], v226 offset:26112
  ds_read_b64_tr_b16 a[232:233], v226 offset:26624
  ds_read_b64_tr_b16 a[234:235], v226 offset:27136
  ds_read_b64_tr_b16 a[236:237], v226 offset:27648
  ds_read_b64_tr_b16 a[238:239], v226 offset:28160
  s_waitcnt lgkmcnt(0)
  ds_read_b64_tr_b16 a[240:241], v226 offset:28672
  ds_read_b64_tr_b16 a[242:243], v226 offset:29184
  ds_read_b64_tr_b16 a[244:245], v226 offset:29696
  ds_read_b64_tr_b16 a[246:247], v226 offset:30208
  ds_read_b64_tr_b16 a[248:249], v226 offset:30720
  ds_read_b64_tr_b16 a[250:251], v226 offset:31232
  ds_read_b64_tr_b16 a[252:253], v226 offset:31744
  ds_read_b64_tr_b16 a[254:255], v226 offset:32256
  s_waitcnt lgkmcnt(0)
  s_barrier
  s_mov_b32 s68, 0
OS_seg:
  s_add_u32 s44, s57, 72
  s_mov_b32 s45, 0xff
  s_mov_b32 s46, 8
  s_cmp_ge_u32 s68, 8
  s_cbranch_scc1 OS_rdy
  s_cmp_lg_u32 s40, 0
  s_cbranch_scc1 Lw_82
  s_lshl_b32 s44, s44, 7
  s_mov_b64 exec, 1
Lw_81:
  buffer_load_dword v252, v253, s[36:39], s44 offen sc1
  s_waitcnt vmcnt(0)
  v_and_b32 v252, s45, v252
  v_cmp_gt_u32 vcc, s46, v252
  s_nop 0
  s_cbranch_vccz Lw_81x
  s_add_u32 s91, s91, 1
  s_cmp_gt_u32 s91, 0x20000
  s_cbranch_scc1 L_abort
  s_sleep 3
  s_branch Lw_81
Lw_81x:
  s_mov_b64 exec, -1
Lw_82:
OS_rdy:
  s_barrier
  s_mul_i32 s62, s57, 262144
  s_lshl_b32 s60, s40, 16
  s_add_u32 s62, s62, s60
  s_add_u32 s62, s62, 0x8c00000
  s_add_u32 s70, s69, 0
  s_and_b32 s70, s70, 0xffff
  s_add_u32 s70, s70, s62
  buffer_load_dwordx4 v[0:3], v230, s[36:39], s70 offen offset:0 sc1
  buffer_load_dwordx4 v[4:7], v230, s[36:39], s70 offen offset:2048 sc1
  s_add_u32 s70, s69, 4096
  s_and_b32 s70, s70, 0xffff
  s_add_u32 s70, s70, s62
  buffer_load_dwordx4 v[8:11], v230, s[36:39], s70 offen offset:0 sc1
  buffer_load_dwordx4 v[12:15], v230, s[36:39], s70 offen offset:2048 sc1
  s_add_u32 s70, s69, 8192
  s_and_b32 s70, s70, 0xffff
  s_add_u32 s70, s70, s62
  buffer_load_dwordx4 v[16:19], v230, s[36:39], s70 offen offset:0 sc1
  buffer_load_dwordx4 v[20:23], v230, s[36:39], s70 offen offset:2048 sc1
  s_add_u32 s70, s69, 12288
  s_and_b32 s70, s70, 0xffff
  s_add_u32 s70, s70, s62
  buffer_load_dwordx4 v[24:27], v230, s[36:39], s70 offen offset:0 sc1
  buffer_load_dwordx4 v[28:31], v230, s[36:39], s70 offen offset:2048 sc1
  s_add_u32 s70, s69, 16384
  s_and_b32 s70, s70, 0xffff
  s_add_u32 s70, s70, s62
  buffer_load_dwordx4 v[32:35], v230, s[36:39], s70 offen offset:0 sc1
  buffer_load_dwordx4 v[36:39], v230, s[36:39], s70 offen offset:2048 sc1
  s_add_u32 s70, s69, 20480
  s_and_b32 s70, s70, 0xffff
  s_add_u32 s70, s70, s62
  buffer_load_dwordx4 v[40:43], v230, s[36:39], s70 offen offset:0 sc1
  buffer_load_dwordx4 v[44:47], v230, s[36:39], s70 offen offset:2048 sc1
  s_add_u32 s70, s69, 24576
  s_and_b32 s70, s70, 0xffff
  s_add_u32 s70, s70, s62
  buffer_load_dwordx4 v[48:51], v230, s[36:39], s70 offen offset:0 sc1
  buffer_load_dwordx4 v[52:55], v230, s[36:39], s70 offen offset:2048 sc1
  s_waitcnt vmcnt(13)
  v_mfma_f32_32x32x16_bf16 v[128:143], a[0:3], v[0:3], 0
  s_add_u32 s70, s69, 28672
  s_and_b32 s70, s70, 0xffff
  s_add_u32 s70, s70, s62
  buffer_load_dwordx4 v[56:59], v230, s[36:39], s70 offen offset:0 sc1
  v_mfma_f32_32x32x16_bf16 v[144:159], a[4:7], v[0:3], 0
  s_waitcnt vmcnt(13)
  v_mfma_f32_32x32x16_bf16 v[128:143], a[8:11], v[4:7], v[128:143]
  buffer_load_dwordx4 v[60:63], v230, s[36:39], s70 offen offset:2048 sc1
  v_mfma_f32_32x32x16_bf16 v[144:159], a[12:15], v[4:7], v[144:159]
  s_waitcnt vmcnt(13)
  v_mfma_f32_32x32x16_bf16 v[128:143], a[16:19], v[8:11], v[128:143]
  s_add_u32 s70, s69, 32768
  s_and_b32 s70, s70, 0xffff
  s_add_u32 s70, s70, s62
  buffer_load_dwordx4 v[64:67], v230, s[36:39], s70 offen offset:0 sc1
  v_mfma_f32_32x32x16_bf16 v[144:159], a[20:23], v[8:11], v[144:159]
  s_waitcnt vmcnt(13)
  v_mfma_f32_32x32x16_bf16 v[128:143], a[24:27], v[12:15], v[128:143]
  buffer_load_dwordx4 v[68:71], v230, s[36:39], s70 offen offset:2048 sc1
  v_mfma_f32_32x32x16_bf16 v[144:159], a[28:31], v[12:15], v[144:159]
  s_waitcnt vmcnt(13)
  v_mfma_f32_32x32x16_bf16 v[128:143], a[32:35], v[16:19], v[128:143]
  s_add_u32 s70, s69, 36864
  s_and_b32 s70, s70, 0xffff
  s_add_u32 s70, s70, s62
  buffer_load_dwordx4 v[72:75], v230, s[36:39], s70 offen offset:0 sc1
  v_mfma_f32_32x32x16_bf16 v[144:159], a[36:39], v[16:19], v[144:159]
  s_waitcnt vmcnt(13)
  v_mfma_f32_32x32x16_bf16 v[128:143], a[40:43], v[20:23], v[128:143]
  buffer_load_dwordx4 v[76:79], v230, s[36:39], s70 offen offset:2048 sc1
  v_mfma_f32_32x32x16_bf16 v[144:159], a[44:47], v[20:23], v[144:159]
  s_waitcnt vmcnt(13)
  v_mfma_f32_32x32x16_bf16 v[128:143], a[48:51], v[24:27], v[128:143]
  s_add_u32 s70, s69, 40960
  s_and_b32 s70, s70, 0xffff
  s_add_u32 s70, s70, s62
  buffer_load_dwordx4 v[80:83], v230, s[36:39], s70 offen offset:0 sc1
  v_mfma_f32_32x32x16_bf16 v[144:159], a[52:55], v[24:27], v[144:159]
  s_waitcnt vmcnt(13)
  v_mfma_f32_32x32x16_bf16 v[128:143], a[56:59], v[28:31], v[128:143]
  buffer_load_dwordx4 v[84:87], v230, s[36:39], s70 offen offset:2048 sc1
  v_mfma_f32_32x32x16_bf16 v[144:159], a[60:63], v[28:31], v[144:159]
  s_waitcnt vmcnt(13)
  v_mfma_f32_32x32x16_bf16 v[128:143], a[64:67], v[32:35], v[128:143]
  s_add_u32 s70, s69, 45056
  s_and_b32 s70, s70, 0xffff
  s_add_u32 s70, s70, s62
  buffer_load_dwordx4 v[88:91], v230, s[36:39], s70 offen offset:0 sc1
  v_mfma_f32_32x32x16_bf16 v[144:159], a[68:71], v[32:35], v[144:159]
  s_waitcnt vmcnt(13)
  v_mfma_f32_32x32x16_bf16 v[128:143], a[72:75], v[36:39], v[128:143]
  buffer_load_dwordx4 v[92:95], v230, s[36:39], s70 offen offset:2048 sc1
  v_mfma_f32_32x32x16_bf16 v[144:159], a[76:79], v[36:39], v[144:159]
  s_waitcnt vmcnt(13)
  v_mfma_f32_32x32x16_bf16 v[128:143], a[80:83], v[40:43], v[128:143]
  s_add_u32 s70, s69, 49152
  s_and_b32 s70, s70, 0xffff
  s_add_u32 s70, s70, s62
  buffer_load_dwordx4 v[96:99], v230, s[36:39], s70 offen offset:0 sc1
  v_mfma_f32_32x32x16_bf16 v[144:159], a[84:87], v[40:43], v[144:159]
  s_waitcnt vmcnt(13)
  v_mfma_f32_32x32x16_bf16 v[128:143], a[88:91], v[44:47], v[128:143]
  buffer_load_dwordx4 v[100:103], v230, s[36:39], s70 offen offset:2048 sc1
  v_mfma_f32_32x32x16_bf16 v[144:159], a[92:95], v[44:47], v[144:159]
  s_waitcnt vmcnt(13)
  v_mfma_f32_32x32x16_bf16 v[128:143], a[96:99], v[48:51], v[128:143]
  s_add_u32 s70, s69, 53248
  s_and_b32 s70, s70, 0xffff
  s_add_u32 s70, s70, s62
  buffer_load_dwordx4 v[104:107], v230, s[36:39], s70 offen offset:0 sc1
  v_mfma_f32_32x32x16_bf16 v[144:159], a[100:103], v[48:51], v[144:159]
  s_waitcnt vmcnt(13)
  v_mfma_f32_32x32x16_bf16 v[128:143], a[104:107], v[52:55], v[128:143]
  buffer_load_dwordx4 v[108:111], v230, s[36:39], s70 offen offset:2048 sc1
  v_mfma_f32_32x32x16_bf16 v[144:159], a[108:111], v[52:55], v[144:159]
  s_waitcnt vmcnt(13)
  v_mfma_f32_32x32x16_bf16 v[128:143], a[112:115], v[56:59], v[128:143]
  s_add_u32 s70, s69, 57344
  s_and_b32 s70, s70, 0xffff
  s_add_u32 s70, s70, s62
  buffer_load_dwordx4 v[112:115], v230, s[36:39], s70 offen offset:0 sc1
  v_mfma_f32_32x32x16_bf16 v[144:159], a[116:119], v[56:59], v[144:159]
  s_waitcnt vmcnt(13)
  v_mfma_f32_32x32x16_bf16 v[128:143], a[120:123], v[60:63], v[128:143]
  buffer_load_dwordx4 v[116:119], v230, s[36:39], s70 offen offset:2048 sc1
  v_mfma_f32_32x32x16_bf16 v[144:159], a[124:127], v[60:63], v[144:159]
  s_waitcnt vmcnt(13)
  v_mfma_f32_32x32x16_bf16 v[128:143], a[128:131], v[64:67], v[128:143]
  s_add_u32 s70, s69, 61440
  s_and_b32 s70, s70, 0xffff
  s_add_u32 s70, s70, s62
  buffer_load_dwordx4 v[120:123], v230, s[36:39], s70 offen offset:0 sc1
  v_mfma_f32_32x32x16_bf16 v[144:159], a[132:135], v[64:67], v[144:159]
  s_waitcnt vmcnt(13)
  v_mfma_f32_32x32x16_bf16 v[128:143], a[136:139], v[68:71], v[128:143]
  buffer_load_dwordx4 v[124:127], v230, s[36:39], s70 offen offset:2048 sc1
  v_mfma_f32_32x32x16_bf16 v[144:159], a[140:143], v[68:71], v[144:159]
  s_waitcnt vmcnt(13)
  v_mfma_f32_32x32x16_bf16 v[128:143], a[144:147], v[72:75], v[128:143]
  s_add_u32 s60, s57, s59
  s_add_u32 s60, s60, 72
  s_lshl_b32 s60, s60, 7
  s_add_u32 s60, s60, 0x8a00000
  s_cmp_lg_u32 s40, 0
  s_cselect_b32 s60, 0x10000000, s60
  buffer_load_dword v251, off, s[36:39], s60 sc1
  v_mfma_f32_32x32x16_bf16 v[144:159], a[148:151], v[72:75], v[144:159]
  s_waitcnt vmcnt(13)
  v_mfma_f32_32x32x16_bf16 v[128:143], a[152:155], v[76:79], v[128:143]
  v_mfma_f32_32x32x16_bf16 v[144:159], a[156:159], v[76:79], v[144:159]
  s_waitcnt vmcnt(12)
  v_mfma_f32_32x32x16_bf16 v[128:143], a[160:163], v[80:83], v[128:143]
  v_mfma_f32_32x32x16_bf16 v[144:159], a[164:167], v[80:83], v[144:159]
  s_waitcnt vmcnt(11)
  v_mfma_f32_32x32x16_bf16 v[128:143], a[168:171], v[84:87], v[128:143]
  v_mfma_f32_32x32x16_bf16 v[144:159], a[172:175], v[84:87], v[144:159]
  s_waitcnt vmcnt(10)
  v_mfma_f32_32x32x16_bf16 v[128:143], a[176:179], v[88:91], v[128:143]
  v_mfma_f32_32x32x16_bf16 v[144:159], a[180:183], v[88:91], v[144:159]
  s_waitcnt vmcnt(9)
  v_mfma_f32_32x32x16_bf16 v[128:143], a[184:187], v[92:95], v[128:143]
  v_mfma_f32_32x32x16_bf16 v[144:159], a[188:191], v[92:95], v[144:159]
  s_waitcnt vmcnt(8)
  v_mfma_f32_32x32x16_bf16 v[128:143], a[192:195], v[96:99], v[128:143]
  v_mfma_f32_32x32x16_bf16 v[144:159], a[196:199], v[96:99], v[144:159]
  s_waitcnt vmcnt(7)
  v_mfma_f32_32x32x16_bf16 v[128:143], a[200:203], v[100:103], v[128:143]
  v_mfma_f32_32x32x16_bf16 v[144:159], a[204:207], v[100:103], v[144:159]
  s_waitcnt vmcnt(6)
  v_mfma_f32_32x32x16_bf16 v[128:143], a[208:211], v[104:107], v[128:143]
  v_mfma_f32_32x32x16_bf16 v[144:159], a[212:215], v[104:107], v[144:159]
  s_waitcnt vmcnt(5)
  v_mfma_f32_32x32x16_bf16 v[128:143], a[216:219], v[108:111], v[128:143]
  v_mfma_f32_32x32x16_bf16 v[144:159], a[220:223], v[108:111], v[144:159]
  s_waitcnt vmcnt(4)
  v_mfma_f32_32x32x16_bf16 v[128:143], a[224:227], v[112:115], v[128:143]
  v_mfma_f32_32x32x16_bf16 v[144:159], a[228:231], v[112:115], v[144:159]
  s_waitcnt vmcnt(3)
  v_mfma_f32_32x32x16_bf16 v[128:143], a[232:235], v[116:119], v[128:143]
  v_mfma_f32_32x32x16_bf16 v[144:159], a[236:239], v[116:119], v[144:159]
  s_waitcnt vmcnt(2)
  v_mfma_f32_32x32x16_bf16 v[128:143], a[240:243], v[120:123], v[128:143]
  v_mfma_f32_32x32x16_bf16 v[144:159], a[244:247], v[120:123], v[144:159]
  s_waitcnt vmcnt(1)
  v_mfma_f32_32x32x16_bf16 v[128:143], a[248:251], v[124:127], v[128:143]
  v_mfma_f32_32x32x16_bf16 v[144:159], a[252:255], v[124:127], v[144:159]
  s_nop 11
  v_cndmask_b32 v128, v128, v144, s[66:67]
  v_cndmask_b32 v129, v129, v145, s[66:67]
  v_cndmask_b32 v130, v130, v146, s[66:67]
  v_cndmask_b32 v131, v131, v147, s[66:67]
  v_cndmask_b32 v132, v132, v148, s[66:67]
  v_cndmask_b32 v133, v133, v149, s[66:67]
  v_cndmask_b32 v134, v134, v150, s[66:67]
  v_cndmask_b32 v135, v135, v151, s[66:67]
  v_cndmask_b32 v136, v136, v152, s[66:67]
  v_cndmask_b32 v137, v137, v153, s[66:67]
  v_cndmask_b32 v138, v138, v154, s[66:67]
  v_cndmask_b32 v139, v139, v155, s[66:67]
  v_cndmask_b32 v140, v140, v156, s[66:67]
  v_cndmask_b32 v141, v141, v157, s[66:67]
  v_cndmask_b32 v142, v142, v158, s[66:67]
  v_cndmask_b32 v143, v143, v159, s[66:67]
  ds_write_b128 v228, v[128:131] offset:0
  ds_write_b128 v228, v[132:135] offset:1024
  ds_write_b128 v228, v[136:139] offset:2048
  ds_write_b128 v228, v[140:143] offset:3072
  s_waitcnt lgkmcnt(0)
  s_barrier
  ds_read_b128 v[160:163], v229 offset:0
  ds_read_b128 v[164:167], v229 offset:256
  ds_read_b128 v[168:171], v229 offset:4096
  ds_read_b128 v[172:175], v229 offset:4352
  ds_read_b128 v[176:179], v229 offset:8192
  ds_read_b128 v[180:183], v229 offset:8448
  ds_read_b128 v[184:187], v229 offset:12288
  ds_read_b128 v[188:191], v229 offset:12544
  v_xor_b32 v228, 0x4000, v228
  v_xor_b32 v229, 0x4000, v229
  s_lshl_b32 s60, s57, 16
  s_lshl_b32 s61, s56, 6
  s_add_u32 s60, s60, s61
  s_waitcnt lgkmcnt(0)
  v_pk_add_f32 v[160:161], v[160:161], v[176:177]
  v_pk_add_f32 v[162:163], v[162:163], v[178:179]
  v_pk_add_f32 v[164:165], v[164:165], v[180:181]
  v_pk_add_f32 v[166:167], v[166:167], v[182:183]
  v_pk_add_f32 v[168:169], v[168:169], v[184:185]
  v_pk_add_f32 v[170:171], v[170:171], v[186:187]
  v_pk_add_f32 v[172:173], v[172:173], v[188:189]
  v_pk_add_f32 v[174:175], v[174:175], v[190:191]
  v_pk_add_f32 v[160:161], v[160:161], v[168:169]
  v_pk_add_f32 v[162:163], v[162:163], v[170:171]
  v_pk_add_f32 v[164:165], v[164:165], v[172:173]
  v_pk_add_f32 v[166:167], v[166:167], v[174:175]
  v_pk_add_f32 v[160:161], v[160:161], v[164:165]
  v_pk_add_f32 v[162:163], v[162:163], v[166:167]
  v_cvt_pk_bf16_f32 v160, v160, v161
  v_cvt_pk_bf16_f32 v161, v162, v163
  s_waitcnt vmcnt(0)
  v_readfirstlane_b32 s68, v251
  buffer_store_dwordx2 v[160:161], v227, s[52:55], s60 offen
  s_add_u32 s57, s57, s59
  s_sub_u32 s58, s58, 1
  s_cmp_lg_u32 s58, 0
  s_cbranch_scc1 OS_seg
  s_bitcmp1_b32 s90, 25
  s_cbranch_scc1 L_fin
  s_mov_b32 s81, 7
  s_mov_b32 s82, 0
  s_branch L_jobend
L_pf:
  s_mov_b32 s48, s28
  s_and_b32 s49, s29, 0xffff
  s_mov_b32 s50, 0x400000
  s_mov_b32 s51, 0x20000
  s_bfe_u32 s52, s90, 0x40003
  s_bitcmp1_b32 s90, 7
  s_cselect_b64 s[48:49], s[14:15], s[48:49]
  s_and_b32 s49, s49, 0xffff
  s_lshl_b32 s52, s52, 18
  s_lshl_b32 s53, s40, 16
  s_add_u32 s52, s52, s53
  v_lshlrev_b32 v0, 6, v255
  buffer_load_dword v1, v0, s[48:51], s52 offen
  s_add_u32 s52, s52, 4096
  buffer_load_dword v2, v0, s[48:51], s52 offen
  s_add_u32 s52, s52, 4096
  buffer_load_dword v3, v0, s[48:51], s52 offen
  s_add_u32 s52, s52, 4096
  buffer_load_dword v4, v0, s[48:51], s52 offen
  s_add_u32 s52, s52, 4096
  buffer_load_dword v5, v0, s[48:51], s52 offen
  s_add_u32 s52, s52, 4096
  buffer_load_dword v6, v0, s[48:51], s52 offen
  s_add_u32 s52, s52, 4096
  buffer_load_dword v7, v0, s[48:51], s52 offen
  s_add_u32 s52, s52, 4096
  buffer_load_dword v8, v0, s[48:51], s52 offen
  s_add_u32 s52, s52, 4096
  buffer_load_dword v9, v0, s[48:51], s52 offen
  s_add_u32 s52, s52, 4096
  buffer_load_dword v10, v0, s[48:51], s52 offen
  s_add_u32 s52, s52, 4096
  buffer_load_dword v11, v0, s[48:51], s52 offen
  s_add_u32 s52, s52, 4096
  buffer_load_dword v12, v0, s[48:51], s52 offen
  s_add_u32 s52, s52, 4096
  buffer_load_dword v13, v0, s[48:51], s52 offen
  s_add_u32 s52, s52, 4096
  buffer_load_dword v14, v0, s[48:51], s52 offen
  s_add_u32 s52, s52, 4096
  buffer_load_dword v15, v0, s[48:51], s52 offen
  s_add_u32 s52, s52, 4096
  buffer_load_dword v16, v0, s[48:51], s52 offen
  s_add_u32 s52, s52, 4096
  s_barrier
  s_mov_b32 s81, 7
  s_mov_b32 s82, 0
  s_branch L_jobend
L_chain:
  s_mov_b32 s52, s88
  s_mov_b32 s89, s41
  v_mov_b32 v240, v0
  s_mov_b32 s48, s8
  s_and_b32 s49, s9, 0xffff
  s_mov_b32 s50, 0x400000
  s_mov_b32 s51, 0x20000
  v_bfe_u32 v241, v240, 0, 4
  v_lshlrev_b32 v241, 4, v241
  v_bfe_u32 v247, v240, 5, 1
  v_lshlrev_b32 v247, 4, v247
  v_xor_b32 v241, v241, v247
  s_and_b32 s81, s40, 1
  s_lshl_b32 s81, s81, 7
  v_xor_b32 v241, s81, v241
  v_lshrrev_b32 v247, 4, v240
  v_lshl_add_u32 v241, v247, 13, v241
  v_bfe_u32 v242, v240, 0, 4
  v_lshlrev_b32 v242, 4, v242
  v_bfe_u32 v247, v240, 5, 1
  v_lshlrev_b32 v247, 5, v247
  v_xor_b32 v242, v242, v247
  s_and_b32 s81, s40, 1
  s_lshl_b32 s81, s81, 7
  v_xor_b32 v242, s81, v242
  v_lshrrev_b32 v247, 4, v240
  v_lshl_add_u32 v242, v247, 13, v242
  v_lshlrev_b32 v243, 4, v240
  s_lshr_b32 s81, s40, 1
  s_lshl_b32 s81, s81, 7
  v_xor_b32 v243, s81, v243
  s_lshl_b32 s57, s40, 18
  s_lshl_b32 s82, s52, 8
  s_add_u32 s57, s57, s82
  s_lshl_b32 s59, s52, 17
  s_lshl_b32 s82, s40, 13
  s_add_u32 s59, s59, s82
  s_lshl_b32 s65, s40, 13
  s_mov_b32 s48, s14
  s_and_b32 s49, s15, 0xffff
  s_add_u32 m0, s65, 0x0
  s_add_u32 s80, s59, 0x0
  buffer_load_dwordx4 v243, s[48:51], s80 offen  lds
  s_add_u32 m0, s65, 0x400
  s_add_u32 s80, s59, 0x400
  v_xor_b32 v248, 64, v243
  buffer_load_dwordx4 v248, s[48:51], s80 offen  lds
  s_add_u32 m0, s65, 0x800
  s_add_u32 s80, s59, 0x800
  buffer_load_dwordx4 v243, s[48:51], s80 offen  lds
  s_add_u32 m0, s65, 0xc00
  s_add_u32 s80, s59, 0xc00
  v_xor_b32 v248, 64, v243
  buffer_load_dwordx4 v248, s[48:51], s80 offen  lds
  s_add_u32 m0, s65, 0x1000
  s_add_u32 s80, s59, 0x1000
  buffer_load_dwordx4 v243, s[48:51], s80 offen  lds
  s_add_u32 m0, s65, 0x1400
  s_add_u32 s80, s59, 0x1400
  v_xor_b32 v248, 64, v243
  buffer_load_dwordx4 v248, s[48:51], s80 offen  lds
  s_add_u32 m0, s65, 0x1800
  s_add_u32 s80, s59, 0x1800
  buffer_load_dwordx4 v243, s[48:51], s80 offen  lds
  s_add_u32 m0, s65, 0x1c00
  s_add_u32 s80, s59, 0x1c00
  v_xor_b32 v248, 64, v243
  buffer_load_dwordx4 v248, s[48:51], s80 offen  lds
  s_mov_b32 s48, s14
  s_and_b32 s49, s15, 0xffff
  s_add_u32 m0, s65, 0x8000
  s_add_u32 s80, s59, 0x8000
  buffer_load_dwordx4 v243, s[48:51], s80 offen  lds
  s_add_u32 m0, s65, 0x8400
  s_add_u32 s80, s59, 0x8400
  v_xor_b32 v248, 64, v243
  buffer_load_dwordx4 v248, s[48:51], s80 offen  lds
  s_add_u32 m0, s65, 0x8800
  s_add_u32 s80, s59, 0x8800
  buffer_load_dwordx4 v243, s[48:51], s80 offen  lds
  s_add_u32 m0, s65, 0x8c00
  s_add_u32 s80, s59, 0x8c00
  v_xor_b32 v248, 64, v243
  buffer_load_dwordx4 v248, s[48:51], s80 offen  lds
  s_add_u32 m0, s65, 0x9000
  s_add_u32 s80, s59, 0x9000
  buffer_load_dwordx4 v243, s[48:51], s80 offen  lds
  s_add_u32 m0, s65, 0x9400
  s_add_u32 s80, s59, 0x9400
  v_xor_b32 v248, 64, v243
  buffer_load_dwordx4 v248, s[48:51], s80 offen  lds
  s_add_u32 m0, s65, 0x9800
  s_add_u32 s80, s59, 0x9800
  buffer_load_dwordx4 v243, s[48:51], s80 offen  lds
  s_add_u32 m0, s65, 0x9c00
  s_add_u32 s80, s59, 0x9c00
  v_xor_b32 v248, 64, v243
  buffer_load_dwordx4 v248, s[48:51], s80 offen  lds
  s_mov_b32 s48, s14
  s_and_b32 s49, s15, 0xffff
  s_add_u32 m0, s65, 0x10000
  s_add_u32 s80, s59, 0x10000
  buffer_load_dwordx4 v243, s[48:51], s80 offen  lds
  s_add_u32 m0, s65, 0x10400
  s_add_u32 s80, s59, 0x10400
  v_xor_b32 v248, 64, v243
  buffer_load_dwordx4 v248, s[48:51], s80 offen  lds
  s_add_u32 m0, s65, 0x10800
  s_add_u32 s80, s59, 0x10800
  buffer_load_dwordx4 v243, s[48:51], s80 offen  lds
  s_add_u32 m0, s65, 0x10c00
  s_add_u32 s80, s59, 0x10c00
  v_xor_b32 v248, 64, v243
  buffer_load_dwordx4 v248, s[48:51], s80 offen  lds
  s_add_u32 m0, s65, 0x11000
  s_add_u32 s80, s59, 0x11000
  buffer_load_dwordx4 v243, s[48:51], s80 offen  lds
  s_add_u32 m0, s65, 0x11400
  s_add_u32 s80, s59, 0x11400
  v_xor_b32 v248, 64, v243
  buffer_load_dwordx4 v248, s[48:51], s80 offen  lds
  s_add_u32 m0, s65, 0x11800
  s_add_u32 s80, s59, 0x11800
  buffer_load_dwordx4 v243, s[48:51], s80 offen  lds
  s_add_u32 m0, s65, 0x11c00
  s_add_u32 s80, s59, 0x11c00
  v_xor_b32 v248, 64, v243
  buffer_load_dwordx4 v248, s[48:51], s80 offen  lds
  v_bfe_u32 v249, v240, 2, 1
  v_lshlrev_b32 v249, 13, v249
  v_bfe_u32 v247, v240, 3, 1
  v_lshl_add_u32 v249, v247, 12, v249
  v_bfe_u32 v247, v240, 4, 2
  v_lshl_add_u32 v249, v247, 9, v249
  v_bfe_u32 v248, v240, 1, 1
  v_lshlrev_b32 v248, 5, v248
  v_bfe_u32 v247, v240, 0, 1
  v_lshl_add_u32 v248, v247, 3, v248
  s_lshl_b32 s81, s40, 6
  v_add_u32 v248, s81, v248
  v_bfe_u32 v244, v240, 2, 1
  v_lshlrev_b32 v244, 7, v244
  v_bfe_u32 v247, v240, 3, 1
  v_lshl_add_u32 v244, v247, 6, v244
  v_bfe_u32 v247, v240, 4, 1
  v_lshl_add_u32 v244, v247, 4, v244
  v_xor_b32 v248, v248, v244
  v_add_u32 v249, v249, v248
  v_bfe_u32 v250, v240, 2, 1
  v_lshlrev_b32 v250, 13, v250
  v_bfe_u32 v247, v240, 3, 1
  v_lshl_add_u32 v250, v247, 12, v250
  v_bfe_u32 v247, v240, 4, 2
  v_lshl_add_u32 v250, v247, 9, v250
  v_bfe_u32 v248, v240, 1, 1
  v_lshlrev_b32 v248, 5, v248
  v_bfe_u32 v247, v240, 0, 1
  v_lshl_add_u32 v248, v247, 3, v248
  v_add_u32 v248, 0x10, v248
  s_lshl_b32 s81, s40, 6
  v_add_u32 v248, s81, v248
  v_bfe_u32 v244, v240, 2, 1
  v_lshlrev_b32 v244, 7, v244
  v_bfe_u32 v247, v240, 3, 1
  v_lshl_add_u32 v244, v247, 6, v244
  v_bfe_u32 v247, v240, 4, 1
  v_lshl_add_u32 v244, v247, 4, v244
  v_xor_b32 v248, v248, v244
  v_add_u32 v250, v250, v248
  v_bfe_u32 v251, v240, 2, 1
  v_lshlrev_b32 v251, 13, v251
  v_bfe_u32 v247, v240, 3, 1
  v_lshl_add_u32 v251, v247, 12, v251
  v_bfe_u32 v247, v240, 4, 2
  v_lshl_add_u32 v251, v247, 9, v251
  v_bfe_u32 v248, v240, 0, 2
  v_lshlrev_b32 v248, 3, v248
  s_lshl_b32 s81, s40, 6
  v_add_u32 v248, s81, v248
  v_bfe_u32 v244, v240, 2, 1
  v_lshlrev_b32 v244, 7, v244
  v_bfe_u32 v247, v240, 3, 1
  v_lshl_add_u32 v244, v247, 6, v244
  v_bfe_u32 v247, v240, 4, 1
  v_lshl_add_u32 v244, v247, 5, v244
  v_xor_b32 v248, v248, v244
  v_add_u32 v251, v251, v248
  v_bfe_u32 v252, v240, 2, 1
  v_lshlrev_b32 v252, 13, v252
  v_bfe_u32 v247, v240, 3, 1
  v_lshl_add_u32 v252, v247, 12, v252
  v_bfe_u32 v247, v240, 4, 2
  v_lshl_add_u32 v252, v247, 9, v252
  v_bfe_u32 v248, v240, 0, 2
  v_lshlrev_b32 v248, 3, v248
  v_add_u32 v248, 0x20, v248
  s_lshl_b32 s81, s40, 6
  v_add_u32 v248, s81, v248
  v_bfe_u32 v244, v240, 2, 1
  v_lshlrev_b32 v244, 7, v244
  v_bfe_u32 v247, v240, 3, 1
  v_lshl_add_u32 v244, v247, 6, v244
  v_bfe_u32 v247, v240, 4, 1
  v_lshl_add_u32 v244, v247, 5, v244
  v_xor_b32 v248, v248, v244
  v_add_u32 v252, v252, v248
  v_bfe_u32 v253, v240, 4, 1
  v_lshlrev_b32 v253, 14, v253
  v_bfe_u32 v247, v240, 5, 1
  v_lshl_add_u32 v253, v247, 12, v253
  v_bfe_u32 v247, v240, 2, 1
  v_lshl_add_u32 v253, v247, 10, v253
  v_bfe_u32 v248, v240, 0, 2
  v_lshlrev_b32 v248, 3, v248
  v_bfe_u32 v247, v240, 3, 1
  v_lshl_add_u32 v248, v247, 5, v248
  v_bfe_u32 v247, v240, 4, 1
  v_lshl_add_u32 v248, v247, 7, v248
  v_bfe_u32 v247, v240, 2, 1
  v_lshl_add_u32 v248, v247, 6, v248
  s_lshl_b32 s81, s40, 8
  v_add_u32 v248, s81, v248
  v_add_u32 v253, v253, v248
  s_mov_b32 s60, s6
  s_and_b32 s61, s7, 0xffff
  s_mov_b32 s62, 0x2000
  s_mov_b32 s63, 0x20000
  s_lshr_b32 s81, s52, 2
  s_lshl_b32 s81, s81, 7
  s_and_b32 s82, s52, 3
  s_lshl_b32 s82, s82, 3
  s_add_u32 s81, s81, s82
  s_lshl_b32 s82, s40, 11
  s_add_u32 s81, s81, s82
  v_bfe_u32 v184, v240, 4, 1
  v_lshlrev_b32 v184, 10, v184
  v_bfe_u32 v189, v240, 5, 1
  v_lshl_add_u32 v184, v189, 5, v184
  v_bfe_u32 v189, v240, 0, 2
  v_lshl_add_u32 v184, v189, 1, v184
  buffer_load_ushort v185, v184, s[60:63], s81 offen
  buffer_load_ushort v186, v184, s[60:63], s81 offen offset:64
  v_lshlrev_b32 v187, 4, v240
  s_lshl_b32 s81, s52, 2
  s_add_u32 s81, s81, s40
  s_lshl_b32 s82, s81, 11
  s_add_u32 s82, s82, 0x8800000
  v_mov_b32 v180, 0xffffffbf
  v_mov_b32 v181, 0xffffffbf
  v_mov_b32 v182, 0xffffffbf
  v_mov_b32 v183, 0xffffffbf
  buffer_store_dwordx4 v[180:183], v187, s[36:39], s82 offen offset:0 sc1
  buffer_store_dwordx4 v[180:183], v187, s[36:39], s82 offen offset:1024 sc1
  s_lshl_b32 s82, s81, 12
  s_add_u32 s82, s82, 0x8902000
  buffer_store_dwordx4 v[180:183], v187, s[36:39], s82 offen offset:0 sc1
  buffer_store_dwordx4 v[180:183], v187, s[36:39], s82 offen offset:1024 sc1
  buffer_store_dwordx4 v[180:183], v187, s[36:39], s82 offen offset:2048 sc1
  buffer_store_dwordx4 v[180:183], v187, s[36:39], s82 offen offset:3072 sc1
  s_waitcnt vmcnt(24) lgkmcnt(0)
  s_barrier
  s_mov_b32 s48, s14
  s_and_b32 s49, s15, 0xffff
  s_add_u32 m0, s65, 0x18000
  s_add_u32 s80, s59, 0x18000
  buffer_load_dwordx4 v243, s[48:51], s80 offen  lds
  s_add_u32 m0, s65, 0x18400
  s_add_u32 s80, s59, 0x18400
  v_xor_b32 v248, 64, v243
  buffer_load_dwordx4 v248, s[48:51], s80 offen  lds
  s_add_u32 m0, s65, 0x18800
  s_add_u32 s80, s59, 0x18800
  buffer_load_dwordx4 v243, s[48:51], s80 offen  lds
  s_add_u32 m0, s65, 0x18c00
  s_add_u32 s80, s59, 0x18c00
  v_xor_b32 v248, 64, v243
  buffer_load_dwordx4 v248, s[48:51], s80 offen  lds
  s_add_u32 m0, s65, 0x19000
  s_add_u32 s80, s59, 0x19000
  buffer_load_dwordx4 v243, s[48:51], s80 offen  lds
  s_add_u32 m0, s65, 0x19400
  s_add_u32 s80, s59, 0x19400
  v_xor_b32 v248, 64, v243
  buffer_load_dwordx4 v248, s[48:51], s80 offen  lds
  s_add_u32 m0, s65, 0x19800
  s_add_u32 s80, s59, 0x19800
  buffer_load_dwordx4 v243, s[48:51], s80 offen  lds
  s_add_u32 m0, s65, 0x19c00
  s_add_u32 s80, s59, 0x19c00
  v_xor_b32 v248, 64, v243
  buffer_load_dwordx4 v248, s[48:51], s80 offen  lds
  v_xor_b32 v244, 0, v253
  v_add_u32 v244, 0x0, v244
  ds_read_b64_tr_b16 v[0:1], v244 offset:0
  ds_read_b64_tr_b16 v[2:3], v244 offset:2048
  ds_read_b64_tr_b16 v[4:5], v244 offset:8192
  ds_read_b64_tr_b16 v[6:7], v244 offset:10240
  v_xor_b32 v244, 64, v253
  v_add_u32 v244, 0x0, v244
  ds_read_b64_tr_b16 v[8:9], v244 offset:0
  ds_read_b64_tr_b16 v[10:11], v244 offset:2048
  ds_read_b64_tr_b16 v[12:13], v244 offset:8192
  ds_read_b64_tr_b16 v[14:15], v244 offset:10240
  v_xor_b32 v244, 128, v253
  v_add_u32 v244, 0x0, v244
  ds_read_b64_tr_b16 v[88:89], v244 offset:0
  ds_read_b64_tr_b16 v[90:91], v244 offset:2048
  ds_read_b64_tr_b16 v[92:93], v244 offset:8192
  ds_read_b64_tr_b16 v[94:95], v244 offset:10240
  v_xor_b32 v244, 192, v253
  v_add_u32 v244, 0x0, v244
  ds_read_b64_tr_b16 v[232:233], v244 offset:0
  ds_read_b64_tr_b16 v[234:235], v244 offset:2048
  ds_read_b64_tr_b16 v[236:237], v244 offset:8192
  ds_read_b64_tr_b16 v[238:239], v244 offset:10240
  s_waitcnt vmcnt(24) lgkmcnt(0)
  s_barrier
  s_mov_b32 s48, s8
  s_and_b32 s49, s9, 0xffff
  s_add_u32 m0, s65, 0x20000
  s_add_u32 s80, s57, 0x0
  buffer_load_dwordx4 v241, s[48:51], s80 offen  lds
  s_add_u32 m0, s65, 0x20400
  s_add_u32 s80, s57, 0x8000
  buffer_load_dwordx4 v241, s[48:51], s80 offen  lds
  s_add_u32 m0, s65, 0x20800
  s_add_u32 s80, s57, 0x10000
  buffer_load_dwordx4 v241, s[48:51], s80 offen  lds
  s_add_u32 m0, s65, 0x20c00
  s_add_u32 s80, s57, 0x18000
  buffer_load_dwordx4 v241, s[48:51], s80 offen  lds
  s_add_u32 m0, s65, 0x21000
  s_add_u32 s80, s57, 0x20000
  v_xor_b32 v248, 64, v241
  buffer_load_dwordx4 v248, s[48:51], s80 offen  lds
  s_add_u32 m0, s65, 0x21400
  s_add_u32 s80, s57, 0x28000
  v_xor_b32 v248, 64, v241
  buffer_load_dwordx4 v248, s[48:51], s80 offen  lds
  s_add_u32 m0, s65, 0x21800
  s_add_u32 s80, s57, 0x30000
  v_xor_b32 v248, 64, v241
  buffer_load_dwordx4 v248, s[48:51], s80 offen  lds
  s_add_u32 m0, s65, 0x21c00
  s_add_u32 s80, s57, 0x38000
  v_xor_b32 v248, 64, v241
  buffer_load_dwordx4 v248, s[48:51], s80 offen  lds
  v_xor_b32 v244, 0, v253
  v_add_u32 v244, 0x8000, v244
  ds_read_b64_tr_b16 v[48:49], v244 offset:0
  ds_read_b64_tr_b16 v[50:51], v244 offset:2048
  ds_read_b64_tr_b16 v[52:53], v244 offset:8192
  ds_read_b64_tr_b16 v[54:55], v244 offset:10240
  v_xor_b32 v244, 64, v253
  v_add_u32 v244, 0x8000, v244
  ds_read_b64_tr_b16 v[64:65], v244 offset:0
  ds_read_b64_tr_b16 v[66:67], v244 offset:2048
  ds_read_b64_tr_b16 v[68:69], v244 offset:8192
  ds_read_b64_tr_b16 v[70:71], v244 offset:10240
  v_xor_b32 v244, 128, v253
  v_add_u32 v244, 0x8000, v244
  ds_read_b64_tr_b16 v[96:97], v244 offset:0
  ds_read_b64_tr_b16 v[98:99], v244 offset:2048
  ds_read_b64_tr_b16 v[100:101], v244 offset:8192
  ds_read_b64_tr_b16 v[102:103], v244 offset:10240
  v_xor_b32 v244, 192, v253
  v_add_u32 v244, 0x8000, v244
  ds_read_b64_tr_b16 v[128:129], v244 offset:0
  ds_read_b64_tr_b16 v[130:131], v244 offset:2048
  ds_read_b64_tr_b16 v[132:133], v244 offset:8192
  ds_read_b64_tr_b16 v[134:135], v244 offset:10240
  s_waitcnt vmcnt(24) lgkmcnt(0)
  s_barrier
  s_mov_b32 s48, s8
  s_and_b32 s49, s9, 0xffff
  s_add_u32 m0, s65, 0x0
  s_add_u32 s80, s57, 0x100000
  buffer_load_dwordx4 v241, s[48:51], s80 offen  lds
  s_add_u32 m0, s65, 0x400
  s_add_u32 s80, s57, 0x108000
  buffer_load_dwordx4 v241, s[48:51], s80 offen  lds
  s_add_u32 m0, s65, 0x800
  s_add_u32 s80, s57, 0x110000
  buffer_load_dwordx4 v241, s[48:51], s80 offen  lds
  s_add_u32 m0, s65, 0xc00
  s_add_u32 s80, s57, 0x118000
  buffer_load_dwordx4 v241, s[48:51], s80 offen  lds
  s_add_u32 m0, s65, 0x1000
  s_add_u32 s80, s57, 0x120000
  v_xor_b32 v248, 64, v241
  buffer_load_dwordx4 v248, s[48:51], s80 offen  lds
  s_add_u32 m0, s65, 0x1400
  s_add_u32 s80, s57, 0x128000
  v_xor_b32 v248, 64, v241
  buffer_load_dwordx4 v248, s[48:51], s80 offen  lds
  s_add_u32 m0, s65, 0x1800
  s_add_u32 s80, s57, 0x130000
  v_xor_b32 v248, 64, v241
  buffer_load_dwordx4 v248, s[48:51], s80 offen  lds
  s_add_u32 m0, s65, 0x1c00
  s_add_u32 s80, s57, 0x138000
  v_xor_b32 v248, 64, v241
  buffer_load_dwordx4 v248, s[48:51], s80 offen  lds
  v_xor_b32 v244, 0, v253
  v_add_u32 v244, 0x10000, v244
  ds_read_b64_tr_b16 v[208:209], v244 offset:0
  ds_read_b64_tr_b16 v[210:211], v244 offset:2048
  ds_read_b64_tr_b16 v[212:213], v244 offset:8192
  ds_read_b64_tr_b16 v[214:215], v244 offset:10240
  v_xor_b32 v244, 64, v253
  v_add_u32 v244, 0x10000, v244
  ds_read_b64_tr_b16 v[216:217], v244 offset:0
  ds_read_b64_tr_b16 v[218:219], v244 offset:2048
  ds_read_b64_tr_b16 v[220:221], v244 offset:8192
  ds_read_b64_tr_b16 v[222:223], v244 offset:10240
  v_xor_b32 v244, 128, v253
  v_add_u32 v244, 0x10000, v244
  ds_read_b64_tr_b16 v[104:105], v244 offset:0
  ds_read_b64_tr_b16 v[106:107], v244 offset:2048
  ds_read_b64_tr_b16 v[108:109], v244 offset:8192
  ds_read_b64_tr_b16 v[110:111], v244 offset:10240
  v_xor_b32 v244, 192, v253
  v_add_u32 v244, 0x10000, v244
  ds_read_b64_tr_b16 v[136:137], v244 offset:0
  ds_read_b64_tr_b16 v[138:139], v244 offset:2048
  ds_read_b64_tr_b16 v[140:141], v244 offset:8192
  ds_read_b64_tr_b16 v[142:143], v244 offset:10240
  s_waitcnt vmcnt(16) lgkmcnt(0)
  s_barrier
  s_mov_b32 s48, s8
  s_and_b32 s49, s9, 0xffff
  s_add_u32 m0, s65, 0x8000
  s_add_u32 s80, s57, 0x200000
  buffer_load_dwordx4 v241, s[48:51], s80 offen  lds
  s_add_u32 m0, s65, 0x8400
  s_add_u32 s80, s57, 0x208000
  buffer_load_dwordx4 v241, s[48:51], s80 offen  lds
  s_add_u32 m0, s65, 0x8800
  s_add_u32 s80, s57, 0x210000
  buffer_load_dwordx4 v241, s[48:51], s80 offen  lds
  s_add_u32 m0, s65, 0x8c00
  s_add_u32 s80, s57, 0x218000
  buffer_load_dwordx4 v241, s[48:51], s80 offen  lds
  s_add_u32 m0, s65, 0x9000
  s_add_u32 s80, s57, 0x220000
  v_xor_b32 v248, 64, v241
  buffer_load_dwordx4 v248, s[48:51], s80 offen  lds
  s_add_u32 m0, s65, 0x9400
  s_add_u32 s80, s57, 0x228000
  v_xor_b32 v248, 64, v241
  buffer_load_dwordx4 v248, s[48:51], s80 offen  lds
  s_add_u32 m0, s65, 0x9800
  s_add_u32 s80, s57, 0x230000
  v_xor_b32 v248, 64, v241
  buffer_load_dwordx4 v248, s[48:51], s80 offen  lds
  s_add_u32 m0, s65, 0x9c00
  s_add_u32 s80, s57, 0x238000
  v_xor_b32 v248, 64, v241
  buffer_load_dwordx4 v248, s[48:51], s80 offen  lds
  v_xor_b32 v244, 0, v253
  v_add_u32 v244, 0x18000, v244
  ds_read_b64_tr_b16 v[80:81], v244 offset:0
  ds_read_b64_tr_b16 v[82:83], v244 offset:2048
  ds_read_b64_tr_b16 v[84:85], v244 offset:8192
  ds_read_b64_tr_b16 v[86:87], v244 offset:10240
  v_xor_b32 v244, 64, v253
  v_add_u32 v244, 0x18000, v244
  ds_read_b64_tr_b16 v[224:225], v244 offset:0
  ds_read_b64_tr_b16 v[226:227], v244 offset:2048
  ds_read_b64_tr_b16 v[228:229], v244 offset:8192
  ds_read_b64_tr_b16 v[230:231], v244 offset:10240
  v_xor_b32 v244, 128, v253
  v_add_u32 v244, 0x18000, v244
  ds_read_b64_tr_b16 v[112:113], v244 offset:0
  ds_read_b64_tr_b16 v[114:115], v244 offset:2048
  ds_read_b64_tr_b16 v[116:117], v244 offset:8192
  ds_read_b64_tr_b16 v[118:119], v244 offset:10240
  v_xor_b32 v244, 192, v253
  v_add_u32 v244, 0x18000, v244
  ds_read_b64_tr_b16 v[120:121], v244 offset:0
  ds_read_b64_tr_b16 v[122:123], v244 offset:2048
  ds_read_b64_tr_b16 v[124:125], v244 offset:8192
  ds_read_b64_tr_b16 v[126:127], v244 offset:10240
  s_waitcnt vmcnt(16) lgkmcnt(0)
  s_barrier
  v_bfe_u32 v188, v240, 4, 2
  v_lshlrev_b32 v188, 4, v188
  v_bfe_u32 v189, v240, 0, 2
  v_lshl_add_u32 v188, v189, 2, v188
  v_lshl_or_b32 v185, v186, 16, v185
  v_cmp_eq_u32 vcc, v180, v185
  s_nop 1
  v_cndmask_b32 v185, v185, -1, vcc
  s_lshl_b32 s81, s52, 2
  s_add_u32 s81, s81, s40
  s_lshl_b32 s81, s81, 6
  s_add_u32 s81, s81, 0x8900000
  s_mov_b32 exec_lo, 0x000f000f
  s_mov_b32 exec_hi, 0x000f000f
  buffer_store_dword v185, v188, s[36:39], s81 offen sc1
  s_mov_b64 exec, -1
  s_mov_b32 s48, s8
  s_and_b32 s49, s9, 0xffff
  s_add_u32 m0, s65, 0x10000
  s_add_u32 s80, s57, 0x300000
  buffer_load_dwordx4 v241, s[48:51], s80 offen  lds
  s_add_u32 m0, s65, 0x10400
  s_add_u32 s80, s57, 0x308000
  buffer_load_dwordx4 v241, s[48:51], s80 offen  lds
  s_add_u32 m0, s65, 0x10800
  s_add_u32 s80, s57, 0x310000
  buffer_load_dwordx4 v241, s[48:51], s80 offen  lds
  s_add_u32 m0, s65, 0x10c00
  s_add_u32 s80, s57, 0x318000
  buffer_load_dwordx4 v241, s[48:51], s80 offen  lds
  s_add_u32 m0, s65, 0x11000
  s_add_u32 s80, s57, 0x320000
  v_xor_b32 v248, 64, v241
  buffer_load_dwordx4 v248, s[48:51], s80 offen  lds
  s_add_u32 m0, s65, 0x11400
  s_add_u32 s80, s57, 0x328000
  v_xor_b32 v248, 64, v241
  buffer_load_dwordx4 v248, s[48:51], s80 offen  lds
  s_add_u32 m0, s65, 0x11800
  s_add_u32 s80, s57, 0x330000
  v_xor_b32 v248, 64, v241
  buffer_load_dwordx4 v248, s[48:51], s80 offen  lds
  s_add_u32 m0, s65, 0x11c00
  s_add_u32 s80, s57, 0x338000
  v_xor_b32 v248, 64, v241
  buffer_load_dwordx4 v248, s[48:51], s80 offen  lds
  v_add_u32 v244, 0x20000, v249
  ds_read_b64_tr_b16 a[0:1], v244 offset:0
  ds_read_b64_tr_b16 a[2:3], v244 offset:256
  ds_read_b64_tr_b16 a[4:5], v244 offset:2048
  ds_read_b64_tr_b16 a[6:7], v244 offset:2304
  ds_read_b64_tr_b16 a[16:17], v244 offset:16384
  ds_read_b64_tr_b16 a[18:19], v244 offset:16640
  ds_read_b64_tr_b16 a[20:21], v244 offset:18432
  ds_read_b64_tr_b16 a[22:23], v244 offset:18688
  v_add_u32 v244, 0x20000, v250
  ds_read_b64_tr_b16 a[8:9], v244 offset:0
  ds_read_b64_tr_b16 a[10:11], v244 offset:256
  ds_read_b64_tr_b16 a[12:13], v244 offset:2048
  ds_read_b64_tr_b16 a[14:15], v244 offset:2304
  ds_read_b64_tr_b16 a[24:25], v244 offset:16384
  ds_read_b64_tr_b16 a[26:27], v244 offset:16640
  ds_read_b64_tr_b16 a[28:29], v244 offset:18432
  ds_read_b64_tr_b16 a[30:31], v244 offset:18688
  s_waitcnt vmcnt(16) lgkmcnt(0)
  s_barrier
  s_mov_b32 s48, s10
  s_and_b32 s49, s11, 0xffff
  s_add_u32 m0, s65, 0x18000
  s_add_u32 s80, s57, 0x0
  buffer_load_dwordx4 v241, s[48:51], s80 offen  lds
  s_add_u32 m0, s65, 0x18400
  s_add_u32 s80, s57, 0x8000
  buffer_load_dwordx4 v241, s[48:51], s80 offen  lds
  s_add_u32 m0, s65, 0x18800
  s_add_u32 s80, s57, 0x10000
  buffer_load_dwordx4 v241, s[48:51], s80 offen  lds
  s_add_u32 m0, s65, 0x18c00
  s_add_u32 s80, s57, 0x18000
  buffer_load_dwordx4 v241, s[48:51], s80 offen  lds
  s_add_u32 m0, s65, 0x19000
  s_add_u32 s80, s57, 0x20000
  v_xor_b32 v248, 64, v241
  buffer_load_dwordx4 v248, s[48:51], s80 offen  lds
  s_add_u32 m0, s65, 0x19400
  s_add_u32 s80, s57, 0x28000
  v_xor_b32 v248, 64, v241
  buffer_load_dwordx4 v248, s[48:51], s80 offen  lds
  s_add_u32 m0, s65, 0x19800
  s_add_u32 s80, s57, 0x30000
  v_xor_b32 v248, 64, v241
  buffer_load_dwordx4 v248, s[48:51], s80 offen  lds
  s_add_u32 m0, s65, 0x19c00
  s_add_u32 s80, s57, 0x38000
  v_xor_b32 v248, 64, v241
  buffer_load_dwordx4 v248, s[48:51], s80 offen  lds
  v_add_u32 v244, 0x0, v249
  ds_read_b64_tr_b16 a[32:33], v244 offset:0
  ds_read_b64_tr_b16 a[34:35], v244 offset:256
  ds_read_b64_tr_b16 a[36:37], v244 offset:2048
  ds_read_b64_tr_b16 a[38:39], v244 offset:2304
  ds_read_b64_tr_b16 a[48:49], v244 offset:16384
  ds_read_b64_tr_b16 a[50:51], v244 offset:16640
  ds_read_b64_tr_b16 a[52:53], v244 offset:18432
  ds_read_b64_tr_b16 a[54:55], v244 offset:18688
  v_add_u32 v244, 0x0, v250
  ds_read_b64_tr_b16 a[40:41], v244 offset:0
  ds_read_b64_tr_b16 a[42:43], v244 offset:256
  ds_read_b64_tr_b16 a[44:45], v244 offset:2048
  ds_read_b64_tr_b16 a[46:47], v244 offset:2304
  ds_read_b64_tr_b16 a[56:57], v244 offset:16384
  ds_read_b64_tr_b16 a[58:59], v244 offset:16640
  ds_read_b64_tr_b16 a[60:61], v244 offset:18432
  ds_read_b64_tr_b16 a[62:63], v244 offset:18688
  s_waitcnt vmcnt(16) lgkmcnt(0)
  s_barrier
  s_mov_b32 s48, s10
  s_and_b32 s49, s11, 0xffff
  s_add_u32 m0, s65, 0x20000
  s_add_u32 s80, s57, 0x100000
  buffer_load_dwordx4 v241, s[48:51], s80 offen  lds
  s_add_u32 m0, s65, 0x20400
  s_add_u32 s80, s57, 0x108000
  buffer_load_dwordx4 v241, s[48:51], s80 offen  lds
  s_add_u32 m0, s65, 0x20800
  s_add_u32 s80, s57, 0x110000
  buffer_load_dwordx4 v241, s[48:51], s80 offen  lds
  s_add_u32 m0, s65, 0x20c00
  s_add_u32 s80, s57, 0x118000
  buffer_load_dwordx4 v241, s[48:51], s80 offen  lds
  s_add_u32 m0, s65, 0x21000
  s_add_u32 s80, s57, 0x120000
  v_xor_b32 v248, 64, v241
  buffer_load_dwordx4 v248, s[48:51], s80 offen  lds
  s_add_u32 m0, s65, 0x21400
  s_add_u32 s80, s57, 0x128000
  v_xor_b32 v248, 64, v241
  buffer_load_dwordx4 v248, s[48:51], s80 offen  lds
  s_add_u32 m0, s65, 0x21800
  s_add_u32 s80, s57, 0x130000
  v_xor_b32 v248, 64, v241
  buffer_load_dwordx4 v248, s[48:51], s80 offen  lds
  s_add_u32 m0, s65, 0x21c00
  s_add_u32 s80, s57, 0x138000
  v_xor_b32 v248, 64, v241
  buffer_load_dwordx4 v248, s[48:51], s80 offen  lds
  v_add_u32 v244, 0x8000, v249
  ds_read_b64_tr_b16 a[64:65], v244 offset:0
  ds_read_b64_tr_b16 a[66:67], v244 offset:256
  ds_read_b64_tr_b16 a[68:69], v244 offset:2048
  ds_read_b64_tr_b16 a[70:71], v244 offset:2304
  ds_read_b64_tr_b16 a[80:81], v244 offset:16384
  ds_read_b64_tr_b16 a[82:83], v244 offset:16640
  ds_read_b64_tr_b16 a[84:85], v244 offset:18432
  ds_read_b64_tr_b16 a[86:87], v244 offset:18688
  v_add_u32 v244, 0x8000, v250
  ds_read_b64_tr_b16 a[72:73], v244 offset:0
  ds_read_b64_tr_b16 a[74:75], v244 offset:256
  ds_read_b64_tr_b16 a[76:77], v244 offset:2048
  ds_read_b64_tr_b16 a[78:79], v244 offset:2304
  ds_read_b64_tr_b16 a[88:89], v244 offset:16384
  ds_read_b64_tr_b16 a[90:91], v244 offset:16640
  ds_read_b64_tr_b16 a[92:93], v244 offset:18432
  ds_read_b64_tr_b16 a[94:95], v244 offset:18688
  s_waitcnt vmcnt(16) lgkmcnt(0)
  s_barrier
  s_mov_b32 s48, s10
  s_and_b32 s49, s11, 0xffff
  s_add_u32 m0, s65, 0x0
  s_add_u32 s80, s57, 0x200000
  buffer_load_dwordx4 v241, s[48:51], s80 offen  lds
  s_add_u32 m0, s65, 0x400
  s_add_u32 s80, s57, 0x208000
  buffer_load_dwordx4 v241, s[48:51], s80 offen  lds
  s_add_u32 m0, s65, 0x800
  s_add_u32 s80, s57, 0x210000
  buffer_load_dwordx4 v241, s[48:51], s80 offen  lds
  s_add_u32 m0, s65, 0xc00
  s_add_u32 s80, s57, 0x218000
  buffer_load_dwordx4 v241, s[48:51], s80 offen  lds
  s_add_u32 m0, s65, 0x1000
  s_add_u32 s80, s57, 0x220000
  v_xor_b32 v248, 64, v241
  buffer_load_dwordx4 v248, s[48:51], s80 offen  lds
  s_add_u32 m0, s65, 0x1400
  s_add_u32 s80, s57, 0x228000
  v_xor_b32 v248, 64, v241
  buffer_load_dwordx4 v248, s[48:51], s80 offen  lds
  s_add_u32 m0, s65, 0x1800
  s_add_u32 s80, s57, 0x230000
  v_xor_b32 v248, 64, v241
  buffer_load_dwordx4 v248, s[48:51], s80 offen  lds
  s_add_u32 m0, s65, 0x1c00
  s_add_u32 s80, s57, 0x238000
  v_xor_b32 v248, 64, v241
  buffer_load_dwordx4 v248, s[48:51], s80 offen  lds
  v_add_u32 v244, 0x10000, v249
  ds_read_b64_tr_b16 a[96:97], v244 offset:0
  ds_read_b64_tr_b16 a[98:99], v244 offset:256
  ds_read_b64_tr_b16 a[100:101], v244 offset:2048
  ds_read_b64_tr_b16 a[102:103], v244 offset:2304
  ds_read_b64_tr_b16 a[112:113], v244 offset:16384
  ds_read_b64_tr_b16 a[114:115], v244 offset:16640
  ds_read_b64_tr_b16 a[116:117], v244 offset:18432
  ds_read_b64_tr_b16 a[118:119], v244 offset:18688
  v_add_u32 v244, 0x10000, v250
  ds_read_b64_tr_b16 a[104:105], v244 offset:0
  ds_read_b64_tr_b16 a[106:107], v244 offset:256
  ds_read_b64_tr_b16 a[108:109], v244 offset:2048
  ds_read_b64_tr_b16 a[110:111], v244 offset:2304
  ds_read_b64_tr_b16 a[120:121], v244 offset:16384
  ds_read_b64_tr_b16 a[122:123], v244 offset:16640
  ds_read_b64_tr_b16 a[124:125], v244 offset:18432
  ds_read_b64_tr_b16 a[126:127], v244 offset:18688
  s_waitcnt vmcnt(16) lgkmcnt(0)
  s_barrier
  s_cmp_eq_u32 s89, 0
  s_cselect_b32 s81, 1, 0x10001
  v_mov_b32 v192, s81
  s_cmp_lg_u32 s40, 0
  s_cbranch_scc1 CH_rdy0
  s_mov_b64 exec, 1
  buffer_atomic_add v192, off, s[84:87], 0 offset:32
  s_mov_b64 exec, -1
CH_rdy0:
  s_mov_b32 s48, s10
  s_and_b32 s49, s11, 0xffff
  s_add_u32 m0, s65, 0x8000
  s_add_u32 s80, s57, 0x300000
  buffer_load_dwordx4 v241, s[48:51], s80 offen  lds
  s_add_u32 m0, s65, 0x8400
  s_add_u32 s80, s57, 0x308000
  buffer_load_dwordx4 v241, s[48:51], s80 offen  lds
  s_add_u32 m0, s65, 0x8800
  s_add_u32 s80, s57, 0x310000
  buffer_load_dwordx4 v241, s[48:51], s80 offen  lds
  s_add_u32 m0, s65, 0x8c00
  s_add_u32 s80, s57, 0x318000
  buffer_load_dwordx4 v241, s[48:51], s80 offen  lds
  s_add_u32 m0, s65, 0x9000
  s_add_u32 s80, s57, 0x320000
  v_xor_b32 v248, 64, v241
  buffer_load_dwordx4 v248, s[48:51], s80 offen  lds
  s_add_u32 m0, s65, 0x9400
  s_add_u32 s80, s57, 0x328000
  v_xor_b32 v248, 64, v241
  buffer_load_dwordx4 v248, s[48:51], s80 offen  lds
  s_add_u32 m0, s65, 0x9800
  s_add_u32 s80, s57, 0x330000
  v_xor_b32 v248, 64, v241
  buffer_load_dwordx4 v248, s[48:51], s80 offen  lds
  s_add_u32 m0, s65, 0x9c00
  s_add_u32 s80, s57, 0x338000
  v_xor_b32 v248, 64, v241
  buffer_load_dwordx4 v248, s[48:51], s80 offen  lds
  v_add_u32 v244, 0x18000, v249
  ds_read_b64_tr_b16 a[128:129], v244 offset:0
  ds_read_b64_tr_b16 a[130:131], v244 offset:256
  ds_read_b64_tr_b16 a[132:133], v244 offset:2048
  ds_read_b64_tr_b16 a[134:135], v244 offset:2304
  ds_read_b64_tr_b16 a[144:145], v244 offset:16384
  ds_read_b64_tr_b16 a[146:147], v244 offset:16640
  ds_read_b64_tr_b16 a[148:149], v244 offset:18432
  ds_read_b64_tr_b16 a[150:151], v244 offset:18688
  v_add_u32 v244, 0x18000, v250
  ds_read_b64_tr_b16 a[136:137], v244 offset:0
  ds_read_b64_tr_b16 a[138:139], v244 offset:256
  ds_read_b64_tr_b16 a[140:141], v244 offset:2048
  ds_read_b64_tr_b16 a[142:143], v244 offset:2304
  ds_read_b64_tr_b16 a[152:153], v244 offset:16384
  ds_read_b64_tr_b16 a[154:155], v244 offset:16640
  ds_read_b64_tr_b16 a[156:157], v244 offset:18432
  ds_read_b64_tr_b16 a[158:159], v244 offset:18688
  s_waitcnt vmcnt(16) lgkmcnt(0)
  s_barrier
  s_mov_b32 s48, s12
  s_and_b32 s49, s13, 0xffff
  s_add_u32 m0, s65, 0x10000
  s_add_u32 s80, s57, 0x0
  buffer_load_dwordx4 v242, s[48:51], s80 offen  lds
  s_add_u32 m0, s65, 0x10400
  s_add_u32 s80, s57, 0x8000
  buffer_load_dwordx4 v242, s[48:51], s80 offen  lds
  s_add_u32 m0, s65, 0x10800
  s_add_u32 s80, s57, 0x10000
  buffer_load_dwordx4 v242, s[48:51], s80 offen  lds
  s_add_u32 m0, s65, 0x10c00
  s_add_u32 s80, s57, 0x18000
  buffer_load_dwordx4 v242, s[48:51], s80 offen  lds
  s_add_u32 m0, s65, 0x11000
  s_add_u32 s80, s57, 0x20000
  v_xor_b32 v248, 64, v242
  buffer_load_dwordx4 v248, s[48:51], s80 offen  lds
  s_add_u32 m0, s65, 0x11400
  s_add_u32 s80, s57, 0x28000
  v_xor_b32 v248, 64, v242
  buffer_load_dwordx4 v248, s[48:51], s80 offen  lds
  s_add_u32 m0, s65, 0x11800
  s_add_u32 s80, s57, 0x30000
  v_xor_b32 v248, 64, v242
  buffer_load_dwordx4 v248, s[48:51], s80 offen  lds
  s_add_u32 m0, s65, 0x11c00
  s_add_u32 s80, s57, 0x38000
  v_xor_b32 v248, 64, v242
  buffer_load_dwordx4 v248, s[48:51], s80 offen  lds
  v_add_u32 v244, 0x20000, v249
  ds_read_b64_tr_b16 a[160:161], v244 offset:0
  ds_read_b64_tr_b16 a[162:163], v244 offset:256
  ds_read_b64_tr_b16 a[164:165], v244 offset:2048
  ds_read_b64_tr_b16 a[166:167], v244 offset:2304
  ds_read_b64_tr_b16 a[176:177], v244 offset:16384
  ds_read_b64_tr_b16 a[178:179], v244 offset:16640
  ds_read_b64_tr_b16 a[180:181], v244 offset:18432
  ds_read_b64_tr_b16 a[182:183], v244 offset:18688
  v_add_u32 v244, 0x20000, v250
  ds_read_b64_tr_b16 a[168:169], v244 offset:0
  ds_read_b64_tr_b16 a[170:171], v244 offset:256
  ds_read_b64_tr_b16 a[172:173], v244 offset:2048
  ds_read_b64_tr_b16 a[174:175], v244 offset:2304
  ds_read_b64_tr_b16 a[184:185], v244 offset:16384
  ds_read_b64_tr_b16 a[186:187], v244 offset:16640
  ds_read_b64_tr_b16 a[188:189], v244 offset:18432
  ds_read_b64_tr_b16 a[190:191], v244 offset:18688
  s_waitcnt vmcnt(16) lgkmcnt(0)
  s_barrier
  s_mov_b32 s48, s12
  s_and_b32 s49, s13, 0xffff
  s_add_u32 m0, s65, 0x18000
  s_add_u32 s80, s57, 0x100000
  buffer_load_dwordx4 v242, s[48:51], s80 offen  lds
  s_add_u32 m0, s65, 0x18400
  s_add_u32 s80, s57, 0x108000
  buffer_load_dwordx4 v242, s[48:51], s80 offen  lds
  s_add_u32 m0, s65, 0x18800
  s_add_u32 s80, s57, 0x110000
  buffer_load_dwordx4 v242, s[48:51], s80 offen  lds
  s_add_u32 m0, s65, 0x18c00
  s_add_u32 s80, s57, 0x118000
  buffer_load_dwordx4 v242, s[48:51], s80 offen  lds
  s_add_u32 m0, s65, 0x19000
  s_add_u32 s80, s57, 0x120000
  v_xor_b32 v248, 64, v242
  buffer_load_dwordx4 v248, s[48:51], s80 offen  lds
  s_add_u32 m0, s65, 0x19400
  s_add_u32 s80, s57, 0x128000
  v_xor_b32 v248, 64, v242
  buffer_load_dwordx4 v248, s[48:51], s80 offen  lds
  s_add_u32 m0, s65, 0x19800
  s_add_u32 s80, s57, 0x130000
  v_xor_b32 v248, 64, v242
  buffer_load_dwordx4 v248, s[48:51], s80 offen  lds
  s_add_u32 m0, s65, 0x19c00
  s_add_u32 s80, s57, 0x138000
  v_xor_b32 v248, 64, v242
  buffer_load_dwordx4 v248, s[48:51], s80 offen  lds
  v_add_u32 v244, 0x0, v249
  ds_read_b64_tr_b16 a[192:193], v244 offset:0
  ds_read_b64_tr_b16 a[194:195], v244 offset:256
  ds_read_b64_tr_b16 a[196:197], v244 offset:2048
  ds_read_b64_tr_b16 a[198:199], v244 offset:2304
  ds_read_b64_tr_b16 a[208:209], v244 offset:16384
  ds_read_b64_tr_b16 a[210:211], v244 offset:16640
  ds_read_b64_tr_b16 a[212:213], v244 offset:18432
  ds_read_b64_tr_b16 a[214:215], v244 offset:18688
  v_add_u32 v244, 0x0, v250
  ds_read_b64_tr_b16 a[200:201], v244 offset:0
  ds_read_b64_tr_b16 a[202:203], v244 offset:256
  ds_read_b64_tr_b16 a[204:205], v244 offset:2048
  ds_read_b64_tr_b16 a[206:207], v244 offset:2304
  ds_read_b64_tr_b16 a[216:217], v244 offset:16384
  ds_read_b64_tr_b16 a[218:219], v244 offset:16640
  ds_read_b64_tr_b16 a[220:221], v244 offset:18432
  ds_read_b64_tr_b16 a[222:223], v244 offset:18688
  s_waitcnt vmcnt(16) lgkmcnt(0)
  s_barrier
  s_mov_b32 s48, s12
  s_and_b32 s49, s13, 0xffff
  s_add_u32 m0, s65, 0x20000
  s_add_u32 s80, s57, 0x200000
  buffer_load_dwordx4 v242, s[48:51], s80 offen  lds
  s_add_u32 m0, s65, 0x20400
  s_add_u32 s80, s57, 0x208000
  buffer_load_dwordx4 v242, s[48:51], s80 offen  lds
  s_add_u32 m0, s65, 0x20800
  s_add_u32 s80, s57, 0x210000
  buffer_load_dwordx4 v242, s[48:51], s80 offen  lds
  s_add_u32 m0, s65, 0x20c00
  s_add_u32 s80, s57, 0x218000
  buffer_load_dwordx4 v242, s[48:51], s80 offen  lds
  s_add_u32 m0, s65, 0x21000
  s_add_u32 s80, s57, 0x220000
  v_xor_b32 v248, 64, v242
  buffer_load_dwordx4 v248, s[48:51], s80 offen  lds
  s_add_u32 m0, s65, 0x21400
  s_add_u32 s80, s57, 0x228000
  v_xor_b32 v248, 64, v242
  buffer_load_dwordx4 v248, s[48:51], s80 offen  lds
  s_add_u32 m0, s65, 0x21800
  s_add_u32 s80, s57, 0x230000
  v_xor_b32 v248, 64, v242
  buffer_load_dwordx4 v248, s[48:51], s80 offen  lds
  s_add_u32 m0, s65, 0x21c00
  s_add_u32 s80, s57, 0x238000
  v_xor_b32 v248, 64, v242
  buffer_load_dwordx4 v248, s[48:51], s80 offen  lds
  v_add_u32 v244, 0x8000, v249
  ds_read_b64_tr_b16 a[224:225], v244 offset:0
  ds_read_b64_tr_b16 a[226:227], v244 offset:256
  ds_read_b64_tr_b16 a[228:229], v244 offset:2048
  ds_read_b64_tr_b16 a[230:231], v244 offset:2304
  ds_read_b64_tr_b16 a[240:241], v244 offset:16384
  ds_read_b64_tr_b16 a[242:243], v244 offset:16640
  ds_read_b64_tr_b16 a[244:245], v244 offset:18432
  ds_read_b64_tr_b16 a[246:247], v244 offset:18688
  v_add_u32 v244, 0x8000, v250
  ds_read_b64_tr_b16 a[232:233], v244 offset:0
  ds_read_b64_tr_b16 a[234:235], v244 offset:256
  ds_read_b64_tr_b16 a[236:237], v244 offset:2048
  ds_read_b64_tr_b16 a[238:239], v244 offset:2304
  ds_read_b64_tr_b16 a[248:249], v244 offset:16384
  ds_read_b64_tr_b16 a[250:251], v244 offset:16640
  ds_read_b64_tr_b16 a[252:253], v244 offset:18432
  ds_read_b64_tr_b16 a[254:255], v244 offset:18688
  s_waitcnt vmcnt(16) lgkmcnt(0)
  s_barrier
  s_mov_b32 s48, s12
  s_and_b32 s49, s13, 0xffff
  s_add_u32 m0, s65, 0x0
  s_add_u32 s80, s57, 0x300000
  buffer_load_dwordx4 v242, s[48:51], s80 offen  lds
  s_add_u32 m0, s65, 0x400
  s_add_u32 s80, s57, 0x308000
  buffer_load_dwordx4 v242, s[48:51], s80 offen  lds
  s_add_u32 m0, s65, 0x800
  s_add_u32 s80, s57, 0x310000
  buffer_load_dwordx4 v242, s[48:51], s80 offen  lds
  s_add_u32 m0, s65, 0xc00
  s_add_u32 s80, s57, 0x318000
  buffer_load_dwordx4 v242, s[48:51], s80 offen  lds
  s_add_u32 m0, s65, 0x1000
  s_add_u32 s80, s57, 0x320000
  v_xor_b32 v248, 64, v242
  buffer_load_dwordx4 v248, s[48:51], s80 offen  lds
  s_add_u32 m0, s65, 0x1400
  s_add_u32 s80, s57, 0x328000
  v_xor_b32 v248, 64, v242
  buffer_load_dwordx4 v248, s[48:51], s80 offen  lds
  s_add_u32 m0, s65, 0x1800
  s_add_u32 s80, s57, 0x330000
  v_xor_b32 v248, 64, v242
  buffer_load_dwordx4 v248, s[48:51], s80 offen  lds
  s_add_u32 m0, s65, 0x1c00
  s_add_u32 s80, s57, 0x338000
  v_xor_b32 v248, 64, v242
  buffer_load_dwordx4 v248, s[48:51], s80 offen  lds
  v_add_u32 v244, 0x10000, v251
  ds_read_b64_tr_b16 v[56:57], v244 offset:0
  ds_read_b64_tr_b16 v[58:59], v244 offset:256
  ds_read_b64_tr_b16 v[60:61], v244 offset:2048
  ds_read_b64_tr_b16 v[62:63], v244 offset:2304
  ds_read_b64_tr_b16 v[144:145], v244 offset:16384
  ds_read_b64_tr_b16 v[146:147], v244 offset:16640
  ds_read_b64_tr_b16 v[148:149], v244 offset:18432
  ds_read_b64_tr_b16 v[150:151], v244 offset:18688
  v_add_u32 v244, 0x10000, v252
  ds_read_b64_tr_b16 v[72:73], v244 offset:0
  ds_read_b64_tr_b16 v[74:75], v244 offset:256
  ds_read_b64_tr_b16 v[76:77], v244 offset:2048
  ds_read_b64_tr_b16 v[78:79], v244 offset:2304
  ds_read_b64_tr_b16 v[152:153], v244 offset:16384
  ds_read_b64_tr_b16 v[154:155], v244 offset:16640
  ds_read_b64_tr_b16 v[156:157], v244 offset:18432
  ds_read_b64_tr_b16 v[158:159], v244 offset:18688
  s_waitcnt vmcnt(16) lgkmcnt(0)
  s_barrier
  buffer_load_dword v254, off, s[84:87], 0 offset:32 sc1
  v_add_u32 v244, 0x18000, v251
  ds_read_b64_tr_b16 v[16:17], v244 offset:0
  ds_read_b64_tr_b16 v[18:19], v244 offset:256
  ds_read_b64_tr_b16 v[20:21], v244 offset:2048
  ds_read_b64_tr_b16 v[22:23], v244 offset:2304
  ds_read_b64_tr_b16 v[160:161], v244 offset:16384
  ds_read_b64_tr_b16 v[162:163], v244 offset:16640
  ds_read_b64_tr_b16 v[164:165], v244 offset:18432
  ds_read_b64_tr_b16 v[166:167], v244 offset:18688
  v_add_u32 v244, 0x18000, v252
  ds_read_b64_tr_b16 v[24:25], v244 offset:0
  ds_read_b64_tr_b16 v[26:27], v244 offset:256
  ds_read_b64_tr_b16 v[28:29], v244 offset:2048
  ds_read_b64_tr_b16 v[30:31], v244 offset:2304
  ds_read_b64_tr_b16 v[168:169], v244 offset:16384
  ds_read_b64_tr_b16 v[170:171], v244 offset:16640
  ds_read_b64_tr_b16 v[172:173], v244 offset:18432
  ds_read_b64_tr_b16 v[174:175], v244 offset:18688
  s_waitcnt vmcnt(8) lgkmcnt(0)
  s_barrier
  v_add_u32 v244, 0x20000, v251
  ds_read_b64_tr_b16 v[32:33], v244 offset:0
  ds_read_b64_tr_b16 v[34:35], v244 offset:256
  ds_read_b64_tr_b16 v[36:37], v244 offset:2048
  ds_read_b64_tr_b16 v[38:39], v244 offset:2304
  ds_read_b64_tr_b16 v[176:177], v244 offset:16384
  ds_read_b64_tr_b16 v[178:179], v244 offset:16640
  ds_read_b64_tr_b16 v[180:181], v244 offset:18432
  ds_read_b64_tr_b16 v[182:183], v244 offset:18688
  v_add_u32 v244, 0x20000, v252
  ds_read_b64_tr_b16 v[40:41], v244 offset:0
  ds_read_b64_tr_b16 v[42:43], v244 offset:256
  ds_read_b64_tr_b16 v[44:45], v244 offset:2048
  ds_read_b64_tr_b16 v[46:47], v244 offset:2304
  ds_read_b64_tr_b16 v[184:185], v244 offset:16384
  ds_read_b64_tr_b16 v[186:187], v244 offset:16640
  ds_read_b64_tr_b16 v[188:189], v244 offset:18432
  ds_read_b64_tr_b16 v[190:191], v244 offset:18688
  s_waitcnt vmcnt(0) lgkmcnt(0)
  s_barrier
  v_readfirstlane_b32 s42, v254
  s_lshl_b32 s79, s52, 7
  s_add_u32 s79, s79, 0x8a05400
  s_and_b32 s82, s42, 0xffff
  s_cmp_ge_u32 s82, 32
  s_cselect_b32 s82, s79, 0x10000000
  buffer_load_dword v254, off, s[36:39], s82 sc1
  s_lshl_b32 s81, s40, 12
  s_add_u32 s81, s81, 0x24000
  v_lshlrev_b32 v245, 4, v240
  v_add_u32 v245, s81, v245
  ds_write_b128 v245, v[0:3] offset:0
  ds_write_b128 v245, v[4:7] offset:1024
  ds_write_b128 v245, v[8:11] offset:2048
  ds_write_b128 v245, v[12:15] offset:3072
  s_waitcnt lgkmcnt(0)
  v_add_u32 v244, 0x0, v251
  ds_read_b64_tr_b16 v[0:1], v244 offset:0
  ds_read_b64_tr_b16 v[2:3], v244 offset:256
  ds_read_b64_tr_b16 v[4:5], v244 offset:2048
  ds_read_b64_tr_b16 v[6:7], v244 offset:2304
  ds_read_b64_tr_b16 v[192:193], v244 offset:16384
  ds_read_b64_tr_b16 v[194:195], v244 offset:16640
  ds_read_b64_tr_b16 v[196:197], v244 offset:18432
  ds_read_b64_tr_b16 v[198:199], v244 offset:18688
  v_add_u32 v244, 0x0, v252
  ds_read_b64_tr_b16 v[8:9], v244 offset:0
  ds_read_b64_tr_b16 v[10:11], v244 offset:256
  ds_read_b64_tr_b16 v[12:13], v244 offset:2048
  ds_read_b64_tr_b16 v[14:15], v244 offset:2304
  ds_read_b64_tr_b16 v[200:201], v244 offset:16384
  ds_read_b64_tr_b16 v[202:203], v244 offset:16640
  ds_read_b64_tr_b16 v[204:205], v244 offset:18432
  ds_read_b64_tr_b16 v[206:207], v244 offset:18688
  s_waitcnt lgkmcnt(0)
  s_barrier
  s_mul_i32 s81, s40, 36864
  s_add_u32 s81, s81, 0x4000
  v_lshlrev_b32 v246, 4, v240
  v_add_u32 v246, s81, v246
  ds_write_b128 v246, v[16:19] offset:4096
  ds_write_b128 v246, v[20:23] offset:5120
  ds_write_b128 v246, v[24:27] offset:6144
  ds_write_b128 v246, v[28:31] offset:7168
  s_waitcnt lgkmcnt(0)
  ds_read_b128 v[16:19], v245 offset:0
  ds_read_b128 v[20:23], v245 offset:1024
  ds_read_b128 v[24:27], v245 offset:2048
  ds_read_b128 v[28:31], v245 offset:3072
  s_waitcnt lgkmcnt(0)
  s_barrier
  ds_write_b128 v246, v[56:59] offset:0
  ds_write_b128 v246, v[60:63] offset:1024
  ds_write_b128 v246, v[72:75] offset:2048
  ds_write_b128 v246, v[76:79] offset:3072
  ds_write_b128 v246, v[32:35] offset:8192
  ds_write_b128 v246, v[36:39] offset:9216
  ds_write_b128 v246, v[40:43] offset:10240
  ds_write_b128 v246, v[44:47] offset:11264
  ds_write_b128 v246, v[0:3] offset:12288
  ds_write_b128 v246, v[4:7] offset:13312
  ds_write_b128 v246, v[8:11] offset:14336
  ds_write_b128 v246, v[12:15] offset:15360
  ds_write_b128 v246, v[48:51] offset:20480
  ds_write_b128 v246, v[52:55] offset:21504
  ds_write_b128 v246, v[64:67] offset:22528
  ds_write_b128 v246, v[68:71] offset:23552
  ds_write_b128 v246, v[80:83] offset:24576
  ds_write_b128 v246, v[84:87] offset:25600
  ds_write_b128 v246, v[88:91] offset:26624
  ds_write_b128 v246, v[92:95] offset:27648
  ds_write_b128 v246, v[96:99] offset:28672
  ds_write_b128 v246, v[100:103] offset:29696
  ds_write_b128 v246, v[104:107] offset:30720
  ds_write_b128 v246, v[108:111] offset:31744
  ds_write_b128 v246, v[112:115] offset:32768
  ds_write_b128 v246, v[116:119] offset:33792
  ds_write_b128 v246, v[120:123] offset:34816
  ds_write_b128 v246, v[124:127] offset:35840
  ds_write_b128 v246, v[16:19] offset:16384
  ds_write_b128 v246, v[20:23] offset:17408
  ds_write_b128 v246, v[24:27] offset:18432
  ds_write_b128 v246, v[28:31] offset:19456
  s_waitcnt lgkmcnt(0)
  s_waitcnt vmcnt(0)
  v_readfirstlane_b32 s78, v254
  v_bfe_u32 v241, v240, 5, 1
  v_lshlrev_b32 v241, 10, v241
  v_bfe_u32 v244, v240, 4, 1
  v_lshl_add_u32 v241, v244, 9, v241
  v_bfe_u32 v244, v240, 0, 4
  v_lshl_add_u32 v241, v244, 4, v241
  v_bfe_u32 v242, v240, 4, 1
  v_lshlrev_b32 v242, 10, v242
  v_bfe_u32 v244, v240, 5, 1
  v_lshl_add_u32 v242, v244, 9, v242
  v_bfe_u32 v244, v240, 0, 4
  v_lshl_add_u32 v242, v244, 4, v242
  v_lshlrev_b32 v243, 5, v240
  s_mul_i32 s81, s52, 0x86000
  s_lshl_b32 s82, s40, 11
  s_add_u32 s81, s81, s82
  s_cmp_gt_u32 s78, 1
  s_cselect_b32 s81, s81, 0x10000000
  s_add_u32 s82, s81, 0x2200000
  s_add_u32 s81, s81, 0x1100000
  buffer_load_dwordx4 v[56:59], v241, s[36:39], s81 offen offset:0 sc1
  buffer_load_dwordx4 v[60:63], v241, s[36:39], s81 offen offset:256 sc1
  buffer_load_dwordx4 v[72:75], v242, s[36:39], s82 offen offset:0 sc1
  buffer_load_dwordx4 v[76:79], v242, s[36:39], s82 offen offset:256 sc1
  s_lshl_b32 s81, s52, 2
  s_add_u32 s81, s81, s40
  s_lshl_b32 s82, s81, 11
  s_add_u32 s82, s82, 0x8800000
  buffer_load_dword v32, v243, s[36:39], s82 offen sc1
  s_lshl_b32 s82, s81, 7
  s_add_u32 s82, s82, 0x8900000
  buffer_load_dword v32, off, s[36:39], s82 sc1
  s_lshl_b32 s81, s40, 12
  s_add_u32 s81, s81, CF_loop-L_pc0
  v_lshlrev_b32 v244, 6, v240
  v_add_u32 v244, s81, v244
  global_load_dword v32, v244, s[92:93]
  v_mov_b32 v0, v240
  v_mov_b32 v240, v128
  v_mov_b32 v241, v129
  v_mov_b32 v242, v130
  v_mov_b32 v243, v131
  v_mov_b32 v244, v132
  v_mov_b32 v245, v133
  v_mov_b32 v246, v134
  v_mov_b32 v247, v135
  v_mov_b32 v248, v136
  v_mov_b32 v249, v137
  v_mov_b32 v250, v138
  v_mov_b32 v251, v139
  v_mov_b32 v252, v140
  v_mov_b32 v253, v141
  v_mov_b32 v254, v142
  v_mov_b32 v255, v143
  v_mov_b32 v0, v0
  s_lshl_b32 s81, s52, 2
  s_add_u32 s81, s81, s40
  s_lshl_b32 s82, s81, 11
  s_add_u32 s58, s82, 0x8800000
  s_lshl_b32 s82, s81, 6
  s_add_u32 s64, s82, 0x8900000
  s_mov_b32 s54, 0x8900000
  s_mov_b32 s55, 0x8901000
  s_mov_b32 s60, 0x8800000
  s_mov_b32 s61, 0x8808000
  s_mul_i32 s81, s52, 0x86000
  s_lshl_b32 s82, s40, 11
  s_add_u32 s81, s81, s82
  s_add_u32 s66, s81, 0x1100000
  s_add_u32 s67, s81, 0x2200000
  s_mul_i32 s81, s52, 0x41000
  s_lshl_b32 s82, s40, 10
  s_add_u32 s81, s81, s82
  s_add_u32 s68, s81, 0x6800000
  s_mov_b32 s70, 0xffffffbf
  s_mov_b32 s72, 0x3e0293ee
  s_mov_b32 s73, 0x3e0293ee
  s_mov_b32 s74, 0x0000ffff
  s_mov_b32 s75, 0x0000ffff
  s_mov_b32 s76, 0xffff0000
  s_mov_b32 s77, 0xffff0000
  s_mov_b32 s62, 0
  s_mov_b32 s63, -1
  s_mov_b32 s53, 0
  s_mov_b32 s80, 0
  v_bfe_u32 v127, v0, 0, 6
  v_lshlrev_b32 v127, 4, v127
  v_bfe_u32 v132, v0, 5, 1
  v_lshlrev_b32 v132, 10, v132
  v_bfe_u32 v141, v0, 4, 1
  v_lshl_add_u32 v132, v141, 9, v132
  v_bfe_u32 v141, v0, 0, 4
  v_lshl_add_u32 v132, v141, 4, v132
  v_bfe_u32 v133, v0, 4, 1
  v_lshlrev_b32 v133, 10, v133
  v_bfe_u32 v141, v0, 5, 1
  v_lshl_add_u32 v133, v141, 9, v133
  v_bfe_u32 v141, v0, 0, 4
  v_lshl_add_u32 v133, v141, 4, v133
CH_rdy:
  s_and_b32 s82, s42, 0xffff
  s_cmp_ge_u32 s82, 32
  s_cbranch_scc1 CH_go
  buffer_load_dword v33, off, s[84:87], 0 offset:32 sc1
  s_add_u32 s91, s91, 1
  s_cmp_gt_u32 s91, 0x20000
  s_cbranch_scc1 L_abort
  s_waitcnt vmcnt(0)
  v_readfirstlane_b32 s42, v33
  s_sleep 4
  s_branch CH_rdy
CH_go:
  s_mov_b32 s56, s79
  s_mov_b32 s81, 1
  s_cmp_lt_u32 s81, s78
  s_cbranch_scc1 CH_kvd
CHs_kv:
  buffer_load_dword v33, off, s[36:39], s79 sc1
  s_add_u32 s91, s91, 1
  s_cmp_gt_u32 s91, 0x20000
  s_cbranch_scc1 L_abort
  s_waitcnt vmcnt(0)
  v_readfirstlane_b32 s78, v33
  s_nop 0
  s_cmp_lt_u32 s81, s78
  s_cbranch_scc1 CHs_kv1
  s_sleep 2
  s_branch CHs_kv
CHs_kv1:
  buffer_load_dwordx4 v[56:59], v132, s[36:39], s66 offen offset:0 sc1
  buffer_load_dwordx4 v[60:63], v132, s[36:39], s66 offen offset:256 sc1
  buffer_load_dwordx4 v[72:75], v133, s[36:39], s67 offen offset:0 sc1
  buffer_load_dwordx4 v[76:79], v133, s[36:39], s67 offen offset:256 sc1
CH_kvd:
  s_add_u32 s66, s66, 8192
  s_add_u32 s67, s67, 8192
  s_lshl_b32 s81, s40, 16
  s_lshl_b32 s82, s52, 6
  s_add_u32 s81, s81, s82
  v_bfe_u32 v130, v0, 2, 2
  v_lshlrev_b32 v130, 13, v130
  v_bfe_u32 v141, v0, 4, 2
  v_lshl_add_u32 v130, v141, 11, v130
  v_bfe_u32 v141, v0, 0, 2
  v_lshl_add_u32 v130, v141, 4, v130
  v_add_u32 v130, s81, v130
  s_lshl_b32 s81, s52, 13
  s_lshl_b32 s82, s40, 6
  s_add_u32 s81, s81, s82
  s_add_u32 s43, s81, 0x8800000
  s_add_u32 s59, s81, 0x8801000
  v_bfe_u32 v131, v0, 4, 2
  v_lshlrev_b32 v131, 4, v131
  v_bfe_u32 v141, v0, 0, 2
  v_lshl_add_u32 v131, v141, 2, v131
  v_bfe_u32 v141, v0, 2, 2
  v_cmp_ne_u32 vcc, 0, v141
  v_mov_b32 v141, 0x40000000
  s_nop 0
  v_cndmask_b32 v141, 0, v141, vcc
  v_add_u32 v131, v131, v141
  v_mov_b64 v[128:129], 0
  s_lshl_b32 s81, s40, 10
  v_bfe_u32 v134, v0, 4, 2
  v_lshlrev_b32 v134, 8, v134
  v_bfe_u32 v141, v0, 0, 3
  v_lshl_add_u32 v134, v141, 5, v134
  v_bfe_u32 v141, v0, 3, 1
  v_lshl_add_u32 v134, v141, 3, v134
  v_add_u32 v134, s81, v134
  s_lshl_b32 s81, s40, 9
  v_bfe_u32 v135, v0, 4, 2
  v_lshlrev_b32 v135, 7, v135
  v_bfe_u32 v141, v0, 0, 3
  v_lshl_add_u32 v135, v141, 4, v135
  v_bfe_u32 v141, v0, 3, 1
  v_lshl_add_u32 v135, v141, 3, v135
  v_add_u32 v135, s81, v135
  v_add_u32 v135, 0x1000, v135
  v_bfe_u32 v141, v0, 5, 1
  v_cmp_ne_u32 vcc, 1, v141
  v_mov_b32 v141, 0x30000
  s_nop 0
  v_cndmask_b32 v141, 0, v141, vcc
  v_add_u32 v135, v135, v141
  v_bfe_u32 v136, v0, 4, 2
  v_lshlrev_b32 v136, 8, v136
  v_bfe_u32 v141, v0, 2, 2
  v_lshl_add_u32 v136, v141, 6, v136
  v_bfe_u32 v141, v0, 0, 1
  v_lshl_add_u32 v136, v141, 5, v136
  v_bfe_u32 v141, v0, 1, 1
  v_lshl_add_u32 v136, v141, 4, v136
  v_bfe_u32 v137, v0, 4, 2
  v_lshlrev_b32 v137, 7, v137
  v_bfe_u32 v141, v0, 2, 2
  v_lshl_add_u32 v137, v141, 5, v137
  v_bfe_u32 v141, v0, 0, 1
  v_lshl_add_u32 v137, v141, 4, v137
  v_bfe_u32 v141, v0, 1, 1
  v_lshl_add_u32 v137, v141, 3, v137
  v_xor_b32 v137, 256, v137
  v_add_u32 v137, 4096, v137
  s_lshl_b32 s81, s40, 8
  v_bfe_u32 v138, v0, 4, 2
  v_mul_u32_u24 v138, 1088, v138
  v_bfe_u32 v141, v0, 0, 4
  v_lshl_add_u32 v138, v141, 3, v138
  v_add_u32 v138, s81, v138
  v_add_u32 v138, 0x1800, v138
  v_bfe_u32 v139, v0, 0, 2
  v_mul_u32_u24 v139, 1088, v139
  v_bfe_u32 v141, v0, 4, 2
  v_lshl_add_u32 v139, v141, 5, v139
  v_bfe_u32 v141, v0, 2, 2
  v_lshl_add_u32 v139, v141, 3, v139
  v_add_u32 v139, 0x1800, v139
  s_mul_i32 s81, s40, 36864
  s_add_u32 s81, s81, 0x4000
  v_add_u32 v140, s81, v127
  v_bfe_u32 v141, v0, 1, 1
  v_mul_u32_u24 v141, 0xaaaa, v141
  v_add_u32 v126, 0x4444, v141
  v_mov_b32 v92, 0x3f803f80
  v_mov_b32 v93, 0x3f803f80
  v_mov_b32 v96, 0x3f803f80
  v_mov_b32 v97, 0x3f803f80
  v_cndmask_b32 v94, 0, v92, s[74:75]
  v_cndmask_b32 v95, 0, v92, s[76:77]
  v_mov_b32 v122, 0
  v_mov_b32 v123, 0
  v_and_b32 v141, 3, v0
  v_mov_b32 v8, 0
  v_mov_b32 v9, 0x3f80
  v_cmp_eq_u32 vcc, 0, v141
  s_nop 1
  v_cndmask_b32 v8, v8, v9, vcc
  v_mov_b32 v9, 0x3f800000
  v_cmp_eq_u32 vcc, 1, v141
  s_nop 1
  v_cndmask_b32 v8, v8, v9, vcc
  v_bfe_u32 v141, v0, 2, 2
  v_cmp_eq_u32 vcc, 0, v141
  s_nop 1
  v_cndmask_b32 v4, 0, v8, vcc
  v_cmp_eq_u32 vcc, 1, v141
  s_nop 1
  v_cndmask_b32 v5, 0, v8, vcc
  v_cmp_eq_u32 vcc, 2, v141
  s_nop 1
  v_cndmask_b32 v6, 0, v8, vcc
  v_cmp_eq_u32 vcc, 3, v141
  s_nop 1
  v_cndmask_b32 v7, 0, v8, vcc
  ds_write_b128 v127, v[4:7] offset:10752
  v_and_b32 v141, 1, v0
  v_mov_b32 v8, 0x3f80
  v_mov_b32 v9, 0x3f800000
  v_cmp_eq_u32 vcc, 1, v141
  s_nop 1
  v_cndmask_b32 v8, v8, v9, vcc
  v_bfe_u32 v141, v0, 1, 2
  v_bfe_u32 v142, v0, 4, 2
  v_cmp_eq_u32 vcc, v141, v142
  s_nop 1
  v_cndmask_b32 v8, 0, v8, vcc
  v_bfe_u32 v141, v0, 3, 1
  v_cmp_eq_u32 vcc, 0, v141
  s_nop 1
  v_cndmask_b32 v124, 0, v8, vcc
  v_cmp_eq_u32 vcc, 1, v141
  s_nop 1
  v_cndmask_b32 v125, 0, v8, vcc
  v_mov_b32 v16, 0xf149f2ca
  v_mov_b32 v17, 0xf149f2ca
  v_mov_b32 v18, 0xf149f2ca
  v_mov_b32 v19, 0xf149f2ca
  ds_write_b128 v127, v[16:19] offset:4096
  ds_write_b128 v127, v[16:19] offset:5120
  s_add_u32 s64, s64, 8192
  s_lshl_b32 s81, s58, 1
  s_add_u32 s81, s81, 0xf7902000
  s_add_u32 s48, s36, s81
  s_addc_u32 s49, s37, 0x80000
  s_mov_b32 s50, 512
  s_mov_b32 s51, 0x20000
  s_mov_b32 s57, 1
  s_mov_b32 s65, 0x42200000
  v_mov_b32 v143, 0
  s_add_u32 s32, s36, 0x8a00080
  s_addc_u32 s33, s37, 0
  s_or_b32 s81, s52, s40
  s_cmp_eq_u32 s81, 0
  s_cselect_b32 s34, 4, 0
  s_mov_b32 s35, 0x20000
  s_mov_b32 s81, s42
  v_mov_b32 v141, 0
  s_mov_b32 s80, 0
  s_waitcnt vmcnt(0) lgkmcnt(0)
  s_barrier
  s_cmp_gt_u32 s81, 0xffff
  s_cbranch_scc1 CS_loop
  s_branch CF_loop
.p2align 6
CF_loop:
  v_mov_b64 v[80:81], v[72:73]
  v_mov_b64 v[84:85], v[74:75]
  v_mov_b64 v[86:87], v[76:77]
  v_mov_b64 v[90:91], v[78:79]
  ds_read_b128 v[64:67], v140 offset:6144
  ds_read_b128 v[68:71], v140 offset:7168
  ds_read_b128 v[72:75], v140 offset:8192
  ds_read_b128 v[76:79], v140 offset:9216
  v_mov_b32_e64 v142, s57
  s_add_u32 s69, s64, 8192
  s_nop 15
  s_nop 15
  s_nop 15
  s_nop 13
CF_i0:
  buffer_load_dwordx4 v[0:3], v127, s[36:39], s54 offen offset:0
  ds_read_b128 v[98:101], v140 offset:0
  ds_read_b128 v[102:105], v140 offset:1024
  ds_read_b128 v[106:109], v140 offset:2048
  ds_read_b128 v[110:113], v140 offset:3072
  ds_read_b128 v[114:117], v140 offset:4096
  ds_read_b128 v[118:121], v140 offset:5120
  buffer_load_dwordx4 v[8:11], v127, s[36:39], s54 offen offset:2048
  v_mov_b64 v[32:33], 0
  v_mov_b64 v[34:35], 0
  v_mov_b64 v[36:37], 0
  v_mov_b64 v[38:39], 0
  v_mov_b64 v[40:41], 0
  v_mov_b64 v[42:43], 0
  buffer_load_dwordx4 v[16:19], v127, s[36:39], s55 offen offset:0
  v_mov_b64 v[44:45], 0
  v_mov_b64 v[46:47], 0
  v_mov_b64 v[48:49], 0
  v_mov_b64 v[50:51], 0
  v_mov_b64 v[52:53], 0
  v_mov_b64_e64 v[54:55], 0
  s_nop 7
  buffer_load_dwordx4 v[24:27], v127, s[36:39], s55 offen offset:2048
  s_nop 15
  s_waitcnt vmcnt(3) lgkmcnt(0)
  v_cmp_eq_u32_e64 vcc, s70, v3
  buffer_load_dwordx4 v[4:7], v127, s[36:39], s54 offen offset:1024
  s_cbranch_vccnz CF_r0_0
CF_c0_0:
  v_smfmac_f32_16x16x64_bf16 v[32:35], v[0:3], a[0:7], v126
  buffer_load_dwordx4 v[12:15], v127, s[36:39], s54 offen offset:3072
  v_smfmac_f32_16x16x64_bf16 v[36:39], v[0:3], a[128:135], v126
  s_waitcnt vmcnt(4)
  v_smfmac_f32_16x16x64_bf16 v[40:43], v[0:3], a[8:15], v126
  v_cmp_eq_u32_e64 vcc, s70, v11
  v_smfmac_f32_16x16x64_bf16 v[44:47], v[0:3], a[136:143], v126
  v_smfmac_f32_16x16x64_bf16 v[48:51], v[0:3], v[98:105], v126
  s_cbranch_vccnz CF_r0_1
CF_c0_1:
  v_smfmac_f32_16x16x64_bf16 v[32:35], v[8:11], a[32:39], v126
  buffer_load_dwordx4 v[20:23], v127, s[36:39], s55 offen offset:1024
  v_smfmac_f32_16x16x64_bf16 v[36:39], v[8:11], a[160:167], v126
  s_waitcnt vmcnt(4)
  v_smfmac_f32_16x16x64_bf16 v[40:43], v[8:11], a[40:47], v126
  v_cmp_eq_u32_e64 vcc, s70, v19
  v_smfmac_f32_16x16x64_bf16 v[44:47], v[8:11], a[168:175], v126
  ds_read_b128 v[98:101], v140 offset:10240
  v_smfmac_f32_16x16x64_bf16 v[52:55], v[0:3], v[106:113], v126
  s_cbranch_vccnz CF_r0_2
CF_c0_2:
  v_smfmac_f32_16x16x64_bf16 v[32:35], v[16:19], a[64:71], v126
  buffer_load_dwordx4 v[28:31], v127, s[36:39], s55 offen offset:3072
  v_smfmac_f32_16x16x64_bf16 v[36:39], v[16:19], a[192:199], v126
  s_waitcnt vmcnt(4)
  v_smfmac_f32_16x16x64_bf16 v[40:43], v[16:19], a[72:79], v126
  v_cmp_eq_u32_e64 vcc, s70, v27
  v_smfmac_f32_16x16x64_bf16 v[44:47], v[16:19], a[200:207], v126
  ds_read_b128 v[102:105], v140 offset:11264
  v_smfmac_f32_16x16x64_bf16 v[48:51], v[8:11], v[114:121], v126
  s_cbranch_vccnz CF_r0_3
CF_c0_3:
  v_smfmac_f32_16x16x64_bf16 v[32:35], v[24:27], a[96:103], v126
  ds_read_b128 v[106:109], v140 offset:12288
  v_smfmac_f32_16x16x64_bf16 v[36:39], v[24:27], a[224:231], v126
  s_waitcnt vmcnt(3)
  v_smfmac_f32_16x16x64_bf16 v[40:43], v[24:27], a[104:111], v126
  v_cmp_eq_u32_e64 vcc, s70, v7
  v_smfmac_f32_16x16x64_bf16 v[44:47], v[24:27], a[232:239], v126
  ds_read_b128 v[110:113], v140 offset:13312
  v_smfmac_f32_16x16x64_bf16 v[52:55], v[8:11], v[64:71], v126
  s_cbranch_vccnz CF_r0_4
CF_c0_4:
  v_smfmac_f32_16x16x64_bf16 v[32:35], v[4:7], a[16:23], v126
  ds_read_b128 v[114:117], v140 offset:14336
  v_smfmac_f32_16x16x64_bf16 v[36:39], v[4:7], a[144:151], v126
  s_waitcnt vmcnt(2)
  v_smfmac_f32_16x16x64_bf16 v[40:43], v[4:7], a[24:31], v126
  v_cmp_eq_u32_e64 vcc, s70, v15
  v_smfmac_f32_16x16x64_bf16 v[44:47], v[4:7], a[152:159], v126
  ds_read_b128 v[118:121], v140 offset:15360
  v_smfmac_f32_16x16x64_bf16 v[48:51], v[16:19], v[72:79], v126
  s_cbranch_vccnz CF_r0_5
CF_c0_5:
  v_smfmac_f32_16x16x64_bf16 v[32:35], v[12:15], a[48:55], v126
  v_smfmac_f32_16x16x64_bf16 v[36:39], v[12:15], a[176:183], v126
  s_waitcnt vmcnt(1)
  v_smfmac_f32_16x16x64_bf16 v[40:43], v[12:15], a[56:63], v126
  v_cmp_eq_u32_e64 vcc, s70, v23
  buffer_load_dwordx4 v[64:67], v132, s[36:39], s66 offen offset:0 sc1
  v_smfmac_f32_16x16x64_bf16 v[44:47], v[12:15], a[184:191], v126
  buffer_load_dwordx4 v[68:71], v132, s[36:39], s66 offen offset:256 sc1
  s_cbranch_vccnz CF_r0_6
CF_c0_6:
  s_waitcnt vmcnt(2) lgkmcnt(0)
  v_smfmac_f32_16x16x64_bf16 v[32:35], v[20:23], a[80:87], v126
  v_cmp_eq_u32_e64 vcc, s70, v31
  v_smfmac_f32_16x16x64_bf16 v[36:39], v[20:23], a[208:215], v126
  s_cbranch_vccnz CF_r0_7
CF_c0_7:
  v_smfmac_f32_16x16x64_bf16 v[32:35], v[28:31], a[112:119], v126
  buffer_load_dwordx4 v[76:79], v133, s[36:39], s67 offen offset:256 sc1
  v_smfmac_f32_16x16x64_bf16 v[36:39], v[28:31], a[240:247], v126
  buffer_load_dwordx4 v[72:75], v133, s[36:39], s67 offen offset:0 sc1
  v_smfmac_f32_16x16x64_bf16 v[40:43], v[20:23], a[88:95], v126
  v_add_f32 v32, v32, v34
  v_smfmac_f32_16x16x64_bf16 v[44:47], v[20:23], a[216:223], v126
  v_add_f32_e64 v33, v33, v35
  v_smfmac_f32_16x16x64_bf16 v[40:43], v[28:31], a[120:127], v126
  v_add_f32_e64 v36, v36, v38
  v_smfmac_f32_16x16x64_bf16 v[44:47], v[28:31], a[248:255], v126
  v_add_f32_e64 v37, v37, v39
  v_cvt_pk_bf16_f32 v32, v32, v33
  v_cvt_pk_bf16_f32 v33, v36, v37
  s_nop 0
  v_add_f32 v40, v40, v42
  v_add_f32_e64 v41, v41, v43
  v_mfma_f32_16x16x16_bf16 v[36:39], v[32:33], v[124:125], 0
  s_nop 0
  v_add_f32 v44, v44, v46
  v_add_f32_e64 v45, v45, v47
  v_cvt_pk_bf16_f32 v40, v40, v41
  v_cvt_pk_bf16_f32 v41, v44, v45
  s_add_u32 s54, s54, 8192
  s_nop 0
  v_mfma_f32_16x16x16_bf16 v[44:47], v[40:41], v[124:125], 0
  buffer_store_dword v142, v127, s[32:35], 0 offen sc1
  v_smfmac_f32_16x16x64_bf16 v[52:55], v[16:19], v[98:105], v126
  v_cvt_pk_bf16_f32 v32, v36, v37
  v_cvt_pk_bf16_f32 v33, v38, v39
  s_nop 1
  v_cvt_pk_bf16_f32 v34, v44, v45
  v_cvt_pk_bf16_f32 v35, v46, v47
  s_add_u32 s55, s55, 8192
  s_nop 0
  v_mfma_f32_16x16x32_bf16 v[44:47], v[32:35], v[32:35], 0
  buffer_load_dword v141, off, s[36:39], s56 sc1
  buffer_load_dword v143, off, s[36:39], s69 sc1
  v_mfma_f32_16x16x32_bf16 v[36:39], v[60:63], v[32:35], 0
  v_mfma_f32_16x16x32_bf16 v[40:43], v[56:59], v[32:35], 0
  v_mov_b32_dpp v44, v46 row_ror:8 row_mask:0xf bank_mask:0xc
  v_mov_b32_dpp v45, v47 row_ror:8 row_mask:0xf bank_mask:0xc
  ds_write_b64 v135, v[44:45]
  v_mov_b32_dpp v32, v122 quad_perm:[0,1,2,3] row_mask:0xf bank_mask:0x3
  v_mov_b32_dpp v33, v123 quad_perm:[0,1,2,3] row_mask:0xf bank_mask:0x3
  s_nop 2
  v_mov_b32_dpp v40, v36 row_ror:8 row_mask:0xf bank_mask:0xc
  v_mov_b32_dpp v41, v37 row_ror:8 row_mask:0xf bank_mask:0xc
  v_mov_b32_dpp v42, v38 row_ror:8 row_mask:0xf bank_mask:0xc
  v_mov_b32_dpp v43, v39 row_ror:8 row_mask:0xf bank_mask:0xc
  ds_write2_b64 v134, v[40:41], v[42:43] offset0:0 offset1:2
  v_smfmac_f32_16x16x64_bf16 v[48:51], v[24:27], v[106:113], v126
  v_mov_b32_dpp v34, v122 row_ror:8 row_mask:0xf bank_mask:0x3
  v_smfmac_f32_16x16x64_bf16 v[52:55], v[24:27], v[114:121], v126
  v_mov_b32_dpp v35, v123 row_ror:8 row_mask:0xf bank_mask:0x3
  v_smfmac_f32_16x16x64_bf16 v[48:51], v[4:7], v[144:151], v126
  buffer_store_dwordx4 v[32:35], v127, s[36:39], s68 offen sc1
  v_smfmac_f32_16x16x64_bf16 v[52:55], v[4:7], v[152:159], v126
  s_add_u32 s68, s68, 4096
  v_smfmac_f32_16x16x64_bf16 v[48:51], v[12:15], v[160:167], v126
  s_add_u32 s66, s66, 8192
  v_smfmac_f32_16x16x64_bf16 v[52:55], v[12:15], v[168:175], v126
  s_add_u32 s67, s67, 8192
  s_waitcnt lgkmcnt(0)
  s_barrier
  ds_read_b128 v[32:35], v136 offset:0
  ds_read_b64 v[56:57], v137 offset:0
  ds_read_b128 v[36:39], v136 offset:1024
  ds_read_b64 v[58:59], v137 offset:512
  v_smfmac_f32_16x16x64_bf16 v[48:51], v[20:23], v[176:183], v126
  ds_read_b128 v[40:43], v136 offset:2048
  ds_read_b64 v[60:61], v137 offset:1024
  v_smfmac_f32_16x16x64_bf16 v[52:55], v[20:23], v[184:191], v126
  ds_read_b128 v[44:47], v136 offset:3072
  ds_read_b64 v[62:63], v137 offset:1536
  v_smfmac_f32_16x16x64_bf16 v[48:51], v[28:31], v[192:199], v126
  ds_read_b128 v[98:101], v140 offset:16384
  ds_read_b128 v[102:105], v140 offset:17408
  v_smfmac_f32_16x16x64_bf16 v[52:55], v[28:31], v[200:207], v126
  ds_read_b128 v[106:109], v140 offset:18432
  ds_read_b128 v[110:113], v140 offset:19456
  s_waitcnt lgkmcnt(8)
  v_pk_add_f32 v[32:33], v[32:33], v[36:37]
  v_pk_add_f32 v[34:35], v[34:35], v[38:39]
  v_pk_add_f32 v[56:57], v[56:57], v[58:59]
  s_waitcnt lgkmcnt(4)
  v_pk_add_f32 v[40:41], v[40:41], v[44:45]
  v_pk_add_f32 v[42:43], v[42:43], v[46:47]
  v_pk_add_f32 v[60:61], v[60:61], v[62:63]
  v_pk_add_f32 v[32:33], v[32:33], v[40:41]
  v_pk_add_f32 v[34:35], v[34:35], v[42:43]
  v_pk_add_f32 v[56:57], v[56:57], v[60:61]
  v_max3_f32 v58, v32, v33, v34
  v_max3_f32 v60, v35, v56, v57
  v_max_f32_e64 v60, v58, v60
  v_pk_add_f32 v[48:49], v[48:49], v[50:51]
  v_pk_add_f32 v[52:53], v[52:53], v[54:55]
  v_max_f32_dpp v58, v60, v60 quad_perm:[2,3,0,1] row_mask:0xf bank_mask:0xf
  v_max_f32_dpp v59, v60, v60 quad_perm:[2,3,0,1] row_mask:0xf bank_mask:0xf
  v_mfma_f32_32x32x8_bf16 v[16:31], v[128:129], v[128:129], 0
  v_cvt_pk_bf16_f32 v122, v48, v49
  v_permlane16_swap_b32 v58, v59
  v_max_f32 v60, v58, v59
  v_max_f32_e64 v58, v58, v59
  v_cvt_pk_bf16_f32 v123, v52, v53
  v_cndmask_b32 v82, 0, v122, s[74:75]
  v_permlane32_swap_b32 v58, v60
  v_max_f32 v58, v58, v60
  v_mul_f32_e64 v58, s72, v58
  v_pk_fma_f32 v[32:33], v[32:33], s[72:73], v[58:59] op_sel_hi:[1,1,0] neg_lo:[0,0,1] neg_hi:[0,0,1]
  v_pk_fma_f32 v[56:57], v[56:57], s[72:73], v[58:59] op_sel_hi:[1,1,0] neg_lo:[0,0,1] neg_hi:[0,0,1]
  v_pk_fma_f32 v[34:35], v[34:35], s[72:73], v[58:59] op_sel_hi:[1,1,0] neg_lo:[0,0,1] neg_hi:[0,0,1]
  v_mfma_f32_32x32x8_bf16 v[0:15], v[128:129], v[128:129], 0
  v_exp_f32 v32, v32
  v_exp_f32 v33, v33
  v_exp_f32 v56, v56
  v_exp_f32 v57, v57
  v_exp_f32 v34, v34
  v_exp_f32 v35, v35
  v_cvt_pk_bf16_f32 v36, v32, v33
  v_cvt_pk_bf16_f32 v37, v56, v57
  v_cvt_pk_bf16_f32 v39, v56, v57
  v_cvt_pk_bf16_f32 v38, v34, v35
  v_cndmask_b32 v83, 0, v122, s[76:77]
  v_cndmask_b32 v88, 0, v123, s[74:75]
  v_smfmac_f32_16x16x64_bf16 v[24:27], v[36:39], v[92:99], v126
  v_cndmask_b32 v89, 0, v123, s[76:77]
  v_smfmac_f32_16x16x64_bf16 v[16:19], v[36:39], v[80:87], v126
  ds_read_b128 v[114:117], v140 offset:20480
  v_smfmac_f32_16x16x64_bf16 v[20:23], v[36:39], v[86:93], v126
  v_add_f32 v24, v24, v26
  v_add_f32 v25, v25, v27
  v_rcp_f32 v24, v24
  v_rcp_f32 v25, v25
  v_pk_add_f32 v[16:17], v[16:17], v[18:19]
  v_pk_mul_f32 v[16:17], v[16:17], v[24:25]
  s_nop 1
  v_pk_add_f32 v[20:21], v[20:21], v[22:23]
  v_cvt_pk_bf16_f32 v56, v16, v17
  v_cvt_pk_bf16_f32 v57, v16, v17
  v_pk_mul_f32 v[20:21], v[20:21], v[24:25]
  v_cvt_pk_bf16_f32 v58, v20, v21
  v_cvt_pk_bf16_f32 v59, v20, v21
  ds_write2_b64 v138, v[56:57], v[58:59] offset0:0 offset1:16
  ds_read_b128 v[118:121], v140 offset:21504
  ds_read_b128 v[48:51], v140 offset:22528
  ds_read_b128 v[52:55], v140 offset:23552
  s_waitcnt lgkmcnt(3)
  s_barrier
  ds_read_b64_tr_b16 v[32:33], v139 offset:0
  ds_read_b64_tr_b16 v[34:35], v139 offset:128
  ds_read_b64_tr_b16 v[36:37], v139 offset:256
  ds_read_b64_tr_b16 v[38:39], v139 offset:384
  ds_read_b64_tr_b16 v[40:41], v139 offset:512
  ds_read_b64_tr_b16 v[42:43], v139 offset:640
  ds_read_b64_tr_b16 v[44:45], v139 offset:768
  ds_read_b64_tr_b16 v[46:47], v139 offset:896
  s_waitcnt lgkmcnt(6)
  v_smfmac_f32_16x16x64_bf16 v[0:3], v[32:35], v[98:105], v126
  ds_read_b128 v[80:83], v140 offset:24576
  v_smfmac_f32_16x16x64_bf16 v[4:7], v[32:35], v[106:113], v126
  ds_read_b128 v[84:87], v140 offset:25600
  s_waitcnt lgkmcnt(6)
  v_smfmac_f32_16x16x64_bf16 v[0:3], v[36:39], v[114:121], v126
  ds_read_b128 v[16:19], v140 offset:26624
  v_smfmac_f32_16x16x64_bf16 v[4:7], v[36:39], v[48:55], v126
  ds_read_b128 v[20:23], v140 offset:27648
  s_waitcnt lgkmcnt(6)
  v_smfmac_f32_16x16x64_bf16 v[0:3], v[40:43], v[208:215], v126
  ds_read_b128 v[24:27], v140 offset:28672
  v_smfmac_f32_16x16x64_bf16 v[4:7], v[40:43], v[216:223], v126
  ds_read_b128 v[28:31], v140 offset:29696
  s_waitcnt lgkmcnt(4)
  v_smfmac_f32_16x16x64_bf16 v[0:3], v[44:47], v[80:87], v126
  ds_read_b128 v[56:59], v140 offset:30720
  v_smfmac_f32_16x16x64_bf16 v[4:7], v[44:47], v[224:231], v126
  ds_read_b128 v[60:63], v140 offset:31744
  s_waitcnt lgkmcnt(4)
  v_smfmac_f32_16x16x64_bf16 v[8:11], v[32:35], v[16:23], v126
  ds_read_b128 v[98:101], v140 offset:32768
  v_smfmac_f32_16x16x64_bf16 v[12:15], v[32:35], v[232:239], v126
  ds_read_b128 v[102:105], v140 offset:33792
  v_cvt_pk_bf16_f32 v0, v0, v4
  v_cvt_pk_bf16_f32 v2, v2, v6
  v_and_b32_e64 v0, -2, v0
  v_cvt_pk_bf16_f32 v1, v1, v5
  v_cvt_pk_bf16_f32 v3, v3, v7
  s_waitcnt lgkmcnt(4)
  v_smfmac_f32_16x16x64_bf16 v[8:11], v[36:39], v[24:31], v126
  ds_read_b128 v[106:109], v140 offset:34816
  buffer_store_dwordx4 v[0:3], v130, s[36:39], s60 offen
  v_smfmac_f32_16x16x64_bf16 v[12:15], v[36:39], v[240:247], v126
  ds_read_b128 v[110:113], v140 offset:35840
  s_waitcnt lgkmcnt(4)
  v_smfmac_f32_16x16x64_bf16 v[8:11], v[40:43], v[56:63], v126
  v_smfmac_f32_16x16x64_bf16 v[12:15], v[40:43], v[248:255], v126
  s_waitcnt lgkmcnt(2)
  v_smfmac_f32_16x16x64_bf16 v[8:11], v[44:47], v[98:105], v126
  s_waitcnt lgkmcnt(0)
  v_smfmac_f32_16x16x64_bf16 v[12:15], v[44:47], v[106:113], v126
  ds_read_b128 v[48:51], v127 offset:10752
  s_nop 6
  v_cvt_pk_bf16_f32 v8, v8, v12
  v_cvt_pk_bf16_f32 v10, v10, v14
  v_and_b32 v8, -2, v8
  v_cvt_pk_bf16_f32 v9, v9, v13
  v_cvt_pk_bf16_f32 v11, v11, v15
  buffer_store_dwordx4 v[8:11], v130, s[36:39], s61 offen
  s_nop 15
  s_nop 15
  s_nop 11
  buffer_load_dwordx4 v[16:19], v127, s[36:39], s58 offen sc1
  buffer_load_dwordx4 v[20:23], v127, s[36:39], s58 offen offset:1024 sc1
  s_nop 15
  s_nop 15
  s_nop 7
  buffer_load_dwordx4 v[24:27], v127, s[36:39], s58 offen sc1
  buffer_load_dwordx4 v[28:31], v127, s[36:39], s58 offen offset:1024 sc1
  s_nop 10
  s_waitcnt vmcnt(3) lgkmcnt(0)
  v_mfma_f32_16x16x32_bf16 v[32:35], v[48:51], v[16:19], 0
  s_waitcnt vmcnt(2)
  v_mfma_f32_16x16x32_bf16 v[32:35], v[48:51], v[20:23], v[32:35]
  v_bitop3_b32 v142, v16, v20, 1 bitop3:0xa8
  v_cmp_ne_u32_e64 vcc, 0, v142
  s_add_u32 s80, s80, 1
  s_cbranch_vccnz CF_p0
CF_pe0:
  s_nop 3
  v_add_f32_dpp v32, v32, v32 row_ror:8 row_mask:0xf bank_mask:0xf
  v_add_f32_dpp v33, v33, v33 row_ror:8 row_mask:0xf bank_mask:0xf
  s_add_u32 s53, s53, 1
  v_add_f32_dpp v32, v32, v32 row_ror:4 row_mask:0xf bank_mask:0xf
  v_add_f32_dpp v33, v33, v33 row_ror:4 row_mask:0xf bank_mask:0xf
  v_cvt_pk_bf16_f32 v32, v32, v33
  buffer_store_dword v32, v131, s[36:39], s64 offen
  s_add_u32 s64, s64, 8192
  s_add_u32 s57, s57, 1
  v_readfirstlane_b32 s82, v141
  s_nop 0
  s_max_u32 s78, s78, s82
  s_add_u32 s81, s53, 1
  s_min_u32 s81, s81, 63
  s_cmp_lt_u32 s81, s78
  s_cbranch_scc0 CF_kv
CF_kvok:
  s_add_u32 s81, s53, 5
  s_min_u32 s81, s81, 63
  s_cmp_lt_u32 s81, s78
  s_cselect_b32 s56, 0x10000000, s79
  s_cmp_eq_u32 s53, 63
  s_cselect_b32 s66, 0x10000000, s66
  s_cselect_b32 s67, 0x10000000, s67
  s_cselect_b32 s64, 0x10000000, s64
  v_mov_b64 v[80:81], v[72:73]
  v_mov_b64 v[84:85], v[74:75]
  v_mov_b64 v[86:87], v[76:77]
  v_mov_b64_e64 v[90:91], v[78:79]
  ds_read_b128 v[56:59], v140 offset:6144
  ds_read_b128 v[60:63], v140 offset:7168
  ds_read_b128 v[72:75], v140 offset:8192
  ds_read_b128 v[76:79], v140 offset:9216
  v_mov_b32_e64 v142, s57
  s_add_u32 s69, s64, 8192
  s_nop 15
  s_nop 15
  s_nop 11
CF_i1:
  buffer_load_dwordx4 v[0:3], v127, s[36:39], s54 offen offset:0
  ds_read_b128 v[98:101], v140 offset:0
  ds_read_b128 v[102:105], v140 offset:1024
  ds_read_b128 v[106:109], v140 offset:2048
  ds_read_b128 v[110:113], v140 offset:3072
  ds_read_b128 v[114:117], v140 offset:4096
  ds_read_b128 v[118:121], v140 offset:5120
  buffer_load_dwordx4 v[8:11], v127, s[36:39], s54 offen offset:2048
  v_mov_b64 v[32:33], 0
  v_mov_b64 v[34:35], 0
  v_mov_b64 v[36:37], 0
  v_mov_b64 v[38:39], 0
  v_mov_b64 v[40:41], 0
  v_mov_b64_e64 v[42:43], 0
  buffer_load_dwordx4 v[16:19], v127, s[36:39], s55 offen offset:0
  v_mov_b64 v[44:45], 0
  v_mov_b64 v[46:47], 0
  v_mov_b64 v[48:49], 0
  v_mov_b64 v[50:51], 0
  v_mov_b64 v[52:53], 0
  v_mov_b64_e64 v[54:55], 0
  s_nop 7
  buffer_load_dwordx4 v[24:27], v127, s[36:39], s55 offen offset:2048
  s_nop 15
  s_waitcnt vmcnt(3) lgkmcnt(0)
  v_cmp_eq_u32_e64 vcc, s70, v3
  buffer_load_dwordx4 v[4:7], v127, s[36:39], s54 offen offset:1024
  s_cbranch_vccnz CF_r1_0
CF_c1_0:
  v_smfmac_f32_16x16x64_bf16 v[32:35], v[0:3], a[0:7], v126
  buffer_load_dwordx4 v[12:15], v127, s[36:39], s54 offen offset:3072
  v_smfmac_f32_16x16x64_bf16 v[36:39], v[0:3], a[128:135], v126
  s_waitcnt vmcnt(4)
  v_smfmac_f32_16x16x64_bf16 v[40:43], v[0:3], a[8:15], v126
  v_cmp_eq_u32_e64 vcc, s70, v11
  v_smfmac_f32_16x16x64_bf16 v[44:47], v[0:3], a[136:143], v126
  v_smfmac_f32_16x16x64_bf16 v[48:51], v[0:3], v[98:105], v126
  s_cbranch_vccnz CF_r1_1
CF_c1_1:
  v_smfmac_f32_16x16x64_bf16 v[32:35], v[8:11], a[32:39], v126
  buffer_load_dwordx4 v[20:23], v127, s[36:39], s55 offen offset:1024
  v_smfmac_f32_16x16x64_bf16 v[36:39], v[8:11], a[160:167], v126
  s_waitcnt vmcnt(4)
  v_smfmac_f32_16x16x64_bf16 v[40:43], v[8:11], a[40:47], v126
  v_cmp_eq_u32_e64 vcc, s70, v19
  v_smfmac_f32_16x16x64_bf16 v[44:47], v[8:11], a[168:175], v126
  ds_read_b128 v[98:101], v140 offset:10240
  v_smfmac_f32_16x16x64_bf16 v[52:55], v[0:3], v[106:113], v126
  s_cbranch_vccnz CF_r1_2
CF_c1_2:
  v_smfmac_f32_16x16x64_bf16 v[32:35], v[16:19], a[64:71], v126
  buffer_load_dwordx4 v[28:31], v127, s[36:39], s55 offen offset:3072
  v_smfmac_f32_16x16x64_bf16 v[36:39], v[16:19], a[192:199], v126
  s_waitcnt vmcnt(4)
  v_smfmac_f32_16x16x64_bf16 v[40:43], v[16:19], a[72:79], v126
  v_cmp_eq_u32_e64 vcc, s70, v27
  v_smfmac_f32_16x16x64_bf16 v[44:47], v[16:19], a[200:207], v126
  ds_read_b128 v[102:105], v140 offset:11264
  v_smfmac_f32_16x16x64_bf16 v[48:51], v[8:11], v[114:121], v126
  s_cbranch_vccnz CF_r1_3
CF_c1_3:
  v_smfmac_f32_16x16x64_bf16 v[32:35], v[24:27], a[96:103], v126
  ds_read_b128 v[106:109], v140 offset:12288
  v_smfmac_f32_16x16x64_bf16 v[36:39], v[24:27], a[224:231], v126
  s_waitcnt vmcnt(3)
  v_smfmac_f32_16x16x64_bf16 v[40:43], v[24:27], a[104:111], v126
  v_cmp_eq_u32_e64 vcc, s70, v7
  v_smfmac_f32_16x16x64_bf16 v[44:47], v[24:27], a[232:239], v126
  ds_read_b128 v[110:113], v140 offset:13312
  v_smfmac_f32_16x16x64_bf16 v[52:55], v[8:11], v[56:63], v126
  s_cbranch_vccnz CF_r1_4
CF_c1_4:
  v_smfmac_f32_16x16x64_bf16 v[32:35], v[4:7], a[16:23], v126
  ds_read_b128 v[114:117], v140 offset:14336
  v_smfmac_f32_16x16x64_bf16 v[36:39], v[4:7], a[144:151], v126
  s_waitcnt vmcnt(2)
  v_smfmac_f32_16x16x64_bf16 v[40:43], v[4:7], a[24:31], v126
  v_cmp_eq_u32_e64 vcc, s70, v15
  v_smfmac_f32_16x16x64_bf16 v[44:47], v[4:7], a[152:159], v126
  ds_read_b128 v[118:121], v140 offset:15360
  v_smfmac_f32_16x16x64_bf16 v[48:51], v[16:19], v[72:79], v126
  s_cbranch_vccnz CF_r1_5
CF_c1_5:
  v_smfmac_f32_16x16x64_bf16 v[32:35], v[12:15], a[48:55], v126
  v_smfmac_f32_16x16x64_bf16 v[36:39], v[12:15], a[176:183], v126
  s_waitcnt vmcnt(1)
  v_smfmac_f32_16x16x64_bf16 v[40:43], v[12:15], a[56:63], v126
  v_cmp_eq_u32_e64 vcc, s70, v23
  buffer_load_dwordx4 v[56:59], v132, s[36:39], s66 offen offset:0 sc1
  v_smfmac_f32_16x16x64_bf16 v[44:47], v[12:15], a[184:191], v126
  buffer_load_dwordx4 v[60:63], v132, s[36:39], s66 offen offset:256 sc1
  s_cbranch_vccnz CF_r1_6
CF_c1_6:
  s_waitcnt vmcnt(2) lgkmcnt(0)
  v_smfmac_f32_16x16x64_bf16 v[32:35], v[20:23], a[80:87], v126
  v_cmp_eq_u32_e64 vcc, s70, v31
  v_smfmac_f32_16x16x64_bf16 v[36:39], v[20:23], a[208:215], v126
  s_cbranch_vccnz CF_r1_7
CF_c1_7:
  v_smfmac_f32_16x16x64_bf16 v[32:35], v[28:31], a[112:119], v126
  buffer_load_dwordx4 v[76:79], v133, s[36:39], s67 offen offset:256 sc1
  v_smfmac_f32_16x16x64_bf16 v[36:39], v[28:31], a[240:247], v126
  buffer_load_dwordx4 v[72:75], v133, s[36:39], s67 offen offset:0 sc1
  v_smfmac_f32_16x16x64_bf16 v[40:43], v[20:23], a[88:95], v126
  v_add_f32 v32, v32, v34
  v_smfmac_f32_16x16x64_bf16 v[44:47], v[20:23], a[216:223], v126
  v_add_f32_e64 v33, v33, v35
  v_smfmac_f32_16x16x64_bf16 v[40:43], v[28:31], a[120:127], v126
  v_add_f32_e64 v36, v36, v38
  v_smfmac_f32_16x16x64_bf16 v[44:47], v[28:31], a[248:255], v126
  v_add_f32_e64 v37, v37, v39
  v_cvt_pk_bf16_f32 v32, v32, v33
  v_cvt_pk_bf16_f32 v33, v36, v37
  s_nop 0
  v_add_f32 v40, v40, v42
  v_add_f32_e64 v41, v41, v43
  v_mfma_f32_16x16x16_bf16 v[36:39], v[32:33], v[124:125], 0
  s_nop 0
  v_add_f32 v44, v44, v46
  v_add_f32_e64 v45, v45, v47
  v_cvt_pk_bf16_f32 v40, v40, v41
  v_cvt_pk_bf16_f32 v41, v44, v45
  s_add_u32 s54, s54, 8192
  s_nop 0
  v_mfma_f32_16x16x16_bf16 v[44:47], v[40:41], v[124:125], 0
  buffer_store_dword v142, v127, s[32:35], 0 offen sc1
  v_smfmac_f32_16x16x64_bf16 v[52:55], v[16:19], v[98:105], v126
  v_cvt_pk_bf16_f32 v32, v36, v37
  v_cvt_pk_bf16_f32 v33, v38, v39
  s_nop 1
  v_cvt_pk_bf16_f32 v34, v44, v45
  v_cvt_pk_bf16_f32 v35, v46, v47
  s_add_u32 s55, s55, 8192
  s_nop 0
  v_mfma_f32_16x16x32_bf16 v[44:47], v[32:35], v[32:35], 0
  buffer_load_dword v143, off, s[36:39], s69 sc1
  v_mfma_f32_16x16x32_bf16 v[36:39], v[68:71], v[32:35], 0
  v_mfma_f32_16x16x32_bf16 v[40:43], v[64:67], v[32:35], 0
  v_mov_b32_dpp v44, v46 row_ror:8 row_mask:0xf bank_mask:0xc
  v_mov_b32_dpp v45, v47 row_ror:8 row_mask:0xf bank_mask:0xc
  ds_write_b64 v135, v[44:45]
  v_mov_b32_dpp v32, v122 quad_perm:[0,1,2,3] row_mask:0xf bank_mask:0x3
  v_mov_b32_dpp v33, v123 quad_perm:[0,1,2,3] row_mask:0xf bank_mask:0x3
  s_nop 2
  v_mov_b32_dpp v40, v36 row_ror:8 row_mask:0xf bank_mask:0xc
  v_mov_b32_dpp v41, v37 row_ror:8 row_mask:0xf bank_mask:0xc
  v_mov_b32_dpp v42, v38 row_ror:8 row_mask:0xf bank_mask:0xc
  v_mov_b32_dpp v43, v39 row_ror:8 row_mask:0xf bank_mask:0xc
  ds_write2_b64 v134, v[40:41], v[42:43] offset0:0 offset1:2
  v_smfmac_f32_16x16x64_bf16 v[48:51], v[24:27], v[106:113], v126
  v_mov_b32_dpp v34, v122 row_ror:8 row_mask:0xf bank_mask:0x3
  v_smfmac_f32_16x16x64_bf16 v[52:55], v[24:27], v[114:121], v126
  v_mov_b32_dpp v35, v123 row_ror:8 row_mask:0xf bank_mask:0x3
  v_smfmac_f32_16x16x64_bf16 v[48:51], v[4:7], v[144:151], v126
  buffer_store_dwordx4 v[32:35], v127, s[36:39], s68 offen sc1
  v_smfmac_f32_16x16x64_bf16 v[52:55], v[4:7], v[152:159], v126
  s_add_u32 s68, s68, 4096
  v_smfmac_f32_16x16x64_bf16 v[48:51], v[12:15], v[160:167], v126
  s_add_u32 s66, s66, 8192
  v_smfmac_f32_16x16x64_bf16 v[52:55], v[12:15], v[168:175], v126
  s_add_u32 s67, s67, 8192
  s_waitcnt lgkmcnt(0)
  s_barrier
  ds_read_b128 v[32:35], v136 offset:0
  ds_read_b64 v[64:65], v137 offset:0
  ds_read_b128 v[36:39], v136 offset:1024
  ds_read_b64 v[66:67], v137 offset:512
  v_smfmac_f32_16x16x64_bf16 v[48:51], v[20:23], v[176:183], v126
  ds_read_b128 v[40:43], v136 offset:2048
  ds_read_b64 v[68:69], v137 offset:1024
  v_smfmac_f32_16x16x64_bf16 v[52:55], v[20:23], v[184:191], v126
  ds_read_b128 v[44:47], v136 offset:3072
  ds_read_b64 v[70:71], v137 offset:1536
  v_smfmac_f32_16x16x64_bf16 v[48:51], v[28:31], v[192:199], v126
  ds_read_b128 v[98:101], v140 offset:16384
  ds_read_b128 v[102:105], v140 offset:17408
  s_cmp_eq_u32 s53, 63
  v_smfmac_f32_16x16x64_bf16 v[52:55], v[28:31], v[200:207], v126
  s_cbranch_scc1 CF_done
  ds_read_b128 v[106:109], v140 offset:18432
  ds_read_b128 v[110:113], v140 offset:19456
  s_waitcnt lgkmcnt(8)
  v_pk_add_f32 v[32:33], v[32:33], v[36:37]
  v_pk_add_f32 v[34:35], v[34:35], v[38:39]
  v_pk_add_f32 v[64:65], v[64:65], v[66:67]
  s_waitcnt lgkmcnt(4)
  v_pk_add_f32 v[40:41], v[40:41], v[44:45]
  v_pk_add_f32 v[42:43], v[42:43], v[46:47]
  v_pk_add_f32 v[68:69], v[68:69], v[70:71]
  v_pk_add_f32 v[32:33], v[32:33], v[40:41]
  v_pk_add_f32 v[34:35], v[34:35], v[42:43]
  v_pk_add_f32 v[64:65], v[64:65], v[68:69]
  v_max3_f32 v66, v32, v33, v34
  v_max3_f32 v68, v35, v64, v65
  v_max_f32_e64 v68, v66, v68
  v_pk_add_f32 v[48:49], v[48:49], v[50:51]
  v_pk_add_f32 v[52:53], v[52:53], v[54:55]
  v_max_f32_dpp v66, v68, v68 quad_perm:[2,3,0,1] row_mask:0xf bank_mask:0xf
  v_max_f32_dpp v67, v68, v68 quad_perm:[2,3,0,1] row_mask:0xf bank_mask:0xf
  v_mfma_f32_32x32x8_bf16 v[16:31], v[128:129], v[128:129], 0
  v_cvt_pk_bf16_f32 v122, v48, v49
  v_permlane16_swap_b32 v66, v67
  v_max_f32 v68, v66, v67
  v_max_f32_e64 v66, v66, v67
  v_cvt_pk_bf16_f32 v123, v52, v53
  v_cndmask_b32 v82, 0, v122, s[74:75]
  v_permlane32_swap_b32 v66, v68
  v_max_f32 v66, v66, v68
  v_mul_f32_e64 v66, s72, v66
  v_pk_fma_f32 v[32:33], v[32:33], s[72:73], v[66:67] op_sel_hi:[1,1,0] neg_lo:[0,0,1] neg_hi:[0,0,1]
  v_pk_fma_f32 v[64:65], v[64:65], s[72:73], v[66:67] op_sel_hi:[1,1,0] neg_lo:[0,0,1] neg_hi:[0,0,1]
  v_pk_fma_f32 v[34:35], v[34:35], s[72:73], v[66:67] op_sel_hi:[1,1,0] neg_lo:[0,0,1] neg_hi:[0,0,1]
  v_mfma_f32_32x32x8_bf16 v[0:15], v[128:129], v[128:129], 0
  v_exp_f32 v32, v32
  v_exp_f32 v33, v33
  v_exp_f32 v64, v64
  v_exp_f32 v65, v65
  v_exp_f32 v34, v34
  v_exp_f32 v35, v35
  v_cvt_pk_bf16_f32 v36, v32, v33
  v_cvt_pk_bf16_f32 v37, v64, v65
  v_cvt_pk_bf16_f32 v39, v64, v65
  v_cvt_pk_bf16_f32 v38, v34, v35
  v_cndmask_b32 v83, 0, v122, s[76:77]
  v_cndmask_b32 v88, 0, v123, s[74:75]
  v_smfmac_f32_16x16x64_bf16 v[24:27], v[36:39], v[92:99], v126
  v_cndmask_b32 v89, 0, v123, s[76:77]
  v_smfmac_f32_16x16x64_bf16 v[16:19], v[36:39], v[80:87], v126
  ds_read_b128 v[114:117], v140 offset:20480
  v_smfmac_f32_16x16x64_bf16 v[20:23], v[36:39], v[86:93], v126
  v_add_f32 v24, v24, v26
  v_add_f32 v25, v25, v27
  v_rcp_f32 v24, v24
  v_rcp_f32 v25, v25
  v_pk_add_f32 v[16:17], v[16:17], v[18:19]
  v_pk_mul_f32 v[16:17], v[16:17], v[24:25]
  s_nop 1
  v_pk_add_f32 v[20:21], v[20:21], v[22:23]
  v_cvt_pk_bf16_f32 v64, v16, v17
  v_cvt_pk_bf16_f32 v65, v16, v17
  v_pk_mul_f32 v[20:21], v[20:21], v[24:25]
  v_cvt_pk_bf16_f32 v66, v20, v21
  v_cvt_pk_bf16_f32 v67, v20, v21
  ds_write2_b64 v138, v[64:65], v[66:67] offset0:0 offset1:16
  ds_read_b128 v[118:121], v140 offset:21504
  ds_read_b128 v[48:51], v140 offset:22528
  ds_read_b128 v[52:55], v140 offset:23552
  s_waitcnt lgkmcnt(3)
  s_barrier
  ds_read_b64_tr_b16 v[32:33], v139 offset:0
  ds_read_b64_tr_b16 v[34:35], v139 offset:128
  ds_read_b64_tr_b16 v[36:37], v139 offset:256
  ds_read_b64_tr_b16 v[38:39], v139 offset:384
  ds_read_b64_tr_b16 v[40:41], v139 offset:512
  ds_read_b64_tr_b16 v[42:43], v139 offset:640
  ds_read_b64_tr_b16 v[44:45], v139 offset:768
  ds_read_b64_tr_b16 v[46:47], v139 offset:896
  s_waitcnt lgkmcnt(6)
  v_smfmac_f32_16x16x64_bf16 v[0:3], v[32:35], v[98:105], v126
  ds_read_b128 v[80:83], v140 offset:24576
  v_smfmac_f32_16x16x64_bf16 v[4:7], v[32:35], v[106:113], v126
  ds_read_b128 v[84:87], v140 offset:25600
  s_waitcnt lgkmcnt(6)
  v_smfmac_f32_16x16x64_bf16 v[0:3], v[36:39], v[114:121], v126
  ds_read_b128 v[16:19], v140 offset:26624
  v_smfmac_f32_16x16x64_bf16 v[4:7], v[36:39], v[48:55], v126
  ds_read_b128 v[20:23], v140 offset:27648
  s_waitcnt lgkmcnt(6)
  v_smfmac_f32_16x16x64_bf16 v[0:3], v[40:43], v[208:215], v126
  ds_read_b128 v[24:27], v140 offset:28672
  v_smfmac_f32_16x16x64_bf16 v[4:7], v[40:43], v[216:223], v126
  ds_read_b128 v[28:31], v140 offset:29696
  s_waitcnt lgkmcnt(4)
  v_smfmac_f32_16x16x64_bf16 v[0:3], v[44:47], v[80:87], v126
  ds_read_b128 v[64:67], v140 offset:30720
  v_smfmac_f32_16x16x64_bf16 v[4:7], v[44:47], v[224:231], v126
  ds_read_b128 v[68:71], v140 offset:31744
  s_waitcnt lgkmcnt(4)
  v_smfmac_f32_16x16x64_bf16 v[8:11], v[32:35], v[16:23], v126
  ds_read_b128 v[98:101], v140 offset:32768
  v_smfmac_f32_16x16x64_bf16 v[12:15], v[32:35], v[232:239], v126
  ds_read_b128 v[102:105], v140 offset:33792
  v_cvt_pk_bf16_f32 v0, v0, v4
  v_cvt_pk_bf16_f32 v2, v2, v6
  v_or_b32_e64 v0, 1, v0
  v_cvt_pk_bf16_f32 v1, v1, v5
  v_cvt_pk_bf16_f32 v3, v3, v7
  s_waitcnt lgkmcnt(4)
  v_smfmac_f32_16x16x64_bf16 v[8:11], v[36:39], v[24:31], v126
  ds_read_b128 v[106:109], v140 offset:34816
  buffer_store_dwordx4 v[0:3], v130, s[36:39], s60 offen
  v_smfmac_f32_16x16x64_bf16 v[12:15], v[36:39], v[240:247], v126
  ds_read_b128 v[110:113], v140 offset:35840
  s_waitcnt lgkmcnt(4)
  v_smfmac_f32_16x16x64_bf16 v[8:11], v[40:43], v[64:71], v126
  v_smfmac_f32_16x16x64_bf16 v[12:15], v[40:43], v[248:255], v126
  s_waitcnt lgkmcnt(2)
  v_smfmac_f32_16x16x64_bf16 v[8:11], v[44:47], v[98:105], v126
  s_waitcnt lgkmcnt(0)
  v_smfmac_f32_16x16x64_bf16 v[12:15], v[44:47], v[106:113], v126
  ds_read_b128 v[48:51], v127 offset:10752
  s_nop 6
  v_cvt_pk_bf16_f32 v8, v8, v12
  v_cvt_pk_bf16_f32 v10, v10, v14
  v_or_b32 v8, 1, v8
  v_cvt_pk_bf16_f32 v9, v9, v13
  v_cvt_pk_bf16_f32 v11, v11, v15
  buffer_store_dwordx4 v[8:11], v130, s[36:39], s61 offen
  s_nop 15
  s_nop 15
  s_nop 11
  buffer_load_dwordx4 v[16:19], v127, s[36:39], s58 offen sc1
  buffer_load_dwordx4 v[20:23], v127, s[36:39], s58 offen offset:1024 sc1
  s_nop 15
  s_nop 15
  s_nop 7
  buffer_load_dwordx4 v[24:27], v127, s[36:39], s58 offen sc1
  buffer_load_dwordx4 v[28:31], v127, s[36:39], s58 offen offset:1024 sc1
  s_nop 10
  s_waitcnt vmcnt(3) lgkmcnt(0)
  v_mfma_f32_16x16x32_bf16 v[32:35], v[48:51], v[16:19], 0
  s_waitcnt vmcnt(2)
  v_mfma_f32_16x16x32_bf16 v[32:35], v[48:51], v[20:23], v[32:35]
  v_bitop3_b32 v142, v16, v20, 1 bitop3:0x80
  v_cmp_ne_u32_e64 vcc, 1, v142
  s_add_u32 s80, s80, 1
  s_cbranch_vccnz CF_p1
CF_pe1:
  s_nop 3
  v_add_f32_dpp v32, v32, v32 row_ror:8 row_mask:0xf bank_mask:0xf
  v_add_f32_dpp v33, v33, v33 row_ror:8 row_mask:0xf bank_mask:0xf
  s_add_u32 s53, s53, 1
  v_add_f32_dpp v32, v32, v32 row_ror:4 row_mask:0xf bank_mask:0xf
  v_add_f32_dpp v33, v33, v33 row_ror:4 row_mask:0xf bank_mask:0xf
  v_cvt_pk_bf16_f32 v32, v32, v33
  buffer_store_dword v32, v131, s[36:39], s64 offen
  s_add_u32 s64, s64, 8192
  s_add_u32 s57, s57, 1
  s_branch CF_loop
CF_r0_0:
  buffer_load_dwordx4 v[0:3], v127, s[36:39], s54 offen offset:0 sc1
  s_add_u32 s80, s80, 0x100
  s_add_u32 s91, s91, 1
  s_cmp_gt_u32 s91, 0x20000
  s_cbranch_scc1 L_abort
  s_nop 3
  buffer_load_dwordx4 v[8:11], v127, s[36:39], s54 offen offset:2048 sc1
  s_nop 8
  buffer_load_dwordx4 v[16:19], v127, s[36:39], s55 offen offset:0 sc1
  s_nop 8
  buffer_load_dwordx4 v[24:27], v127, s[36:39], s55 offen offset:2048 sc1
  s_nop 8
  buffer_load_dwordx4 v[4:7], v127, s[36:39], s54 offen offset:1024 sc1
  s_nop 0
  s_waitcnt vmcnt(4)
  v_cmp_eq_u32_e64 vcc, s70, v3
  s_nop 0
  s_cbranch_vccz CF_c0_0
  s_branch CF_r0_0
CF_r0_1:
  buffer_load_dwordx4 v[8:11], v127, s[36:39], s54 offen offset:2048 sc1
  s_add_u32 s80, s80, 0x100
  s_add_u32 s91, s91, 1
  s_cmp_gt_u32 s91, 0x20000
  s_cbranch_scc1 L_abort
  s_nop 3
  buffer_load_dwordx4 v[16:19], v127, s[36:39], s55 offen offset:0 sc1
  s_nop 8
  buffer_load_dwordx4 v[24:27], v127, s[36:39], s55 offen offset:2048 sc1
  s_nop 8
  buffer_load_dwordx4 v[4:7], v127, s[36:39], s54 offen offset:1024 sc1
  s_nop 8
  buffer_load_dwordx4 v[12:15], v127, s[36:39], s54 offen offset:3072 sc1
  s_nop 0
  s_waitcnt vmcnt(4)
  v_cmp_eq_u32 vcc, s70, v11
  s_nop 0
  s_cbranch_vccz CF_c0_1
  s_branch CF_r0_1
CF_r0_2:
  buffer_load_dwordx4 v[16:19], v127, s[36:39], s55 offen offset:0 sc1
  s_add_u32 s80, s80, 0x100
  s_add_u32 s91, s91, 1
  s_cmp_gt_u32 s91, 0x20000
  s_cbranch_scc1 L_abort
  s_nop 3
  buffer_load_dwordx4 v[24:27], v127, s[36:39], s55 offen offset:2048 sc1
  s_nop 8
  buffer_load_dwordx4 v[4:7], v127, s[36:39], s54 offen offset:1024 sc1
  s_nop 8
  buffer_load_dwordx4 v[12:15], v127, s[36:39], s54 offen offset:3072 sc1
  s_nop 8
  buffer_load_dwordx4 v[20:23], v127, s[36:39], s55 offen offset:1024 sc1
  s_nop 0
  s_waitcnt vmcnt(4)
  v_cmp_eq_u32 vcc, s70, v19
  s_nop 0
  s_cbranch_vccz CF_c0_2
  s_branch CF_r0_2
CF_r0_3:
  buffer_load_dwordx4 v[24:27], v127, s[36:39], s55 offen offset:2048 sc1
  s_add_u32 s80, s80, 0x100
  s_add_u32 s91, s91, 1
  s_cmp_gt_u32 s91, 0x20000
  s_cbranch_scc1 L_abort
  s_nop 3
  buffer_load_dwordx4 v[4:7], v127, s[36:39], s54 offen offset:1024 sc1
  s_nop 8
  buffer_load_dwordx4 v[12:15], v127, s[36:39], s54 offen offset:3072 sc1
  s_nop 8
  buffer_load_dwordx4 v[20:23], v127, s[36:39], s55 offen offset:1024 sc1
  s_nop 8
  buffer_load_dwordx4 v[28:31], v127, s[36:39], s55 offen offset:3072 sc1
  s_nop 0
  s_waitcnt vmcnt(4)
  v_cmp_eq_u32 vcc, s70, v27
  s_nop 0
  s_cbranch_vccz CF_c0_3
  s_branch CF_r0_3
CF_r0_4:
  buffer_load_dwordx4 v[4:7], v127, s[36:39], s54 offen offset:1024 sc1
  s_add_u32 s80, s80, 0x100
  s_add_u32 s91, s91, 1
  s_cmp_gt_u32 s91, 0x20000
  s_cbranch_scc1 L_abort
  s_nop 3
  buffer_load_dwordx4 v[12:15], v127, s[36:39], s54 offen offset:3072 sc1
  s_nop 8
  buffer_load_dwordx4 v[20:23], v127, s[36:39], s55 offen offset:1024 sc1
  s_nop 8
  buffer_load_dwordx4 v[28:31], v127, s[36:39], s55 offen offset:3072 sc1
  s_nop 12
  s_waitcnt vmcnt(3)
  v_cmp_eq_u32_e64 vcc, s70, v7
  s_nop 0
  s_cbranch_vccz CF_c0_4
  s_branch CF_r0_4
CF_r0_5:
  buffer_load_dwordx4 v[12:15], v127, s[36:39], s54 offen offset:3072 sc1
  s_add_u32 s80, s80, 0x100
  s_add_u32 s91, s91, 1
  s_cmp_gt_u32 s91, 0x20000
  s_cbranch_scc1 L_abort
  s_nop 3
  buffer_load_dwordx4 v[20:23], v127, s[36:39], s55 offen offset:1024 sc1
  s_nop 8
  buffer_load_dwordx4 v[28:31], v127, s[36:39], s55 offen offset:3072 sc1
  s_nop 15
  s_nop 8
  s_waitcnt vmcnt(2)
  v_cmp_eq_u32_e64 vcc, s70, v15
  s_nop 0
  s_cbranch_vccz CF_c0_5
  s_branch CF_r0_5
CF_r0_6:
  buffer_load_dwordx4 v[20:23], v127, s[36:39], s55 offen offset:1024 sc1
  s_add_u32 s80, s80, 0x100
  s_add_u32 s91, s91, 1
  s_cmp_gt_u32 s91, 0x20000
  s_cbranch_scc1 L_abort
  s_nop 3
  buffer_load_dwordx4 v[28:31], v127, s[36:39], s55 offen offset:3072 sc1
  s_nop 15
  s_nop 15
  s_nop 4
  s_waitcnt vmcnt(0)
  v_cmp_eq_u32_e64 vcc, s70, v23
  s_nop 0
  s_cbranch_vccz CF_c0_6
  s_branch CF_r0_6
CF_r0_7:
  buffer_load_dwordx4 v[28:31], v127, s[36:39], s55 offen offset:3072 sc1
  s_add_u32 s80, s80, 0x100
  s_add_u32 s91, s91, 1
  s_cmp_gt_u32 s91, 0x20000
  s_cbranch_scc1 L_abort
  s_nop 15
  s_nop 15
  s_nop 11
  s_waitcnt vmcnt(0)
  v_cmp_eq_u32 vcc, s70, v31
  s_nop 0
  s_cbranch_vccz CF_c0_7
  s_branch CF_r0_7
CF_p0:
CF_pl0:
  buffer_load_dwordx4 v[16:19], v127, s[36:39], s58 offen sc1
  buffer_load_dwordx4 v[20:23], v127, s[36:39], s58 offen offset:1024 sc1
  s_waitcnt vmcnt(3) lgkmcnt(0)
  v_mfma_f32_16x16x32_bf16 v[32:35], v[48:51], v[24:27], 0
  s_waitcnt vmcnt(2)
  v_mfma_f32_16x16x32_bf16 v[32:35], v[48:51], v[28:31], v[32:35]
  v_bitop3_b32 v142, v24, v28, 1 bitop3:0xa8
  v_cmp_ne_u32_e64 vcc, 0, v142
  s_add_u32 s80, s80, 1
  s_cbranch_vccz CF_pe0
  buffer_load_dwordx4 v[24:27], v127, s[36:39], s58 offen sc1
  buffer_load_dwordx4 v[28:31], v127, s[36:39], s58 offen offset:1024 sc1
  s_waitcnt vmcnt(3) lgkmcnt(0)
  v_mfma_f32_16x16x32_bf16 v[32:35], v[48:51], v[16:19], 0
  s_waitcnt vmcnt(2)
  v_mfma_f32_16x16x32_bf16 v[32:35], v[48:51], v[20:23], v[32:35]
  v_bitop3_b32 v142, v16, v20, 1 bitop3:0xa8
  v_cmp_ne_u32 vcc, 0, v142
  s_add_u32 s80, s80, 1
  s_cbranch_vccz CF_pe0
  s_add_u32 s91, s91, 1
  s_cmp_gt_u32 s91, 0x20000
  s_cbranch_scc1 L_abort
  s_branch CF_pl0
CF_kv:
  buffer_load_dword v141, off, s[36:39], s79 sc1
  s_add_u32 s91, s91, 1
  s_cmp_gt_u32 s91, 0x20000
  s_cbranch_scc1 L_abort
  s_waitcnt vmcnt(0)
  v_readfirstlane_b32 s78, v141
  s_nop 0
  s_cmp_lt_u32 s81, s78
  s_cbranch_scc1 CF_kv1
  s_sleep 2
  s_branch CF_kv
CF_kv1:
  s_branch CF_kvok
CF_r1_0:
  buffer_load_dwordx4 v[0:3], v127, s[36:39], s54 offen offset:0 sc1
  s_add_u32 s80, s80, 0x100
  s_add_u32 s91, s91, 1
  s_cmp_gt_u32 s91, 0x20000
  s_cbranch_scc1 L_abort
  s_nop 3
  buffer_load_dwordx4 v[8:11], v127, s[36:39], s54 offen offset:2048 sc1
  s_nop 8
  buffer_load_dwordx4 v[16:19], v127, s[36:39], s55 offen offset:0 sc1
  s_nop 8
  buffer_load_dwordx4 v[24:27], v127, s[36:39], s55 offen offset:2048 sc1
  s_nop 8
  buffer_load_dwordx4 v[4:7], v127, s[36:39], s54 offen offset:1024 sc1
  s_nop 0
  s_waitcnt vmcnt(4)
  v_cmp_eq_u32 vcc, s70, v3
  s_nop 0
  s_cbranch_vccz CF_c1_0
  s_branch CF_r1_0
CF_r1_1:
  buffer_load_dwordx4 v[8:11], v127, s[36:39], s54 offen offset:2048 sc1
  s_add_u32 s80, s80, 0x100
  s_add_u32 s91, s91, 1
  s_cmp_gt_u32 s91, 0x20000
  s_cbranch_scc1 L_abort
  s_nop 3
  buffer_load_dwordx4 v[16:19], v127, s[36:39], s55 offen offset:0 sc1
  s_nop 8
  buffer_load_dwordx4 v[24:27], v127, s[36:39], s55 offen offset:2048 sc1
  s_nop 8
  buffer_load_dwordx4 v[4:7], v127, s[36:39], s54 offen offset:1024 sc1
  s_nop 8
  buffer_load_dwordx4 v[12:15], v127, s[36:39], s54 offen offset:3072 sc1
  s_nop 0
  s_waitcnt vmcnt(4)
  v_cmp_eq_u32 vcc, s70, v11
  s_nop 0
  s_cbranch_vccz CF_c1_1
  s_branch CF_r1_1
CF_r1_2:
  buffer_load_dwordx4 v[16:19], v127, s[36:39], s55 offen offset:0 sc1
  s_add_u32 s80, s80, 0x100
  s_add_u32 s91, s91, 1
  s_cmp_gt_u32 s91, 0x20000
  s_cbranch_scc1 L_abort
  s_nop 3
  buffer_load_dwordx4 v[24:27], v127, s[36:39], s55 offen offset:2048 sc1
  s_nop 8
  buffer_load_dwordx4 v[4:7], v127, s[36:39], s54 offen offset:1024 sc1
  s_nop 8
  buffer_load_dwordx4 v[12:15], v127, s[36:39], s54 offen offset:3072 sc1
  s_nop 8
  buffer_load_dwordx4 v[20:23], v127, s[36:39], s55 offen offset:1024 sc1
  s_nop 0
  s_waitcnt vmcnt(4)
  v_cmp_eq_u32 vcc, s70, v19
  s_nop 0
  s_cbranch_vccz CF_c1_2
  s_branch CF_r1_2
CF_r1_3:
  buffer_load_dwordx4 v[24:27], v127, s[36:39], s55 offen offset:2048 sc1
  s_add_u32 s80, s80, 0x100
  s_add_u32 s91, s91, 1
  s_cmp_gt_u32 s91, 0x20000
  s_cbranch_scc1 L_abort
  s_nop 3
  buffer_load_dwordx4 v[4:7], v127, s[36:39], s54 offen offset:1024 sc1
  s_nop 8
  buffer_load_dwordx4 v[12:15], v127, s[36:39], s54 offen offset:3072 sc1
  s_nop 8
  buffer_load_dwordx4 v[20:23], v127, s[36:39], s55 offen offset:1024 sc1
  s_nop 8
  buffer_load_dwordx4 v[28:31], v127, s[36:39], s55 offen offset:3072 sc1
  s_nop 0
  s_waitcnt vmcnt(4)
  v_cmp_eq_u32 vcc, s70, v27
  s_nop 0
  s_cbranch_vccz CF_c1_3
  s_branch CF_r1_3
CF_r1_4:
  buffer_load_dwordx4 v[4:7], v127, s[36:39], s54 offen offset:1024 sc1
  s_add_u32 s80, s80, 0x100
  s_add_u32 s91, s91, 1
  s_cmp_gt_u32 s91, 0x20000
  s_cbranch_scc1 L_abort
  s_nop 3
  buffer_load_dwordx4 v[12:15], v127, s[36:39], s54 offen offset:3072 sc1
  s_nop 8
  buffer_load_dwordx4 v[20:23], v127, s[36:39], s55 offen offset:1024 sc1
  s_nop 8
  buffer_load_dwordx4 v[28:31], v127, s[36:39], s55 offen offset:3072 sc1
  s_nop 12
  s_waitcnt vmcnt(3)
  v_cmp_eq_u32_e64 vcc, s70, v7
  s_nop 0
  s_cbranch_vccz CF_c1_4
  s_branch CF_r1_4
CF_r1_5:
  buffer_load_dwordx4 v[12:15], v127, s[36:39], s54 offen offset:3072 sc1
  s_add_u32 s80, s80, 0x100
  s_add_u32 s91, s91, 1
  s_cmp_gt_u32 s91, 0x20000
  s_cbranch_scc1 L_abort
  s_nop 3
  buffer_load_dwordx4 v[20:23], v127, s[36:39], s55 offen offset:1024 sc1
  s_nop 8
  buffer_load_dwordx4 v[28:31], v127, s[36:39], s55 offen offset:3072 sc1
  s_nop 15
  s_nop 8
  s_waitcnt vmcnt(2)
  v_cmp_eq_u32_e64 vcc, s70, v15
  s_nop 0
  s_cbranch_vccz CF_c1_5
  s_branch CF_r1_5
CF_r1_6:
  buffer_load_dwordx4 v[20:23], v127, s[36:39], s55 offen offset:1024 sc1
  s_add_u32 s80, s80, 0x100
  s_add_u32 s91, s91, 1
  s_cmp_gt_u32 s91, 0x20000
  s_cbranch_scc1 L_abort
  s_nop 3
  buffer_load_dwordx4 v[28:31], v127, s[36:39], s55 offen offset:3072 sc1
  s_nop 15
  s_nop 15
  s_nop 4
  s_waitcnt vmcnt(0)
  v_cmp_eq_u32_e64 vcc, s70, v23
  s_nop 0
  s_cbranch_vccz CF_c1_6
  s_branch CF_r1_6
CF_r1_7:
  buffer_load_dwordx4 v[28:31], v127, s[36:39], s55 offen offset:3072 sc1
  s_add_u32 s80, s80, 0x100
  s_add_u32 s91, s91, 1
  s_cmp_gt_u32 s91, 0x20000
  s_cbranch_scc1 L_abort
  s_nop 15
  s_nop 15
  s_nop 11
  s_waitcnt vmcnt(0)
  v_cmp_eq_u32 vcc, s70, v31
  s_nop 0
  s_cbranch_vccz CF_c1_7
  s_branch CF_r1_7
CF_p1:
CF_pl1:
  buffer_load_dwordx4 v[16:19], v127, s[36:39], s58 offen sc1
  buffer_load_dwordx4 v[20:23], v127, s[36:39], s58 offen offset:1024 sc1
  s_waitcnt vmcnt(3) lgkmcnt(0)
  v_mfma_f32_16x16x32_bf16 v[32:35], v[48:51], v[24:27], 0
  s_waitcnt vmcnt(2)
  v_mfma_f32_16x16x32_bf16 v[32:35], v[48:51], v[28:31], v[32:35]
  v_bitop3_b32 v142, v24, v28, 1 bitop3:0x80
  v_cmp_ne_u32_e64 vcc, 1, v142
  s_add_u32 s80, s80, 1
  s_cbranch_vccz CF_pe1
  buffer_load_dwordx4 v[24:27], v127, s[36:39], s58 offen sc1
  buffer_load_dwordx4 v[28:31], v127, s[36:39], s58 offen offset:1024 sc1
  s_waitcnt vmcnt(3) lgkmcnt(0)
  v_mfma_f32_16x16x32_bf16 v[32:35], v[48:51], v[16:19], 0
  s_waitcnt vmcnt(2)
  v_mfma_f32_16x16x32_bf16 v[32:35], v[48:51], v[20:23], v[32:35]
  v_bitop3_b32 v142, v16, v20, 1 bitop3:0x80
  v_cmp_ne_u32 vcc, 1, v142
  s_add_u32 s80, s80, 1
  s_cbranch_vccz CF_pe1
  s_add_u32 s91, s91, 1
  s_cmp_gt_u32 s91, 0x20000
  s_cbranch_scc1 L_abort
  s_branch CF_pl1
CF_done:
  s_branch CH_fin
CS_loop:
  v_mov_b64 v[80:81], v[72:73]
  v_mov_b64 v[84:85], v[74:75]
  v_mov_b64 v[86:87], v[76:77]
  v_mov_b64 v[90:91], v[78:79]
  ds_read_b128 v[64:67], v140 offset:6144
  ds_read_b128 v[68:71], v140 offset:7168
  ds_read_b128 v[72:75], v140 offset:8192
  ds_read_b128 v[76:79], v140 offset:9216
  v_mov_b32 v142, s57
  s_add_u32 s69, s64, 8192
  s_nop 15
  s_nop 15
  s_nop 15
  s_nop 13
CS_i0:
  buffer_load_dwordx4 v[0:3], v127, s[36:39], s54 offen offset:0
  ds_read_b128 v[98:101], v140 offset:0
  ds_read_b128 v[102:105], v140 offset:1024
  ds_read_b128 v[106:109], v140 offset:2048
  ds_read_b128 v[110:113], v140 offset:3072
  ds_read_b128 v[114:117], v140 offset:4096
  ds_read_b128 v[118:121], v140 offset:5120
  buffer_load_dwordx4 v[8:11], v127, s[36:39], s54 offen offset:2048
  v_mov_b64 v[32:33], 0
  v_mov_b64 v[34:35], 0
  v_mov_b64 v[36:37], 0
  v_mov_b64 v[38:39], 0
  v_mov_b64 v[40:41], 0
  v_mov_b64 v[42:43], 0
  buffer_load_dwordx4 v[16:19], v127, s[36:39], s55 offen offset:0
  v_mov_b64 v[44:45], 0
  v_mov_b64 v[46:47], 0
  v_mov_b64 v[48:49], 0
  v_mov_b64 v[50:51], 0
  v_mov_b64 v[52:53], 0
  v_mov_b64 v[54:55], 0
  s_nop 7
  buffer_load_dwordx4 v[24:27], v127, s[36:39], s55 offen offset:2048
  s_nop 15
  s_waitcnt vmcnt(3) lgkmcnt(0)
  v_max3_u32 v141, v0, v1, v2
  v_max_u32 v141, v141, v3
  v_cmp_eq_u32 vcc, s70, v141
  buffer_load_dwordx4 v[4:7], v127, s[36:39], s54 offen offset:1024
  s_cbranch_vccnz CS_r0_0
CS_c0_0:
  v_smfmac_f32_16x16x64_bf16 v[32:35], v[0:3], a[0:7], v126
  buffer_load_dwordx4 v[12:15], v127, s[36:39], s54 offen offset:3072
  v_smfmac_f32_16x16x64_bf16 v[36:39], v[0:3], a[128:135], v126
  s_waitcnt vmcnt(4)
  v_max3_u32 v141, v8, v9, v10
  v_smfmac_f32_16x16x64_bf16 v[40:43], v[0:3], a[8:15], v126
  v_max_u32 v141, v141, v11
  v_cmp_eq_u32 vcc, s70, v141
  v_smfmac_f32_16x16x64_bf16 v[44:47], v[0:3], a[136:143], v126
  v_smfmac_f32_16x16x64_bf16 v[48:51], v[0:3], v[98:105], v126
  s_cbranch_vccnz CS_r0_1
CS_c0_1:
  v_smfmac_f32_16x16x64_bf16 v[32:35], v[8:11], a[32:39], v126
  buffer_load_dwordx4 v[20:23], v127, s[36:39], s55 offen offset:1024
  v_smfmac_f32_16x16x64_bf16 v[36:39], v[8:11], a[160:167], v126
  s_waitcnt vmcnt(4)
  v_max3_u32 v141, v16, v17, v18
  v_smfmac_f32_16x16x64_bf16 v[40:43], v[8:11], a[40:47], v126
  v_max_u32 v141, v141, v19
  v_cmp_eq_u32 vcc, s70, v141
  v_smfmac_f32_16x16x64_bf16 v[44:47], v[8:11], a[168:175], v126
  ds_read_b128 v[98:101], v140 offset:10240
  v_smfmac_f32_16x16x64_bf16 v[52:55], v[0:3], v[106:113], v126
  s_cbranch_vccnz CS_r0_2
CS_c0_2:
  v_smfmac_f32_16x16x64_bf16 v[32:35], v[16:19], a[64:71], v126
  buffer_load_dwordx4 v[28:31], v127, s[36:39], s55 offen offset:3072
  v_smfmac_f32_16x16x64_bf16 v[36:39], v[16:19], a[192:199], v126
  s_waitcnt vmcnt(4)
  v_max3_u32 v141, v24, v25, v26
  v_smfmac_f32_16x16x64_bf16 v[40:43], v[16:19], a[72:79], v126
  v_max_u32 v141, v141, v27
  v_cmp_eq_u32 vcc, s70, v141
  v_smfmac_f32_16x16x64_bf16 v[44:47], v[16:19], a[200:207], v126
  ds_read_b128 v[102:105], v140 offset:11264
  v_smfmac_f32_16x16x64_bf16 v[48:51], v[8:11], v[114:121], v126
  s_cbranch_vccnz CS_r0_3
CS_c0_3:
  v_smfmac_f32_16x16x64_bf16 v[32:35], v[24:27], a[96:103], v126
  ds_read_b128 v[106:109], v140 offset:12288
  v_smfmac_f32_16x16x64_bf16 v[36:39], v[24:27], a[224:231], v126
  s_waitcnt vmcnt(3)
  v_max3_u32 v141, v4, v5, v6
  v_smfmac_f32_16x16x64_bf16 v[40:43], v[24:27], a[104:111], v126
  v_max_u32 v141, v141, v7
  v_cmp_eq_u32 vcc, s70, v141
  v_smfmac_f32_16x16x64_bf16 v[44:47], v[24:27], a[232:239], v126
  ds_read_b128 v[110:113], v140 offset:13312
  v_smfmac_f32_16x16x64_bf16 v[52:55], v[8:11], v[64:71], v126
  s_cbranch_vccnz CS_r0_4
CS_c0_4:
  v_smfmac_f32_16x16x64_bf16 v[32:35], v[4:7], a[16:23], v126
  ds_read_b128 v[114:117], v140 offset:14336
  v_smfmac_f32_16x16x64_bf16 v[36:39], v[4:7], a[144:151], v126
  s_waitcnt vmcnt(2)
  v_max3_u32 v141, v12, v13, v14
  v_smfmac_f32_16x16x64_bf16 v[40:43], v[4:7], a[24:31], v126
  v_max_u32 v141, v141, v15
  v_cmp_eq_u32 vcc, s70, v141
  v_smfmac_f32_16x16x64_bf16 v[44:47], v[4:7], a[152:159], v126
  ds_read_b128 v[118:121], v140 offset:15360
  v_smfmac_f32_16x16x64_bf16 v[48:51], v[16:19], v[72:79], v126
  s_cbranch_vccnz CS_r0_5
CS_c0_5:
  v_smfmac_f32_16x16x64_bf16 v[32:35], v[12:15], a[48:55], v126
  v_smfmac_f32_16x16x64_bf16 v[36:39], v[12:15], a[176:183], v126
  s_waitcnt vmcnt(1)
  v_max3_u32 v141, v20, v21, v22
  v_smfmac_f32_16x16x64_bf16 v[40:43], v[12:15], a[56:63], v126
  v_max_u32 v141, v141, v23
  v_cmp_eq_u32 vcc, s70, v141
  buffer_load_dwordx4 v[64:67], v132, s[36:39], s66 offen offset:0 sc1
  v_smfmac_f32_16x16x64_bf16 v[44:47], v[12:15], a[184:191], v126
  buffer_load_dwordx4 v[68:71], v132, s[36:39], s66 offen offset:256 sc1
  s_cbranch_vccnz CS_r0_6
CS_c0_6:
  s_waitcnt vmcnt(2) lgkmcnt(0)
  v_smfmac_f32_16x16x64_bf16 v[32:35], v[20:23], a[80:87], v126
  v_max3_u32 v141, v28, v29, v30
  v_max_u32 v141, v141, v31
  v_cmp_eq_u32 vcc, s70, v141
  v_smfmac_f32_16x16x64_bf16 v[36:39], v[20:23], a[208:215], v126
  s_cbranch_vccnz CS_r0_7
CS_c0_7:
  v_smfmac_f32_16x16x64_bf16 v[32:35], v[28:31], a[112:119], v126
  buffer_load_dwordx4 v[76:79], v133, s[36:39], s67 offen offset:256 sc1
  v_smfmac_f32_16x16x64_bf16 v[36:39], v[28:31], a[240:247], v126
  buffer_load_dwordx4 v[72:75], v133, s[36:39], s67 offen offset:0 sc1
  v_smfmac_f32_16x16x64_bf16 v[40:43], v[20:23], a[88:95], v126
  v_add_f32 v32, v32, v34
  v_smfmac_f32_16x16x64_bf16 v[44:47], v[20:23], a[216:223], v126
  v_add_f32 v33, v33, v35
  v_smfmac_f32_16x16x64_bf16 v[40:43], v[28:31], a[120:127], v126
  v_add_f32 v36, v36, v38
  v_smfmac_f32_16x16x64_bf16 v[44:47], v[28:31], a[248:255], v126
  v_add_f32 v37, v37, v39
  v_cvt_pk_bf16_f32 v32, v32, v33
  v_cvt_pk_bf16_f32 v33, v36, v37
  s_nop 0
  v_add_f32 v40, v40, v42
  v_add_f32 v41, v41, v43
  v_mfma_f32_16x16x16_bf16 v[36:39], v[32:33], v[124:125], 0
  s_nop 0
  v_add_f32 v44, v44, v46
  v_add_f32 v45, v45, v47
  v_cvt_pk_bf16_f32 v40, v40, v41
  v_cvt_pk_bf16_f32 v41, v44, v45
  s_add_u32 s54, s54, 8192
  s_nop 0
  v_mfma_f32_16x16x16_bf16 v[44:47], v[40:41], v[124:125], 0
  buffer_store_dword v142, v127, s[32:35], 0 offen sc1
  v_smfmac_f32_16x16x64_bf16 v[52:55], v[16:19], v[98:105], v126
  v_cvt_pk_bf16_f32 v32, v36, v37
  v_cvt_pk_bf16_f32 v33, v38, v39
  s_nop 1
  v_cvt_pk_bf16_f32 v34, v44, v45
  v_cvt_pk_bf16_f32 v35, v46, v47
  s_add_u32 s55, s55, 8192
  s_nop 0
  v_mfma_f32_16x16x32_bf16 v[44:47], v[32:35], v[32:35], 0
  buffer_load_dword v141, off, s[36:39], s56 sc1
  buffer_load_dword v143, off, s[36:39], s69 sc1
  v_mfma_f32_16x16x32_bf16 v[36:39], v[60:63], v[32:35], 0
  v_mfma_f32_16x16x32_bf16 v[40:43], v[56:59], v[32:35], 0
  v_mov_b32_dpp v44, v46 row_ror:8 row_mask:0xf bank_mask:0xc
  v_mov_b32_dpp v45, v47 row_ror:8 row_mask:0xf bank_mask:0xc
  ds_write_b64 v135, v[44:45]
  v_mov_b32_dpp v32, v122 quad_perm:[0,1,2,3] row_mask:0xf bank_mask:0x3
  v_mov_b32_dpp v33, v123 quad_perm:[0,1,2,3] row_mask:0xf bank_mask:0x3
  s_nop 2
  v_mov_b32_dpp v40, v36 row_ror:8 row_mask:0xf bank_mask:0xc
  v_mov_b32_dpp v41, v37 row_ror:8 row_mask:0xf bank_mask:0xc
  v_mov_b32_dpp v42, v38 row_ror:8 row_mask:0xf bank_mask:0xc
  v_mov_b32_dpp v43, v39 row_ror:8 row_mask:0xf bank_mask:0xc
  ds_write2_b64 v134, v[40:41], v[42:43] offset0:0 offset1:2
  v_smfmac_f32_16x16x64_bf16 v[48:51], v[24:27], v[106:113], v126
  v_mov_b32_dpp v34, v122 row_ror:8 row_mask:0xf bank_mask:0x3
  v_smfmac_f32_16x16x64_bf16 v[52:55], v[24:27], v[114:121], v126
  v_mov_b32_dpp v35, v123 row_ror:8 row_mask:0xf bank_mask:0x3
  v_smfmac_f32_16x16x64_bf16 v[48:51], v[4:7], v[144:151], v126
  buffer_store_dwordx4 v[32:35], v127, s[36:39], s68 offen sc1
  v_smfmac_f32_16x16x64_bf16 v[52:55], v[4:7], v[152:159], v126
  s_add_u32 s68, s68, 4096
  v_smfmac_f32_16x16x64_bf16 v[48:51], v[12:15], v[160:167], v126
  s_add_u32 s66, s66, 8192
  v_smfmac_f32_16x16x64_bf16 v[52:55], v[12:15], v[168:175], v126
  s_add_u32 s67, s67, 8192
  s_waitcnt lgkmcnt(0)
  s_barrier
  ds_read_b128 v[32:35], v136 offset:0
  ds_read_b64 v[56:57], v137 offset:0
  ds_read_b128 v[36:39], v136 offset:1024
  ds_read_b64 v[58:59], v137 offset:512
  v_smfmac_f32_16x16x64_bf16 v[48:51], v[20:23], v[176:183], v126
  ds_read_b128 v[40:43], v136 offset:2048
  ds_read_b64 v[60:61], v137 offset:1024
  v_smfmac_f32_16x16x64_bf16 v[52:55], v[20:23], v[184:191], v126
  ds_read_b128 v[44:47], v136 offset:3072
  ds_read_b64 v[62:63], v137 offset:1536
  v_smfmac_f32_16x16x64_bf16 v[48:51], v[28:31], v[192:199], v126
  ds_read_b128 v[98:101], v140 offset:16384
  ds_read_b128 v[102:105], v140 offset:17408
  v_smfmac_f32_16x16x64_bf16 v[52:55], v[28:31], v[200:207], v126
  ds_read_b128 v[106:109], v140 offset:18432
  ds_read_b128 v[110:113], v140 offset:19456
  s_waitcnt lgkmcnt(8)
  v_pk_add_f32 v[32:33], v[32:33], v[36:37]
  v_pk_add_f32 v[34:35], v[34:35], v[38:39]
  v_pk_add_f32 v[56:57], v[56:57], v[58:59]
  s_waitcnt lgkmcnt(4)
  v_pk_add_f32 v[40:41], v[40:41], v[44:45]
  v_pk_add_f32 v[42:43], v[42:43], v[46:47]
  v_pk_add_f32 v[60:61], v[60:61], v[62:63]
  v_pk_add_f32 v[32:33], v[32:33], v[40:41]
  v_pk_add_f32 v[34:35], v[34:35], v[42:43]
  v_pk_add_f32 v[56:57], v[56:57], v[60:61]
  v_max3_f32 v58, v32, v33, v34
  v_max3_f32 v60, v35, v56, v57
  v_max_f32 v60, v58, v60
  v_pk_add_f32 v[48:49], v[48:49], v[50:51]
  v_pk_add_f32 v[52:53], v[52:53], v[54:55]
  v_max_f32_dpp v58, v60, v60 quad_perm:[2,3,0,1] row_mask:0xf bank_mask:0xf
  v_max_f32_dpp v59, v60, v60 quad_perm:[2,3,0,1] row_mask:0xf bank_mask:0xf
  v_mfma_f32_32x32x8_bf16 v[16:31], v[128:129], v[128:129], 0
  v_cvt_pk_bf16_f32 v122, v48, v49
  v_permlane16_swap_b32 v58, v59
  v_max_f32 v60, v58, v59
  v_max_f32 v58, v58, v59
  v_cvt_pk_bf16_f32 v123, v52, v53
  v_cndmask_b32 v82, 0, v122, s[74:75]
  v_permlane32_swap_b32 v58, v60
  v_max_f32 v58, v58, v60
  v_mul_f32 v58, s72, v58
  v_pk_fma_f32 v[32:33], v[32:33], s[72:73], v[58:59] op_sel_hi:[1,1,0] neg_lo:[0,0,1] neg_hi:[0,0,1]
  v_pk_fma_f32 v[56:57], v[56:57], s[72:73], v[58:59] op_sel_hi:[1,1,0] neg_lo:[0,0,1] neg_hi:[0,0,1]
  v_pk_fma_f32 v[34:35], v[34:35], s[72:73], v[58:59] op_sel_hi:[1,1,0] neg_lo:[0,0,1] neg_hi:[0,0,1]
  v_mfma_f32_32x32x8_bf16 v[0:15], v[128:129], v[128:129], 0
  v_exp_f32 v32, v32
  v_exp_f32 v33, v33
  v_exp_f32 v56, v56
  v_exp_f32 v57, v57
  v_exp_f32 v34, v34
  v_exp_f32 v35, v35
  v_cvt_pk_bf16_f32 v36, v32, v33
  v_cvt_pk_bf16_f32 v37, v56, v57
  v_cvt_pk_bf16_f32 v39, v56, v57
  v_cvt_pk_bf16_f32 v38, v34, v35
  v_cndmask_b32 v83, 0, v122, s[76:77]
  v_cndmask_b32 v88, 0, v123, s[74:75]
  v_smfmac_f32_16x16x64_bf16 v[24:27], v[36:39], v[92:99], v126
  v_cndmask_b32 v89, 0, v123, s[76:77]
  v_smfmac_f32_16x16x64_bf16 v[16:19], v[36:39], v[80:87], v126
  ds_read_b128 v[114:117], v140 offset:20480
  v_smfmac_f32_16x16x64_bf16 v[20:23], v[36:39], v[86:93], v126
  v_add_f32 v24, v24, v26
  v_add_f32 v25, v25, v27
  v_rcp_f32 v24, v24
  v_rcp_f32 v25, v25
  v_pk_add_f32 v[16:17], v[16:17], v[18:19]
  v_pk_mul_f32 v[16:17], v[16:17], v[24:25]
  s_nop 1
  v_pk_add_f32 v[20:21], v[20:21], v[22:23]
  v_cvt_pk_bf16_f32 v56, v16, v17
  v_cvt_pk_bf16_f32 v57, v16, v17
  v_pk_mul_f32 v[20:21], v[20:21], v[24:25]
  v_cvt_pk_bf16_f32 v58, v20, v21
  v_cvt_pk_bf16_f32 v59, v20, v21
  ds_write2_b64 v138, v[56:57], v[58:59] offset0:0 offset1:16
  ds_read_b128 v[118:121], v140 offset:21504
  ds_read_b128 v[48:51], v140 offset:22528
  ds_read_b128 v[52:55], v140 offset:23552
  s_waitcnt lgkmcnt(3)
  s_barrier
  ds_read_b64_tr_b16 v[32:33], v139 offset:0
  ds_read_b64_tr_b16 v[34:35], v139 offset:128
  ds_read_b64_tr_b16 v[36:37], v139 offset:256
  ds_read_b64_tr_b16 v[38:39], v139 offset:384
  ds_read_b64_tr_b16 v[40:41], v139 offset:512
  ds_read_b64_tr_b16 v[42:43], v139 offset:640
  ds_read_b64_tr_b16 v[44:45], v139 offset:768
  ds_read_b64_tr_b16 v[46:47], v139 offset:896
  s_waitcnt lgkmcnt(6)
  v_smfmac_f32_16x16x64_bf16 v[0:3], v[32:35], v[98:105], v126
  ds_read_b128 v[80:83], v140 offset:24576
  v_smfmac_f32_16x16x64_bf16 v[4:7], v[32:35], v[106:113], v126
  ds_read_b128 v[84:87], v140 offset:25600
  s_waitcnt lgkmcnt(6)
  v_smfmac_f32_16x16x64_bf16 v[0:3], v[36:39], v[114:121], v126
  ds_read_b128 v[16:19], v140 offset:26624
  v_smfmac_f32_16x16x64_bf16 v[4:7], v[36:39], v[48:55], v126
  ds_read_b128 v[20:23], v140 offset:27648
  s_waitcnt lgkmcnt(6)
  v_smfmac_f32_16x16x64_bf16 v[0:3], v[40:43], v[208:215], v126
  ds_read_b128 v[24:27], v140 offset:28672
  v_smfmac_f32_16x16x64_bf16 v[4:7], v[40:43], v[216:223], v126
  ds_read_b128 v[28:31], v140 offset:29696
  s_waitcnt lgkmcnt(4)
  v_smfmac_f32_16x16x64_bf16 v[0:3], v[44:47], v[80:87], v126
  ds_read_b128 v[56:59], v140 offset:30720
  v_smfmac_f32_16x16x64_bf16 v[4:7], v[44:47], v[224:231], v126
  ds_read_b128 v[60:63], v140 offset:31744
  s_waitcnt lgkmcnt(4)
  v_smfmac_f32_16x16x64_bf16 v[8:11], v[32:35], v[16:23], v126
  ds_read_b128 v[98:101], v140 offset:32768
  v_smfmac_f32_16x16x64_bf16 v[12:15], v[32:35], v[232:239], v126
  ds_read_b128 v[102:105], v140 offset:33792
  v_cvt_pk_bf16_f32 v0, v0, v4
  v_cvt_pk_bf16_f32 v2, v2, v6
  v_and_b32 v0, -2, v0
  v_and_b32 v2, -2, v2
  v_cvt_pk_bf16_f32 v1, v1, v5
  s_waitcnt lgkmcnt(4)
  v_smfmac_f32_16x16x64_bf16 v[8:11], v[36:39], v[24:31], v126
  ds_read_b128 v[106:109], v140 offset:34816
  v_cvt_pk_bf16_f32 v3, v3, v7
  v_smfmac_f32_16x16x64_bf16 v[12:15], v[36:39], v[240:247], v126
  ds_read_b128 v[110:113], v140 offset:35840
  buffer_store_dwordx4 v[0:3], v130, s[36:39], s60 offen sc1
  s_waitcnt lgkmcnt(4)
  v_smfmac_f32_16x16x64_bf16 v[8:11], v[40:43], v[56:63], v126
  v_smfmac_f32_16x16x64_bf16 v[12:15], v[40:43], v[248:255], v126
  s_waitcnt lgkmcnt(2)
  v_smfmac_f32_16x16x64_bf16 v[8:11], v[44:47], v[98:105], v126
  s_waitcnt lgkmcnt(0)
  v_smfmac_f32_16x16x64_bf16 v[12:15], v[44:47], v[106:113], v126
  ds_read_b128 v[48:51], v127 offset:10752
  s_nop 6
  v_cvt_pk_bf16_f32 v8, v8, v12
  v_cvt_pk_bf16_f32 v10, v10, v14
  v_and_b32 v8, -2, v8
  v_and_b32 v10, -2, v10
  v_cvt_pk_bf16_f32 v9, v9, v13
  v_cvt_pk_bf16_f32 v11, v11, v15
  buffer_store_dwordx4 v[8:11], v130, s[36:39], s61 offen sc1
  s_nop 15
  s_nop 15
  s_nop 11
  buffer_load_dwordx4 v[16:19], v127, s[36:39], s58 offen sc1
  buffer_load_dwordx4 v[20:23], v127, s[36:39], s58 offen offset:1024 sc1
  s_nop 15
  s_nop 15
  s_nop 7
  buffer_load_dwordx4 v[24:27], v127, s[36:39], s58 offen sc1
  buffer_load_dwordx4 v[28:31], v127, s[36:39], s58 offen offset:1024 sc1
  s_nop 10
  s_waitcnt vmcnt(3) lgkmcnt(0)
  v_mfma_f32_16x16x32_bf16 v[32:35], v[48:51], v[16:19], 0
  s_waitcnt vmcnt(2)
  v_mfma_f32_16x16x32_bf16 v[32:35], v[48:51], v[20:23], v[32:35]
  v_bitop3_b32 v142, v16, v18, v20 bitop3:0xfe
  v_bitop3_b32 v142, v142, v22, 1 bitop3:0xa8
  v_cmp_ne_u32 vcc, 0, v142
  s_add_u32 s80, s80, 1
  s_cbranch_vccnz CS_p0
CS_pe0:
  s_nop 2
  v_add_f32_dpp v32, v32, v32 row_ror:8 row_mask:0xf bank_mask:0xf
  v_add_f32_dpp v33, v33, v33 row_ror:8 row_mask:0xf bank_mask:0xf
  s_add_u32 s53, s53, 1
  v_add_f32_dpp v32, v32, v32 row_ror:4 row_mask:0xf bank_mask:0xf
  v_add_f32_dpp v33, v33, v33 row_ror:4 row_mask:0xf bank_mask:0xf
  v_cvt_pk_bf16_f32 v32, v32, v33
  buffer_store_dword v32, v131, s[36:39], s64 offen sc1
  s_add_u32 s64, s64, 8192
  s_add_u32 s57, s57, 1
  v_readfirstlane_b32 s82, v141
  s_nop 0
  s_max_u32 s78, s78, s82
  s_add_u32 s81, s53, 1
  s_min_u32 s81, s81, 63
  s_cmp_lt_u32 s81, s78
  s_cbranch_scc0 CS_kv
CS_kvok:
  s_add_u32 s81, s53, 5
  s_min_u32 s81, s81, 63
  s_cmp_lt_u32 s81, s78
  s_cselect_b32 s56, 0x10000000, s79
  s_cmp_eq_u32 s53, 63
  s_cselect_b32 s66, 0x10000000, s66
  s_cselect_b32 s67, 0x10000000, s67
  s_cselect_b32 s64, 0x10000000, s64
  v_mov_b64 v[80:81], v[72:73]
  v_mov_b64 v[84:85], v[74:75]
  v_mov_b64 v[86:87], v[76:77]
  v_mov_b64 v[90:91], v[78:79]
  ds_read_b128 v[56:59], v140 offset:6144
  ds_read_b128 v[60:63], v140 offset:7168
  ds_read_b128 v[72:75], v140 offset:8192
  ds_read_b128 v[76:79], v140 offset:9216
  v_mov_b32 v142, s57
  s_add_u32 s69, s64, 8192
  s_nop 15
  s_nop 15
  s_nop 11
CS_i1:
  buffer_load_dwordx4 v[0:3], v127, s[36:39], s54 offen offset:0
  ds_read_b128 v[98:101], v140 offset:0
  ds_read_b128 v[102:105], v140 offset:1024
  ds_read_b128 v[106:109], v140 offset:2048
  ds_read_b128 v[110:113], v140 offset:3072
  ds_read_b128 v[114:117], v140 offset:4096
  ds_read_b128 v[118:121], v140 offset:5120
  buffer_load_dwordx4 v[8:11], v127, s[36:39], s54 offen offset:2048
  v_mov_b64 v[32:33], 0
  v_mov_b64 v[34:35], 0
  v_mov_b64 v[36:37], 0
  v_mov_b64 v[38:39], 0
  v_mov_b64 v[40:41], 0
  v_mov_b64 v[42:43], 0
  buffer_load_dwordx4 v[16:19], v127, s[36:39], s55 offen offset:0
  v_mov_b64 v[44:45], 0
  v_mov_b64 v[46:47], 0
  v_mov_b64 v[48:49], 0
  v_mov_b64 v[50:51], 0
  v_mov_b64 v[52:53], 0
  v_mov_b64 v[54:55], 0
  s_nop 7
  buffer_load_dwordx4 v[24:27], v127, s[36:39], s55 offen offset:2048
  s_nop 15
  s_waitcnt vmcnt(3) lgkmcnt(0)
  v_max3_u32 v141, v0, v1, v2
  v_max_u32 v141, v141, v3
  v_cmp_eq_u32 vcc, s70, v141
  buffer_load_dwordx4 v[4:7], v127, s[36:39], s54 offen offset:1024
  s_cbranch_vccnz CS_r1_0
CS_c1_0:
  v_smfmac_f32_16x16x64_bf16 v[32:35], v[0:3], a[0:7], v126
  buffer_load_dwordx4 v[12:15], v127, s[36:39], s54 offen offset:3072
  v_smfmac_f32_16x16x64_bf16 v[36:39], v[0:3], a[128:135], v126
  s_waitcnt vmcnt(4)
  v_max3_u32 v141, v8, v9, v10
  v_smfmac_f32_16x16x64_bf16 v[40:43], v[0:3], a[8:15], v126
  v_max_u32 v141, v141, v11
  v_cmp_eq_u32 vcc, s70, v141
  v_smfmac_f32_16x16x64_bf16 v[44:47], v[0:3], a[136:143], v126
  v_smfmac_f32_16x16x64_bf16 v[48:51], v[0:3], v[98:105], v126
  s_cbranch_vccnz CS_r1_1
CS_c1_1:
  v_smfmac_f32_16x16x64_bf16 v[32:35], v[8:11], a[32:39], v126
  buffer_load_dwordx4 v[20:23], v127, s[36:39], s55 offen offset:1024
  v_smfmac_f32_16x16x64_bf16 v[36:39], v[8:11], a[160:167], v126
  s_waitcnt vmcnt(4)
  v_max3_u32 v141, v16, v17, v18
  v_smfmac_f32_16x16x64_bf16 v[40:43], v[8:11], a[40:47], v126
  v_max_u32 v141, v141, v19
  v_cmp_eq_u32 vcc, s70, v141
  v_smfmac_f32_16x16x64_bf16 v[44:47], v[8:11], a[168:175], v126
  ds_read_b128 v[98:101], v140 offset:10240
  v_smfmac_f32_16x16x64_bf16 v[52:55], v[0:3], v[106:113], v126
  s_cbranch_vccnz CS_r1_2
CS_c1_2:
  v_smfmac_f32_16x16x64_bf16 v[32:35], v[16:19], a[64:71], v126
  buffer_load_dwordx4 v[28:31], v127, s[36:39], s55 offen offset:3072
  v_smfmac_f32_16x16x64_bf16 v[36:39], v[16:19], a[192:199], v126
  s_waitcnt vmcnt(4)
  v_max3_u32 v141, v24, v25, v26
  v_smfmac_f32_16x16x64_bf16 v[40:43], v[16:19], a[72:79], v126
  v_max_u32 v141, v141, v27
  v_cmp_eq_u32 vcc, s70, v141
  v_smfmac_f32_16x16x64_bf16 v[44:47], v[16:19], a[200:207], v126
  ds_read_b128 v[102:105], v140 offset:11264
  v_smfmac_f32_16x16x64_bf16 v[48:51], v[8:11], v[114:121], v126
  s_cbranch_vccnz CS_r1_3
CS_c1_3:
  v_smfmac_f32_16x16x64_bf16 v[32:35], v[24:27], a[96:103], v126
  ds_read_b128 v[106:109], v140 offset:12288
  v_smfmac_f32_16x16x64_bf16 v[36:39], v[24:27], a[224:231], v126
  s_waitcnt vmcnt(3)
  v_max3_u32 v141, v4, v5, v6
  v_smfmac_f32_16x16x64_bf16 v[40:43], v[24:27], a[104:111], v126
  v_max_u32 v141, v141, v7
  v_cmp_eq_u32 vcc, s70, v141
  v_smfmac_f32_16x16x64_bf16 v[44:47], v[24:27], a[232:239], v126
  ds_read_b128 v[110:113], v140 offset:13312
  v_smfmac_f32_16x16x64_bf16 v[52:55], v[8:11], v[56:63], v126
  s_cbranch_vccnz CS_r1_4
CS_c1_4:
  v_smfmac_f32_16x16x64_bf16 v[32:35], v[4:7], a[16:23], v126
  ds_read_b128 v[114:117], v140 offset:14336
  v_smfmac_f32_16x16x64_bf16 v[36:39], v[4:7], a[144:151], v126
  s_waitcnt vmcnt(2)
  v_max3_u32 v141, v12, v13, v14
  v_smfmac_f32_16x16x64_bf16 v[40:43], v[4:7], a[24:31], v126
  v_max_u32 v141, v141, v15
  v_cmp_eq_u32 vcc, s70, v141
  v_smfmac_f32_16x16x64_bf16 v[44:47], v[4:7], a[152:159], v126
  ds_read_b128 v[118:121], v140 offset:15360
  v_smfmac_f32_16x16x64_bf16 v[48:51], v[16:19], v[72:79], v126
  s_cbranch_vccnz CS_r1_5
CS_c1_5:
  v_smfmac_f32_16x16x64_bf16 v[32:35], v[12:15], a[48:55], v126
  v_smfmac_f32_16x16x64_bf16 v[36:39], v[12:15], a[176:183], v126
  s_waitcnt vmcnt(1)
  v_max3_u32 v141, v20, v21, v22
  v_smfmac_f32_16x16x64_bf16 v[40:43], v[12:15], a[56:63], v126
  v_max_u32 v141, v141, v23
  v_cmp_eq_u32 vcc, s70, v141
  buffer_load_dwordx4 v[56:59], v132, s[36:39], s66 offen offset:0 sc1
  v_smfmac_f32_16x16x64_bf16 v[44:47], v[12:15], a[184:191], v126
  buffer_load_dwordx4 v[60:63], v132, s[36:39], s66 offen offset:256 sc1
  s_cbranch_vccnz CS_r1_6
CS_c1_6:
  s_waitcnt vmcnt(2) lgkmcnt(0)
  v_smfmac_f32_16x16x64_bf16 v[32:35], v[20:23], a[80:87], v126
  v_max3_u32 v141, v28, v29, v30
  v_max_u32 v141, v141, v31
  v_cmp_eq_u32 vcc, s70, v141
  v_smfmac_f32_16x16x64_bf16 v[36:39], v[20:23], a[208:215], v126
  s_cbranch_vccnz CS_r1_7
CS_c1_7:
  v_smfmac_f32_16x16x64_bf16 v[32:35], v[28:31], a[112:119], v126
  buffer_load_dwordx4 v[76:79], v133, s[36:39], s67 offen offset:256 sc1
  v_smfmac_f32_16x16x64_bf16 v[36:39], v[28:31], a[240:247], v126
  buffer_load_dwordx4 v[72:75], v133, s[36:39], s67 offen offset:0 sc1
  v_smfmac_f32_16x16x64_bf16 v[40:43], v[20:23], a[88:95], v126
  v_add_f32 v32, v32, v34
  v_smfmac_f32_16x16x64_bf16 v[44:47], v[20:23], a[216:223], v126
  v_add_f32 v33, v33, v35
  v_smfmac_f32_16x16x64_bf16 v[40:43], v[28:31], a[120:127], v126
  v_add_f32 v36, v36, v38
  v_smfmac_f32_16x16x64_bf16 v[44:47], v[28:31], a[248:255], v126
  v_add_f32 v37, v37, v39
  v_cvt_pk_bf16_f32 v32, v32, v33
  v_cvt_pk_bf16_f32 v33, v36, v37
  s_nop 0
  v_add_f32 v40, v40, v42
  v_add_f32 v41, v41, v43
  v_mfma_f32_16x16x16_bf16 v[36:39], v[32:33], v[124:125], 0
  s_nop 0
  v_add_f32 v44, v44, v46
  v_add_f32 v45, v45, v47
  v_cvt_pk_bf16_f32 v40, v40, v41
  v_cvt_pk_bf16_f32 v41, v44, v45
  s_add_u32 s54, s54, 8192
  s_nop 0
  v_mfma_f32_16x16x16_bf16 v[44:47], v[40:41], v[124:125], 0
  buffer_store_dword v142, v127, s[32:35], 0 offen sc1
  v_smfmac_f32_16x16x64_bf16 v[52:55], v[16:19], v[98:105], v126
  v_cvt_pk_bf16_f32 v32, v36, v37
  v_cvt_pk_bf16_f32 v33, v38, v39
  s_nop 1
  v_cvt_pk_bf16_f32 v34, v44, v45
  v_cvt_pk_bf16_f32 v35, v46, v47
  s_add_u32 s55, s55, 8192
  s_nop 0
  v_mfma_f32_16x16x32_bf16 v[44:47], v[32:35], v[32:35], 0
  buffer_load_dword v143, off, s[36:39], s69 sc1
  v_mfma_f32_16x16x32_bf16 v[36:39], v[68:71], v[32:35], 0
  v_mfma_f32_16x16x32_bf16 v[40:43], v[64:67], v[32:35], 0
  v_mov_b32_dpp v44, v46 row_ror:8 row_mask:0xf bank_mask:0xc
  v_mov_b32_dpp v45, v47 row_ror:8 row_mask:0xf bank_mask:0xc
  ds_write_b64 v135, v[44:45]
  v_mov_b32_dpp v32, v122 quad_perm:[0,1,2,3] row_mask:0xf bank_mask:0x3
  v_mov_b32_dpp v33, v123 quad_perm:[0,1,2,3] row_mask:0xf bank_mask:0x3
  s_nop 2
  v_mov_b32_dpp v40, v36 row_ror:8 row_mask:0xf bank_mask:0xc
  v_mov_b32_dpp v41, v37 row_ror:8 row_mask:0xf bank_mask:0xc
  v_mov_b32_dpp v42, v38 row_ror:8 row_mask:0xf bank_mask:0xc
  v_mov_b32_dpp v43, v39 row_ror:8 row_mask:0xf bank_mask:0xc
  ds_write2_b64 v134, v[40:41], v[42:43] offset0:0 offset1:2
  v_smfmac_f32_16x16x64_bf16 v[48:51], v[24:27], v[106:113], v126
  v_mov_b32_dpp v34, v122 row_ror:8 row_mask:0xf bank_mask:0x3
  v_smfmac_f32_16x16x64_bf16 v[52:55], v[24:27], v[114:121], v126
  v_mov_b32_dpp v35, v123 row_ror:8 row_mask:0xf bank_mask:0x3
  v_smfmac_f32_16x16x64_bf16 v[48:51], v[4:7], v[144:151], v126
  buffer_store_dwordx4 v[32:35], v127, s[36:39], s68 offen sc1
  v_smfmac_f32_16x16x64_bf16 v[52:55], v[4:7], v[152:159], v126
  s_add_u32 s68, s68, 4096
  v_smfmac_f32_16x16x64_bf16 v[48:51], v[12:15], v[160:167], v126
  s_add_u32 s66, s66, 8192
  v_smfmac_f32_16x16x64_bf16 v[52:55], v[12:15], v[168:175], v126
  s_add_u32 s67, s67, 8192
  s_waitcnt lgkmcnt(0)
  s_barrier
  ds_read_b128 v[32:35], v136 offset:0
  ds_read_b64 v[64:65], v137 offset:0
  ds_read_b128 v[36:39], v136 offset:1024
  ds_read_b64 v[66:67], v137 offset:512
  v_smfmac_f32_16x16x64_bf16 v[48:51], v[20:23], v[176:183], v126
  ds_read_b128 v[40:43], v136 offset:2048
  ds_read_b64 v[68:69], v137 offset:1024
  v_smfmac_f32_16x16x64_bf16 v[52:55], v[20:23], v[184:191], v126
  ds_read_b128 v[44:47], v136 offset:3072
  ds_read_b64 v[70:71], v137 offset:1536
  v_smfmac_f32_16x16x64_bf16 v[48:51], v[28:31], v[192:199], v126
  ds_read_b128 v[98:101], v140 offset:16384
  ds_read_b128 v[102:105], v140 offset:17408
  s_cmp_eq_u32 s53, 63
  v_smfmac_f32_16x16x64_bf16 v[52:55], v[28:31], v[200:207], v126
  s_cbranch_scc1 CS_done
  ds_read_b128 v[106:109], v140 offset:18432
  ds_read_b128 v[110:113], v140 offset:19456
  s_waitcnt lgkmcnt(8)
  v_pk_add_f32 v[32:33], v[32:33], v[36:37]
  v_pk_add_f32 v[34:35], v[34:35], v[38:39]
  v_pk_add_f32 v[64:65], v[64:65], v[66:67]
  s_waitcnt lgkmcnt(4)
  v_pk_add_f32 v[40:41], v[40:41], v[44:45]
  v_pk_add_f32 v[42:43], v[42:43], v[46:47]
  v_pk_add_f32 v[68:69], v[68:69], v[70:71]
  v_pk_add_f32 v[32:33], v[32:33], v[40:41]
  v_pk_add_f32 v[34:35], v[34:35], v[42:43]
  v_pk_add_f32 v[64:65], v[64:65], v[68:69]
  v_max3_f32 v66, v32, v33, v34
  v_max3_f32 v68, v35, v64, v65
  v_max_f32 v68, v66, v68
  v_pk_add_f32 v[48:49], v[48:49], v[50:51]
  v_pk_add_f32 v[52:53], v[52:53], v[54:55]
  v_max_f32_dpp v66, v68, v68 quad_perm:[2,3,0,1] row_mask:0xf bank_mask:0xf
  v_max_f32_dpp v67, v68, v68 quad_perm:[2,3,0,1] row_mask:0xf bank_mask:0xf
  v_mfma_f32_32x32x8_bf16 v[16:31], v[128:129], v[128:129], 0
  v_cvt_pk_bf16_f32 v122, v48, v49
  v_permlane16_swap_b32 v66, v67
  v_max_f32 v68, v66, v67
  v_max_f32 v66, v66, v67
  v_cvt_pk_bf16_f32 v123, v52, v53
  v_cndmask_b32 v82, 0, v122, s[74:75]
  v_permlane32_swap_b32 v66, v68
  v_max_f32 v66, v66, v68
  v_mul_f32 v66, s72, v66
  v_pk_fma_f32 v[32:33], v[32:33], s[72:73], v[66:67] op_sel_hi:[1,1,0] neg_lo:[0,0,1] neg_hi:[0,0,1]
  v_pk_fma_f32 v[64:65], v[64:65], s[72:73], v[66:67] op_sel_hi:[1,1,0] neg_lo:[0,0,1] neg_hi:[0,0,1]
  v_pk_fma_f32 v[34:35], v[34:35], s[72:73], v[66:67] op_sel_hi:[1,1,0] neg_lo:[0,0,1] neg_hi:[0,0,1]
  v_mfma_f32_32x32x8_bf16 v[0:15], v[128:129], v[128:129], 0
  v_exp_f32 v32, v32
  v_exp_f32 v33, v33
  v_exp_f32 v64, v64
  v_exp_f32 v65, v65
  v_exp_f32 v34, v34
  v_exp_f32 v35, v35
  v_cvt_pk_bf16_f32 v36, v32, v33
  v_cvt_pk_bf16_f32 v37, v64, v65
  v_cvt_pk_bf16_f32 v39, v64, v65
  v_cvt_pk_bf16_f32 v38, v34, v35
  v_cndmask_b32 v83, 0, v122, s[76:77]
  v_cndmask_b32 v88, 0, v123, s[74:75]
  v_smfmac_f32_16x16x64_bf16 v[24:27], v[36:39], v[92:99], v126
  v_cndmask_b32 v89, 0, v123, s[76:77]
  v_smfmac_f32_16x16x64_bf16 v[16:19], v[36:39], v[80:87], v126
  ds_read_b128 v[114:117], v140 offset:20480
  v_smfmac_f32_16x16x64_bf16 v[20:23], v[36:39], v[86:93], v126
  v_add_f32 v24, v24, v26
  v_add_f32 v25, v25, v27
  v_rcp_f32 v24, v24
  v_rcp_f32 v25, v25
  v_pk_add_f32 v[16:17], v[16:17], v[18:19]
  v_pk_mul_f32 v[16:17], v[16:17], v[24:25]
  s_nop 1
  v_pk_add_f32 v[20:21], v[20:21], v[22:23]
  v_cvt_pk_bf16_f32 v64, v16, v17
  v_cvt_pk_bf16_f32 v65, v16, v17
  v_pk_mul_f32 v[20:21], v[20:21], v[24:25]
  v_cvt_pk_bf16_f32 v66, v20, v21
  v_cvt_pk_bf16_f32 v67, v20, v21
  ds_write2_b64 v138, v[64:65], v[66:67] offset0:0 offset1:16
  ds_read_b128 v[118:121], v140 offset:21504
  ds_read_b128 v[48:51], v140 offset:22528
  ds_read_b128 v[52:55], v140 offset:23552
  s_waitcnt lgkmcnt(3)
  s_barrier
  ds_read_b64_tr_b16 v[32:33], v139 offset:0
  ds_read_b64_tr_b16 v[34:35], v139 offset:128
  ds_read_b64_tr_b16 v[36:37], v139 offset:256
  ds_read_b64_tr_b16 v[38:39], v139 offset:384
  ds_read_b64_tr_b16 v[40:41], v139 offset:512
  ds_read_b64_tr_b16 v[42:43], v139 offset:640
  ds_read_b64_tr_b16 v[44:45], v139 offset:768
  ds_read_b64_tr_b16 v[46:47], v139 offset:896
  s_waitcnt lgkmcnt(6)
  v_smfmac_f32_16x16x64_bf16 v[0:3], v[32:35], v[98:105], v126
  ds_read_b128 v[80:83], v140 offset:24576
  v_smfmac_f32_16x16x64_bf16 v[4:7], v[32:35], v[106:113], v126
  ds_read_b128 v[84:87], v140 offset:25600
  s_waitcnt lgkmcnt(6)
  v_smfmac_f32_16x16x64_bf16 v[0:3], v[36:39], v[114:121], v126
  ds_read_b128 v[16:19], v140 offset:26624
  v_smfmac_f32_16x16x64_bf16 v[4:7], v[36:39], v[48:55], v126
  ds_read_b128 v[20:23], v140 offset:27648
  s_waitcnt lgkmcnt(6)
  v_smfmac_f32_16x16x64_bf16 v[0:3], v[40:43], v[208:215], v126
  ds_read_b128 v[24:27], v140 offset:28672
  v_smfmac_f32_16x16x64_bf16 v[4:7], v[40:43], v[216:223], v126
  ds_read_b128 v[28:31], v140 offset:29696
  s_waitcnt lgkmcnt(4)
  v_smfmac_f32_16x16x64_bf16 v[0:3], v[44:47], v[80:87], v126
  ds_read_b128 v[64:67], v140 offset:30720
  v_smfmac_f32_16x16x64_bf16 v[4:7], v[44:47], v[224:231], v126
  ds_read_b128 v[68:71], v140 offset:31744
  s_waitcnt lgkmcnt(4)
  v_smfmac_f32_16x16x64_bf16 v[8:11], v[32:35], v[16:23], v126
  ds_read_b128 v[98:101], v140 offset:32768
  v_smfmac_f32_16x16x64_bf16 v[12:15], v[32:35], v[232:239], v126
  ds_read_b128 v[102:105], v140 offset:33792
  v_cvt_pk_bf16_f32 v0, v0, v4
  v_cvt_pk_bf16_f32 v2, v2, v6
  v_or_b32 v0, 1, v0
  v_or_b32 v2, 1, v2
  v_cvt_pk_bf16_f32 v1, v1, v5
  s_waitcnt lgkmcnt(4)
  v_smfmac_f32_16x16x64_bf16 v[8:11], v[36:39], v[24:31], v126
  ds_read_b128 v[106:109], v140 offset:34816
  v_cvt_pk_bf16_f32 v3, v3, v7
  v_smfmac_f32_16x16x64_bf16 v[12:15], v[36:39], v[240:247], v126
  ds_read_b128 v[110:113], v140 offset:35840
  buffer_store_dwordx4 v[0:3], v130, s[36:39], s60 offen sc1
  s_waitcnt lgkmcnt(4)
  v_smfmac_f32_16x16x64_bf16 v[8:11], v[40:43], v[64:71], v126
  v_smfmac_f32_16x16x64_bf16 v[12:15], v[40:43], v[248:255], v126
  s_waitcnt lgkmcnt(2)
  v_smfmac_f32_16x16x64_bf16 v[8:11], v[44:47], v[98:105], v126
  s_waitcnt lgkmcnt(0)
  v_smfmac_f32_16x16x64_bf16 v[12:15], v[44:47], v[106:113], v126
  ds_read_b128 v[48:51], v127 offset:10752
  s_nop 6
  v_cvt_pk_bf16_f32 v8, v8, v12
  v_cvt_pk_bf16_f32 v10, v10, v14
  v_or_b32 v8, 1, v8
  v_or_b32 v10, 1, v10
  v_cvt_pk_bf16_f32 v9, v9, v13
  v_cvt_pk_bf16_f32 v11, v11, v15
  buffer_store_dwordx4 v[8:11], v130, s[36:39], s61 offen sc1
  s_nop 15
  s_nop 15
  s_nop 11
  buffer_load_dwordx4 v[16:19], v127, s[36:39], s58 offen sc1
  buffer_load_dwordx4 v[20:23], v127, s[36:39], s58 offen offset:1024 sc1
  s_nop 15
  s_nop 15
  s_nop 7
  buffer_load_dwordx4 v[24:27], v127, s[36:39], s58 offen sc1
  buffer_load_dwordx4 v[28:31], v127, s[36:39], s58 offen offset:1024 sc1
  s_nop 10
  s_waitcnt vmcnt(3) lgkmcnt(0)
  v_mfma_f32_16x16x32_bf16 v[32:35], v[48:51], v[16:19], 0
  s_waitcnt vmcnt(2)
  v_mfma_f32_16x16x32_bf16 v[32:35], v[48:51], v[20:23], v[32:35]
  v_bitop3_b32 v142, v16, v18, v20 bitop3:0x80
  v_bitop3_b32 v142, v142, v22, 1 bitop3:0x80
  v_cmp_ne_u32 vcc, 1, v142
  s_add_u32 s80, s80, 1
  s_cbranch_vccnz CS_p1
CS_pe1:
  s_nop 2
  v_add_f32_dpp v32, v32, v32 row_ror:8 row_mask:0xf bank_mask:0xf
  v_add_f32_dpp v33, v33, v33 row_ror:8 row_mask:0xf bank_mask:0xf
  s_add_u32 s53, s53, 1
  v_add_f32_dpp v32, v32, v32 row_ror:4 row_mask:0xf bank_mask:0xf
  v_add_f32_dpp v33, v33, v33 row_ror:4 row_mask:0xf bank_mask:0xf
  v_cvt_pk_bf16_f32 v32, v32, v33
  buffer_store_dword v32, v131, s[36:39], s64 offen sc1
  s_add_u32 s64, s64, 8192
  s_add_u32 s57, s57, 1
  s_branch CS_loop
CS_r0_0:
  buffer_load_dwordx4 v[0:3], v127, s[36:39], s54 offen offset:0 sc1
  s_add_u32 s80, s80, 0x100
  s_add_u32 s91, s91, 1
  s_cmp_gt_u32 s91, 0x20000
  s_cbranch_scc1 L_abort
  s_nop 3
  buffer_load_dwordx4 v[8:11], v127, s[36:39], s54 offen offset:2048 sc1
  s_nop 8
  buffer_load_dwordx4 v[16:19], v127, s[36:39], s55 offen offset:0 sc1
  s_nop 8
  buffer_load_dwordx4 v[24:27], v127, s[36:39], s55 offen offset:2048 sc1
  s_nop 8
  buffer_load_dwordx4 v[4:7], v127, s[36:39], s54 offen offset:1024 sc1
  s_nop 0
  s_waitcnt vmcnt(4)
  v_max3_u32 v141, v0, v1, v2
  v_max_u32 v141, v141, v3
  v_cmp_eq_u32 vcc, s70, v141
  s_nop 0
  s_cbranch_vccz CS_c0_0
  s_branch CS_r0_0
CS_r0_1:
  buffer_load_dwordx4 v[8:11], v127, s[36:39], s54 offen offset:2048 sc1
  s_add_u32 s80, s80, 0x100
  s_add_u32 s91, s91, 1
  s_cmp_gt_u32 s91, 0x20000
  s_cbranch_scc1 L_abort
  s_nop 3
  buffer_load_dwordx4 v[16:19], v127, s[36:39], s55 offen offset:0 sc1
  s_nop 8
  buffer_load_dwordx4 v[24:27], v127, s[36:39], s55 offen offset:2048 sc1
  s_nop 8
  buffer_load_dwordx4 v[4:7], v127, s[36:39], s54 offen offset:1024 sc1
  s_nop 8
  buffer_load_dwordx4 v[12:15], v127, s[36:39], s54 offen offset:3072 sc1
  s_nop 0
  s_waitcnt vmcnt(4)
  v_max3_u32 v141, v8, v9, v10
  v_max_u32 v141, v141, v11
  v_cmp_eq_u32 vcc, s70, v141
  s_nop 0
  s_cbranch_vccz CS_c0_1
  s_branch CS_r0_1
CS_r0_2:
  buffer_load_dwordx4 v[16:19], v127, s[36:39], s55 offen offset:0 sc1
  s_add_u32 s80, s80, 0x100
  s_add_u32 s91, s91, 1
  s_cmp_gt_u32 s91, 0x20000
  s_cbranch_scc1 L_abort
  s_nop 3
  buffer_load_dwordx4 v[24:27], v127, s[36:39], s55 offen offset:2048 sc1
  s_nop 8
  buffer_load_dwordx4 v[4:7], v127, s[36:39], s54 offen offset:1024 sc1
  s_nop 8
  buffer_load_dwordx4 v[12:15], v127, s[36:39], s54 offen offset:3072 sc1
  s_nop 8
  buffer_load_dwordx4 v[20:23], v127, s[36:39], s55 offen offset:1024 sc1
  s_nop 0
  s_waitcnt vmcnt(4)
  v_max3_u32 v141, v16, v17, v18
  v_max_u32 v141, v141, v19
  v_cmp_eq_u32 vcc, s70, v141
  s_nop 0
  s_cbranch_vccz CS_c0_2
  s_branch CS_r0_2
CS_r0_3:
  buffer_load_dwordx4 v[24:27], v127, s[36:39], s55 offen offset:2048 sc1
  s_add_u32 s80, s80, 0x100
  s_add_u32 s91, s91, 1
  s_cmp_gt_u32 s91, 0x20000
  s_cbranch_scc1 L_abort
  s_nop 3
  buffer_load_dwordx4 v[4:7], v127, s[36:39], s54 offen offset:1024 sc1
  s_nop 8
  buffer_load_dwordx4 v[12:15], v127, s[36:39], s54 offen offset:3072 sc1
  s_nop 8
  buffer_load_dwordx4 v[20:23], v127, s[36:39], s55 offen offset:1024 sc1
  s_nop 8
  buffer_load_dwordx4 v[28:31], v127, s[36:39], s55 offen offset:3072 sc1
  s_nop 0
  s_waitcnt vmcnt(4)
  v_max3_u32 v141, v24, v25, v26
  v_max_u32 v141, v141, v27
  v_cmp_eq_u32 vcc, s70, v141
  s_nop 0
  s_cbranch_vccz CS_c0_3
  s_branch CS_r0_3
CS_r0_4:
  buffer_load_dwordx4 v[4:7], v127, s[36:39], s54 offen offset:1024 sc1
  s_add_u32 s80, s80, 0x100
  s_add_u32 s91, s91, 1
  s_cmp_gt_u32 s91, 0x20000
  s_cbranch_scc1 L_abort
  s_nop 3
  buffer_load_dwordx4 v[12:15], v127, s[36:39], s54 offen offset:3072 sc1
  s_nop 8
  buffer_load_dwordx4 v[20:23], v127, s[36:39], s55 offen offset:1024 sc1
  s_nop 8
  buffer_load_dwordx4 v[28:31], v127, s[36:39], s55 offen offset:3072 sc1
  s_nop 12
  s_waitcnt vmcnt(3)
  v_max3_u32 v141, v4, v5, v6
  v_max_u32 v141, v141, v7
  v_cmp_eq_u32 vcc, s70, v141
  s_nop 0
  s_cbranch_vccz CS_c0_4
  s_branch CS_r0_4
CS_r0_5:
  buffer_load_dwordx4 v[12:15], v127, s[36:39], s54 offen offset:3072 sc1
  s_add_u32 s80, s80, 0x100
  s_add_u32 s91, s91, 1
  s_cmp_gt_u32 s91, 0x20000
  s_cbranch_scc1 L_abort
  s_nop 3
  buffer_load_dwordx4 v[20:23], v127, s[36:39], s55 offen offset:1024 sc1
  s_nop 8
  buffer_load_dwordx4 v[28:31], v127, s[36:39], s55 offen offset:3072 sc1
  s_nop 15
  s_nop 8
  s_waitcnt vmcnt(2)
  v_max3_u32 v141, v12, v13, v14
  v_max_u32 v141, v141, v15
  v_cmp_eq_u32 vcc, s70, v141
  s_nop 0
  s_cbranch_vccz CS_c0_5
  s_branch CS_r0_5
CS_r0_6:
  buffer_load_dwordx4 v[20:23], v127, s[36:39], s55 offen offset:1024 sc1
  s_add_u32 s80, s80, 0x100
  s_add_u32 s91, s91, 1
  s_cmp_gt_u32 s91, 0x20000
  s_cbranch_scc1 L_abort
  s_nop 3
  buffer_load_dwordx4 v[28:31], v127, s[36:39], s55 offen offset:3072 sc1
  s_nop 15
  s_nop 15
  s_nop 4
  s_waitcnt vmcnt(0)
  v_max3_u32 v141, v20, v21, v22
  v_max_u32 v141, v141, v23
  v_cmp_eq_u32 vcc, s70, v141
  s_nop 0
  s_cbranch_vccz CS_c0_6
  s_branch CS_r0_6
CS_r0_7:
  buffer_load_dwordx4 v[28:31], v127, s[36:39], s55 offen offset:3072 sc1
  s_add_u32 s80, s80, 0x100
  s_add_u32 s91, s91, 1
  s_cmp_gt_u32 s91, 0x20000
  s_cbranch_scc1 L_abort
  s_nop 15
  s_nop 15
  s_nop 11
  s_waitcnt vmcnt(0)
  v_max3_u32 v141, v28, v29, v30
  v_max_u32 v141, v141, v31
  v_cmp_eq_u32 vcc, s70, v141
  s_nop 0
  s_cbranch_vccz CS_c0_7
  s_branch CS_r0_7
CS_p0:
CS_pl0:
  buffer_load_dwordx4 v[16:19], v127, s[36:39], s58 offen sc1
  buffer_load_dwordx4 v[20:23], v127, s[36:39], s58 offen offset:1024 sc1
  s_waitcnt vmcnt(3) lgkmcnt(0)
  v_mfma_f32_16x16x32_bf16 v[32:35], v[48:51], v[24:27], 0
  s_waitcnt vmcnt(2)
  v_mfma_f32_16x16x32_bf16 v[32:35], v[48:51], v[28:31], v[32:35]
  v_bitop3_b32 v142, v24, v26, v28 bitop3:0xfe
  v_bitop3_b32 v142, v142, v30, 1 bitop3:0xa8
  v_cmp_ne_u32 vcc, 0, v142
  s_add_u32 s80, s80, 1
  s_cbranch_vccz CS_pe0
  buffer_load_dwordx4 v[24:27], v127, s[36:39], s58 offen sc1
  buffer_load_dwordx4 v[28:31], v127, s[36:39], s58 offen offset:1024 sc1
  s_waitcnt vmcnt(3) lgkmcnt(0)
  v_mfma_f32_16x16x32_bf16 v[32:35], v[48:51], v[16:19], 0
  s_waitcnt vmcnt(2)
  v_mfma_f32_16x16x32_bf16 v[32:35], v[48:51], v[20:23], v[32:35]
  v_bitop3_b32 v142, v16, v18, v20 bitop3:0xfe
  v_bitop3_b32 v142, v142, v22, 1 bitop3:0xa8
  v_cmp_ne_u32 vcc, 0, v142
  s_add_u32 s80, s80, 1
  s_cbranch_vccz CS_pe0
  s_add_u32 s91, s91, 1
  s_cmp_gt_u32 s91, 0x20000
  s_cbranch_scc1 L_abort
  s_branch CS_pl0
CS_kv:
  buffer_load_dword v141, off, s[36:39], s79 sc1
  s_add_u32 s91, s91, 1
  s_cmp_gt_u32 s91, 0x20000
  s_cbranch_scc1 L_abort
  s_waitcnt vmcnt(0)
  v_readfirstlane_b32 s78, v141
  s_nop 0
  s_cmp_lt_u32 s81, s78
  s_cbranch_scc1 CS_kv1
  s_sleep 2
  s_branch CS_kv
CS_kv1:
  s_branch CS_kvok
CS_r1_0:
  buffer_load_dwordx4 v[0:3], v127, s[36:39], s54 offen offset:0 sc1
  s_add_u32 s80, s80, 0x100
  s_add_u32 s91, s91, 1
  s_cmp_gt_u32 s91, 0x20000
  s_cbranch_scc1 L_abort
  s_nop 3
  buffer_load_dwordx4 v[8:11], v127, s[36:39], s54 offen offset:2048 sc1
  s_nop 8
  buffer_load_dwordx4 v[16:19], v127, s[36:39], s55 offen offset:0 sc1
  s_nop 8
  buffer_load_dwordx4 v[24:27], v127, s[36:39], s55 offen offset:2048 sc1
  s_nop 8
  buffer_load_dwordx4 v[4:7], v127, s[36:39], s54 offen offset:1024 sc1
  s_nop 0
  s_waitcnt vmcnt(4)
  v_max3_u32 v141, v0, v1, v2
  v_max_u32 v141, v141, v3
  v_cmp_eq_u32 vcc, s70, v141
  s_nop 0
  s_cbranch_vccz CS_c1_0
  s_branch CS_r1_0
CS_r1_1:
  buffer_load_dwordx4 v[8:11], v127, s[36:39], s54 offen offset:2048 sc1
  s_add_u32 s80, s80, 0x100
  s_add_u32 s91, s91, 1
  s_cmp_gt_u32 s91, 0x20000
  s_cbranch_scc1 L_abort
  s_nop 3
  buffer_load_dwordx4 v[16:19], v127, s[36:39], s55 offen offset:0 sc1
  s_nop 8
  buffer_load_dwordx4 v[24:27], v127, s[36:39], s55 offen offset:2048 sc1
  s_nop 8
  buffer_load_dwordx4 v[4:7], v127, s[36:39], s54 offen offset:1024 sc1
  s_nop 8
  buffer_load_dwordx4 v[12:15], v127, s[36:39], s54 offen offset:3072 sc1
  s_nop 0
  s_waitcnt vmcnt(4)
  v_max3_u32 v141, v8, v9, v10
  v_max_u32 v141, v141, v11
  v_cmp_eq_u32 vcc, s70, v141
  s_nop 0
  s_cbranch_vccz CS_c1_1
  s_branch CS_r1_1
CS_r1_2:
  buffer_load_dwordx4 v[16:19], v127, s[36:39], s55 offen offset:0 sc1
  s_add_u32 s80, s80, 0x100
  s_add_u32 s91, s91, 1
  s_cmp_gt_u32 s91, 0x20000
  s_cbranch_scc1 L_abort
  s_nop 3
  buffer_load_dwordx4 v[24:27], v127, s[36:39], s55 offen offset:2048 sc1
  s_nop 8
  buffer_load_dwordx4 v[4:7], v127, s[36:39], s54 offen offset:1024 sc1
  s_nop 8
  buffer_load_dwordx4 v[12:15], v127, s[36:39], s54 offen offset:3072 sc1
  s_nop 8
  buffer_load_dwordx4 v[20:23], v127, s[36:39], s55 offen offset:1024 sc1
  s_nop 0
  s_waitcnt vmcnt(4)
  v_max3_u32 v141, v16, v17, v18
  v_max_u32 v141, v141, v19
  v_cmp_eq_u32 vcc, s70, v141
  s_nop 0
  s_cbranch_vccz CS_c1_2
  s_branch CS_r1_2
CS_r1_3:
  buffer_load_dwordx4 v[24:27], v127, s[36:39], s55 offen offset:2048 sc1
  s_add_u32 s80, s80, 0x100
  s_add_u32 s91, s91, 1
  s_cmp_gt_u32 s91, 0x20000
  s_cbranch_scc1 L_abort
  s_nop 3
  buffer_load_dwordx4 v[4:7], v127, s[36:39], s54 offen offset:1024 sc1
  s_nop 8
  buffer_load_dwordx4 v[12:15], v127, s[36:39], s54 offen offset:3072 sc1
  s_nop 8
  buffer_load_dwordx4 v[20:23], v127, s[36:39], s55 offen offset:1024 sc1
  s_nop 8
  buffer_load_dwordx4 v[28:31], v127, s[36:39], s55 offen offset:3072 sc1
  s_nop 0
  s_waitcnt vmcnt(4)
  v_max3_u32 v141, v24, v25, v26
  v_max_u32 v141, v141, v27
  v_cmp_eq_u32 vcc, s70, v141
  s_nop 0
  s_cbranch_vccz CS_c1_3
  s_branch CS_r1_3
CS_r1_4:
  buffer_load_dwordx4 v[4:7], v127, s[36:39], s54 offen offset:1024 sc1
  s_add_u32 s80, s80, 0x100
  s_add_u32 s91, s91, 1
  s_cmp_gt_u32 s91, 0x20000
  s_cbranch_scc1 L_abort
  s_nop 3
  buffer_load_dwordx4 v[12:15], v127, s[36:39], s54 offen offset:3072 sc1
  s_nop 8
  buffer_load_dwordx4 v[20:23], v127, s[36:39], s55 offen offset:1024 sc1
  s_nop 8
  buffer_load_dwordx4 v[28:31], v127, s[36:39], s55 offen offset:3072 sc1
  s_nop 12
  s_waitcnt vmcnt(3)
  v_max3_u32 v141, v4, v5, v6
  v_max_u32 v141, v141, v7
  v_cmp_eq_u32 vcc, s70, v141
  s_nop 0
  s_cbranch_vccz CS_c1_4
  s_branch CS_r1_4
CS_r1_5:
  buffer_load_dwordx4 v[12:15], v127, s[36:39], s54 offen offset:3072 sc1
  s_add_u32 s80, s80, 0x100
  s_add_u32 s91, s91, 1
  s_cmp_gt_u32 s91, 0x20000
  s_cbranch_scc1 L_abort
  s_nop 3
  buffer_load_dwordx4 v[20:23], v127, s[36:39], s55 offen offset:1024 sc1
  s_nop 8
  buffer_load_dwordx4 v[28:31], v127, s[36:39], s55 offen offset:3072 sc1
  s_nop 15
  s_nop 8
  s_waitcnt vmcnt(2)
  v_max3_u32 v141, v12, v13, v14
  v_max_u32 v141, v141, v15
  v_cmp_eq_u32 vcc, s70, v141
  s_nop 0
  s_cbranch_vccz CS_c1_5
  s_branch CS_r1_5
CS_r1_6:
  buffer_load_dwordx4 v[20:23], v127, s[36:39], s55 offen offset:1024 sc1
  s_add_u32 s80, s80, 0x100
  s_add_u32 s91, s91, 1
  s_cmp_gt_u32 s91, 0x20000
  s_cbranch_scc1 L_abort
  s_nop 3
  buffer_load_dwordx4 v[28:31], v127, s[36:39], s55 offen offset:3072 sc1
  s_nop 15
  s_nop 15
  s_nop 4
  s_waitcnt vmcnt(0)
  v_max3_u32 v141, v20, v21, v22
  v_max_u32 v141, v141, v23
  v_cmp_eq_u32 vcc, s70, v141
  s_nop 0
  s_cbranch_vccz CS_c1_6
  s_branch CS_r1_6
CS_r1_7:
  buffer_load_dwordx4 v[28:31], v127, s[36:39], s55 offen offset:3072 sc1
  s_add_u32 s80, s80, 0x100
  s_add_u32 s91, s91, 1
  s_cmp_gt_u32 s91, 0x20000
  s_cbranch_scc1 L_abort
  s_nop 15
  s_nop 15
  s_nop 11
  s_waitcnt vmcnt(0)
  v_max3_u32 v141, v28, v29, v30
  v_max_u32 v141, v141, v31
  v_cmp_eq_u32 vcc, s70, v141
  s_nop 0
  s_cbranch_vccz CS_c1_7
  s_branch CS_r1_7
CS_p1:
CS_pl1:
  buffer_load_dwordx4 v[16:19], v127, s[36:39], s58 offen sc1
  buffer_load_dwordx4 v[20:23], v127, s[36:39], s58 offen offset:1024 sc1
  s_waitcnt vmcnt(3) lgkmcnt(0)
  v_mfma_f32_16x16x32_bf16 v[32:35], v[48:51], v[24:27], 0
  s_waitcnt vmcnt(2)
  v_mfma_f32_16x16x32_bf16 v[32:35], v[48:51], v[28:31], v[32:35]
  v_bitop3_b32 v142, v24, v26, v28 bitop3:0x80
  v_bitop3_b32 v142, v142, v30, 1 bitop3:0x80
  v_cmp_ne_u32 vcc, 1, v142
  s_add_u32 s80, s80, 1
  s_cbranch_vccz CS_pe1
  buffer_load_dwordx4 v[24:27], v127, s[36:39], s58 offen sc1
  buffer_load_dwordx4 v[28:31], v127, s[36:39], s58 offen offset:1024 sc1
  s_waitcnt vmcnt(3) lgkmcnt(0)
  v_mfma_f32_16x16x32_bf16 v[32:35], v[48:51], v[16:19], 0
  s_waitcnt vmcnt(2)
  v_mfma_f32_16x16x32_bf16 v[32:35], v[48:51], v[20:23], v[32:35]
  v_bitop3_b32 v142, v16, v18, v20 bitop3:0x80
  v_bitop3_b32 v142, v142, v22, 1 bitop3:0x80
  v_cmp_ne_u32 vcc, 1, v142
  s_add_u32 s80, s80, 1
  s_cbranch_vccz CS_pe1
  s_add_u32 s91, s91, 1
  s_cmp_gt_u32 s91, 0x20000
  s_cbranch_scc1 L_abort
  s_branch CS_pl1
CS_done:
CH_fin:
  s_waitcnt lgkmcnt(0)
  s_nop 1
  v_pk_add_f32 v[48:49], v[48:49], v[50:51]
  s_nop 2
  v_pk_add_f32 v[52:53], v[52:53], v[54:55]
  v_cvt_pk_bf16_f32 v122, v48, v49
  v_cvt_pk_bf16_f32 v123, v52, v53
  s_nop 0
  v_mov_b32_dpp v32, v122 quad_perm:[0,1,2,3] row_mask:0xf bank_mask:0x3
  v_mov_b32_dpp v33, v123 quad_perm:[0,1,2,3] row_mask:0xf bank_mask:0x3
  v_mov_b32_dpp v34, v122 row_ror:8 row_mask:0xf bank_mask:0x3
  v_mov_b32_dpp v35, v123 row_ror:8 row_mask:0xf bank_mask:0x3
  buffer_store_dwordx4 v[32:35], v127, s[36:39], s68 offen sc1
  s_waitcnt vmcnt(0)
  s_barrier
  s_add_u32 s81, s79, 4096
  s_cmp_lg_u32 s40, 0
  s_cselect_b32 s81, 0x10000000, s81
  v_mov_b32 v2, 0x7f
  s_mov_b64 exec, 1
  buffer_store_dword v2, off, s[36:39], s81 sc1
  s_mov_b64 exec, -1
L_fin:
L_exit:
  s_endpgm
L_abort:
  s_mov_b64 exec, 1
  v_mov_b32 v0, 131072
  v_mov_b32 v1, 0xffff
  ds_write_b32 v0, v1
  s_lshl_b32 s41, s40, 8
  s_or_b32 s41, s41, s2
  s_or_b32 s41, s41, 0x10000
  v_mov_b32 v0, s41
  v_mov_b32 v1, s90
  v_mov_b32 v2, s44
  v_mov_b32 v3, s53
  buffer_store_dwordx4 v[0:3], off, s[84:87], 0 offset:80
  s_waitcnt vmcnt(0) lgkmcnt(0)
  s_endpgm
.p2align 6
.type L_table,@object
L_table:
.long 0x0,0x0,0x0,0x0,0x0,0x0,0x0,0x0,0x0,0x0,0x0,0x0,0x0,0x0,0x0,0x0
.long 0x0,0x0,0x0,0x0,0x0,0x0,0x0,0x0,0x0,0x0,0x0,0x0,0x0,0x0,0x0,0x0
.long 0x0,0x0,0x0,0x0,0x0,0x0,0x0,0x0,0x0,0x0,0x0,0x0,0x0,0x0,0x0,0x0
.long 0x0,0x0,0x0,0x0,0x0,0x0,0x0,0x0,0x0,0x0,0x0,0x0,0x0,0x0,0x0,0x0
.long 0x0,0x0,0x0,0x0,0x0,0x0,0x0,0x0,0x0,0x0,0x0,0x0,0x0,0x0,0x0,0x0
.long 0x0,0x0,0x0,0x0,0x0,0x0,0x0,0x0,0x0,0x0,0x0,0x0,0x0,0x0,0x0,0x0
.long 0x0,0x0,0x0,0x0,0x0,0x0,0x0,0x0,0x0,0x0,0x0,0x0,0x0,0x0,0x0,0x0
.long 0x0,0x0,0x0,0x0,0x0,0x0,0x0,0x0,0x0,0x0,0x0,0x0,0x0,0x0,0x0,0x0
.long 0x0,0x0,0x0,0x0,0x0,0x0,0x0,0x0,0x0,0x0,0x0,0x0,0x0,0x0,0x0,0x0
.long 0x0,0x0,0x0,0x0,0x0,0x0,0x0,0x0,0x0,0x0,0x0,0x0,0x0,0x0,0x0,0x0
.long 0x0,0x0,0x0,0x0,0x0,0x0,0x0,0x0,0x0,0x0,0x0,0x0,0x0,0x0,0x0,0x0
.long 0x0,0x0,0x0,0x0,0x0,0x0,0x0,0x0,0x0,0x0,0x0,0x0,0x0,0x0,0x0,0x0
.long 0x0,0x0,0x0,0x0,0x0,0x0,0x0,0x0,0x0,0x0,0x0,0x0,0x0,0x0,0x0,0x0
.long 0x0,0x0,0x0,0x0,0x0,0x0,0x0,0x0,0x0,0x0,0x0,0x0,0x0,0x0,0x0,0x0
.long 0x0,0x0,0x0,0x0,0x0,0x0,0x0,0x0,0x0,0x0,0x0,0x0,0x0,0x0,0x0,0x0
.long 0x0,0x0,0x0,0x0,0x0,0x0,0x0,0x0,0x0,0x0,0x0,0x0,0x0,0x0,0x0,0x0
.long 0x100001,0x100021,0x100041,0x100061,0x100081,0x1000a1,0x1000c1,0x1000e1,0x100101,0x100121,0x100141,0x100161,0x100181,0x1001a1,0x1001c1,0x1001e1
.long 0x100201,0x100221,0x100241,0x100261,0x100281,0x1002a1,0x1002c1,0x1002e1,0x100301,0x100321,0x100341,0x100361,0x100381,0x1003a1,0x1003c1,0x1003e1
.long 0x6c,0x36c,0x7c,0x37c,0x4c,0x34c,0x5c,0x35c,0x2c,0x32c,0x3c,0x33c,0xc,0x30c,0x1c,0x31c
.long 0x205b03,0x205b13,0x205b23,0x205b33,0x205b43,0x205b53,0x205b63,0x205b73,0x205b83,0x205b93,0x205ba3,0x205bb3,0x205bc3,0x205bd3,0x205be3,0x205bf3
.long 0x0,0x0,0x0,0x0,0x0,0x0,0x0,0x0,0x0,0x0,0x0,0x0,0x0,0x0,0x0,0x0
.long 0x0,0x0,0x0,0x0,0x0,0x0,0x0,0x0,0x0,0x0,0x0,0x0,0x0,0x0,0x0,0x0
.long 0x0,0x0,0x0,0x0,0x0,0x0,0x0,0x0,0x0,0x0,0x0,0x0,0x0,0x0,0x0,0x0
.long 0x0,0x0,0x0,0x0,0x0,0x0,0x0,0x0,0x0,0x0,0x0,0x0,0x0,0x0,0x0,0x0
.long 0x0,0x0,0x0,0x0,0x0,0x0,0x0,0x0,0x0,0x0,0x0,0x0,0x0,0x0,0x0,0x0
.long 0x0,0x0,0x0,0x0,0x0,0x0,0x0,0x0,0x0,0x0,0x0,0x0,0x0,0x0,0x0,0x0
.long 0x0,0x0,0x0,0x0,0x0,0x0,0x0,0x0,0x0,0x0,0x0,0x0,0x0,0x0,0x0,0x0
.long 0x0,0x0,0x0,0x0,0x0,0x0,0x0,0x0,0x0,0x0,0x0,0x0,0x0,0x0,0x0,0x0
.long 0x0,0x0,0x0,0x0,0x0,0x0,0x0,0x0,0x0,0x0,0x0,0x0,0x0,0x0,0x0,0x0
.long 0x0,0x0,0x0,0x0,0x0,0x0,0x0,0x0,0x0,0x0,0x0,0x0,0x0,0x0,0x0,0x0
.long 0x0,0x0,0x0,0x0,0x0,0x0,0x0,0x0,0x0,0x0,0x0,0x0,0x0,0x0,0x0,0x0
.long 0x0,0x0,0x0,0x0,0x0,0x0,0x0,0x0,0x0,0x0,0x0,0x0,0x0,0x0,0x0,0x0
.long 0x40009,0x42009,0x44009,0x46009,0x40029,0x42029,0x44029,0x46029,0x40049,0x42049,0x44049,0x46049,0x40069,0x42069,0x44069,0x46069
.long 0x40089,0x42089,0x44089,0x46089,0x400a9,0x420a9,0x440a9,0x460a9,0x400c9,0x420c9,0x440c9,0x460c9,0x400e9,0x420e9,0x440e9,0x460e9
.long 0x702,0x732,0x762,0x792,0x7c2,0x602,0x632,0x662,0x692,0x6c2,0x502,0x532,0x562,0x592,0x5c2,0x402
.long 0x432,0x462,0x492,0x4c2,0x40011,0x42011,0x44011,0x46011,0x40031,0x42031,0x44031,0x46031,0x40051,0x42051,0x44051,0x46051
.long 0x2211805,0x221180d,0x2211815,0x221181d,0x2211825,0x221182d,0x2211835,0x221183d,0x3211805,0x321180d,0x3211815,0x321181d,0x3211825,0x321182d,0x3211835,0x321183d
.long 0x220f885,0x220f88d,0x220f895,0x220f89d,0x220f8a5,0x220f8ad,0x220f8b5,0x220f8bd,0x320f885,0x320f88d,0x320f895,0x320f89d,0x320f8a5,0x320f8ad,0x320f8b5,0x320f8bd
.long 0x0,0x0,0x0,0x0,0x0,0x0,0x0,0x0,0x0,0x0,0x0,0x0,0x0,0x0,0x0,0x0
.long 0x0,0x0,0x0,0x0,0x0,0x0,0x0,0x0,0x0,0x0,0x0,0x0,0x0,0x0,0x0,0x0
.long 0x0,0x0,0x0,0x0,0x0,0x0,0x0,0x0,0x0,0x0,0x0,0x0,0x0,0x0,0x0,0x0
.long 0x0,0x0,0x0,0x0,0x0,0x0,0x0,0x0,0x0,0x0,0x0,0x0,0x0,0x0,0x0,0x0
.long 0x0,0x0,0x0,0x0,0x0,0x0,0x0,0x0,0x0,0x0,0x0,0x0,0x0,0x0,0x0,0x0
.long 0x0,0x0,0x0,0x0,0x0,0x0,0x0,0x0,0x0,0x0,0x0,0x0,0x0,0x0,0x0,0x0
.long 0x0,0x0,0x0,0x0,0x0,0x0,0x0,0x0,0x0,0x0,0x0,0x0,0x0,0x0,0x0,0x0
.long 0x0,0x0,0x0,0x0,0x0,0x0,0x0,0x0,0x0,0x0,0x0,0x0,0x0,0x0,0x0,0x0
.long 0x0,0x0,0x0,0x0,0x0,0x0,0x0,0x0,0x0,0x0,0x0,0x0,0x0,0x0,0x0,0x0
.long 0x0,0x0,0x0,0x0,0x0,0x0,0x0,0x0,0x0,0x0,0x0,0x0,0x0,0x0,0x0,0x0
.long 0x40109,0x42109,0x44109,0x46109,0x40129,0x42129,0x44129,0x46129,0x40149,0x42149,0x44149,0x46149,0x40169,0x42169,0x44169,0x46169
.long 0x40189,0x42189,0x44189,0x46189,0x401a9,0x421a9,0x441a9,0x461a9,0x401c9,0x421c9,0x441c9,0x461c9,0x401e9,0x421e9,0x441e9,0x461e9
.long 0x70a,0x73a,0x76a,0x79a,0x7ca,0x60a,0x63a,0x66a,0x69a,0x6ca,0x50a,0x53a,0x56a,0x59a,0x5ca,0x40a
.long 0x43a,0x46a,0x49a,0x4ca,0x40071,0x42071,0x44071,0x46071,0x40091,0x42091,0x44091,0x46091,0x400b1,0x420b1,0x440b1,0x460b1
.long 0x888003,0x88801b,0x888033,0x88820b,0x888223,0x88823b,0x888413,0x88842b,0x302,0x30a,0x33a,0x36a,0x39a,0x3ca,0x202,0x20a
.long 0x23a,0x26a,0x29a,0x2ca,0x102,0x10a,0x13a,0x16a,0x19a,0x1ca,0x2,0xa,0x3a,0x6a,0x9a,0xca
.long 0x882803,0x88282b,0x882893,0x8828bb,0x882923,0x88298b,0x8829b3,0x16c,0x26c,0x17c,0x27c,0x14c,0x24c,0x15c,0x25c,0x12c
.long 0x22c,0x13c,0x23c,0x10c,0x20c,0x11c,0x21c,0x882a03,0x882a1b,0x882a33,0x882a8b,0x882aa3,0x882abb,0x205b0b,0x205b1b,0x205b2b
.long 0x205b3b,0x205b4b,0x205b5b,0x205b6b,0x205b7b,0x205b8b,0x205b9b,0x205bab,0x205bbb,0x205bcb,0x205bdb,0x205beb,0x205bfb,0x0,0x0,0x0
.long 0x0,0x0,0x0,0x0,0x0,0x0,0x0,0x0,0x0,0x0,0x0,0x0,0x0,0x0,0x0,0x0
.long 0x0,0x0,0x0,0x0,0x0,0x0,0x0,0x0,0x0,0x0,0x0,0x0,0x0,0x0,0x0,0x0
.long 0x0,0x0,0x0,0x0,0x0,0x0,0x0,0x0,0x0,0x0,0x0,0x0,0x0,0x0,0x0,0x0
.long 0x0,0x0,0x0,0x0,0x0,0x0,0x0,0x0,0x0,0x0,0x0,0x0,0x0,0x0,0x0,0x0
.long 0x0,0x0,0x0,0x0,0x0,0x0,0x0,0x0,0x0,0x0,0x0,0x0,0x0,0x0,0x0,0x0
.long 0x0,0x0,0x0,0x0,0x0,0x0,0x0,0x0,0x0,0x0,0x0,0x0,0x0,0x0,0x0,0x0
.long 0x0,0x0,0x0,0x0,0x0,0x0,0x0,0x0,0x0,0x0,0x0,0x0,0x0,0x0,0x0,0x0
.long 0x40209,0x42209,0x44209,0x46209,0x40229,0x42229,0x44229,0x46229,0x40249,0x42249,0x44249,0x46249,0x40269,0x42269,0x44269,0x46269
.long 0x40289,0x42289,0x44289,0x46289,0x402a9,0x422a9,0x442a9,0x462a9,0x402c9,0x422c9,0x442c9,0x462c9,0x402e9,0x422e9,0x442e9,0x462e9
.long 0x712,0x742,0x772,0x7a2,0x7d2,0x7f2,0x612,0x642,0x672,0x6a2,0x6d2,0x6f2,0x512,0x542,0x572,0x5a2
.long 0x5d2,0x5f2,0x412,0x442,0x472,0x4a2,0x4d2,0x4f2,0x400d1,0x420d1,0x440d1,0x460d1,0x400f1,0x420f1,0x440f1,0x460f1
.long 0x332,0x312,0x342,0x372,0x3a2,0x3d2,0x3f2,0x232,0x212,0x242,0x272,0x2a2,0x2d2,0x2f2,0x132,0x112
.long 0x142,0x172,0x1a2,0x1d2,0x1f2,0x884603,0x884613,0x884623,0x884633,0x884703,0x884713,0x884723,0x884733,0x32,0x12,0x42
.long 0x72,0xa2,0xd2,0xf2,0x88280b,0x882833,0x88289b,0x8c,0x38c,0x9c,0x39c,0xac,0x3ac,0xbc,0x3bc,0xcc
.long 0x3cc,0xdc,0x3dc,0xec,0x3ec,0xfc,0x3fc,0x882903,0x88292b,0x882993,0x8829bb,0x882a0b,0x882a23,0x882a3b,0x882a93,0x882aab
.long 0x2211845,0x221184d,0x2211855,0x221185d,0x2211865,0x221186d,0x2211875,0x221187d,0x220f8c5,0x220f8cd,0x220f8d5,0x220f8dd,0x220f8e5,0x220f8ed,0x220f8f5,0x220f8fd
.long 0x2203f85,0x2203f8d,0x2203f95,0x2203f9d,0x2203fa5,0x2203fad,0x2203fb5,0x2203fbd,0x0,0x0,0x0,0x0,0x0,0x0,0x0,0x0
.long 0x0,0x0,0x0,0x0,0x0,0x0,0x0,0x0,0x0,0x0,0x0,0x0,0x0,0x0,0x0,0x0
.long 0x0,0x0,0x0,0x0,0x0,0x0,0x0,0x0,0x0,0x0,0x0,0x0,0x0,0x0,0x0,0x0
.long 0x0,0x0,0x0,0x0,0x0,0x0,0x0,0x0,0x0,0x0,0x0,0x0,0x0,0x0,0x0,0x0
.long 0x0,0x0,0x0,0x0,0x0,0x0,0x0,0x0,0x0,0x0,0x0,0x0,0x0,0x0,0x0,0x0
.long 0x0,0x0,0x0,0x0,0x0,0x0,0x0,0x0,0x0,0x0,0x0,0x0,0x0,0x0,0x0,0x0
.long 0x0,0x0,0x0,0x0,0x0,0x0,0x0,0x0,0x0,0x0,0x0,0x0,0x0,0x0,0x0,0x0
.long 0x40309,0x42309,0x44309,0x46309,0x40329,0x42329,0x44329,0x46329,0x40349,0x42349,0x44349,0x46349,0x40369,0x42369,0x44369,0x46369
.long 0x40389,0x42389,0x44389,0x46389,0x403a9,0x423a9,0x443a9,0x463a9,0x403c9,0x423c9,0x443c9,0x463c9,0x403e9,0x423e9,0x443e9,0x463e9
.long 0x71a,0x74a,0x77a,0x7aa,0x7da,0x61a,0x64a,0x67a,0x6aa,0x6da,0x51a,0x54a,0x57a,0x5aa,0x5da,0x41a
.long 0x44a,0x47a,0x4aa,0x4da,0x40111,0x42111,0x44111,0x46111,0x40131,0x42131,0x44131,0x46131,0x40151,0x42151,0x44151,0x46151
.long 0x88800b,0x888023,0x88803b,0x888213,0x88822b,0x888403,0x88841b,0x888433,0x362,0x31a,0x34a,0x37a,0x3aa,0x3da,0x262,0x21a
.long 0x24a,0x27a,0x2aa,0x2da,0x162,0x11a,0x14a,0x17a,0x1aa,0x1da,0x62,0x1a,0x4a,0x7a,0xaa,0xda
.long 0x882813,0x88283b,0x8828a3,0x18c,0x28c,0x19c,0x29c,0x1ac,0x2ac,0x1bc,0x2bc,0x1cc,0x2cc,0x1dc,0x2dc,0x1ec
.long 0x2ec,0x1fc,0x2fc,0x88290b,0x882933,0x88299b,0x882a13,0x882a2b,0x882a83,0x882a9b,0x882ab3,0x3211845,0x321184d,0x3211855,0x321185d,0x3211865
.long 0x321186d,0x3211875,0x321187d,0x320f8c5,0x320f8cd,0x320f8d5,0x320f8dd,0x320f8e5,0x320f8ed,0x320f8f5,0x320f8fd,0x2203fc5,0x2203fcd,0x2203fd5,0x2203fdd,0x2203fe5
.long 0x2203fed,0x2203ff5,0x2203ffd,0x0,0x0,0x0,0x0,0x0,0x0,0x0,0x0,0x0,0x0,0x0,0x0,0x0
.long 0x0,0x0,0x0,0x0,0x0,0x0,0x0,0x0,0x0,0x0,0x0,0x0,0x0,0x0,0x0,0x0
.long 0x0,0x0,0x0,0x0,0x0,0x0,0x0,0x0,0x0,0x0,0x0,0x0,0x0,0x0,0x0,0x0
.long 0x0,0x0,0x0,0x0,0x0,0x0,0x0,0x0,0x0,0x0,0x0,0x0,0x0,0x0,0x0,0x0
.long 0x0,0x0,0x0,0x0,0x0,0x0,0x0,0x0,0x0,0x0,0x0,0x0,0x0,0x0,0x0,0x0
.long 0x0,0x0,0x0,0x0,0x0,0x0,0x0,0x0,0x0,0x0,0x0,0x0,0x0,0x0,0x0,0x0
.long 0x0,0x0,0x0,0x0,0x0,0x0,0x0,0x0,0x0,0x0,0x0,0x0,0x0,0x0,0x0,0x0
.long 0x40019,0x42019,0x44019,0x46019,0x40039,0x42039,0x44039,0x46039,0x40059,0x42059,0x44059,0x46059,0x40079,0x42079,0x44079,0x46079
.long 0x40099,0x42099,0x44099,0x46099,0x400b9,0x420b9,0x440b9,0x460b9,0x400d9,0x420d9,0x440d9,0x460d9,0x400f9,0x420f9,0x440f9,0x460f9
.long 0x722,0x752,0x782,0x7b2,0x7e2,0x7fa,0x622,0x652,0x682,0x6b2,0x6e2,0x6fa,0x522,0x552,0x582,0x5b2
.long 0x5e2,0x5fa,0x422,0x452,0x482,0x4b2,0x4e2,0x4fa,0x40171,0x42171,0x44171,0x46171,0x40191,0x42191,0x44191,0x46191
.long 0x392,0x322,0x352,0x382,0x3b2,0x3e2,0x3fa,0x292,0x222,0x252,0x282,0x2b2,0x2e2,0x2fa,0x192,0x122
.long 0x152,0x182,0x1b2,0x1e2,0x1fa,0x88460b,0x88461b,0x88462b,0x88463b,0x88470b,0x88471b,0x88472b,0x88473b,0x92,0x22,0x52
.long 0x82,0xb2,0xe2,0xfa,0x88281b,0x882883,0x8828ab,0x4,0x304,0x14,0x314,0x24,0x324,0x34,0x334,0x882913
.long 0x88293b,0x8829a3,0x44,0x344,0x54,0x354,0x64,0x364,0x74,0x374,0x84,0x384,0x894,0xc94,0xb94,0xf94
.long 0x8a4,0xca4,0xba4,0xfa4,0x8b4,0xcb4,0xbb4,0xfb4,0x3203f85,0x3203f8d,0x3203f95,0x3203f9d,0x3203fa5,0x3203fad,0x3203fb5,0x3203fbd
.long 0x0,0x0,0x0,0x0,0x0,0x0,0x0,0x0,0x0,0x0,0x0,0x0,0x0,0x0,0x0,0x0
.long 0x0,0x0,0x0,0x0,0x0,0x0,0x0,0x0,0x0,0x0,0x0,0x0,0x0,0x0,0x0,0x0
.long 0x0,0x0,0x0,0x0,0x0,0x0,0x0,0x0,0x0,0x0,0x0,0x0,0x0,0x0,0x0,0x0
.long 0x0,0x0,0x0,0x0,0x0,0x0,0x0,0x0,0x0,0x0,0x0,0x0,0x0,0x0,0x0,0x0
.long 0x0,0x0,0x0,0x0,0x0,0x0,0x0,0x0,0x0,0x0,0x0,0x0,0x0,0x0,0x0,0x0
.long 0x0,0x0,0x0,0x0,0x0,0x0,0x0,0x0,0x0,0x0,0x0,0x0,0x0,0x0,0x0,0x0
.long 0x0,0x0,0x0,0x0,0x0,0x0,0x0,0x0,0x0,0x0,0x0,0x0,0x0,0x0,0x0,0x0
.long 0x40119,0x42119,0x44119,0x46119,0x40139,0x42139,0x44139,0x46139,0x40159,0x42159,0x44159,0x46159,0x40179,0x42179,0x44179,0x46179
.long 0x40199,0x42199,0x44199,0x46199,0x401b9,0x421b9,0x441b9,0x461b9,0x401d9,0x421d9,0x441d9,0x461d9,0x401f9,0x421f9,0x441f9,0x461f9
.long 0x72a,0x75a,0x78a,0x7ba,0x7ea,0x62a,0x65a,0x68a,0x6ba,0x6ea,0x52a,0x55a,0x58a,0x5ba,0x5ea,0x42a
.long 0x45a,0x48a,0x4ba,0x4ea,0x401b1,0x421b1,0x441b1,0x461b1,0x401d1,0x421d1,0x441d1,0x461d1,0x401f1,0x421f1,0x441f1,0x461f1
.long 0x888013,0x88802b,0x888203,0x88821b,0x888233,0x88840b,0x888423,0x88843b,0x3c2,0x32a,0x35a,0x38a,0x3ba,0x3ea,0x2c2,0x22a
.long 0x25a,0x28a,0x2ba,0x2ea,0x1c2,0x12a,0x15a,0x18a,0x1ba,0x1ea,0xc2,0x2a,0x5a,0x8a,0xba,0xea
.long 0x882823,0x88288b,0x8828b3,0x104,0x204,0x114,0x214,0x124,0x224,0x134,0x234,0x88291b,0x882983,0x8829ab,0x144,0x244
.long 0x154,0x254,0x164,0x264,0x174,0x274,0x184,0x284,0x994,0xd94,0xa94,0xe94,0x9a4,0xda4,0xaa4,0xea4
.long 0x9b4,0xdb4,0xab4,0xeb4,0x3203fc5,0x3203fcd,0x3203fd5,0x3203fdd,0x3203fe5,0x3203fed,0x3203ff5,0x3203ffd,0x0,0x0,0x0,0x0
.long 0x0,0x0,0x0,0x0,0x0,0x0,0x0,0x0,0x0,0x0,0x0,0x0,0x0,0x0,0x0,0x0
.long 0x0,0x0,0x0,0x0,0x0,0x0,0x0,0x0,0x0,0x0,0x0,0x0,0x0,0x0,0x0,0x0
.long 0x0,0x0,0x0,0x0,0x0,0x0,0x0,0x0,0x0,0x0,0x0,0x0,0x0,0x0,0x0,0x0
.long 0x0,0x0,0x0,0x0,0x0,0x0,0x0,0x0,0x0,0x0,0x0,0x0,0x0,0x0,0x0,0x0
.long 0x0,0x0,0x0,0x0,0x0,0x0,0x0,0x0,0x0,0x0,0x0,0x0,0x0,0x0,0x0,0x0
.long 0x0,0x0,0x0,0x0,0x0,0x0,0x0,0x0,0x0,0x0,0x0,0x0,0x0,0x0,0x0,0x0
.long 0x0,0x0,0x0,0x0,0x0,0x0,0x0,0x0,0x0,0x0,0x0,0x0,0x0,0x0,0x0,0x0
.size L_table, 8192
.section .rodata,"a"
.p2align 6
.amdhsa_kernel fused_kernel
  .amdhsa_next_free_vgpr 512
  .amdhsa_next_free_sgpr 102
  .amdhsa_accum_offset 256
  .amdhsa_group_segment_fixed_size 0
  .amdhsa_kernarg_size 128
  .amdhsa_user_sgpr_count 2
  .amdhsa_user_sgpr_kernarg_segment_ptr 1
  .amdhsa_system_sgpr_workgroup_id_x 1
.end_amdhsa_kernel
```
